```python
import torch

def _softmax(x, axis=-1):
    return torch.softmax(x, dim=axis)
def _gelu(x):
    return torch.nn.functional.gelu(x, approximate="tanh")
def _silu(x):
    return torch.nn.functional.silu(x)
def _sigmoid(x):
    return torch.sigmoid(x)
def _layernorm(x, axis=-1, eps=1e-5):
    m = x.mean(dim=axis, keepdim=True)
    v = x.var(dim=axis, keepdim=True, unbiased=False)
    return (x - m) / torch.sqrt(v + eps)
def _scatter_add(tgt, idx, src, axis=0):
    return tgt.clone().index_add_(axis, idx, src)
def _segment_sum(src, seg, n):
    out = torch.zeros((n,) + src.shape[1:], dtype=src.dtype)
    return out.index_add_(0, seg, src)
def _pad(x, pw):
    flat = tuple(v for pair in reversed(pw) for v in pair)
    return torch.nn.functional.pad(x, flat)

kernel_name = 'concat_heads__gqa_block_cached__gqa_block_cached__near_ridge'

def setup_inputs():

    _w = (lambda a: (lambda t: t.to(torch.bfloat16) if t.is_floating_point() else t)(torch.as_tensor(a)))
    def _A_setup():
        B, Sq, D = 16, 96, 512
        Hq, Hkv, Sk, Dh = 32, 32, 96, 128
        assert Hq % Hkv == 0, (Hq, Hkv)
        return {
            "x": _w((lambda *s: torch.randn(*s, dtype=torch.bfloat16) * 0.8)(B, Sq, D)),
            "k_cache": _w((lambda *s: torch.randn(*s, dtype=torch.bfloat16) * 0.8)(B, Hkv, Sk, Dh)),
            "v_cache": _w((lambda *s: torch.randn(*s, dtype=torch.bfloat16) * 0.05)(B, Hkv, Sk, Dh)),
            "wq": _w((lambda *s: torch.randn(*s, dtype=torch.bfloat16) * 0.8)(D, Hq * Dh) * (D ** -0.5)),
            "wo": _w((lambda *s: torch.randn(*s, dtype=torch.bfloat16) * 0.05)(Hq * Dh, D) * ((Hq * Dh) ** -0.5)),
        }
    _A_in = _A_setup()

    def _B_setup():
        B, Sq, D = 16, 96, 512
        Hq, Hkv, Sk, Dh = 32, 32, 96, 128
        assert Hq % Hkv == 0, (Hq, Hkv)
        return {
            "x": _w((lambda *s: torch.randn(*s, dtype=torch.bfloat16) * 0.8)(B, Sq, D)),
            "k_cache": _w((lambda *s: torch.randn(*s, dtype=torch.bfloat16) * 0.8)(B, Hkv, Sk, Dh)),
            "v_cache": _w((lambda *s: torch.randn(*s, dtype=torch.bfloat16) * 0.05)(B, Hkv, Sk, Dh)),
            "wq": _w((lambda *s: torch.randn(*s, dtype=torch.bfloat16) * 0.8)(D, Hq * Dh) * (D ** -0.5)),
            "wo": _w((lambda *s: torch.randn(*s, dtype=torch.bfloat16) * 0.05)(Hq * Dh, D) * ((Hq * Dh) ** -0.5)),
        }
    _B_in = _B_setup()

    return {
        "A_x": _A_in["x"],
        "A_k_cache": _A_in["k_cache"],
        "A_v_cache": _A_in["v_cache"],
        "A_wq": _A_in["wq"],
        "A_wo": _A_in["wo"],
        "B_x": _B_in["x"],
        "B_k_cache": _B_in["k_cache"],
        "B_v_cache": _B_in["v_cache"],
        "B_wq": _B_in["wq"],
        "B_wo": _B_in["wo"],
    }

def reference(A_x, A_k_cache, A_v_cache, A_wq, A_wo, B_x, B_k_cache, B_v_cache, B_wq, B_wo):
    def _A_ref(x, k_cache, v_cache, wq, wo):
        B, Sq, D = x.shape
        Hq, Dh = 32, 128
        Hkv = k_cache.shape[1]
        rep = Hq // Hkv
        q = (lambda x, *d: x.permute(*d))((x @ wq).reshape(B, Sq, Hq, Dh), 0, 2, 1, 3)
        k = (lambda x, n, axis: torch.repeat_interleave(x, n, dim=axis))(k_cache, rep, axis=1)
        v = (lambda x, n, axis: torch.repeat_interleave(x, n, dim=axis))(v_cache, rep, axis=1)
        scores = torch.einsum("bhqd,bhkd->bhqk", q, k) * (Dh ** -0.5)
        p = _softmax(scores, axis=-1)
        o = torch.einsum("bhqk,bhkd->bhqd", p, v)
        return (lambda x, *d: x.permute(*d))(o, 0, 2, 1, 3).reshape(B, Sq, Hq * Dh) @ wo

    def _B_ref(x, k_cache, v_cache, wq, wo):
        B, Sq, D = x.shape
        Hq, Dh = 32, 128
        Hkv = k_cache.shape[1]
        rep = Hq // Hkv
        q = (lambda x, *d: x.permute(*d))((x @ wq).reshape(B, Sq, Hq, Dh), 0, 2, 1, 3)
        k = (lambda x, n, axis: torch.repeat_interleave(x, n, dim=axis))(k_cache, rep, axis=1)
        v = (lambda x, n, axis: torch.repeat_interleave(x, n, dim=axis))(v_cache, rep, axis=1)
        scores = torch.einsum("bhqd,bhkd->bhqk", q, k) * (Dh ** -0.5)
        p = _softmax(scores, axis=-1)
        o = torch.einsum("bhqk,bhkd->bhqd", p, v)
        return (lambda x, *d: x.permute(*d))(o, 0, 2, 1, 3).reshape(B, Sq, Hq * Dh) @ wo

    a = _A_ref(A_x, A_k_cache, A_v_cache, A_wq, A_wo)
    b = _B_ref(B_x, B_k_cache, B_v_cache, B_wq, B_wo)
    return torch.concatenate([a, b], axis=-1)
```

```asm
; @launch kernel=attn_kernel grid=(256,1,1) block=(256,1,1) lds=163840
.amdgcn_target "amdgcn-amd-amdhsa--gfx950"
.text
.globl attn_kernel
.p2align 8
.type attn_kernel,@function
attn_kernel:
    s_cmp_ge_u32 s2, 256
    s_cbranch_scc1 k_end
    s_getpc_b64 s[44:45]
pc_here:
    s_lshr_b32 s72, s2, 3
    s_lshl_b32 s72, s72, 12
    v_cmp_gt_u32 vcc, 32, v0
    s_and_b32 s45, s45, 0xffff
    s_mov_b32 s46, code_end-pc_here
    s_mov_b32 s47, 0x00020000
    v_lshlrev_b32 v255, 7, v0
    v_cndmask_b32 v255, -1, v255, vcc
    buffer_load_dword v255, v255, s[44:47], s72 offen
    s_bfe_u32 s65, s2, 0x10002
    s_and_b32 s65, s2, 1
    s_mul_i32 s16, s65, 40
    s_add_u32 s18, s0, s16
    s_addc_u32 s19, s1, 0
    s_load_dwordx8 s[8:15], s[18:19], 0
    s_load_dwordx2 s[16:17], s[18:19], 32
    s_load_dwordx4 s[4:7], s[0:1], 80
    s_load_dwordx2 s[18:19], s[0:1], 96
    v_lshrrev_b32 v135, 6, v0
    v_and_b32 v130, 63, v0
    v_readfirstlane_b32 s3, v135
    s_and_b32 s63, s2, 6
    s_bfe_u32 s72, s2, 0x10003
    s_add_u32 s63, s63, s72
    s_lshr_b32 s64, s2, 4
    s_lshl_b32 s66, s65, 4
    s_add_u32 s66, s66, s64
    v_and_b32 v131, 15, v130
    v_lshrrev_b32 v132, 4, v130
    v_lshrrev_b32 v133, 3, v130
    v_and_b32 v134, 7, v130
    v_lshlrev_b32 v248, 4, v130
    v_add_u32 v250, 98304, v248
    s_mov_b32 s52, 8192
    s_mov_b32 s53, 16384
    s_mov_b32 s54, 24576
    s_mov_b32 s55, 32768
    s_mov_b32 s56, 40960
    s_mov_b32 s57, 49152
    s_mov_b32 s58, 57344
    s_mov_b32 s60, 0x05040100
    s_mov_b32 s61, 0x07060302
    s_mov_b32 s68, 0x3e0293ee
    s_cmp_eq_u32 s3, 0
    s_cselect_b32 s70, 1, 0
    s_mov_b32 s71, 0
    s_lshl_b32 s72, s64, 5
    s_lshl_b32 s73, s63, 2
    s_add_u32 s72, s72, s73
    s_add_u32 s72, s72, s3
    s_mul_i32 s62, s72, 24576
    s_lshl_b32 s72, s3, 14
    s_add_u32 s92, s72, 98304
    v_lshrrev_b32 v135, 1, v133
    v_xor_b32 v135, v135, v134
    s_mul_i32 s74, s64, 98304
    s_mul_i32 s72, s3, 3
    s_add_u32 s72, s72, 0
    s_lshl_b32 s89, s72, 10
    s_lshl_b32 s73, s72, 13
    s_add_u32 s86, s73, s74
    s_and_b32 s72, s72, 1
    s_lshl_b32 s72, s72, 2
    v_xor_b32 v136, s72, v135
    v_lshlrev_b32 v136, 4, v136
    v_lshl_add_u32 v251, v133, 10, v136
    s_mul_i32 s72, s3, 3
    s_add_u32 s72, s72, 1
    s_lshl_b32 s90, s72, 10
    s_lshl_b32 s73, s72, 13
    s_add_u32 s87, s73, s74
    s_and_b32 s72, s72, 1
    s_lshl_b32 s72, s72, 2
    v_xor_b32 v136, s72, v135
    v_lshlrev_b32 v136, 4, v136
    v_lshl_add_u32 v252, v133, 10, v136
    s_mul_i32 s72, s3, 3
    s_add_u32 s72, s72, 2
    s_lshl_b32 s91, s72, 10
    s_lshl_b32 s73, s72, 13
    s_add_u32 s88, s73, s74
    s_and_b32 s72, s72, 1
    s_lshl_b32 s72, s72, 2
    v_xor_b32 v136, s72, v135
    v_lshlrev_b32 v136, 4, v136
    v_lshl_add_u32 v253, v133, 10, v136
    s_lshl_b32 s72, s63, 10
    s_lshl_b32 s73, s3, 8
    s_add_u32 s72, s72, s73
    v_lshlrev_b32 v135, 4, v131
    v_lshl_add_u32 v136, v132, 16, v135
    s_and_b32 s84, s2, 8
    s_lshl_b32 s80, s84, 18
    s_add_u32 s72, s72, s80
    s_and_b32 s82, s84, 14
    s_lshl_b32 s82, s82, 6
    s_and_b32 s83, s84, 1
    s_lshl_b32 s83, s83, 6
    s_cmp_eq_u32 s83, 0
    s_mov_b32 s80, 0xc0000
    s_cmov_b32 s80, 0x40000
    s_mov_b32 s81, 0xfffc0000
    s_cmov_b32 s81, 0x40000
    v_add_u32 v240, s72, v136
    s_lshl_b32 s72, s63, 19
    s_add_u32 s72, s72, s73
    v_and_b32 v136, 1, v132
    v_lshl_add_u32 v135, v136, 12, v135
    v_lshrrev_b32 v136, 1, v132
    v_lshl_add_u32 v136, v136, 16, v135
    v_add_u32 v247, s72, v136
    v_xor_b32 v135, v131, v132
    v_lshlrev_b32 v135, 4, v135
    v_lshl_add_u32 v113, v132, 8, v135
    v_lshlrev_b32 v135, 2, v132
    v_xor_b32 v135, v135, v131
    v_lshlrev_b32 v135, 4, v135
    v_lshl_add_u32 v117, v131, 8, v135
    v_add_u32 v117, s92, v117
    v_xor_b32 v114, 64, v113
    v_xor_b32 v118, 16, v117
    v_xor_b32 v115, 128, v113
    v_xor_b32 v119, 32, v117
    v_xor_b32 v116, 192, v113
    v_xor_b32 v120, 48, v117
    v_mov_b32 v246, v113
    v_mov_b32 v245, v114
    v_lshrrev_b32 v135, 1, v131
    v_xor_b32 v135, v135, v132
    v_lshlrev_b32 v136, 7, v131
    v_lshl_add_u32 v241, v135, 4, v136
    v_xor_b32 v241, s83, v241
    v_xor_b32 v242, 64, v241
    v_add_u32 v243, 0xc000, v241
    v_add_u32 v244, 0xc000, v242
    v_add_u32 v249, s92, v248
    s_lshl_b32 s72, s64, 2
    s_add_u32 s72, s72, s3
    s_lshl_b32 s72, s72, 16
    s_lshl_b32 s73, s63, 10
    s_add_u32 s72, s72, s73
    v_lshlrev_b32 v135, 7, v134
    v_lshl_add_u32 v135, v133, 13, v135
    v_add_u32 v112, s72, v135
    s_waitcnt lgkmcnt(0)
    s_mov_b32 s20, s8
    s_and_b32 s21, s9, 0xffff
    s_mov_b32 s22, 1572864
    s_mov_b32 s23, 0x00020000
    s_mov_b32 s24, s10
    s_and_b32 s25, s11, 0xffff
    s_mov_b32 s26, 12582912
    s_mov_b32 s27, 0x00020000
    s_mov_b32 s28, s12
    s_and_b32 s29, s13, 0xffff
    s_mov_b32 s30, 12582912
    s_mov_b32 s31, 0x00020000
    s_mov_b32 s32, s14
    s_and_b32 s33, s15, 0xffff
    s_mov_b32 s34, 4194304
    s_mov_b32 s35, 0x00020000
    s_mov_b32 s40, s16
    s_and_b32 s41, s17, 0xffff
    s_mov_b32 s42, 4194304
    s_mov_b32 s43, 0x00020000
    s_mov_b32 s44, s4
    s_and_b32 s45, s5, 0xffff
    s_mov_b32 s46, 3145728
    s_mov_b32 s47, 0x00020000
    s_mov_b32 s48, s6
    s_and_b32 s49, s7, 0xffff
    s_mov_b32 s50, 256
    s_mov_b32 s51, 0x00020000
    s_mov_b32 s36, s18
    s_and_b32 s37, s19, 0xffff
    s_mov_b32 s38, 268435456
    s_mov_b32 s39, 0x00020000
    s_lshl_b32 s4, s3, 13
    s_sub_u32 s5, s92, s4
    s_lshl_b32 s72, s64, 1
    s_lshr_b32 s73, s3, 1
    s_add_u32 s72, s72, s73
    s_lshl_b32 s72, s72, 13
    s_lshl_b32 s73, s63, 10
    s_add_u32 s72, s72, s73
    s_and_b32 s73, s3, 1
    s_lshl_b32 s73, s73, 9
    s_add_u32 s72, s72, s73
    s_add_u32 s6, s14, s72
    s_addc_u32 s7, s15, 0
    s_and_b32 s67, s64, 3
    s_cmp_eq_u32 s67, 1
    s_cbranch_scc1 cls1
    s_cmp_eq_u32 s67, 2
    s_cbranch_scc1 cls2
    s_cmp_eq_u32 s67, 3
    s_cbranch_scc1 cls3
cls0:
    s_add_u32 s72, s82, 0
    s_and_b32 s72, s72, 0x3ff
    s_add_u32 s72, s72, s86
    s_add_u32 m0, s89, 0
    s_nop 0
    buffer_load_dwordx4 v251, s[20:23], s72 offen lds
    s_add_u32 s72, s82, 0
    s_and_b32 s72, s72, 0x3ff
    s_add_u32 s72, s72, s87
    s_add_u32 m0, s90, 0
    s_nop 0
    buffer_load_dwordx4 v252, s[20:23], s72 offen lds
    s_add_u32 s72, s82, 0
    s_and_b32 s72, s72, 0x3ff
    s_add_u32 s72, s72, s88
    s_add_u32 m0, s91, 0
    s_nop 0
    buffer_load_dwordx4 v253, s[20:23], s72 offen lds
    buffer_load_dwordx4 v[192:195], v240, s[32:35], 0 offen
    buffer_load_dwordx4 v[196:199], v240, s[32:35], s52 offen
    buffer_load_dwordx4 v[200:203], v240, s[32:35], s53 offen
    buffer_load_dwordx4 v[204:207], v240, s[32:35], s54 offen
    buffer_load_dwordx4 v[208:211], v240, s[32:35], s55 offen
    buffer_load_dwordx4 v[212:215], v240, s[32:35], s56 offen
    buffer_load_dwordx4 v[216:219], v240, s[32:35], s57 offen
    buffer_load_dwordx4 v[220:223], v240, s[32:35], s58 offen
    s_add_u32 s72, s82, 128
    s_and_b32 s72, s72, 0x3ff
    s_add_u32 s72, s72, s86
    s_add_u32 m0, s89, 12288
    s_nop 0
    buffer_load_dwordx4 v251, s[20:23], s72 offen lds
    s_add_u32 s72, s82, 128
    s_and_b32 s72, s72, 0x3ff
    s_add_u32 s72, s72, s87
    s_add_u32 m0, s90, 12288
    s_nop 0
    buffer_load_dwordx4 v252, s[20:23], s72 offen lds
    s_add_u32 s72, s82, 128
    s_and_b32 s72, s72, 0x3ff
    s_add_u32 s72, s72, s88
    s_add_u32 m0, s91, 12288
    s_nop 0
    buffer_load_dwordx4 v253, s[20:23], s72 offen lds
    v_add_u32 v240, s81, v240
    v_and_b32 v240, 0x3fffff, v240
    buffer_load_dwordx4 v[32:35], v240, s[32:35], 0 offen
    buffer_load_dwordx4 v[36:39], v240, s[32:35], s52 offen
    buffer_load_dwordx4 v[40:43], v240, s[32:35], s53 offen
    buffer_load_dwordx4 v[44:47], v240, s[32:35], s54 offen
    buffer_load_dwordx4 v[48:51], v240, s[32:35], s55 offen
    buffer_load_dwordx4 v[52:55], v240, s[32:35], s56 offen
    buffer_load_dwordx4 v[56:59], v240, s[32:35], s57 offen
    buffer_load_dwordx4 v[60:63], v240, s[32:35], s58 offen
    buffer_load_dword v254, v112, s[32:35], 0 offen
    s_waitcnt vmcnt(9)
    s_barrier
    ds_read_b128 a[192:195], v241 offset:0
    ds_read_b128 a[196:199], v241 offset:2048
    ds_read_b128 a[200:203], v241 offset:4096
    ds_read_b128 a[204:207], v241 offset:6144
    ds_read_b128 a[208:211], v241 offset:8192
    ds_read_b128 a[212:215], v241 offset:10240
    v_perm_b32 v96, v196, v192, s60
    v_perm_b32 v97, v204, v200, s60
    v_perm_b32 v98, v212, v208, s60
    v_perm_b32 v99, v220, v216, s60
    s_waitcnt lgkmcnt(0)
    s_nop 0
    v_mfma_f32_16x16x32_bf16 a[0:3], v[96:99], a[192:195], 0
    v_perm_b32 v100, v196, v192, s61
    v_perm_b32 v101, v204, v200, s61
    v_mfma_f32_16x16x32_bf16 a[32:35], v[96:99], a[196:199], 0
    v_perm_b32 v102, v212, v208, s61
    v_mfma_f32_16x16x32_bf16 a[64:67], v[96:99], a[200:203], 0
    v_perm_b32 v103, v220, v216, s61
    v_mfma_f32_16x16x32_bf16 a[96:99], v[96:99], a[204:207], 0
    v_add_u32 v240, s80, v240
    v_mfma_f32_16x16x32_bf16 a[128:131], v[96:99], a[208:211], 0
    v_and_b32 v240, 0x3fffff, v240
    v_mfma_f32_16x16x32_bf16 a[160:163], v[96:99], a[212:215], 0
    buffer_load_dwordx4 v[64:67], v240, s[32:35], 0 offen
    v_mfma_f32_16x16x32_bf16 a[4:7], v[100:103], a[192:195], 0
    v_perm_b32 v104, v197, v193, s60
    v_mfma_f32_16x16x32_bf16 a[36:39], v[100:103], a[196:199], 0
    v_perm_b32 v105, v205, v201, s60
    v_mfma_f32_16x16x32_bf16 a[68:71], v[100:103], a[200:203], 0
    v_perm_b32 v106, v213, v209, s60
    v_mfma_f32_16x16x32_bf16 a[100:103], v[100:103], a[204:207], 0
    v_perm_b32 v107, v221, v217, s60
    v_mfma_f32_16x16x32_bf16 a[132:135], v[100:103], a[208:211], 0
    buffer_load_dwordx4 v[68:71], v240, s[32:35], s52 offen
    v_mfma_f32_16x16x32_bf16 a[164:167], v[100:103], a[212:215], 0
    buffer_load_dwordx4 v[72:75], v240, s[32:35], s53 offen
    v_mfma_f32_16x16x32_bf16 a[8:11], v[104:107], a[192:195], 0
    v_perm_b32 v108, v197, v193, s61
    v_mfma_f32_16x16x32_bf16 a[40:43], v[104:107], a[196:199], 0
    v_perm_b32 v109, v205, v201, s61
    v_mfma_f32_16x16x32_bf16 a[72:75], v[104:107], a[200:203], 0
    v_perm_b32 v110, v213, v209, s61
    v_mfma_f32_16x16x32_bf16 a[104:107], v[104:107], a[204:207], 0
    v_perm_b32 v111, v221, v217, s61
    v_mfma_f32_16x16x32_bf16 a[136:139], v[104:107], a[208:211], 0
    buffer_load_dwordx4 v[76:79], v240, s[32:35], s54 offen
    v_mfma_f32_16x16x32_bf16 a[168:171], v[104:107], a[212:215], 0
    buffer_load_dwordx4 v[80:83], v240, s[32:35], s55 offen
    v_mfma_f32_16x16x32_bf16 a[12:15], v[108:111], a[192:195], 0
    v_perm_b32 v96, v198, v194, s60
    v_perm_b32 v97, v206, v202, s60
    v_mfma_f32_16x16x32_bf16 a[44:47], v[108:111], a[196:199], 0
    v_perm_b32 v98, v214, v210, s60
    v_mfma_f32_16x16x32_bf16 a[76:79], v[108:111], a[200:203], 0
    v_perm_b32 v99, v222, v218, s60
    v_mfma_f32_16x16x32_bf16 a[108:111], v[108:111], a[204:207], 0
    buffer_load_dwordx4 v[84:87], v240, s[32:35], s56 offen
    buffer_load_dwordx4 v[88:91], v240, s[32:35], s57 offen
    v_mfma_f32_16x16x32_bf16 a[140:143], v[108:111], a[208:211], 0
    ds_read_b128 a[216:219], v242 offset:0
    v_mfma_f32_16x16x32_bf16 a[172:175], v[108:111], a[212:215], 0
    ds_read_b128 a[220:223], v242 offset:2048
    v_mfma_f32_16x16x32_bf16 a[16:19], v[96:99], a[192:195], 0
    v_perm_b32 v100, v198, v194, s61
    v_perm_b32 v101, v206, v202, s61
    v_mfma_f32_16x16x32_bf16 a[48:51], v[96:99], a[196:199], 0
    v_perm_b32 v102, v214, v210, s61
    v_mfma_f32_16x16x32_bf16 a[80:83], v[96:99], a[200:203], 0
    v_perm_b32 v103, v222, v218, s61
    v_mfma_f32_16x16x32_bf16 a[112:115], v[96:99], a[204:207], 0
    buffer_load_dwordx4 v[92:95], v240, s[32:35], s58 offen
    v_mfma_f32_16x16x32_bf16 a[144:147], v[96:99], a[208:211], 0
    ds_read_b128 a[224:227], v242 offset:4096
    v_mfma_f32_16x16x32_bf16 a[176:179], v[96:99], a[212:215], 0
    ds_read_b128 a[228:231], v242 offset:6144
    v_mfma_f32_16x16x32_bf16 a[20:23], v[100:103], a[192:195], 0
    v_perm_b32 v104, v199, v195, s60
    v_perm_b32 v105, v207, v203, s60
    v_mfma_f32_16x16x32_bf16 a[52:55], v[100:103], a[196:199], 0
    v_perm_b32 v106, v215, v211, s60
    v_perm_b32 v107, v223, v219, s60
    v_mfma_f32_16x16x32_bf16 a[84:87], v[100:103], a[200:203], 0
    s_add_u32 s72, s82, 256
    s_and_b32 s72, s72, 0x3ff
    v_mfma_f32_16x16x32_bf16 a[116:119], v[100:103], a[204:207], 0
    s_add_u32 s72, s72, s86
    s_add_u32 m0, s89, 24576
    v_mfma_f32_16x16x32_bf16 a[148:151], v[100:103], a[208:211], 0
    buffer_load_dwordx4 v251, s[20:23], s72 offen lds
    ds_read_b128 a[232:235], v242 offset:8192
    v_mfma_f32_16x16x32_bf16 a[180:183], v[100:103], a[212:215], 0
    ds_read_b128 a[236:239], v242 offset:10240
    v_mfma_f32_16x16x32_bf16 a[24:27], v[104:107], a[192:195], 0
    v_perm_b32 v108, v199, v195, s61
    v_perm_b32 v109, v207, v203, s61
    v_mfma_f32_16x16x32_bf16 a[56:59], v[104:107], a[196:199], 0
    v_perm_b32 v110, v215, v211, s61
    v_mfma_f32_16x16x32_bf16 a[88:91], v[104:107], a[200:203], 0
    v_perm_b32 v111, v223, v219, s61
    s_add_u32 s72, s82, 256
    v_mfma_f32_16x16x32_bf16 a[120:123], v[104:107], a[204:207], 0
    s_and_b32 s72, s72, 0x3ff
    v_mfma_f32_16x16x32_bf16 a[152:155], v[104:107], a[208:211], 0
    s_add_u32 s72, s72, s87
    s_add_u32 m0, s90, 24576
    v_mfma_f32_16x16x32_bf16 a[184:187], v[104:107], a[212:215], 0
    buffer_load_dwordx4 v252, s[20:23], s72 offen lds
    v_mfma_f32_16x16x32_bf16 a[28:31], v[108:111], a[192:195], 0
    s_waitcnt vmcnt(11)
    v_perm_b32 v96, v36, v32, s60
    v_mfma_f32_16x16x32_bf16 a[60:63], v[108:111], a[196:199], 0
    v_perm_b32 v97, v44, v40, s60
    v_perm_b32 v98, v52, v48, s60
    v_mfma_f32_16x16x32_bf16 a[92:95], v[108:111], a[200:203], 0
    v_perm_b32 v99, v60, v56, s60
    v_mfma_f32_16x16x32_bf16 a[124:127], v[108:111], a[204:207], 0
    s_add_u32 s72, s82, 256
    s_and_b32 s72, s72, 0x3ff
    v_mfma_f32_16x16x32_bf16 a[156:159], v[108:111], a[208:211], 0
    s_add_u32 s72, s72, s88
    s_add_u32 m0, s91, 24576
    v_mfma_f32_16x16x32_bf16 a[188:191], v[108:111], a[212:215], 0
    buffer_load_dwordx4 v253, s[20:23], s72 offen lds
    s_waitcnt lgkmcnt(0)
    v_mfma_f32_16x16x32_bf16 a[0:3], v[96:99], a[216:219], a[0:3]
    v_perm_b32 v100, v36, v32, s61
    v_mfma_f32_16x16x32_bf16 a[32:35], v[96:99], a[220:223], a[32:35]
    v_perm_b32 v101, v44, v40, s61
    v_mfma_f32_16x16x32_bf16 a[64:67], v[96:99], a[224:227], a[64:67]
    v_mfma_f32_16x16x32_bf16 a[96:99], v[96:99], a[228:231], a[96:99]
    v_perm_b32 v102, v52, v48, s61
    v_mfma_f32_16x16x32_bf16 a[128:131], v[96:99], a[232:235], a[128:131]
    v_perm_b32 v103, v60, v56, s61
    v_mfma_f32_16x16x32_bf16 a[160:163], v[96:99], a[236:239], a[160:163]
    s_nop 0
    v_mfma_f32_16x16x32_bf16 a[4:7], v[100:103], a[216:219], a[4:7]
    v_perm_b32 v104, v37, v33, s60
    v_perm_b32 v105, v45, v41, s60
    v_mfma_f32_16x16x32_bf16 a[36:39], v[100:103], a[220:223], a[36:39]
    v_perm_b32 v106, v53, v49, s60
    v_mfma_f32_16x16x32_bf16 a[68:71], v[100:103], a[224:227], a[68:71]
    v_perm_b32 v107, v61, v57, s60
    s_add_u32 s72, s82, 384
    v_mfma_f32_16x16x32_bf16 a[100:103], v[100:103], a[228:231], a[100:103]
    s_and_b32 s72, s72, 0x3ff
    v_mfma_f32_16x16x32_bf16 a[132:135], v[100:103], a[232:235], a[132:135]
    s_add_u32 s72, s72, s86
    s_add_u32 m0, s89, 36864
    v_mfma_f32_16x16x32_bf16 a[164:167], v[100:103], a[236:239], a[164:167]
    buffer_load_dwordx4 v251, s[20:23], s72 offen lds
    v_mfma_f32_16x16x32_bf16 a[8:11], v[104:107], a[216:219], a[8:11]
    v_perm_b32 v108, v37, v33, s61
    v_perm_b32 v109, v45, v41, s61
    v_mfma_f32_16x16x32_bf16 a[40:43], v[104:107], a[220:223], a[40:43]
    v_perm_b32 v110, v53, v49, s61
    v_mfma_f32_16x16x32_bf16 a[72:75], v[104:107], a[224:227], a[72:75]
    v_perm_b32 v111, v61, v57, s61
    s_add_u32 s72, s82, 384
    v_mfma_f32_16x16x32_bf16 a[104:107], v[104:107], a[228:231], a[104:107]
    s_and_b32 s72, s72, 0x3ff
    v_mfma_f32_16x16x32_bf16 a[136:139], v[104:107], a[232:235], a[136:139]
    s_add_u32 s72, s72, s87
    s_add_u32 m0, s90, 36864
    v_mfma_f32_16x16x32_bf16 a[168:171], v[104:107], a[236:239], a[168:171]
    buffer_load_dwordx4 v252, s[20:23], s72 offen lds
    v_mfma_f32_16x16x32_bf16 a[12:15], v[108:111], a[216:219], a[12:15]
    v_perm_b32 v96, v38, v34, s60
    v_perm_b32 v97, v46, v42, s60
    v_mfma_f32_16x16x32_bf16 a[44:47], v[108:111], a[220:223], a[44:47]
    v_perm_b32 v98, v54, v50, s60
    v_perm_b32 v99, v62, v58, s60
    v_mfma_f32_16x16x32_bf16 a[76:79], v[108:111], a[224:227], a[76:79]
    s_add_u32 s72, s82, 384
    s_and_b32 s72, s72, 0x3ff
    v_mfma_f32_16x16x32_bf16 a[108:111], v[108:111], a[228:231], a[108:111]
    s_add_u32 s72, s72, s88
    s_add_u32 m0, s91, 36864
    v_mfma_f32_16x16x32_bf16 a[140:143], v[108:111], a[232:235], a[140:143]
    buffer_load_dwordx4 v253, s[20:23], s72 offen lds
    ds_read_b128 a[192:195], v241 offset:12288
    v_mfma_f32_16x16x32_bf16 a[172:175], v[108:111], a[236:239], a[172:175]
    ds_read_b128 a[196:199], v241 offset:14336
    v_mfma_f32_16x16x32_bf16 a[16:19], v[96:99], a[216:219], a[16:19]
    v_perm_b32 v100, v38, v34, s61
    v_perm_b32 v101, v46, v42, s61
    v_mfma_f32_16x16x32_bf16 a[48:51], v[96:99], a[220:223], a[48:51]
    v_perm_b32 v102, v54, v50, s61
    v_perm_b32 v103, v62, v58, s61
    v_mfma_f32_16x16x32_bf16 a[80:83], v[96:99], a[224:227], a[80:83]
    v_add_u32 v240, s81, v240
    v_mfma_f32_16x16x32_bf16 a[112:115], v[96:99], a[228:231], a[112:115]
    v_and_b32 v240, 0x3fffff, v240
    buffer_load_dwordx4 v[0:3], v240, s[32:35], 0 offen
    v_mfma_f32_16x16x32_bf16 a[144:147], v[96:99], a[232:235], a[144:147]
    buffer_load_dwordx4 v[4:7], v240, s[32:35], s52 offen
    ds_read_b128 a[200:203], v241 offset:16384
    v_mfma_f32_16x16x32_bf16 a[176:179], v[96:99], a[236:239], a[176:179]
    ds_read_b128 a[204:207], v241 offset:18432
    v_mfma_f32_16x16x32_bf16 a[20:23], v[100:103], a[216:219], a[20:23]
    v_perm_b32 v104, v39, v35, s60
    v_perm_b32 v105, v47, v43, s60
    v_mfma_f32_16x16x32_bf16 a[52:55], v[100:103], a[220:223], a[52:55]
    v_perm_b32 v106, v55, v51, s60
    v_mfma_f32_16x16x32_bf16 a[84:87], v[100:103], a[224:227], a[84:87]
    v_perm_b32 v107, v63, v59, s60
    v_mfma_f32_16x16x32_bf16 a[116:119], v[100:103], a[228:231], a[116:119]
    buffer_load_dwordx4 v[8:11], v240, s[32:35], s53 offen
    buffer_load_dwordx4 v[12:15], v240, s[32:35], s54 offen
    v_mfma_f32_16x16x32_bf16 a[148:151], v[100:103], a[232:235], a[148:151]
    ds_read_b128 a[208:211], v241 offset:20480
    v_mfma_f32_16x16x32_bf16 a[180:183], v[100:103], a[236:239], a[180:183]
    ds_read_b128 a[212:215], v241 offset:22528
    v_mfma_f32_16x16x32_bf16 a[24:27], v[104:107], a[216:219], a[24:27]
    v_perm_b32 v108, v39, v35, s61
    v_mfma_f32_16x16x32_bf16 a[56:59], v[104:107], a[220:223], a[56:59]
    v_perm_b32 v109, v47, v43, s61
    v_mfma_f32_16x16x32_bf16 a[88:91], v[104:107], a[224:227], a[88:91]
    v_perm_b32 v110, v55, v51, s61
    v_mfma_f32_16x16x32_bf16 a[120:123], v[104:107], a[228:231], a[120:123]
    v_perm_b32 v111, v63, v59, s61
    v_mfma_f32_16x16x32_bf16 a[152:155], v[104:107], a[232:235], a[152:155]
    buffer_load_dwordx4 v[16:19], v240, s[32:35], s55 offen
    v_mfma_f32_16x16x32_bf16 a[184:187], v[104:107], a[236:239], a[184:187]
    v_mfma_f32_16x16x32_bf16 a[28:31], v[108:111], a[216:219], a[28:31]
    s_waitcnt vmcnt(11)
    v_perm_b32 v96, v68, v64, s60
    v_mfma_f32_16x16x32_bf16 a[60:63], v[108:111], a[220:223], a[60:63]
    v_perm_b32 v97, v76, v72, s60
    v_mfma_f32_16x16x32_bf16 a[92:95], v[108:111], a[224:227], a[92:95]
    v_perm_b32 v98, v84, v80, s60
    v_mfma_f32_16x16x32_bf16 a[124:127], v[108:111], a[228:231], a[124:127]
    v_perm_b32 v99, v92, v88, s60
    v_mfma_f32_16x16x32_bf16 a[156:159], v[108:111], a[232:235], a[156:159]
    buffer_load_dwordx4 v[20:23], v240, s[32:35], s56 offen
    v_mfma_f32_16x16x32_bf16 a[188:191], v[108:111], a[236:239], a[188:191]
    buffer_load_dwordx4 v[24:27], v240, s[32:35], s57 offen
    s_waitcnt lgkmcnt(0)
    v_mfma_f32_16x16x32_bf16 a[0:3], v[96:99], a[192:195], a[0:3]
    v_perm_b32 v100, v68, v64, s61
    v_perm_b32 v101, v76, v72, s61
    v_mfma_f32_16x16x32_bf16 a[32:35], v[96:99], a[196:199], a[32:35]
    v_perm_b32 v102, v84, v80, s61
    v_mfma_f32_16x16x32_bf16 a[64:67], v[96:99], a[200:203], a[64:67]
    v_perm_b32 v103, v92, v88, s61
    v_mfma_f32_16x16x32_bf16 a[96:99], v[96:99], a[204:207], a[96:99]
    buffer_load_dwordx4 v[28:31], v240, s[32:35], s58 offen
    v_add_u32 v240, s80, v240
    v_mfma_f32_16x16x32_bf16 a[128:131], v[96:99], a[208:211], a[128:131]
    v_and_b32 v240, 0x3fffff, v240
    v_mfma_f32_16x16x32_bf16 a[160:163], v[96:99], a[212:215], a[160:163]
    buffer_load_dwordx4 v[128:131], v240, s[32:35], 0 offen
    v_mfma_f32_16x16x32_bf16 a[4:7], v[100:103], a[192:195], a[4:7]
    v_perm_b32 v104, v69, v65, s60
    v_mfma_f32_16x16x32_bf16 a[36:39], v[100:103], a[196:199], a[36:39]
    v_perm_b32 v105, v77, v73, s60
    v_mfma_f32_16x16x32_bf16 a[68:71], v[100:103], a[200:203], a[68:71]
    v_perm_b32 v106, v85, v81, s60
    v_mfma_f32_16x16x32_bf16 a[100:103], v[100:103], a[204:207], a[100:103]
    v_perm_b32 v107, v93, v89, s60
    v_mfma_f32_16x16x32_bf16 a[132:135], v[100:103], a[208:211], a[132:135]
    buffer_load_dwordx4 v[132:135], v240, s[32:35], s52 offen
    v_mfma_f32_16x16x32_bf16 a[164:167], v[100:103], a[212:215], a[164:167]
    buffer_load_dwordx4 v[136:139], v240, s[32:35], s53 offen
    v_mfma_f32_16x16x32_bf16 a[8:11], v[104:107], a[192:195], a[8:11]
    v_perm_b32 v108, v69, v65, s61
    v_mfma_f32_16x16x32_bf16 a[40:43], v[104:107], a[196:199], a[40:43]
    v_perm_b32 v109, v77, v73, s61
    v_mfma_f32_16x16x32_bf16 a[72:75], v[104:107], a[200:203], a[72:75]
    v_perm_b32 v110, v85, v81, s61
    v_mfma_f32_16x16x32_bf16 a[104:107], v[104:107], a[204:207], a[104:107]
    v_perm_b32 v111, v93, v89, s61
    v_mfma_f32_16x16x32_bf16 a[136:139], v[104:107], a[208:211], a[136:139]
    buffer_load_dwordx4 v[140:143], v240, s[32:35], s54 offen
    v_mfma_f32_16x16x32_bf16 a[168:171], v[104:107], a[212:215], a[168:171]
    v_mfma_f32_16x16x32_bf16 a[12:15], v[108:111], a[192:195], a[12:15]
    v_perm_b32 v96, v70, v66, s60
    v_perm_b32 v97, v78, v74, s60
    v_mfma_f32_16x16x32_bf16 a[44:47], v[108:111], a[196:199], a[44:47]
    v_perm_b32 v98, v86, v82, s60
    v_mfma_f32_16x16x32_bf16 a[76:79], v[108:111], a[200:203], a[76:79]
    v_perm_b32 v99, v94, v90, s60
    v_mfma_f32_16x16x32_bf16 a[108:111], v[108:111], a[204:207], a[108:111]
    buffer_load_dwordx4 v[144:147], v240, s[32:35], s55 offen
    buffer_load_dwordx4 v[148:151], v240, s[32:35], s56 offen
    v_mfma_f32_16x16x32_bf16 a[140:143], v[108:111], a[208:211], a[140:143]
    ds_read_b128 a[216:219], v242 offset:12288
    v_mfma_f32_16x16x32_bf16 a[172:175], v[108:111], a[212:215], a[172:175]
    ds_read_b128 a[220:223], v242 offset:14336
    v_mfma_f32_16x16x32_bf16 a[16:19], v[96:99], a[192:195], a[16:19]
    v_perm_b32 v100, v70, v66, s61
    v_perm_b32 v101, v78, v74, s61
    v_mfma_f32_16x16x32_bf16 a[48:51], v[96:99], a[196:199], a[48:51]
    v_perm_b32 v102, v86, v82, s61
    v_mfma_f32_16x16x32_bf16 a[80:83], v[96:99], a[200:203], a[80:83]
    v_perm_b32 v103, v94, v90, s61
    v_mfma_f32_16x16x32_bf16 a[112:115], v[96:99], a[204:207], a[112:115]
    buffer_load_dwordx4 v[152:155], v240, s[32:35], s57 offen
    buffer_load_dwordx4 v[156:159], v240, s[32:35], s58 offen
    v_mfma_f32_16x16x32_bf16 a[144:147], v[96:99], a[208:211], a[144:147]
    ds_read_b128 a[224:227], v242 offset:16384
    v_mfma_f32_16x16x32_bf16 a[176:179], v[96:99], a[212:215], a[176:179]
    ds_read_b128 a[228:231], v242 offset:18432
    v_mfma_f32_16x16x32_bf16 a[20:23], v[100:103], a[192:195], a[20:23]
    v_perm_b32 v104, v71, v67, s60
    v_perm_b32 v105, v79, v75, s60
    v_mfma_f32_16x16x32_bf16 a[52:55], v[100:103], a[196:199], a[52:55]
    v_perm_b32 v106, v87, v83, s60
    v_perm_b32 v107, v95, v91, s60
    v_mfma_f32_16x16x32_bf16 a[84:87], v[100:103], a[200:203], a[84:87]
    v_add_u32 v240, s81, v240
    v_mfma_f32_16x16x32_bf16 a[116:119], v[100:103], a[204:207], a[116:119]
    v_and_b32 v240, 0x3fffff, v240
    buffer_load_dwordx4 v[160:163], v240, s[32:35], 0 offen
    v_mfma_f32_16x16x32_bf16 a[148:151], v[100:103], a[208:211], a[148:151]
    buffer_load_dwordx4 v[164:167], v240, s[32:35], s52 offen
    ds_read_b128 a[232:235], v242 offset:20480
    v_mfma_f32_16x16x32_bf16 a[180:183], v[100:103], a[212:215], a[180:183]
    ds_read_b128 a[236:239], v242 offset:22528
    v_mfma_f32_16x16x32_bf16 a[24:27], v[104:107], a[192:195], a[24:27]
    v_perm_b32 v108, v71, v67, s61
    v_mfma_f32_16x16x32_bf16 a[56:59], v[104:107], a[196:199], a[56:59]
    v_perm_b32 v109, v79, v75, s61
    v_mfma_f32_16x16x32_bf16 a[88:91], v[104:107], a[200:203], a[88:91]
    v_perm_b32 v110, v87, v83, s61
    v_mfma_f32_16x16x32_bf16 a[120:123], v[104:107], a[204:207], a[120:123]
    v_perm_b32 v111, v95, v91, s61
    v_mfma_f32_16x16x32_bf16 a[152:155], v[104:107], a[208:211], a[152:155]
    buffer_load_dwordx4 v[168:171], v240, s[32:35], s53 offen
    v_mfma_f32_16x16x32_bf16 a[184:187], v[104:107], a[212:215], a[184:187]
    v_mfma_f32_16x16x32_bf16 a[28:31], v[108:111], a[192:195], a[28:31]
    s_waitcnt vmcnt(11)
    v_perm_b32 v96, v4, v0, s60
    v_mfma_f32_16x16x32_bf16 a[60:63], v[108:111], a[196:199], a[60:63]
    v_perm_b32 v97, v12, v8, s60
    v_mfma_f32_16x16x32_bf16 a[92:95], v[108:111], a[200:203], a[92:95]
    v_perm_b32 v98, v20, v16, s60
    v_mfma_f32_16x16x32_bf16 a[124:127], v[108:111], a[204:207], a[124:127]
    v_perm_b32 v99, v28, v24, s60
    v_mfma_f32_16x16x32_bf16 a[156:159], v[108:111], a[208:211], a[156:159]
    buffer_load_dwordx4 v[172:175], v240, s[32:35], s54 offen
    v_mfma_f32_16x16x32_bf16 a[188:191], v[108:111], a[212:215], a[188:191]
    buffer_load_dwordx4 v[176:179], v240, s[32:35], s55 offen
    s_waitcnt lgkmcnt(0)
    v_mfma_f32_16x16x32_bf16 a[0:3], v[96:99], a[216:219], a[0:3]
    v_perm_b32 v100, v4, v0, s61
    v_mfma_f32_16x16x32_bf16 a[32:35], v[96:99], a[220:223], a[32:35]
    v_perm_b32 v101, v12, v8, s61
    v_mfma_f32_16x16x32_bf16 a[64:67], v[96:99], a[224:227], a[64:67]
    v_perm_b32 v102, v20, v16, s61
    v_mfma_f32_16x16x32_bf16 a[96:99], v[96:99], a[228:231], a[96:99]
    v_perm_b32 v103, v28, v24, s61
    v_mfma_f32_16x16x32_bf16 a[128:131], v[96:99], a[232:235], a[128:131]
    buffer_load_dwordx4 v[180:183], v240, s[32:35], s56 offen
    v_mfma_f32_16x16x32_bf16 a[160:163], v[96:99], a[236:239], a[160:163]
    buffer_load_dwordx4 v[184:187], v240, s[32:35], s57 offen
    v_mfma_f32_16x16x32_bf16 a[4:7], v[100:103], a[216:219], a[4:7]
    v_perm_b32 v104, v5, v1, s60
    v_mfma_f32_16x16x32_bf16 a[36:39], v[100:103], a[220:223], a[36:39]
    v_perm_b32 v105, v13, v9, s60
    v_mfma_f32_16x16x32_bf16 a[68:71], v[100:103], a[224:227], a[68:71]
    v_perm_b32 v106, v21, v17, s60
    v_mfma_f32_16x16x32_bf16 a[100:103], v[100:103], a[228:231], a[100:103]
    v_perm_b32 v107, v29, v25, s60
    v_mfma_f32_16x16x32_bf16 a[132:135], v[100:103], a[232:235], a[132:135]
    buffer_load_dwordx4 v[188:191], v240, s[32:35], s58 offen
    v_mfma_f32_16x16x32_bf16 a[164:167], v[100:103], a[236:239], a[164:167]
    v_mfma_f32_16x16x32_bf16 a[8:11], v[104:107], a[216:219], a[8:11]
    v_perm_b32 v108, v5, v1, s61
    v_perm_b32 v109, v13, v9, s61
    v_mfma_f32_16x16x32_bf16 a[40:43], v[104:107], a[220:223], a[40:43]
    v_perm_b32 v110, v21, v17, s61
    v_mfma_f32_16x16x32_bf16 a[72:75], v[104:107], a[224:227], a[72:75]
    v_perm_b32 v111, v29, v25, s61
    v_mfma_f32_16x16x32_bf16 a[104:107], v[104:107], a[228:231], a[104:107]
    s_add_u32 s73, s62, 0
    v_mfma_f32_16x16x32_bf16 a[136:139], v[104:107], a[232:235], a[136:139]
    s_add_u32 m0, s92, 0
    v_mfma_f32_16x16x32_bf16 a[168:171], v[104:107], a[236:239], a[168:171]
    buffer_load_dwordx4 v113, s[24:27], s73 offen nt lds
    v_mfma_f32_16x16x32_bf16 a[12:15], v[108:111], a[216:219], a[12:15]
    v_perm_b32 v96, v6, v2, s60
    v_perm_b32 v97, v14, v10, s60
    v_mfma_f32_16x16x32_bf16 a[44:47], v[108:111], a[220:223], a[44:47]
    v_perm_b32 v98, v22, v18, s60
    v_perm_b32 v99, v30, v26, s60
    v_mfma_f32_16x16x32_bf16 a[76:79], v[108:111], a[224:227], a[76:79]
    s_add_u32 s73, s62, 1024
    s_add_u32 m0, s92, 1024
    v_mfma_f32_16x16x32_bf16 a[108:111], v[108:111], a[228:231], a[108:111]
    buffer_load_dwordx4 v114, s[24:27], s73 offen nt lds
    v_mfma_f32_16x16x32_bf16 a[140:143], v[108:111], a[232:235], a[140:143]
    s_barrier
    ds_read_b128 a[192:195], v241 offset:24576
    v_mfma_f32_16x16x32_bf16 a[172:175], v[108:111], a[236:239], a[172:175]
    ds_read_b128 a[196:199], v241 offset:26624
    v_mfma_f32_16x16x32_bf16 a[16:19], v[96:99], a[216:219], a[16:19]
    v_perm_b32 v100, v6, v2, s61
    v_perm_b32 v101, v14, v10, s61
    v_mfma_f32_16x16x32_bf16 a[48:51], v[96:99], a[220:223], a[48:51]
    v_perm_b32 v102, v22, v18, s61
    v_mfma_f32_16x16x32_bf16 a[80:83], v[96:99], a[224:227], a[80:83]
    v_perm_b32 v103, v30, v26, s61
    s_add_u32 s73, s62, 2048
    v_mfma_f32_16x16x32_bf16 a[112:115], v[96:99], a[228:231], a[112:115]
    s_add_u32 m0, s92, 2048
    v_mfma_f32_16x16x32_bf16 a[144:147], v[96:99], a[232:235], a[144:147]
    buffer_load_dwordx4 v115, s[24:27], s73 offen nt lds
    ds_read_b128 a[200:203], v241 offset:28672
    v_mfma_f32_16x16x32_bf16 a[176:179], v[96:99], a[236:239], a[176:179]
    ds_read_b128 a[204:207], v241 offset:30720
    v_mfma_f32_16x16x32_bf16 a[20:23], v[100:103], a[216:219], a[20:23]
    v_perm_b32 v104, v7, v3, s60
    v_perm_b32 v105, v15, v11, s60
    v_mfma_f32_16x16x32_bf16 a[52:55], v[100:103], a[220:223], a[52:55]
    v_perm_b32 v106, v23, v19, s60
    v_mfma_f32_16x16x32_bf16 a[84:87], v[100:103], a[224:227], a[84:87]
    v_perm_b32 v107, v31, v27, s60
    s_add_u32 s73, s62, 3072
    v_mfma_f32_16x16x32_bf16 a[116:119], v[100:103], a[228:231], a[116:119]
    s_add_u32 m0, s92, 3072
    v_mfma_f32_16x16x32_bf16 a[148:151], v[100:103], a[232:235], a[148:151]
    buffer_load_dwordx4 v116, s[24:27], s73 offen nt lds
    ds_read_b128 a[208:211], v241 offset:32768
    v_mfma_f32_16x16x32_bf16 a[180:183], v[100:103], a[236:239], a[180:183]
    ds_read_b128 a[212:215], v241 offset:34816
    v_mfma_f32_16x16x32_bf16 a[24:27], v[104:107], a[216:219], a[24:27]
    v_perm_b32 v108, v7, v3, s61
    v_perm_b32 v109, v15, v11, s61
    v_mfma_f32_16x16x32_bf16 a[56:59], v[104:107], a[220:223], a[56:59]
    v_perm_b32 v110, v23, v19, s61
    v_mfma_f32_16x16x32_bf16 a[88:91], v[104:107], a[224:227], a[88:91]
    v_perm_b32 v111, v31, v27, s61
    v_mfma_f32_16x16x32_bf16 a[120:123], v[104:107], a[228:231], a[120:123]
    s_add_u32 s73, s62, 4096
    v_mfma_f32_16x16x32_bf16 a[152:155], v[104:107], a[232:235], a[152:155]
    s_add_u32 m0, s92, 4096
    v_mfma_f32_16x16x32_bf16 a[184:187], v[104:107], a[236:239], a[184:187]
    buffer_load_dwordx4 v113, s[24:27], s73 offen nt lds
    v_mfma_f32_16x16x32_bf16 a[28:31], v[108:111], a[216:219], a[28:31]
    s_waitcnt vmcnt(13)
    v_mfma_f32_16x16x32_bf16 a[60:63], v[108:111], a[220:223], a[60:63]
    v_perm_b32 v96, v132, v128, s60
    v_mfma_f32_16x16x32_bf16 a[92:95], v[108:111], a[224:227], a[92:95]
    v_perm_b32 v97, v140, v136, s60
    v_mfma_f32_16x16x32_bf16 a[124:127], v[108:111], a[228:231], a[124:127]
    v_perm_b32 v98, v148, v144, s60
    v_mfma_f32_16x16x32_bf16 a[156:159], v[108:111], a[232:235], a[156:159]
    v_perm_b32 v99, v156, v152, s60
    v_mfma_f32_16x16x32_bf16 a[188:191], v[108:111], a[236:239], a[188:191]
    s_waitcnt lgkmcnt(0)
    v_mfma_f32_16x16x32_bf16 a[0:3], v[96:99], a[192:195], a[0:3]
    v_perm_b32 v100, v132, v128, s61
    v_perm_b32 v101, v140, v136, s61
    v_mfma_f32_16x16x32_bf16 a[32:35], v[96:99], a[196:199], a[32:35]
    v_perm_b32 v102, v148, v144, s61
    v_mfma_f32_16x16x32_bf16 a[64:67], v[96:99], a[200:203], a[64:67]
    v_perm_b32 v103, v156, v152, s61
    v_mfma_f32_16x16x32_bf16 a[96:99], v[96:99], a[204:207], a[96:99]
    s_add_u32 s73, s62, 5120
    v_mfma_f32_16x16x32_bf16 a[128:131], v[96:99], a[208:211], a[128:131]
    s_add_u32 m0, s92, 5120
    v_mfma_f32_16x16x32_bf16 a[160:163], v[96:99], a[212:215], a[160:163]
    buffer_load_dwordx4 v114, s[24:27], s73 offen nt lds
    v_mfma_f32_16x16x32_bf16 a[4:7], v[100:103], a[192:195], a[4:7]
    v_perm_b32 v104, v133, v129, s60
    v_perm_b32 v105, v141, v137, s60
    v_mfma_f32_16x16x32_bf16 a[36:39], v[100:103], a[196:199], a[36:39]
    v_perm_b32 v106, v149, v145, s60
    v_mfma_f32_16x16x32_bf16 a[68:71], v[100:103], a[200:203], a[68:71]
    v_perm_b32 v107, v157, v153, s60
    v_mfma_f32_16x16x32_bf16 a[100:103], v[100:103], a[204:207], a[100:103]
    s_add_u32 s73, s62, 6144
    v_mfma_f32_16x16x32_bf16 a[132:135], v[100:103], a[208:211], a[132:135]
    s_add_u32 m0, s92, 6144
    v_mfma_f32_16x16x32_bf16 a[164:167], v[100:103], a[212:215], a[164:167]
    buffer_load_dwordx4 v115, s[24:27], s73 offen nt lds
    v_mfma_f32_16x16x32_bf16 a[8:11], v[104:107], a[192:195], a[8:11]
    v_perm_b32 v108, v133, v129, s61
    v_perm_b32 v109, v141, v137, s61
    v_mfma_f32_16x16x32_bf16 a[40:43], v[104:107], a[196:199], a[40:43]
    v_perm_b32 v110, v149, v145, s61
    v_mfma_f32_16x16x32_bf16 a[72:75], v[104:107], a[200:203], a[72:75]
    v_perm_b32 v111, v157, v153, s61
    v_mfma_f32_16x16x32_bf16 a[104:107], v[104:107], a[204:207], a[104:107]
    s_add_u32 s73, s62, 7168
    v_mfma_f32_16x16x32_bf16 a[136:139], v[104:107], a[208:211], a[136:139]
    s_add_u32 m0, s92, 7168
    v_mfma_f32_16x16x32_bf16 a[168:171], v[104:107], a[212:215], a[168:171]
    buffer_load_dwordx4 v116, s[24:27], s73 offen nt lds
    v_mfma_f32_16x16x32_bf16 a[12:15], v[108:111], a[192:195], a[12:15]
    v_perm_b32 v96, v134, v130, s60
    v_perm_b32 v97, v142, v138, s60
    v_mfma_f32_16x16x32_bf16 a[44:47], v[108:111], a[196:199], a[44:47]
    v_perm_b32 v98, v150, v146, s60
    v_perm_b32 v99, v158, v154, s60
    v_mfma_f32_16x16x32_bf16 a[76:79], v[108:111], a[200:203], a[76:79]
    v_add_u32 v240, s80, v240
    v_mfma_f32_16x16x32_bf16 a[108:111], v[108:111], a[204:207], a[108:111]
    v_and_b32 v240, 0x3fffff, v240
    buffer_load_dwordx4 v[192:195], v240, s[32:35], 0 offen
    v_mfma_f32_16x16x32_bf16 a[140:143], v[108:111], a[208:211], a[140:143]
    buffer_load_dwordx4 v[196:199], v240, s[32:35], s52 offen
    ds_read_b128 a[216:219], v242 offset:24576
    v_mfma_f32_16x16x32_bf16 a[172:175], v[108:111], a[212:215], a[172:175]
    ds_read_b128 a[220:223], v242 offset:26624
    v_mfma_f32_16x16x32_bf16 a[16:19], v[96:99], a[192:195], a[16:19]
    v_perm_b32 v100, v134, v130, s61
    v_perm_b32 v101, v142, v138, s61
    v_mfma_f32_16x16x32_bf16 a[48:51], v[96:99], a[196:199], a[48:51]
    v_perm_b32 v102, v150, v146, s61
    v_mfma_f32_16x16x32_bf16 a[80:83], v[96:99], a[200:203], a[80:83]
    v_perm_b32 v103, v158, v154, s61
    v_mfma_f32_16x16x32_bf16 a[112:115], v[96:99], a[204:207], a[112:115]
    buffer_load_dwordx4 v[200:203], v240, s[32:35], s53 offen
    buffer_load_dwordx4 v[204:207], v240, s[32:35], s54 offen
    v_mfma_f32_16x16x32_bf16 a[144:147], v[96:99], a[208:211], a[144:147]
    ds_read_b128 a[224:227], v242 offset:28672
    v_mfma_f32_16x16x32_bf16 a[176:179], v[96:99], a[212:215], a[176:179]
    ds_read_b128 a[228:231], v242 offset:30720
    v_mfma_f32_16x16x32_bf16 a[20:23], v[100:103], a[192:195], a[20:23]
    v_perm_b32 v104, v135, v131, s60
    v_perm_b32 v105, v143, v139, s60
    v_mfma_f32_16x16x32_bf16 a[52:55], v[100:103], a[196:199], a[52:55]
    v_perm_b32 v106, v151, v147, s60
    v_mfma_f32_16x16x32_bf16 a[84:87], v[100:103], a[200:203], a[84:87]
    v_perm_b32 v107, v159, v155, s60
    v_mfma_f32_16x16x32_bf16 a[116:119], v[100:103], a[204:207], a[116:119]
    buffer_load_dwordx4 v[208:211], v240, s[32:35], s55 offen
    v_mfma_f32_16x16x32_bf16 a[148:151], v[100:103], a[208:211], a[148:151]
    ds_read_b128 a[232:235], v242 offset:32768
    v_mfma_f32_16x16x32_bf16 a[180:183], v[100:103], a[212:215], a[180:183]
    ds_read_b128 a[236:239], v242 offset:34816
    v_mfma_f32_16x16x32_bf16 a[24:27], v[104:107], a[192:195], a[24:27]
    v_perm_b32 v108, v135, v131, s61
    v_mfma_f32_16x16x32_bf16 a[56:59], v[104:107], a[196:199], a[56:59]
    v_perm_b32 v109, v143, v139, s61
    v_mfma_f32_16x16x32_bf16 a[88:91], v[104:107], a[200:203], a[88:91]
    v_perm_b32 v110, v151, v147, s61
    v_mfma_f32_16x16x32_bf16 a[120:123], v[104:107], a[204:207], a[120:123]
    v_perm_b32 v111, v159, v155, s61
    v_mfma_f32_16x16x32_bf16 a[152:155], v[104:107], a[208:211], a[152:155]
    buffer_load_dwordx4 v[212:215], v240, s[32:35], s56 offen
    v_mfma_f32_16x16x32_bf16 a[184:187], v[104:107], a[212:215], a[184:187]
    buffer_load_dwordx4 v[216:219], v240, s[32:35], s57 offen
    v_mfma_f32_16x16x32_bf16 a[28:31], v[108:111], a[192:195], a[28:31]
    s_waitcnt vmcnt(15)
    v_perm_b32 v96, v164, v160, s60
    v_mfma_f32_16x16x32_bf16 a[60:63], v[108:111], a[196:199], a[60:63]
    v_perm_b32 v97, v172, v168, s60
    v_perm_b32 v98, v180, v176, s60
    v_mfma_f32_16x16x32_bf16 a[92:95], v[108:111], a[200:203], a[92:95]
    v_perm_b32 v99, v188, v184, s60
    buffer_load_dwordx4 v[220:223], v240, s[32:35], s58 offen
    v_mfma_f32_16x16x32_bf16 a[124:127], v[108:111], a[204:207], a[124:127]
    s_add_u32 s72, s82, 512
    s_and_b32 s72, s72, 0x3ff
    v_mfma_f32_16x16x32_bf16 a[156:159], v[108:111], a[208:211], a[156:159]
    s_add_u32 s72, s72, s86
    s_add_u32 m0, s89, 49152
    v_mfma_f32_16x16x32_bf16 a[188:191], v[108:111], a[212:215], a[188:191]
    buffer_load_dwordx4 v251, s[20:23], s72 offen lds
    s_waitcnt lgkmcnt(0)
    v_mfma_f32_16x16x32_bf16 a[0:3], v[96:99], a[216:219], a[0:3]
    v_perm_b32 v100, v164, v160, s61
    v_perm_b32 v101, v172, v168, s61
    v_perm_b32 v102, v180, v176, s61
    v_mfma_f32_16x16x32_bf16 a[32:35], v[96:99], a[220:223], a[32:35]
    v_perm_b32 v103, v188, v184, s61
    s_add_u32 s72, s82, 512
    v_mfma_f32_16x16x32_bf16 a[64:67], v[96:99], a[224:227], a[64:67]
    s_and_b32 s72, s72, 0x3ff
    s_add_u32 s72, s72, s87
    v_mfma_f32_16x16x32_bf16 a[96:99], v[96:99], a[228:231], a[96:99]
    s_add_u32 m0, s90, 49152
    s_nop 0
    buffer_load_dwordx4 v252, s[20:23], s72 offen lds
    s_add_u32 s72, s82, 512
    v_mfma_f32_16x16x32_bf16 a[128:131], v[96:99], a[232:235], a[128:131]
    s_and_b32 s72, s72, 0x3ff
    s_add_u32 s72, s72, s88
    v_mfma_f32_16x16x32_bf16 a[160:163], v[96:99], a[236:239], a[160:163]
    s_add_u32 m0, s91, 49152
    s_nop 0
    buffer_load_dwordx4 v253, s[20:23], s72 offen lds
    v_mfma_f32_16x16x32_bf16 a[4:7], v[100:103], a[216:219], a[4:7]
    v_perm_b32 v104, v165, v161, s60
    v_perm_b32 v105, v173, v169, s60
    v_mfma_f32_16x16x32_bf16 a[36:39], v[100:103], a[220:223], a[36:39]
    v_perm_b32 v106, v181, v177, s60
    v_mfma_f32_16x16x32_bf16 a[68:71], v[100:103], a[224:227], a[68:71]
    v_perm_b32 v107, v189, v185, s60
    s_add_u32 s72, s82, 640
    v_mfma_f32_16x16x32_bf16 a[100:103], v[100:103], a[228:231], a[100:103]
    s_and_b32 s72, s72, 0x3ff
    v_mfma_f32_16x16x32_bf16 a[132:135], v[100:103], a[232:235], a[132:135]
    s_add_u32 s72, s72, s86
    s_add_u32 m0, s89, 61440
    v_mfma_f32_16x16x32_bf16 a[164:167], v[100:103], a[236:239], a[164:167]
    buffer_load_dwordx4 v251, s[20:23], s72 offen lds
    v_mfma_f32_16x16x32_bf16 a[8:11], v[104:107], a[216:219], a[8:11]
    v_perm_b32 v108, v165, v161, s61
    v_perm_b32 v109, v173, v169, s61
    v_perm_b32 v110, v181, v177, s61
    v_mfma_f32_16x16x32_bf16 a[40:43], v[104:107], a[220:223], a[40:43]
    v_perm_b32 v111, v189, v185, s61
    s_add_u32 s72, s82, 640
    v_mfma_f32_16x16x32_bf16 a[72:75], v[104:107], a[224:227], a[72:75]
    s_and_b32 s72, s72, 0x3ff
    s_add_u32 s72, s72, s87
    v_mfma_f32_16x16x32_bf16 a[104:107], v[104:107], a[228:231], a[104:107]
    s_add_u32 m0, s90, 61440
    s_nop 0
    buffer_load_dwordx4 v252, s[20:23], s72 offen lds
    s_add_u32 s72, s82, 640
    v_mfma_f32_16x16x32_bf16 a[136:139], v[104:107], a[232:235], a[136:139]
    s_and_b32 s72, s72, 0x3ff
    s_add_u32 s72, s72, s88
    v_mfma_f32_16x16x32_bf16 a[168:171], v[104:107], a[236:239], a[168:171]
    s_add_u32 m0, s91, 61440
    s_nop 0
    buffer_load_dwordx4 v253, s[20:23], s72 offen lds
    v_mfma_f32_16x16x32_bf16 a[12:15], v[108:111], a[216:219], a[12:15]
    v_perm_b32 v96, v166, v162, s60
    v_perm_b32 v97, v174, v170, s60
    v_mfma_f32_16x16x32_bf16 a[44:47], v[108:111], a[220:223], a[44:47]
    v_perm_b32 v98, v182, v178, s60
    v_perm_b32 v99, v190, v186, s60
    v_mfma_f32_16x16x32_bf16 a[76:79], v[108:111], a[224:227], a[76:79]
    v_add_u32 v240, s81, v240
    v_mfma_f32_16x16x32_bf16 a[108:111], v[108:111], a[228:231], a[108:111]
    v_and_b32 v240, 0x3fffff, v240
    buffer_load_dwordx4 v[32:35], v240, s[32:35], 0 offen
    v_mfma_f32_16x16x32_bf16 a[140:143], v[108:111], a[232:235], a[140:143]
    buffer_load_dwordx4 v[36:39], v240, s[32:35], s52 offen
    ds_read_b128 a[192:195], v241 offset:36864
    v_mfma_f32_16x16x32_bf16 a[172:175], v[108:111], a[236:239], a[172:175]
    ds_read_b128 a[196:199], v241 offset:38912
    v_mfma_f32_16x16x32_bf16 a[16:19], v[96:99], a[216:219], a[16:19]
    v_perm_b32 v100, v166, v162, s61
    v_perm_b32 v101, v174, v170, s61
    v_mfma_f32_16x16x32_bf16 a[48:51], v[96:99], a[220:223], a[48:51]
    v_perm_b32 v102, v182, v178, s61
    v_mfma_f32_16x16x32_bf16 a[80:83], v[96:99], a[224:227], a[80:83]
    v_perm_b32 v103, v190, v186, s61
    v_mfma_f32_16x16x32_bf16 a[112:115], v[96:99], a[228:231], a[112:115]
    buffer_load_dwordx4 v[40:43], v240, s[32:35], s53 offen
    buffer_load_dwordx4 v[44:47], v240, s[32:35], s54 offen
    v_mfma_f32_16x16x32_bf16 a[144:147], v[96:99], a[232:235], a[144:147]
    ds_read_b128 a[200:203], v241 offset:40960
    v_mfma_f32_16x16x32_bf16 a[176:179], v[96:99], a[236:239], a[176:179]
    ds_read_b128 a[204:207], v241 offset:43008
    v_mfma_f32_16x16x32_bf16 a[20:23], v[100:103], a[216:219], a[20:23]
    v_perm_b32 v104, v167, v163, s60
    v_perm_b32 v105, v175, v171, s60
    v_mfma_f32_16x16x32_bf16 a[52:55], v[100:103], a[220:223], a[52:55]
    v_perm_b32 v106, v183, v179, s60
    v_mfma_f32_16x16x32_bf16 a[84:87], v[100:103], a[224:227], a[84:87]
    v_perm_b32 v107, v191, v187, s60
    v_mfma_f32_16x16x32_bf16 a[116:119], v[100:103], a[228:231], a[116:119]
    buffer_load_dwordx4 v[48:51], v240, s[32:35], s55 offen
    v_mfma_f32_16x16x32_bf16 a[148:151], v[100:103], a[232:235], a[148:151]
    ds_read_b128 a[208:211], v241 offset:45056
    v_mfma_f32_16x16x32_bf16 a[180:183], v[100:103], a[236:239], a[180:183]
    ds_read_b128 a[212:215], v241 offset:47104
    v_mfma_f32_16x16x32_bf16 a[24:27], v[104:107], a[216:219], a[24:27]
    v_perm_b32 v108, v167, v163, s61
    v_mfma_f32_16x16x32_bf16 a[56:59], v[104:107], a[220:223], a[56:59]
    v_perm_b32 v109, v175, v171, s61
    v_mfma_f32_16x16x32_bf16 a[88:91], v[104:107], a[224:227], a[88:91]
    v_perm_b32 v110, v183, v179, s61
    v_mfma_f32_16x16x32_bf16 a[120:123], v[104:107], a[228:231], a[120:123]
    v_perm_b32 v111, v191, v187, s61
    v_mfma_f32_16x16x32_bf16 a[152:155], v[104:107], a[232:235], a[152:155]
    buffer_load_dwordx4 v[52:55], v240, s[32:35], s56 offen
    v_mfma_f32_16x16x32_bf16 a[184:187], v[104:107], a[236:239], a[184:187]
    buffer_load_dwordx4 v[56:59], v240, s[32:35], s57 offen
    v_mfma_f32_16x16x32_bf16 a[28:31], v[108:111], a[216:219], a[28:31]
    s_waitcnt vmcnt(13)
    v_perm_b32 v96, v196, v192, s60
    v_mfma_f32_16x16x32_bf16 a[60:63], v[108:111], a[220:223], a[60:63]
    v_perm_b32 v97, v204, v200, s60
    v_mfma_f32_16x16x32_bf16 a[92:95], v[108:111], a[224:227], a[92:95]
    v_perm_b32 v98, v212, v208, s60
    v_perm_b32 v99, v220, v216, s60
    v_mfma_f32_16x16x32_bf16 a[124:127], v[108:111], a[228:231], a[124:127]
    buffer_load_dwordx4 v[60:63], v240, s[32:35], s58 offen
    v_mfma_f32_16x16x32_bf16 a[156:159], v[108:111], a[232:235], a[156:159]
    v_add_u32 v240, s80, v240
    v_and_b32 v240, 0x3fffff, v240
    v_mfma_f32_16x16x32_bf16 a[188:191], v[108:111], a[236:239], a[188:191]
    buffer_load_dwordx4 v[64:67], v240, s[32:35], 0 offen
    s_waitcnt lgkmcnt(0)
    v_mfma_f32_16x16x32_bf16 a[0:3], v[96:99], a[192:195], a[0:3]
    v_perm_b32 v100, v196, v192, s61
    v_mfma_f32_16x16x32_bf16 a[32:35], v[96:99], a[196:199], a[32:35]
    v_perm_b32 v101, v204, v200, s61
    v_mfma_f32_16x16x32_bf16 a[64:67], v[96:99], a[200:203], a[64:67]
    v_perm_b32 v102, v212, v208, s61
    v_mfma_f32_16x16x32_bf16 a[96:99], v[96:99], a[204:207], a[96:99]
    v_perm_b32 v103, v220, v216, s61
    v_mfma_f32_16x16x32_bf16 a[128:131], v[96:99], a[208:211], a[128:131]
    buffer_load_dwordx4 v[68:71], v240, s[32:35], s52 offen
    v_mfma_f32_16x16x32_bf16 a[160:163], v[96:99], a[212:215], a[160:163]
    buffer_load_dwordx4 v[72:75], v240, s[32:35], s53 offen
    v_mfma_f32_16x16x32_bf16 a[4:7], v[100:103], a[192:195], a[4:7]
    v_perm_b32 v104, v197, v193, s60
    v_mfma_f32_16x16x32_bf16 a[36:39], v[100:103], a[196:199], a[36:39]
    v_perm_b32 v105, v205, v201, s60
    v_mfma_f32_16x16x32_bf16 a[68:71], v[100:103], a[200:203], a[68:71]
    v_perm_b32 v106, v213, v209, s60
    v_mfma_f32_16x16x32_bf16 a[100:103], v[100:103], a[204:207], a[100:103]
    v_perm_b32 v107, v221, v217, s60
    v_mfma_f32_16x16x32_bf16 a[132:135], v[100:103], a[208:211], a[132:135]
    buffer_load_dwordx4 v[76:79], v240, s[32:35], s54 offen
    v_mfma_f32_16x16x32_bf16 a[164:167], v[100:103], a[212:215], a[164:167]
    buffer_load_dwordx4 v[80:83], v240, s[32:35], s55 offen
    v_mfma_f32_16x16x32_bf16 a[8:11], v[104:107], a[192:195], a[8:11]
    v_perm_b32 v108, v197, v193, s61
    v_mfma_f32_16x16x32_bf16 a[40:43], v[104:107], a[196:199], a[40:43]
    v_perm_b32 v109, v205, v201, s61
    v_mfma_f32_16x16x32_bf16 a[72:75], v[104:107], a[200:203], a[72:75]
    v_perm_b32 v110, v213, v209, s61
    v_mfma_f32_16x16x32_bf16 a[104:107], v[104:107], a[204:207], a[104:107]
    v_perm_b32 v111, v221, v217, s61
    v_mfma_f32_16x16x32_bf16 a[136:139], v[104:107], a[208:211], a[136:139]
    buffer_load_dwordx4 v[84:87], v240, s[32:35], s56 offen
    v_mfma_f32_16x16x32_bf16 a[168:171], v[104:107], a[212:215], a[168:171]
    v_mfma_f32_16x16x32_bf16 a[12:15], v[108:111], a[192:195], a[12:15]
    v_perm_b32 v96, v198, v194, s60
    v_perm_b32 v97, v206, v202, s60
    v_mfma_f32_16x16x32_bf16 a[44:47], v[108:111], a[196:199], a[44:47]
    v_perm_b32 v98, v214, v210, s60
    v_mfma_f32_16x16x32_bf16 a[76:79], v[108:111], a[200:203], a[76:79]
    v_perm_b32 v99, v222, v218, s60
    v_mfma_f32_16x16x32_bf16 a[108:111], v[108:111], a[204:207], a[108:111]
    buffer_load_dwordx4 v[88:91], v240, s[32:35], s57 offen
    buffer_load_dwordx4 v[92:95], v240, s[32:35], s58 offen
    v_mfma_f32_16x16x32_bf16 a[140:143], v[108:111], a[208:211], a[140:143]
    ds_read_b128 a[216:219], v242 offset:36864
    v_mfma_f32_16x16x32_bf16 a[172:175], v[108:111], a[212:215], a[172:175]
    ds_read_b128 a[220:223], v242 offset:38912
    v_mfma_f32_16x16x32_bf16 a[16:19], v[96:99], a[192:195], a[16:19]
    v_perm_b32 v100, v198, v194, s61
    v_perm_b32 v101, v206, v202, s61
    v_mfma_f32_16x16x32_bf16 a[48:51], v[96:99], a[196:199], a[48:51]
    v_perm_b32 v102, v214, v210, s61
    v_perm_b32 v103, v222, v218, s61
    v_mfma_f32_16x16x32_bf16 a[80:83], v[96:99], a[200:203], a[80:83]
    v_add_u32 v240, s81, v240
    v_mfma_f32_16x16x32_bf16 a[112:115], v[96:99], a[204:207], a[112:115]
    v_and_b32 v240, 0x3fffff, v240
    buffer_load_dwordx4 v[0:3], v240, s[32:35], 0 offen
    v_mfma_f32_16x16x32_bf16 a[144:147], v[96:99], a[208:211], a[144:147]
    buffer_load_dwordx4 v[4:7], v240, s[32:35], s52 offen
    ds_read_b128 a[224:227], v242 offset:40960
    v_mfma_f32_16x16x32_bf16 a[176:179], v[96:99], a[212:215], a[176:179]
    ds_read_b128 a[228:231], v242 offset:43008
    v_mfma_f32_16x16x32_bf16 a[20:23], v[100:103], a[192:195], a[20:23]
    v_perm_b32 v104, v199, v195, s60
    v_perm_b32 v105, v207, v203, s60
    v_mfma_f32_16x16x32_bf16 a[52:55], v[100:103], a[196:199], a[52:55]
    v_perm_b32 v106, v215, v211, s60
    v_mfma_f32_16x16x32_bf16 a[84:87], v[100:103], a[200:203], a[84:87]
    v_perm_b32 v107, v223, v219, s60
    v_mfma_f32_16x16x32_bf16 a[116:119], v[100:103], a[204:207], a[116:119]
    buffer_load_dwordx4 v[8:11], v240, s[32:35], s53 offen
    buffer_load_dwordx4 v[12:15], v240, s[32:35], s54 offen
    v_mfma_f32_16x16x32_bf16 a[148:151], v[100:103], a[208:211], a[148:151]
    ds_read_b128 a[232:235], v242 offset:45056
    v_mfma_f32_16x16x32_bf16 a[180:183], v[100:103], a[212:215], a[180:183]
    ds_read_b128 a[236:239], v242 offset:47104
    v_mfma_f32_16x16x32_bf16 a[24:27], v[104:107], a[192:195], a[24:27]
    v_perm_b32 v108, v199, v195, s61
    v_mfma_f32_16x16x32_bf16 a[56:59], v[104:107], a[196:199], a[56:59]
    v_perm_b32 v109, v207, v203, s61
    v_mfma_f32_16x16x32_bf16 a[88:91], v[104:107], a[200:203], a[88:91]
    v_perm_b32 v110, v215, v211, s61
    v_mfma_f32_16x16x32_bf16 a[120:123], v[104:107], a[204:207], a[120:123]
    v_perm_b32 v111, v223, v219, s61
    v_mfma_f32_16x16x32_bf16 a[152:155], v[104:107], a[208:211], a[152:155]
    buffer_load_dwordx4 v[16:19], v240, s[32:35], s55 offen
    v_mfma_f32_16x16x32_bf16 a[184:187], v[104:107], a[212:215], a[184:187]
    v_mfma_f32_16x16x32_bf16 a[28:31], v[108:111], a[192:195], a[28:31]
    s_waitcnt vmcnt(13)
    v_perm_b32 v96, v36, v32, s60
    v_mfma_f32_16x16x32_bf16 a[60:63], v[108:111], a[196:199], a[60:63]
    v_perm_b32 v97, v44, v40, s60
    v_mfma_f32_16x16x32_bf16 a[92:95], v[108:111], a[200:203], a[92:95]
    v_perm_b32 v98, v52, v48, s60
    v_mfma_f32_16x16x32_bf16 a[124:127], v[108:111], a[204:207], a[124:127]
    v_perm_b32 v99, v60, v56, s60
    v_mfma_f32_16x16x32_bf16 a[156:159], v[108:111], a[208:211], a[156:159]
    buffer_load_dwordx4 v[20:23], v240, s[32:35], s56 offen
    v_mfma_f32_16x16x32_bf16 a[188:191], v[108:111], a[212:215], a[188:191]
    buffer_load_dwordx4 v[24:27], v240, s[32:35], s57 offen
    s_waitcnt lgkmcnt(0)
    v_mfma_f32_16x16x32_bf16 a[0:3], v[96:99], a[216:219], a[0:3]
    v_perm_b32 v100, v36, v32, s61
    v_mfma_f32_16x16x32_bf16 a[32:35], v[96:99], a[220:223], a[32:35]
    v_perm_b32 v101, v44, v40, s61
    v_mfma_f32_16x16x32_bf16 a[64:67], v[96:99], a[224:227], a[64:67]
    v_perm_b32 v102, v52, v48, s61
    v_mfma_f32_16x16x32_bf16 a[96:99], v[96:99], a[228:231], a[96:99]
    v_perm_b32 v103, v60, v56, s61
    v_mfma_f32_16x16x32_bf16 a[128:131], v[96:99], a[232:235], a[128:131]
    buffer_load_dwordx4 v[28:31], v240, s[32:35], s58 offen
    v_mfma_f32_16x16x32_bf16 a[160:163], v[96:99], a[236:239], a[160:163]
    v_mfma_f32_16x16x32_bf16 a[4:7], v[100:103], a[216:219], a[4:7]
    v_perm_b32 v104, v37, v33, s60
    v_perm_b32 v105, v45, v41, s60
    v_mfma_f32_16x16x32_bf16 a[36:39], v[100:103], a[220:223], a[36:39]
    v_perm_b32 v106, v53, v49, s60
    v_mfma_f32_16x16x32_bf16 a[68:71], v[100:103], a[224:227], a[68:71]
    v_perm_b32 v107, v61, v57, s60
    v_mfma_f32_16x16x32_bf16 a[100:103], v[100:103], a[228:231], a[100:103]
    s_add_u32 s73, s62, 8192
    v_mfma_f32_16x16x32_bf16 a[132:135], v[100:103], a[232:235], a[132:135]
    s_add_u32 m0, s92, 8192
    v_mfma_f32_16x16x32_bf16 a[164:167], v[100:103], a[236:239], a[164:167]
    buffer_load_dwordx4 v113, s[24:27], s73 offen nt lds
    v_mfma_f32_16x16x32_bf16 a[8:11], v[104:107], a[216:219], a[8:11]
    v_perm_b32 v108, v37, v33, s61
    v_perm_b32 v109, v45, v41, s61
    v_mfma_f32_16x16x32_bf16 a[40:43], v[104:107], a[220:223], a[40:43]
    v_perm_b32 v110, v53, v49, s61
    v_mfma_f32_16x16x32_bf16 a[72:75], v[104:107], a[224:227], a[72:75]
    v_perm_b32 v111, v61, v57, s61
    v_mfma_f32_16x16x32_bf16 a[104:107], v[104:107], a[228:231], a[104:107]
    s_add_u32 s73, s62, 9216
    v_mfma_f32_16x16x32_bf16 a[136:139], v[104:107], a[232:235], a[136:139]
    s_add_u32 m0, s92, 9216
    v_mfma_f32_16x16x32_bf16 a[168:171], v[104:107], a[236:239], a[168:171]
    buffer_load_dwordx4 v114, s[24:27], s73 offen nt lds
    v_mfma_f32_16x16x32_bf16 a[12:15], v[108:111], a[216:219], a[12:15]
    v_perm_b32 v96, v38, v34, s60
    v_perm_b32 v97, v46, v42, s60
    v_mfma_f32_16x16x32_bf16 a[44:47], v[108:111], a[220:223], a[44:47]
    v_perm_b32 v98, v54, v50, s60
    v_perm_b32 v99, v62, v58, s60
    v_mfma_f32_16x16x32_bf16 a[76:79], v[108:111], a[224:227], a[76:79]
    s_add_u32 s73, s62, 10240
    s_add_u32 m0, s92, 10240
    v_mfma_f32_16x16x32_bf16 a[108:111], v[108:111], a[228:231], a[108:111]
    buffer_load_dwordx4 v115, s[24:27], s73 offen nt lds
    v_mfma_f32_16x16x32_bf16 a[140:143], v[108:111], a[232:235], a[140:143]
    s_barrier
    ds_read_b128 a[192:195], v243 offset:0
    v_mfma_f32_16x16x32_bf16 a[172:175], v[108:111], a[236:239], a[172:175]
    ds_read_b128 a[196:199], v243 offset:2048
    v_mfma_f32_16x16x32_bf16 a[16:19], v[96:99], a[216:219], a[16:19]
    v_perm_b32 v100, v38, v34, s61
    v_perm_b32 v101, v46, v42, s61
    v_mfma_f32_16x16x32_bf16 a[48:51], v[96:99], a[220:223], a[48:51]
    v_perm_b32 v102, v54, v50, s61
    v_mfma_f32_16x16x32_bf16 a[80:83], v[96:99], a[224:227], a[80:83]
    v_perm_b32 v103, v62, v58, s61
    s_add_u32 s73, s62, 11264
    v_mfma_f32_16x16x32_bf16 a[112:115], v[96:99], a[228:231], a[112:115]
    s_add_u32 m0, s92, 11264
    v_mfma_f32_16x16x32_bf16 a[144:147], v[96:99], a[232:235], a[144:147]
    buffer_load_dwordx4 v116, s[24:27], s73 offen nt lds
    ds_read_b128 a[200:203], v243 offset:4096
    v_mfma_f32_16x16x32_bf16 a[176:179], v[96:99], a[236:239], a[176:179]
    ds_read_b128 a[204:207], v243 offset:6144
    v_mfma_f32_16x16x32_bf16 a[20:23], v[100:103], a[216:219], a[20:23]
    v_perm_b32 v104, v39, v35, s60
    v_perm_b32 v105, v47, v43, s60
    v_mfma_f32_16x16x32_bf16 a[52:55], v[100:103], a[220:223], a[52:55]
    v_perm_b32 v106, v55, v51, s60
    v_mfma_f32_16x16x32_bf16 a[84:87], v[100:103], a[224:227], a[84:87]
    v_perm_b32 v107, v63, v59, s60
    s_add_u32 s73, s62, 12288
    v_mfma_f32_16x16x32_bf16 a[116:119], v[100:103], a[228:231], a[116:119]
    s_add_u32 m0, s92, 12288
    v_mfma_f32_16x16x32_bf16 a[148:151], v[100:103], a[232:235], a[148:151]
    buffer_load_dwordx4 v113, s[24:27], s73 offen nt lds
    ds_read_b128 a[208:211], v243 offset:8192
    v_mfma_f32_16x16x32_bf16 a[180:183], v[100:103], a[236:239], a[180:183]
    ds_read_b128 a[212:215], v243 offset:10240
    v_mfma_f32_16x16x32_bf16 a[24:27], v[104:107], a[216:219], a[24:27]
    v_perm_b32 v108, v39, v35, s61
    v_perm_b32 v109, v47, v43, s61
    v_mfma_f32_16x16x32_bf16 a[56:59], v[104:107], a[220:223], a[56:59]
    v_perm_b32 v110, v55, v51, s61
    v_mfma_f32_16x16x32_bf16 a[88:91], v[104:107], a[224:227], a[88:91]
    v_perm_b32 v111, v63, v59, s61
    v_mfma_f32_16x16x32_bf16 a[120:123], v[104:107], a[228:231], a[120:123]
    s_add_u32 s73, s62, 13312
    v_mfma_f32_16x16x32_bf16 a[152:155], v[104:107], a[232:235], a[152:155]
    s_add_u32 m0, s92, 13312
    v_mfma_f32_16x16x32_bf16 a[184:187], v[104:107], a[236:239], a[184:187]
    buffer_load_dwordx4 v114, s[24:27], s73 offen nt lds
    v_mfma_f32_16x16x32_bf16 a[28:31], v[108:111], a[216:219], a[28:31]
    s_waitcnt vmcnt(14)
    v_mfma_f32_16x16x32_bf16 a[60:63], v[108:111], a[220:223], a[60:63]
    v_perm_b32 v96, v68, v64, s60
    v_mfma_f32_16x16x32_bf16 a[92:95], v[108:111], a[224:227], a[92:95]
    v_perm_b32 v97, v76, v72, s60
    v_mfma_f32_16x16x32_bf16 a[124:127], v[108:111], a[228:231], a[124:127]
    v_perm_b32 v98, v84, v80, s60
    v_mfma_f32_16x16x32_bf16 a[156:159], v[108:111], a[232:235], a[156:159]
    v_perm_b32 v99, v92, v88, s60
    v_mfma_f32_16x16x32_bf16 a[188:191], v[108:111], a[236:239], a[188:191]
    s_waitcnt lgkmcnt(0)
    v_mfma_f32_16x16x32_bf16 a[0:3], v[96:99], a[192:195], a[0:3]
    v_perm_b32 v100, v68, v64, s61
    v_perm_b32 v101, v76, v72, s61
    v_mfma_f32_16x16x32_bf16 a[32:35], v[96:99], a[196:199], a[32:35]
    v_perm_b32 v102, v84, v80, s61
    v_mfma_f32_16x16x32_bf16 a[64:67], v[96:99], a[200:203], a[64:67]
    v_perm_b32 v103, v92, v88, s61
    v_mfma_f32_16x16x32_bf16 a[96:99], v[96:99], a[204:207], a[96:99]
    s_add_u32 s73, s62, 14336
    v_mfma_f32_16x16x32_bf16 a[128:131], v[96:99], a[208:211], a[128:131]
    s_add_u32 m0, s92, 14336
    v_mfma_f32_16x16x32_bf16 a[160:163], v[96:99], a[212:215], a[160:163]
    buffer_load_dwordx4 v115, s[24:27], s73 offen nt lds
    v_mfma_f32_16x16x32_bf16 a[4:7], v[100:103], a[192:195], a[4:7]
    v_perm_b32 v104, v69, v65, s60
    v_perm_b32 v105, v77, v73, s60
    v_mfma_f32_16x16x32_bf16 a[36:39], v[100:103], a[196:199], a[36:39]
    v_perm_b32 v106, v85, v81, s60
    v_mfma_f32_16x16x32_bf16 a[68:71], v[100:103], a[200:203], a[68:71]
    v_perm_b32 v107, v93, v89, s60
    v_mfma_f32_16x16x32_bf16 a[100:103], v[100:103], a[204:207], a[100:103]
    s_add_u32 s73, s62, 15360
    v_mfma_f32_16x16x32_bf16 a[132:135], v[100:103], a[208:211], a[132:135]
    s_add_u32 m0, s92, 15360
    v_mfma_f32_16x16x32_bf16 a[164:167], v[100:103], a[212:215], a[164:167]
    buffer_load_dwordx4 v116, s[24:27], s73 offen nt lds
    v_mfma_f32_16x16x32_bf16 a[8:11], v[104:107], a[192:195], a[8:11]
    v_perm_b32 v108, v69, v65, s61
    v_perm_b32 v109, v77, v73, s61
    v_mfma_f32_16x16x32_bf16 a[40:43], v[104:107], a[196:199], a[40:43]
    v_perm_b32 v110, v85, v81, s61
    v_mfma_f32_16x16x32_bf16 a[72:75], v[104:107], a[200:203], a[72:75]
    v_perm_b32 v111, v93, v89, s61
    v_mfma_f32_16x16x32_bf16 a[104:107], v[104:107], a[204:207], a[104:107]
    v_add_u32 v240, s80, v240
    v_and_b32 v240, 0x3fffff, v240
    v_mfma_f32_16x16x32_bf16 a[136:139], v[104:107], a[208:211], a[136:139]
    buffer_load_dwordx4 v[128:131], v240, s[32:35], 0 offen
    v_mfma_f32_16x16x32_bf16 a[168:171], v[104:107], a[212:215], a[168:171]
    buffer_load_dwordx4 v[132:135], v240, s[32:35], s52 offen
    v_mfma_f32_16x16x32_bf16 a[12:15], v[108:111], a[192:195], a[12:15]
    v_perm_b32 v96, v70, v66, s60
    v_perm_b32 v97, v78, v74, s60
    v_mfma_f32_16x16x32_bf16 a[44:47], v[108:111], a[196:199], a[44:47]
    v_perm_b32 v98, v86, v82, s60
    v_mfma_f32_16x16x32_bf16 a[76:79], v[108:111], a[200:203], a[76:79]
    v_perm_b32 v99, v94, v90, s60
    v_mfma_f32_16x16x32_bf16 a[108:111], v[108:111], a[204:207], a[108:111]
    buffer_load_dwordx4 v[136:139], v240, s[32:35], s53 offen
    buffer_load_dwordx4 v[140:143], v240, s[32:35], s54 offen
    v_mfma_f32_16x16x32_bf16 a[140:143], v[108:111], a[208:211], a[140:143]
    ds_read_b128 a[216:219], v244 offset:0
    v_mfma_f32_16x16x32_bf16 a[172:175], v[108:111], a[212:215], a[172:175]
    ds_read_b128 a[220:223], v244 offset:2048
    v_mfma_f32_16x16x32_bf16 a[16:19], v[96:99], a[192:195], a[16:19]
    v_perm_b32 v100, v70, v66, s61
    v_perm_b32 v101, v78, v74, s61
    v_mfma_f32_16x16x32_bf16 a[48:51], v[96:99], a[196:199], a[48:51]
    v_perm_b32 v102, v86, v82, s61
    v_mfma_f32_16x16x32_bf16 a[80:83], v[96:99], a[200:203], a[80:83]
    v_perm_b32 v103, v94, v90, s61
    v_mfma_f32_16x16x32_bf16 a[112:115], v[96:99], a[204:207], a[112:115]
    buffer_load_dwordx4 v[144:147], v240, s[32:35], s55 offen
    buffer_load_dwordx4 v[148:151], v240, s[32:35], s56 offen
    v_mfma_f32_16x16x32_bf16 a[144:147], v[96:99], a[208:211], a[144:147]
    ds_read_b128 a[224:227], v244 offset:4096
    v_mfma_f32_16x16x32_bf16 a[176:179], v[96:99], a[212:215], a[176:179]
    ds_read_b128 a[228:231], v244 offset:6144
    v_mfma_f32_16x16x32_bf16 a[20:23], v[100:103], a[192:195], a[20:23]
    v_perm_b32 v104, v71, v67, s60
    v_perm_b32 v105, v79, v75, s60
    v_mfma_f32_16x16x32_bf16 a[52:55], v[100:103], a[196:199], a[52:55]
    v_perm_b32 v106, v87, v83, s60
    v_mfma_f32_16x16x32_bf16 a[84:87], v[100:103], a[200:203], a[84:87]
    v_perm_b32 v107, v95, v91, s60
    v_mfma_f32_16x16x32_bf16 a[116:119], v[100:103], a[204:207], a[116:119]
    buffer_load_dwordx4 v[152:155], v240, s[32:35], s57 offen
    v_mfma_f32_16x16x32_bf16 a[148:151], v[100:103], a[208:211], a[148:151]
    ds_read_b128 a[232:235], v244 offset:8192
    v_mfma_f32_16x16x32_bf16 a[180:183], v[100:103], a[212:215], a[180:183]
    ds_read_b128 a[236:239], v244 offset:10240
    v_mfma_f32_16x16x32_bf16 a[24:27], v[104:107], a[192:195], a[24:27]
    v_perm_b32 v108, v71, v67, s61
    v_perm_b32 v109, v79, v75, s61
    v_mfma_f32_16x16x32_bf16 a[56:59], v[104:107], a[196:199], a[56:59]
    v_perm_b32 v110, v87, v83, s61
    v_perm_b32 v111, v95, v91, s61
    v_mfma_f32_16x16x32_bf16 a[88:91], v[104:107], a[200:203], a[88:91]
    buffer_load_dwordx4 v[156:159], v240, s[32:35], s58 offen
    v_mfma_f32_16x16x32_bf16 a[120:123], v[104:107], a[204:207], a[120:123]
    s_add_u32 s72, s82, 768
    s_and_b32 s72, s72, 0x3ff
    v_mfma_f32_16x16x32_bf16 a[152:155], v[104:107], a[208:211], a[152:155]
    s_add_u32 s72, s72, s86
    s_add_u32 m0, s89, 73728
    v_mfma_f32_16x16x32_bf16 a[184:187], v[104:107], a[212:215], a[184:187]
    buffer_load_dwordx4 v251, s[20:23], s72 offen lds
    v_mfma_f32_16x16x32_bf16 a[28:31], v[108:111], a[192:195], a[28:31]
    s_waitcnt vmcnt(17)
    v_perm_b32 v96, v4, v0, s60
    v_perm_b32 v97, v12, v8, s60
    v_mfma_f32_16x16x32_bf16 a[60:63], v[108:111], a[196:199], a[60:63]
    v_perm_b32 v98, v20, v16, s60
    v_perm_b32 v99, v28, v24, s60
    v_mfma_f32_16x16x32_bf16 a[92:95], v[108:111], a[200:203], a[92:95]
    s_add_u32 s72, s82, 768
    s_and_b32 s72, s72, 0x3ff
    s_add_u32 s72, s72, s87
    v_mfma_f32_16x16x32_bf16 a[124:127], v[108:111], a[204:207], a[124:127]
    s_add_u32 m0, s90, 73728
    s_nop 0
    buffer_load_dwordx4 v252, s[20:23], s72 offen lds
    v_mfma_f32_16x16x32_bf16 a[156:159], v[108:111], a[208:211], a[156:159]
    s_add_u32 s72, s82, 768
    s_and_b32 s72, s72, 0x3ff
    s_add_u32 s72, s72, s88
    v_mfma_f32_16x16x32_bf16 a[188:191], v[108:111], a[212:215], a[188:191]
    s_add_u32 m0, s91, 73728
    s_nop 0
    buffer_load_dwordx4 v253, s[20:23], s72 offen lds
    s_waitcnt lgkmcnt(0)
    v_mfma_f32_16x16x32_bf16 a[0:3], v[96:99], a[216:219], a[0:3]
    v_perm_b32 v100, v4, v0, s61
    v_perm_b32 v101, v12, v8, s61
    v_perm_b32 v102, v20, v16, s61
    v_mfma_f32_16x16x32_bf16 a[32:35], v[96:99], a[220:223], a[32:35]
    v_perm_b32 v103, v28, v24, s61
    s_add_u32 s72, s82, 896
    v_mfma_f32_16x16x32_bf16 a[64:67], v[96:99], a[224:227], a[64:67]
    s_and_b32 s72, s72, 0x3ff
    s_add_u32 s72, s72, s86
    v_mfma_f32_16x16x32_bf16 a[96:99], v[96:99], a[228:231], a[96:99]
    s_add_u32 m0, s89, 86016
    s_nop 0
    buffer_load_dwordx4 v251, s[20:23], s72 offen lds
    s_add_u32 s72, s82, 896
    v_mfma_f32_16x16x32_bf16 a[128:131], v[96:99], a[232:235], a[128:131]
    s_and_b32 s72, s72, 0x3ff
    s_add_u32 s72, s72, s87
    v_mfma_f32_16x16x32_bf16 a[160:163], v[96:99], a[236:239], a[160:163]
    s_add_u32 m0, s90, 86016
    s_nop 0
    buffer_load_dwordx4 v252, s[20:23], s72 offen lds
    v_mfma_f32_16x16x32_bf16 a[4:7], v[100:103], a[216:219], a[4:7]
    v_perm_b32 v104, v5, v1, s60
    v_perm_b32 v105, v13, v9, s60
    v_mfma_f32_16x16x32_bf16 a[36:39], v[100:103], a[220:223], a[36:39]
    v_perm_b32 v106, v21, v17, s60
    v_mfma_f32_16x16x32_bf16 a[68:71], v[100:103], a[224:227], a[68:71]
    v_perm_b32 v107, v29, v25, s60
    s_add_u32 s72, s82, 896
    v_mfma_f32_16x16x32_bf16 a[100:103], v[100:103], a[228:231], a[100:103]
    s_and_b32 s72, s72, 0x3ff
    v_mfma_f32_16x16x32_bf16 a[132:135], v[100:103], a[232:235], a[132:135]
    s_add_u32 s72, s72, s88
    s_add_u32 m0, s91, 86016
    v_mfma_f32_16x16x32_bf16 a[164:167], v[100:103], a[236:239], a[164:167]
    buffer_load_dwordx4 v253, s[20:23], s72 offen lds
    v_mfma_f32_16x16x32_bf16 a[8:11], v[104:107], a[216:219], a[8:11]
    v_perm_b32 v108, v5, v1, s61
    v_perm_b32 v109, v13, v9, s61
    v_mfma_f32_16x16x32_bf16 a[40:43], v[104:107], a[220:223], a[40:43]
    v_perm_b32 v110, v21, v17, s61
    v_mfma_f32_16x16x32_bf16 a[72:75], v[104:107], a[224:227], a[72:75]
    v_perm_b32 v111, v29, v25, s61
    v_mfma_f32_16x16x32_bf16 a[104:107], v[104:107], a[228:231], a[104:107]
    v_add_u32 v240, s81, v240
    v_and_b32 v240, 0x3fffff, v240
    v_mfma_f32_16x16x32_bf16 a[136:139], v[104:107], a[232:235], a[136:139]
    buffer_load_dwordx4 v[160:163], v240, s[32:35], 0 offen
    v_mfma_f32_16x16x32_bf16 a[168:171], v[104:107], a[236:239], a[168:171]
    buffer_load_dwordx4 v[164:167], v240, s[32:35], s52 offen
    v_mfma_f32_16x16x32_bf16 a[12:15], v[108:111], a[216:219], a[12:15]
    v_perm_b32 v96, v6, v2, s60
    v_perm_b32 v97, v14, v10, s60
    v_mfma_f32_16x16x32_bf16 a[44:47], v[108:111], a[220:223], a[44:47]
    v_perm_b32 v98, v22, v18, s60
    v_mfma_f32_16x16x32_bf16 a[76:79], v[108:111], a[224:227], a[76:79]
    v_perm_b32 v99, v30, v26, s60
    v_mfma_f32_16x16x32_bf16 a[108:111], v[108:111], a[228:231], a[108:111]
    buffer_load_dwordx4 v[168:171], v240, s[32:35], s53 offen
    buffer_load_dwordx4 v[172:175], v240, s[32:35], s54 offen
    v_mfma_f32_16x16x32_bf16 a[140:143], v[108:111], a[232:235], a[140:143]
    ds_read_b128 a[192:195], v243 offset:12288
    v_mfma_f32_16x16x32_bf16 a[172:175], v[108:111], a[236:239], a[172:175]
    ds_read_b128 a[196:199], v243 offset:14336
    v_mfma_f32_16x16x32_bf16 a[16:19], v[96:99], a[216:219], a[16:19]
    v_perm_b32 v100, v6, v2, s61
    v_perm_b32 v101, v14, v10, s61
    v_mfma_f32_16x16x32_bf16 a[48:51], v[96:99], a[220:223], a[48:51]
    v_perm_b32 v102, v22, v18, s61
    v_mfma_f32_16x16x32_bf16 a[80:83], v[96:99], a[224:227], a[80:83]
    v_perm_b32 v103, v30, v26, s61
    v_mfma_f32_16x16x32_bf16 a[112:115], v[96:99], a[228:231], a[112:115]
    buffer_load_dwordx4 v[176:179], v240, s[32:35], s55 offen
    buffer_load_dwordx4 v[180:183], v240, s[32:35], s56 offen
    v_mfma_f32_16x16x32_bf16 a[144:147], v[96:99], a[232:235], a[144:147]
    ds_read_b128 a[200:203], v243 offset:16384
    v_mfma_f32_16x16x32_bf16 a[176:179], v[96:99], a[236:239], a[176:179]
    ds_read_b128 a[204:207], v243 offset:18432
    v_mfma_f32_16x16x32_bf16 a[20:23], v[100:103], a[216:219], a[20:23]
    v_perm_b32 v104, v7, v3, s60
    v_perm_b32 v105, v15, v11, s60
    v_mfma_f32_16x16x32_bf16 a[52:55], v[100:103], a[220:223], a[52:55]
    v_perm_b32 v106, v23, v19, s60
    v_mfma_f32_16x16x32_bf16 a[84:87], v[100:103], a[224:227], a[84:87]
    v_perm_b32 v107, v31, v27, s60
    v_mfma_f32_16x16x32_bf16 a[116:119], v[100:103], a[228:231], a[116:119]
    buffer_load_dwordx4 v[184:187], v240, s[32:35], s57 offen
    v_mfma_f32_16x16x32_bf16 a[148:151], v[100:103], a[232:235], a[148:151]
    ds_read_b128 a[208:211], v243 offset:20480
    v_mfma_f32_16x16x32_bf16 a[180:183], v[100:103], a[236:239], a[180:183]
    ds_read_b128 a[212:215], v243 offset:22528
    v_mfma_f32_16x16x32_bf16 a[24:27], v[104:107], a[216:219], a[24:27]
    v_perm_b32 v108, v7, v3, s61
    v_perm_b32 v109, v15, v11, s61
    v_mfma_f32_16x16x32_bf16 a[56:59], v[104:107], a[220:223], a[56:59]
    v_perm_b32 v110, v23, v19, s61
    v_mfma_f32_16x16x32_bf16 a[88:91], v[104:107], a[224:227], a[88:91]
    v_perm_b32 v111, v31, v27, s61
    v_mfma_f32_16x16x32_bf16 a[120:123], v[104:107], a[228:231], a[120:123]
    buffer_load_dwordx4 v[188:191], v240, s[32:35], s58 offen
    v_add_u32 v240, s80, v240
    v_mfma_f32_16x16x32_bf16 a[152:155], v[104:107], a[232:235], a[152:155]
    v_and_b32 v240, 0x3fffff, v240
    v_mfma_f32_16x16x32_bf16 a[184:187], v[104:107], a[236:239], a[184:187]
    buffer_load_dwordx4 v[192:195], v240, s[32:35], 0 offen
    v_mfma_f32_16x16x32_bf16 a[28:31], v[108:111], a[216:219], a[28:31]
    s_waitcnt vmcnt(15)
    v_perm_b32 v96, v132, v128, s60
    v_mfma_f32_16x16x32_bf16 a[60:63], v[108:111], a[220:223], a[60:63]
    v_perm_b32 v97, v140, v136, s60
    v_mfma_f32_16x16x32_bf16 a[92:95], v[108:111], a[224:227], a[92:95]
    v_perm_b32 v98, v148, v144, s60
    v_mfma_f32_16x16x32_bf16 a[124:127], v[108:111], a[228:231], a[124:127]
    v_perm_b32 v99, v156, v152, s60
    v_mfma_f32_16x16x32_bf16 a[156:159], v[108:111], a[232:235], a[156:159]
    buffer_load_dwordx4 v[196:199], v240, s[32:35], s52 offen
    v_mfma_f32_16x16x32_bf16 a[188:191], v[108:111], a[236:239], a[188:191]
    buffer_load_dwordx4 v[200:203], v240, s[32:35], s53 offen
    s_waitcnt lgkmcnt(0)
    v_mfma_f32_16x16x32_bf16 a[0:3], v[96:99], a[192:195], a[0:3]
    v_perm_b32 v100, v132, v128, s61
    v_mfma_f32_16x16x32_bf16 a[32:35], v[96:99], a[196:199], a[32:35]
    v_perm_b32 v101, v140, v136, s61
    v_mfma_f32_16x16x32_bf16 a[64:67], v[96:99], a[200:203], a[64:67]
    v_perm_b32 v102, v148, v144, s61
    v_mfma_f32_16x16x32_bf16 a[96:99], v[96:99], a[204:207], a[96:99]
    v_perm_b32 v103, v156, v152, s61
    v_mfma_f32_16x16x32_bf16 a[128:131], v[96:99], a[208:211], a[128:131]
    buffer_load_dwordx4 v[204:207], v240, s[32:35], s54 offen
    v_mfma_f32_16x16x32_bf16 a[160:163], v[96:99], a[212:215], a[160:163]
    buffer_load_dwordx4 v[208:211], v240, s[32:35], s55 offen
    v_mfma_f32_16x16x32_bf16 a[4:7], v[100:103], a[192:195], a[4:7]
    v_perm_b32 v104, v133, v129, s60
    v_mfma_f32_16x16x32_bf16 a[36:39], v[100:103], a[196:199], a[36:39]
    v_perm_b32 v105, v141, v137, s60
    v_mfma_f32_16x16x32_bf16 a[68:71], v[100:103], a[200:203], a[68:71]
    v_perm_b32 v106, v149, v145, s60
    v_mfma_f32_16x16x32_bf16 a[100:103], v[100:103], a[204:207], a[100:103]
    v_perm_b32 v107, v157, v153, s60
    v_mfma_f32_16x16x32_bf16 a[132:135], v[100:103], a[208:211], a[132:135]
    buffer_load_dwordx4 v[212:215], v240, s[32:35], s56 offen
    v_mfma_f32_16x16x32_bf16 a[164:167], v[100:103], a[212:215], a[164:167]
    v_mfma_f32_16x16x32_bf16 a[8:11], v[104:107], a[192:195], a[8:11]
    v_perm_b32 v108, v133, v129, s61
    v_mfma_f32_16x16x32_bf16 a[40:43], v[104:107], a[196:199], a[40:43]
    v_perm_b32 v109, v141, v137, s61
    v_mfma_f32_16x16x32_bf16 a[72:75], v[104:107], a[200:203], a[72:75]
    v_perm_b32 v110, v149, v145, s61
    v_mfma_f32_16x16x32_bf16 a[104:107], v[104:107], a[204:207], a[104:107]
    v_perm_b32 v111, v157, v153, s61
    v_mfma_f32_16x16x32_bf16 a[136:139], v[104:107], a[208:211], a[136:139]
    buffer_load_dwordx4 v[216:219], v240, s[32:35], s57 offen
    v_mfma_f32_16x16x32_bf16 a[168:171], v[104:107], a[212:215], a[168:171]
    buffer_load_dwordx4 v[220:223], v240, s[32:35], s58 offen
    v_mfma_f32_16x16x32_bf16 a[12:15], v[108:111], a[192:195], a[12:15]
    v_perm_b32 v96, v134, v130, s60
    v_perm_b32 v97, v142, v138, s60
    v_mfma_f32_16x16x32_bf16 a[44:47], v[108:111], a[196:199], a[44:47]
    v_perm_b32 v98, v150, v146, s60
    v_perm_b32 v99, v158, v154, s60
    v_mfma_f32_16x16x32_bf16 a[76:79], v[108:111], a[200:203], a[76:79]
    v_add_u32 v240, s81, v240
    v_mfma_f32_16x16x32_bf16 a[108:111], v[108:111], a[204:207], a[108:111]
    v_and_b32 v240, 0x3fffff, v240
    buffer_load_dwordx4 v[32:35], v240, s[32:35], 0 offen
    v_mfma_f32_16x16x32_bf16 a[140:143], v[108:111], a[208:211], a[140:143]
    buffer_load_dwordx4 v[36:39], v240, s[32:35], s52 offen
    ds_read_b128 a[216:219], v244 offset:12288
    v_mfma_f32_16x16x32_bf16 a[172:175], v[108:111], a[212:215], a[172:175]
    ds_read_b128 a[220:223], v244 offset:14336
    v_mfma_f32_16x16x32_bf16 a[16:19], v[96:99], a[192:195], a[16:19]
    v_perm_b32 v100, v134, v130, s61
    v_perm_b32 v101, v142, v138, s61
    v_mfma_f32_16x16x32_bf16 a[48:51], v[96:99], a[196:199], a[48:51]
    v_perm_b32 v102, v150, v146, s61
    v_mfma_f32_16x16x32_bf16 a[80:83], v[96:99], a[200:203], a[80:83]
    v_perm_b32 v103, v158, v154, s61
    v_mfma_f32_16x16x32_bf16 a[112:115], v[96:99], a[204:207], a[112:115]
    buffer_load_dwordx4 v[40:43], v240, s[32:35], s53 offen
    buffer_load_dwordx4 v[44:47], v240, s[32:35], s54 offen
    v_mfma_f32_16x16x32_bf16 a[144:147], v[96:99], a[208:211], a[144:147]
    ds_read_b128 a[224:227], v244 offset:16384
    v_mfma_f32_16x16x32_bf16 a[176:179], v[96:99], a[212:215], a[176:179]
    ds_read_b128 a[228:231], v244 offset:18432
    v_mfma_f32_16x16x32_bf16 a[20:23], v[100:103], a[192:195], a[20:23]
    v_perm_b32 v104, v135, v131, s60
    v_perm_b32 v105, v143, v139, s60
    v_mfma_f32_16x16x32_bf16 a[52:55], v[100:103], a[196:199], a[52:55]
    v_perm_b32 v106, v151, v147, s60
    v_mfma_f32_16x16x32_bf16 a[84:87], v[100:103], a[200:203], a[84:87]
    v_perm_b32 v107, v159, v155, s60
    v_mfma_f32_16x16x32_bf16 a[116:119], v[100:103], a[204:207], a[116:119]
    buffer_load_dwordx4 v[48:51], v240, s[32:35], s55 offen
    buffer_load_dwordx4 v[52:55], v240, s[32:35], s56 offen
    v_mfma_f32_16x16x32_bf16 a[148:151], v[100:103], a[208:211], a[148:151]
    ds_read_b128 a[232:235], v244 offset:20480
    v_mfma_f32_16x16x32_bf16 a[180:183], v[100:103], a[212:215], a[180:183]
    ds_read_b128 a[236:239], v244 offset:22528
    v_mfma_f32_16x16x32_bf16 a[24:27], v[104:107], a[192:195], a[24:27]
    v_perm_b32 v108, v135, v131, s61
    v_mfma_f32_16x16x32_bf16 a[56:59], v[104:107], a[196:199], a[56:59]
    v_perm_b32 v109, v143, v139, s61
    v_mfma_f32_16x16x32_bf16 a[88:91], v[104:107], a[200:203], a[88:91]
    v_perm_b32 v110, v151, v147, s61
    v_mfma_f32_16x16x32_bf16 a[120:123], v[104:107], a[204:207], a[120:123]
    v_perm_b32 v111, v159, v155, s61
    v_mfma_f32_16x16x32_bf16 a[152:155], v[104:107], a[208:211], a[152:155]
    buffer_load_dwordx4 v[56:59], v240, s[32:35], s57 offen
    v_mfma_f32_16x16x32_bf16 a[184:187], v[104:107], a[212:215], a[184:187]
    v_mfma_f32_16x16x32_bf16 a[28:31], v[108:111], a[192:195], a[28:31]
    s_waitcnt vmcnt(15)
    v_mfma_f32_16x16x32_bf16 a[60:63], v[108:111], a[196:199], a[60:63]
    v_perm_b32 v96, v164, v160, s60
    v_mfma_f32_16x16x32_bf16 a[92:95], v[108:111], a[200:203], a[92:95]
    v_perm_b32 v97, v172, v168, s60
    v_mfma_f32_16x16x32_bf16 a[124:127], v[108:111], a[204:207], a[124:127]
    v_perm_b32 v98, v180, v176, s60
    v_mfma_f32_16x16x32_bf16 a[156:159], v[108:111], a[208:211], a[156:159]
    v_perm_b32 v99, v188, v184, s60
    v_mfma_f32_16x16x32_bf16 a[188:191], v[108:111], a[212:215], a[188:191]
    buffer_load_dwordx4 v[60:63], v240, s[32:35], s58 offen
    s_waitcnt lgkmcnt(0)
    v_mfma_f32_16x16x32_bf16 a[0:3], v[96:99], a[216:219], a[0:3]
    v_perm_b32 v100, v164, v160, s61
    v_perm_b32 v101, v172, v168, s61
    v_mfma_f32_16x16x32_bf16 a[32:35], v[96:99], a[220:223], a[32:35]
    v_perm_b32 v102, v180, v176, s61
    v_perm_b32 v103, v188, v184, s61
    v_mfma_f32_16x16x32_bf16 a[64:67], v[96:99], a[224:227], a[64:67]
    s_add_u32 s73, s62, 16384
    s_add_u32 m0, s4, 0
    v_mfma_f32_16x16x32_bf16 a[96:99], v[96:99], a[228:231], a[96:99]
    buffer_load_dwordx4 v113, s[24:27], s73 offen nt lds
    v_mfma_f32_16x16x32_bf16 a[128:131], v[96:99], a[232:235], a[128:131]
    ds_read_b128 v[128:131], v117 offset:0
    v_mfma_f32_16x16x32_bf16 a[160:163], v[96:99], a[236:239], a[160:163]
    ds_read_b128 v[132:135], v118 offset:0
    ds_read_b128 v[136:139], v119 offset:0
    v_mfma_f32_16x16x32_bf16 a[4:7], v[100:103], a[216:219], a[4:7]
    v_perm_b32 v104, v165, v161, s60
    v_perm_b32 v105, v173, v169, s60
    v_mfma_f32_16x16x32_bf16 a[36:39], v[100:103], a[220:223], a[36:39]
    v_perm_b32 v106, v181, v177, s60
    v_perm_b32 v107, v189, v185, s60
    v_mfma_f32_16x16x32_bf16 a[68:71], v[100:103], a[224:227], a[68:71]
    s_add_u32 s73, s62, 17408
    v_mfma_f32_16x16x32_bf16 a[100:103], v[100:103], a[228:231], a[100:103]
    s_add_u32 m0, s4, 1024
    s_nop 0
    buffer_load_dwordx4 v114, s[24:27], s73 offen nt lds
    v_mfma_f32_16x16x32_bf16 a[132:135], v[100:103], a[232:235], a[132:135]
    ds_read_b128 v[140:143], v120 offset:0
    ds_read_b128 v[144:147], v117 offset:4096
    v_mfma_f32_16x16x32_bf16 a[164:167], v[100:103], a[236:239], a[164:167]
    ds_read_b128 v[148:151], v118 offset:4096
    v_mfma_f32_16x16x32_bf16 a[8:11], v[104:107], a[216:219], a[8:11]
    v_perm_b32 v108, v165, v161, s61
    v_perm_b32 v109, v173, v169, s61
    v_mfma_f32_16x16x32_bf16 a[40:43], v[104:107], a[220:223], a[40:43]
    v_perm_b32 v110, v181, v177, s61
    v_perm_b32 v111, v189, v185, s61
    v_mfma_f32_16x16x32_bf16 a[72:75], v[104:107], a[224:227], a[72:75]
    s_add_u32 s73, s62, 18432
    v_mfma_f32_16x16x32_bf16 a[104:107], v[104:107], a[228:231], a[104:107]
    s_add_u32 m0, s4, 2048
    s_nop 0
    buffer_load_dwordx4 v115, s[24:27], s73 offen nt lds
    v_mfma_f32_16x16x32_bf16 a[136:139], v[104:107], a[232:235], a[136:139]
    ds_read_b128 v[152:155], v119 offset:4096
    ds_read_b128 v[156:159], v120 offset:4096
    v_mfma_f32_16x16x32_bf16 a[168:171], v[104:107], a[236:239], a[168:171]
    v_mfma_f32_16x16x32_bf16 a[12:15], v[108:111], a[216:219], a[12:15]
    v_perm_b32 v96, v166, v162, s60
    v_perm_b32 v97, v174, v170, s60
    v_mfma_f32_16x16x32_bf16 a[44:47], v[108:111], a[220:223], a[44:47]
    v_perm_b32 v98, v182, v178, s60
    v_perm_b32 v99, v190, v186, s60
    v_mfma_f32_16x16x32_bf16 a[76:79], v[108:111], a[224:227], a[76:79]
    s_add_u32 s73, s62, 19456
    s_add_u32 m0, s4, 3072
    v_mfma_f32_16x16x32_bf16 a[108:111], v[108:111], a[228:231], a[108:111]
    buffer_load_dwordx4 v116, s[24:27], s73 offen nt lds
    v_mfma_f32_16x16x32_bf16 a[140:143], v[108:111], a[232:235], a[140:143]
    s_barrier
    ds_read_b128 a[192:195], v243 offset:24576
    v_mfma_f32_16x16x32_bf16 a[172:175], v[108:111], a[236:239], a[172:175]
    ds_read_b128 a[196:199], v243 offset:26624
    v_mfma_f32_16x16x32_bf16 a[16:19], v[96:99], a[216:219], a[16:19]
    v_perm_b32 v100, v166, v162, s61
    v_perm_b32 v101, v174, v170, s61
    v_mfma_f32_16x16x32_bf16 a[48:51], v[96:99], a[220:223], a[48:51]
    v_perm_b32 v102, v182, v178, s61
    v_mfma_f32_16x16x32_bf16 a[80:83], v[96:99], a[224:227], a[80:83]
    v_perm_b32 v103, v190, v186, s61
    s_add_u32 s73, s62, 20480
    v_mfma_f32_16x16x32_bf16 a[112:115], v[96:99], a[228:231], a[112:115]
    s_add_u32 m0, s4, 4096
    v_mfma_f32_16x16x32_bf16 a[144:147], v[96:99], a[232:235], a[144:147]
    buffer_load_dwordx4 v113, s[24:27], s73 offen nt lds
    ds_read_b128 a[200:203], v243 offset:28672
    v_mfma_f32_16x16x32_bf16 a[176:179], v[96:99], a[236:239], a[176:179]
    ds_read_b128 a[204:207], v243 offset:30720
    v_mfma_f32_16x16x32_bf16 a[20:23], v[100:103], a[216:219], a[20:23]
    v_perm_b32 v104, v167, v163, s60
    v_perm_b32 v105, v175, v171, s60
    v_mfma_f32_16x16x32_bf16 a[52:55], v[100:103], a[220:223], a[52:55]
    v_perm_b32 v106, v183, v179, s60
    v_mfma_f32_16x16x32_bf16 a[84:87], v[100:103], a[224:227], a[84:87]
    v_perm_b32 v107, v191, v187, s60
    s_add_u32 s73, s62, 21504
    v_mfma_f32_16x16x32_bf16 a[116:119], v[100:103], a[228:231], a[116:119]
    s_add_u32 m0, s4, 5120
    v_mfma_f32_16x16x32_bf16 a[148:151], v[100:103], a[232:235], a[148:151]
    buffer_load_dwordx4 v114, s[24:27], s73 offen nt lds
    ds_read_b128 a[208:211], v243 offset:32768
    v_mfma_f32_16x16x32_bf16 a[180:183], v[100:103], a[236:239], a[180:183]
    ds_read_b128 a[212:215], v243 offset:34816
    v_mfma_f32_16x16x32_bf16 a[24:27], v[104:107], a[216:219], a[24:27]
    v_perm_b32 v108, v167, v163, s61
    v_mfma_f32_16x16x32_bf16 a[56:59], v[104:107], a[220:223], a[56:59]
    v_perm_b32 v109, v175, v171, s61
    v_mfma_f32_16x16x32_bf16 a[88:91], v[104:107], a[224:227], a[88:91]
    v_mfma_f32_16x16x32_bf16 a[120:123], v[104:107], a[228:231], a[120:123]
    v_perm_b32 v110, v183, v179, s61
    v_mfma_f32_16x16x32_bf16 a[152:155], v[104:107], a[232:235], a[152:155]
    v_perm_b32 v111, v191, v187, s61
    v_mfma_f32_16x16x32_bf16 a[184:187], v[104:107], a[236:239], a[184:187]
    s_nop 0
    v_mfma_f32_16x16x32_bf16 a[28:31], v[108:111], a[216:219], a[28:31]
    s_waitcnt vmcnt(14)
    v_perm_b32 v96, v196, v192, s60
    v_mfma_f32_16x16x32_bf16 a[60:63], v[108:111], a[220:223], a[60:63]
    v_perm_b32 v97, v204, v200, s60
    v_mfma_f32_16x16x32_bf16 a[92:95], v[108:111], a[224:227], a[92:95]
    v_perm_b32 v98, v212, v208, s60
    v_mfma_f32_16x16x32_bf16 a[124:127], v[108:111], a[228:231], a[124:127]
    v_perm_b32 v99, v220, v216, s60
    s_add_u32 s73, s62, 22528
    v_mfma_f32_16x16x32_bf16 a[156:159], v[108:111], a[232:235], a[156:159]
    s_add_u32 m0, s4, 6144
    v_mfma_f32_16x16x32_bf16 a[188:191], v[108:111], a[236:239], a[188:191]
    buffer_load_dwordx4 v115, s[24:27], s73 offen nt lds
    s_waitcnt lgkmcnt(0)
    v_mfma_f32_16x16x32_bf16 a[0:3], v[96:99], a[192:195], a[0:3]
    v_perm_b32 v100, v196, v192, s61
    v_perm_b32 v101, v204, v200, s61
    v_mfma_f32_16x16x32_bf16 a[32:35], v[96:99], a[196:199], a[32:35]
    v_perm_b32 v102, v212, v208, s61
    v_perm_b32 v103, v220, v216, s61
    v_mfma_f32_16x16x32_bf16 a[64:67], v[96:99], a[200:203], a[64:67]
    s_add_u32 s73, s62, 23552
    s_add_u32 m0, s4, 7168
    v_mfma_f32_16x16x32_bf16 a[96:99], v[96:99], a[204:207], a[96:99]
    buffer_load_dwordx4 v116, s[24:27], s73 offen nt lds
    v_mfma_f32_16x16x32_bf16 a[128:131], v[96:99], a[208:211], a[128:131]
    ds_read_b128 v[160:163], v117 offset:8192
    v_mfma_f32_16x16x32_bf16 a[160:163], v[96:99], a[212:215], a[160:163]
    ds_read_b128 v[164:167], v118 offset:8192
    ds_read_b128 v[168:171], v119 offset:8192
    v_mfma_f32_16x16x32_bf16 a[4:7], v[100:103], a[192:195], a[4:7]
    v_perm_b32 v104, v197, v193, s60
    v_perm_b32 v105, v205, v201, s60
    v_mfma_f32_16x16x32_bf16 a[36:39], v[100:103], a[196:199], a[36:39]
    v_perm_b32 v106, v213, v209, s60
    v_perm_b32 v107, v221, v217, s60
    v_mfma_f32_16x16x32_bf16 a[68:71], v[100:103], a[200:203], a[68:71]
    v_add_u32 v240, s80, v240
    v_and_b32 v240, 0x3fffff, v240
    v_mfma_f32_16x16x32_bf16 a[100:103], v[100:103], a[204:207], a[100:103]
    buffer_load_dwordx4 v[64:67], v240, s[32:35], 0 offen
    buffer_load_dwordx4 v[68:71], v240, s[32:35], s52 offen
    v_mfma_f32_16x16x32_bf16 a[132:135], v[100:103], a[208:211], a[132:135]
    ds_read_b128 v[172:175], v120 offset:8192
    ds_read_b128 v[176:179], v117 offset:12288
    v_mfma_f32_16x16x32_bf16 a[164:167], v[100:103], a[212:215], a[164:167]
    ds_read_b128 v[180:183], v118 offset:12288
    v_mfma_f32_16x16x32_bf16 a[8:11], v[104:107], a[192:195], a[8:11]
    v_perm_b32 v108, v197, v193, s61
    v_perm_b32 v109, v205, v201, s61
    v_mfma_f32_16x16x32_bf16 a[40:43], v[104:107], a[196:199], a[40:43]
    v_perm_b32 v110, v213, v209, s61
    v_mfma_f32_16x16x32_bf16 a[72:75], v[104:107], a[200:203], a[72:75]
    v_perm_b32 v111, v221, v217, s61
    buffer_load_dwordx4 v[72:75], v240, s[32:35], s53 offen
    v_mfma_f32_16x16x32_bf16 a[104:107], v[104:107], a[204:207], a[104:107]
    buffer_load_dwordx4 v[76:79], v240, s[32:35], s54 offen
    v_mfma_f32_16x16x32_bf16 a[136:139], v[104:107], a[208:211], a[136:139]
    ds_read_b128 v[184:187], v119 offset:12288
    ds_read_b128 v[188:191], v120 offset:12288
    v_mfma_f32_16x16x32_bf16 a[168:171], v[104:107], a[212:215], a[168:171]
    v_mfma_f32_16x16x32_bf16 a[12:15], v[108:111], a[192:195], a[12:15]
    v_perm_b32 v96, v198, v194, s60
    v_perm_b32 v97, v206, v202, s60
    v_mfma_f32_16x16x32_bf16 a[44:47], v[108:111], a[196:199], a[44:47]
    v_perm_b32 v98, v214, v210, s60
    v_mfma_f32_16x16x32_bf16 a[76:79], v[108:111], a[200:203], a[76:79]
    v_perm_b32 v99, v222, v218, s60
    v_mfma_f32_16x16x32_bf16 a[108:111], v[108:111], a[204:207], a[108:111]
    buffer_load_dwordx4 v[80:83], v240, s[32:35], s55 offen
    buffer_load_dwordx4 v[84:87], v240, s[32:35], s56 offen
    v_mfma_f32_16x16x32_bf16 a[140:143], v[108:111], a[208:211], a[140:143]
    ds_read_b128 a[216:219], v244 offset:24576
    v_mfma_f32_16x16x32_bf16 a[172:175], v[108:111], a[212:215], a[172:175]
    ds_read_b128 a[220:223], v244 offset:26624
    v_mfma_f32_16x16x32_bf16 a[16:19], v[96:99], a[192:195], a[16:19]
    v_perm_b32 v100, v198, v194, s61
    v_perm_b32 v101, v206, v202, s61
    v_mfma_f32_16x16x32_bf16 a[48:51], v[96:99], a[196:199], a[48:51]
    v_perm_b32 v102, v214, v210, s61
    v_mfma_f32_16x16x32_bf16 a[80:83], v[96:99], a[200:203], a[80:83]
    v_perm_b32 v103, v222, v218, s61
    v_mfma_f32_16x16x32_bf16 a[112:115], v[96:99], a[204:207], a[112:115]
    buffer_load_dwordx4 v[88:91], v240, s[32:35], s57 offen
    v_mfma_f32_16x16x32_bf16 a[144:147], v[96:99], a[208:211], a[144:147]
    ds_read_b128 a[224:227], v244 offset:28672
    v_mfma_f32_16x16x32_bf16 a[176:179], v[96:99], a[212:215], a[176:179]
    ds_read_b128 a[228:231], v244 offset:30720
    v_mfma_f32_16x16x32_bf16 a[20:23], v[100:103], a[192:195], a[20:23]
    v_perm_b32 v104, v199, v195, s60
    v_perm_b32 v105, v207, v203, s60
    v_mfma_f32_16x16x32_bf16 a[52:55], v[100:103], a[196:199], a[52:55]
    v_perm_b32 v106, v215, v211, s60
    v_perm_b32 v107, v223, v219, s60
    v_mfma_f32_16x16x32_bf16 a[84:87], v[100:103], a[200:203], a[84:87]
    buffer_load_dwordx4 v[92:95], v240, s[32:35], s58 offen
    v_mfma_f32_16x16x32_bf16 a[116:119], v[100:103], a[204:207], a[116:119]
    v_add_u32 v240, s81, v240
    v_and_b32 v240, 0x3fffff, v240
    v_mfma_f32_16x16x32_bf16 a[148:151], v[100:103], a[208:211], a[148:151]
    buffer_load_dwordx4 v[0:3], v240, s[32:35], 0 offen
    ds_read_b128 a[232:235], v244 offset:32768
    v_mfma_f32_16x16x32_bf16 a[180:183], v[100:103], a[212:215], a[180:183]
    ds_read_b128 a[236:239], v244 offset:34816
    v_mfma_f32_16x16x32_bf16 a[24:27], v[104:107], a[192:195], a[24:27]
    v_perm_b32 v108, v199, v195, s61
    v_mfma_f32_16x16x32_bf16 a[56:59], v[104:107], a[196:199], a[56:59]
    v_perm_b32 v109, v207, v203, s61
    v_mfma_f32_16x16x32_bf16 a[88:91], v[104:107], a[200:203], a[88:91]
    v_perm_b32 v110, v215, v211, s61
    v_mfma_f32_16x16x32_bf16 a[120:123], v[104:107], a[204:207], a[120:123]
    v_perm_b32 v111, v223, v219, s61
    v_mfma_f32_16x16x32_bf16 a[152:155], v[104:107], a[208:211], a[152:155]
    buffer_load_dwordx4 v[4:7], v240, s[32:35], s52 offen
    v_mfma_f32_16x16x32_bf16 a[184:187], v[104:107], a[212:215], a[184:187]
    buffer_load_dwordx4 v[8:11], v240, s[32:35], s53 offen
    v_mfma_f32_16x16x32_bf16 a[28:31], v[108:111], a[192:195], a[28:31]
    s_waitcnt vmcnt(19)
    v_perm_b32 v96, v36, v32, s60
    v_mfma_f32_16x16x32_bf16 a[60:63], v[108:111], a[196:199], a[60:63]
    v_perm_b32 v97, v44, v40, s60
    v_mfma_f32_16x16x32_bf16 a[92:95], v[108:111], a[200:203], a[92:95]
    v_perm_b32 v98, v52, v48, s60
    v_mfma_f32_16x16x32_bf16 a[124:127], v[108:111], a[204:207], a[124:127]
    v_perm_b32 v99, v60, v56, s60
    v_mfma_f32_16x16x32_bf16 a[156:159], v[108:111], a[208:211], a[156:159]
    buffer_load_dwordx4 v[12:15], v240, s[32:35], s54 offen
    v_mfma_f32_16x16x32_bf16 a[188:191], v[108:111], a[212:215], a[188:191]
    buffer_load_dwordx4 v[16:19], v240, s[32:35], s55 offen
    s_waitcnt lgkmcnt(0)
    v_mfma_f32_16x16x32_bf16 a[0:3], v[96:99], a[216:219], a[0:3]
    v_perm_b32 v100, v36, v32, s61
    v_mfma_f32_16x16x32_bf16 a[32:35], v[96:99], a[220:223], a[32:35]
    v_perm_b32 v101, v44, v40, s61
    v_mfma_f32_16x16x32_bf16 a[64:67], v[96:99], a[224:227], a[64:67]
    v_perm_b32 v102, v52, v48, s61
    v_mfma_f32_16x16x32_bf16 a[96:99], v[96:99], a[228:231], a[96:99]
    v_perm_b32 v103, v60, v56, s61
    v_mfma_f32_16x16x32_bf16 a[128:131], v[96:99], a[232:235], a[128:131]
    buffer_load_dwordx4 v[20:23], v240, s[32:35], s56 offen
    v_mfma_f32_16x16x32_bf16 a[160:163], v[96:99], a[236:239], a[160:163]
    v_mfma_f32_16x16x32_bf16 a[4:7], v[100:103], a[216:219], a[4:7]
    v_perm_b32 v104, v37, v33, s60
    v_mfma_f32_16x16x32_bf16 a[36:39], v[100:103], a[220:223], a[36:39]
    v_perm_b32 v105, v45, v41, s60
    v_mfma_f32_16x16x32_bf16 a[68:71], v[100:103], a[224:227], a[68:71]
    v_perm_b32 v106, v53, v49, s60
    v_mfma_f32_16x16x32_bf16 a[100:103], v[100:103], a[228:231], a[100:103]
    v_perm_b32 v107, v61, v57, s60
    v_mfma_f32_16x16x32_bf16 a[132:135], v[100:103], a[232:235], a[132:135]
    buffer_load_dwordx4 v[24:27], v240, s[32:35], s57 offen
    v_mfma_f32_16x16x32_bf16 a[164:167], v[100:103], a[236:239], a[164:167]
    buffer_load_dwordx4 v[28:31], v240, s[32:35], s58 offen
    v_mfma_f32_16x16x32_bf16 a[8:11], v[104:107], a[216:219], a[8:11]
    v_perm_b32 v108, v37, v33, s61
    v_perm_b32 v109, v45, v41, s61
    v_mfma_f32_16x16x32_bf16 a[40:43], v[104:107], a[220:223], a[40:43]
    v_perm_b32 v110, v53, v49, s61
    v_mfma_f32_16x16x32_bf16 a[72:75], v[104:107], a[224:227], a[72:75]
    v_perm_b32 v111, v61, v57, s61
    v_mfma_f32_16x16x32_bf16 a[104:107], v[104:107], a[228:231], a[104:107]
    s_add_u32 s73, s62, 0
    v_mfma_f32_16x16x32_bf16 a[136:139], v[104:107], a[232:235], a[136:139]
    s_add_u32 m0, s92, 0
    v_mfma_f32_16x16x32_bf16 a[168:171], v[104:107], a[236:239], a[168:171]
    buffer_load_dwordx4 v246, s[28:31], s73 offen nt lds
    v_mfma_f32_16x16x32_bf16 a[12:15], v[108:111], a[216:219], a[12:15]
    v_perm_b32 v96, v38, v34, s60
    v_perm_b32 v97, v46, v42, s60
    v_mfma_f32_16x16x32_bf16 a[44:47], v[108:111], a[220:223], a[44:47]
    v_perm_b32 v98, v54, v50, s60
    v_mfma_f32_16x16x32_bf16 a[76:79], v[108:111], a[224:227], a[76:79]
    v_perm_b32 v99, v62, v58, s60
    s_add_u32 s73, s62, 1024
    v_mfma_f32_16x16x32_bf16 a[108:111], v[108:111], a[228:231], a[108:111]
    s_add_u32 m0, s92, 1024
    v_mfma_f32_16x16x32_bf16 a[140:143], v[108:111], a[232:235], a[140:143]
    buffer_load_dwordx4 v245, s[28:31], s73 offen nt lds
    ds_read_b128 a[192:195], v243 offset:36864
    v_mfma_f32_16x16x32_bf16 a[172:175], v[108:111], a[236:239], a[172:175]
    ds_read_b128 a[196:199], v243 offset:38912
    v_mfma_f32_16x16x32_bf16 a[16:19], v[96:99], a[216:219], a[16:19]
    v_perm_b32 v100, v38, v34, s61
    v_perm_b32 v101, v46, v42, s61
    v_mfma_f32_16x16x32_bf16 a[48:51], v[96:99], a[220:223], a[48:51]
    v_perm_b32 v102, v54, v50, s61
    v_mfma_f32_16x16x32_bf16 a[80:83], v[96:99], a[224:227], a[80:83]
    v_perm_b32 v103, v62, v58, s61
    s_add_u32 s73, s62, 2048
    v_mfma_f32_16x16x32_bf16 a[112:115], v[96:99], a[228:231], a[112:115]
    s_add_u32 m0, s92, 2048
    v_mfma_f32_16x16x32_bf16 a[144:147], v[96:99], a[232:235], a[144:147]
    buffer_load_dwordx4 v246, s[28:31], s73 offen nt lds
    ds_read_b128 a[200:203], v243 offset:40960
    v_mfma_f32_16x16x32_bf16 a[176:179], v[96:99], a[236:239], a[176:179]
    ds_read_b128 a[204:207], v243 offset:43008
    v_mfma_f32_16x16x32_bf16 a[20:23], v[100:103], a[216:219], a[20:23]
    v_perm_b32 v104, v39, v35, s60
    v_mfma_f32_16x16x32_bf16 a[52:55], v[100:103], a[220:223], a[52:55]
    v_perm_b32 v105, v47, v43, s60
    v_mfma_f32_16x16x32_bf16 a[84:87], v[100:103], a[224:227], a[84:87]
    v_perm_b32 v106, v55, v51, s60
    v_mfma_f32_16x16x32_bf16 a[116:119], v[100:103], a[228:231], a[116:119]
    v_perm_b32 v107, v63, v59, s60
    v_mfma_f32_16x16x32_bf16 a[148:151], v[100:103], a[232:235], a[148:151]
    ds_read_b128 a[208:211], v243 offset:45056
    v_mfma_f32_16x16x32_bf16 a[180:183], v[100:103], a[236:239], a[180:183]
    ds_read_b128 a[212:215], v243 offset:47104
    v_mfma_f32_16x16x32_bf16 a[24:27], v[104:107], a[216:219], a[24:27]
    v_perm_b32 v108, v39, v35, s61
    v_perm_b32 v109, v47, v43, s61
    v_mfma_f32_16x16x32_bf16 a[56:59], v[104:107], a[220:223], a[56:59]
    v_perm_b32 v110, v55, v51, s61
    v_mfma_f32_16x16x32_bf16 a[88:91], v[104:107], a[224:227], a[88:91]
    v_perm_b32 v111, v63, v59, s61
    v_mfma_f32_16x16x32_bf16 a[120:123], v[104:107], a[228:231], a[120:123]
    s_add_u32 s73, s62, 3072
    v_mfma_f32_16x16x32_bf16 a[152:155], v[104:107], a[232:235], a[152:155]
    s_add_u32 m0, s92, 3072
    v_mfma_f32_16x16x32_bf16 a[184:187], v[104:107], a[236:239], a[184:187]
    buffer_load_dwordx4 v245, s[28:31], s73 offen nt lds
    v_mfma_f32_16x16x32_bf16 a[28:31], v[108:111], a[216:219], a[28:31]
    s_waitcnt vmcnt(12)
    v_perm_b32 v96, v68, v64, s60
    v_mfma_f32_16x16x32_bf16 a[60:63], v[108:111], a[220:223], a[60:63]
    v_perm_b32 v97, v76, v72, s60
    v_mfma_f32_16x16x32_bf16 a[92:95], v[108:111], a[224:227], a[92:95]
    v_perm_b32 v98, v84, v80, s60
    v_mfma_f32_16x16x32_bf16 a[124:127], v[108:111], a[228:231], a[124:127]
    v_perm_b32 v99, v92, v88, s60
    s_add_u32 s73, s62, 4096
    v_mfma_f32_16x16x32_bf16 a[156:159], v[108:111], a[232:235], a[156:159]
    s_add_u32 m0, s92, 4096
    v_mfma_f32_16x16x32_bf16 a[188:191], v[108:111], a[236:239], a[188:191]
    buffer_load_dwordx4 v246, s[28:31], s73 offen nt lds
    s_waitcnt lgkmcnt(0)
    v_mfma_f32_16x16x32_bf16 a[0:3], v[96:99], a[192:195], a[0:3]
    v_perm_b32 v100, v68, v64, s61
    v_perm_b32 v101, v76, v72, s61
    v_perm_b32 v102, v84, v80, s61
    v_mfma_f32_16x16x32_bf16 a[32:35], v[96:99], a[196:199], a[32:35]
    v_perm_b32 v103, v92, v88, s61
    s_add_u32 s73, s62, 5120
    s_add_u32 m0, s92, 5120
    v_mfma_f32_16x16x32_bf16 a[64:67], v[96:99], a[200:203], a[64:67]
    buffer_load_dwordx4 v245, s[28:31], s73 offen nt lds
    v_mfma_f32_16x16x32_bf16 a[96:99], v[96:99], a[204:207], a[96:99]
    v_subrev_u32 v117, s5, v117
    v_subrev_u32 v118, s5, v118
    v_mfma_f32_16x16x32_bf16 a[128:131], v[96:99], a[208:211], a[128:131]
    v_subrev_u32 v119, s5, v119
    v_subrev_u32 v120, s5, v120
    ds_read_b128 v[192:195], v117 offset:0
    v_mfma_f32_16x16x32_bf16 a[160:163], v[96:99], a[212:215], a[160:163]
    ds_read_b128 v[196:199], v118 offset:0
    ds_read_b128 v[200:203], v119 offset:0
    v_mfma_f32_16x16x32_bf16 a[4:7], v[100:103], a[192:195], a[4:7]
    v_perm_b32 v104, v69, v65, s60
    v_perm_b32 v105, v77, v73, s60
    v_mfma_f32_16x16x32_bf16 a[36:39], v[100:103], a[196:199], a[36:39]
    v_perm_b32 v106, v85, v81, s60
    v_perm_b32 v107, v93, v89, s60
    v_mfma_f32_16x16x32_bf16 a[68:71], v[100:103], a[200:203], a[68:71]
    s_add_u32 s73, s62, 6144
    v_mfma_f32_16x16x32_bf16 a[100:103], v[100:103], a[204:207], a[100:103]
    s_add_u32 m0, s92, 6144
    s_nop 0
    buffer_load_dwordx4 v246, s[28:31], s73 offen nt lds
    v_mfma_f32_16x16x32_bf16 a[132:135], v[100:103], a[208:211], a[132:135]
    ds_read_b128 v[204:207], v120 offset:0
    ds_read_b128 v[208:211], v117 offset:4096
    v_mfma_f32_16x16x32_bf16 a[164:167], v[100:103], a[212:215], a[164:167]
    ds_read_b128 v[212:215], v118 offset:4096
    v_mfma_f32_16x16x32_bf16 a[8:11], v[104:107], a[192:195], a[8:11]
    v_perm_b32 v108, v69, v65, s61
    v_perm_b32 v109, v77, v73, s61
    v_mfma_f32_16x16x32_bf16 a[40:43], v[104:107], a[196:199], a[40:43]
    v_perm_b32 v110, v85, v81, s61
    v_perm_b32 v111, v93, v89, s61
    v_mfma_f32_16x16x32_bf16 a[72:75], v[104:107], a[200:203], a[72:75]
    s_add_u32 s73, s62, 7168
    v_mfma_f32_16x16x32_bf16 a[104:107], v[104:107], a[204:207], a[104:107]
    s_add_u32 m0, s92, 7168
    s_nop 0
    buffer_load_dwordx4 v245, s[28:31], s73 offen nt lds
    v_mfma_f32_16x16x32_bf16 a[136:139], v[104:107], a[208:211], a[136:139]
    ds_read_b128 v[216:219], v119 offset:4096
    ds_read_b128 v[220:223], v120 offset:4096
    v_mfma_f32_16x16x32_bf16 a[168:171], v[104:107], a[212:215], a[168:171]
    v_mfma_f32_16x16x32_bf16 a[12:15], v[108:111], a[192:195], a[12:15]
    v_perm_b32 v96, v70, v66, s60
    v_perm_b32 v97, v78, v74, s60
    v_mfma_f32_16x16x32_bf16 a[44:47], v[108:111], a[196:199], a[44:47]
    v_perm_b32 v98, v86, v82, s60
    v_perm_b32 v99, v94, v90, s60
    v_mfma_f32_16x16x32_bf16 a[76:79], v[108:111], a[200:203], a[76:79]
    v_mfma_f32_16x16x32_bf16 a[108:111], v[108:111], a[204:207], a[108:111]
    s_add_u32 s73, s62, 8192
    s_add_u32 m0, s92, 8192
    v_mfma_f32_16x16x32_bf16 a[140:143], v[108:111], a[208:211], a[140:143]
    buffer_load_dwordx4 v246, s[28:31], s73 offen nt lds
    ds_read_b128 a[216:219], v244 offset:36864
    v_mfma_f32_16x16x32_bf16 a[172:175], v[108:111], a[212:215], a[172:175]
    ds_read_b128 a[220:223], v244 offset:38912
    v_mfma_f32_16x16x32_bf16 a[16:19], v[96:99], a[192:195], a[16:19]
    v_perm_b32 v100, v70, v66, s61
    v_mfma_f32_16x16x32_bf16 a[48:51], v[96:99], a[196:199], a[48:51]
    v_perm_b32 v101, v78, v74, s61
    v_mfma_f32_16x16x32_bf16 a[80:83], v[96:99], a[200:203], a[80:83]
    v_perm_b32 v102, v86, v82, s61
    v_mfma_f32_16x16x32_bf16 a[112:115], v[96:99], a[204:207], a[112:115]
    v_perm_b32 v103, v94, v90, s61
    v_mfma_f32_16x16x32_bf16 a[144:147], v[96:99], a[208:211], a[144:147]
    ds_read_b128 a[224:227], v244 offset:40960
    v_mfma_f32_16x16x32_bf16 a[176:179], v[96:99], a[212:215], a[176:179]
    ds_read_b128 a[228:231], v244 offset:43008
    v_mfma_f32_16x16x32_bf16 a[20:23], v[100:103], a[192:195], a[20:23]
    v_perm_b32 v104, v71, v67, s60
    v_perm_b32 v105, v79, v75, s60
    v_mfma_f32_16x16x32_bf16 a[52:55], v[100:103], a[196:199], a[52:55]
    v_perm_b32 v106, v87, v83, s60
    v_mfma_f32_16x16x32_bf16 a[84:87], v[100:103], a[200:203], a[84:87]
    v_perm_b32 v107, v95, v91, s60
    s_add_u32 s73, s62, 9216
    v_mfma_f32_16x16x32_bf16 a[116:119], v[100:103], a[204:207], a[116:119]
    s_add_u32 m0, s92, 9216
    v_mfma_f32_16x16x32_bf16 a[148:151], v[100:103], a[208:211], a[148:151]
    buffer_load_dwordx4 v245, s[28:31], s73 offen nt lds
    ds_read_b128 a[232:235], v244 offset:45056
    v_mfma_f32_16x16x32_bf16 a[180:183], v[100:103], a[212:215], a[180:183]
    ds_read_b128 a[236:239], v244 offset:47104
    v_mfma_f32_16x16x32_bf16 a[24:27], v[104:107], a[192:195], a[24:27]
    v_perm_b32 v108, v71, v67, s61
    v_perm_b32 v109, v79, v75, s61
    v_mfma_f32_16x16x32_bf16 a[56:59], v[104:107], a[196:199], a[56:59]
    v_perm_b32 v110, v87, v83, s61
    v_mfma_f32_16x16x32_bf16 a[88:91], v[104:107], a[200:203], a[88:91]
    v_perm_b32 v111, v95, v91, s61
    v_mfma_f32_16x16x32_bf16 a[120:123], v[104:107], a[204:207], a[120:123]
    s_add_u32 s73, s62, 10240
    v_mfma_f32_16x16x32_bf16 a[152:155], v[104:107], a[208:211], a[152:155]
    s_add_u32 m0, s92, 10240
    v_mfma_f32_16x16x32_bf16 a[184:187], v[104:107], a[212:215], a[184:187]
    buffer_load_dwordx4 v246, s[28:31], s73 offen nt lds
    v_mfma_f32_16x16x32_bf16 a[28:31], v[108:111], a[192:195], a[28:31]
    s_waitcnt vmcnt(11)
    v_perm_b32 v64, v4, v0, s60
    v_mfma_f32_16x16x32_bf16 a[60:63], v[108:111], a[196:199], a[60:63]
    v_perm_b32 v65, v12, v8, s60
    v_mfma_f32_16x16x32_bf16 a[92:95], v[108:111], a[200:203], a[92:95]
    v_perm_b32 v66, v20, v16, s60
    v_mfma_f32_16x16x32_bf16 a[124:127], v[108:111], a[204:207], a[124:127]
    v_perm_b32 v67, v28, v24, s60
    s_add_u32 s73, s62, 11264
    v_mfma_f32_16x16x32_bf16 a[156:159], v[108:111], a[208:211], a[156:159]
    s_add_u32 m0, s92, 11264
    v_mfma_f32_16x16x32_bf16 a[188:191], v[108:111], a[212:215], a[188:191]
    buffer_load_dwordx4 v245, s[28:31], s73 offen nt lds
    s_waitcnt lgkmcnt(0)
    v_mfma_f32_16x16x32_bf16 a[0:3], v[64:67], a[216:219], a[0:3]
    v_perm_b32 v68, v4, v0, s61
    v_perm_b32 v69, v12, v8, s61
    v_perm_b32 v70, v20, v16, s61
    v_perm_b32 v71, v28, v24, s61
    s_nop 1
    v_mfma_f32_16x16x32_bf16 a[4:7], v[68:71], a[216:219], a[4:7]
    v_perm_b32 v72, v5, v1, s60
    v_perm_b32 v73, v13, v9, s60
    v_perm_b32 v74, v21, v17, s60
    v_perm_b32 v75, v29, v25, s60
    s_nop 1
    v_mfma_f32_16x16x32_bf16 a[8:11], v[72:75], a[216:219], a[8:11]
    v_perm_b32 v76, v5, v1, s61
    v_perm_b32 v77, v13, v9, s61
    v_perm_b32 v78, v21, v17, s61
    v_perm_b32 v79, v29, v25, s61
    s_nop 1
    v_mfma_f32_16x16x32_bf16 a[12:15], v[76:79], a[216:219], a[12:15]
    v_perm_b32 v80, v6, v2, s60
    v_perm_b32 v81, v14, v10, s60
    v_perm_b32 v82, v22, v18, s60
    v_perm_b32 v83, v30, v26, s60
    s_nop 1
    v_mfma_f32_16x16x32_bf16 a[16:19], v[80:83], a[216:219], a[16:19]
    v_perm_b32 v84, v6, v2, s61
    v_perm_b32 v85, v14, v10, s61
    v_perm_b32 v86, v22, v18, s61
    v_perm_b32 v87, v30, v26, s61
    s_nop 1
    v_mfma_f32_16x16x32_bf16 a[20:23], v[84:87], a[216:219], a[20:23]
    v_perm_b32 v88, v7, v3, s60
    v_perm_b32 v89, v15, v11, s60
    v_perm_b32 v90, v23, v19, s60
    v_perm_b32 v91, v31, v27, s60
    s_nop 1
    v_mfma_f32_16x16x32_bf16 a[24:27], v[88:91], a[216:219], a[24:27]
    v_perm_b32 v92, v7, v3, s61
    v_perm_b32 v93, v15, v11, s61
    v_perm_b32 v94, v23, v19, s61
    v_perm_b32 v95, v31, v27, s61
    s_nop 1
    v_mfma_f32_16x16x32_bf16 a[28:31], v[92:95], a[216:219], a[28:31]
    v_mfma_f32_16x16x32_bf16 a[32:35], v[64:67], a[220:223], a[32:35]
    v_mfma_f32_16x16x32_bf16 a[36:39], v[68:71], a[220:223], a[36:39]
    s_add_u32 s73, s62, 12288
    s_add_u32 m0, s92, 12288
    s_nop 0
    buffer_load_dwordx4 v246, s[28:31], s73 offen nt lds
    s_add_u32 s73, s62, 13312
    v_mfma_f32_16x16x32_bf16 a[40:43], v[72:75], a[220:223], a[40:43]
    s_add_u32 m0, s92, 13312
    s_nop 0
    buffer_load_dwordx4 v245, s[28:31], s73 offen nt lds
    v_accvgpr_read_b32 v251, a0
    v_accvgpr_read_b32 v252, a4
    v_mfma_f32_16x16x32_bf16 a[44:47], v[76:79], a[220:223], a[44:47]
    v_cvt_pk_bf16_f32 v32, v251, v252
    v_accvgpr_read_b32 v253, a8
    v_accvgpr_read_b32 v254, a12
    v_cvt_pk_bf16_f32 v33, v253, v254
    v_mfma_f32_16x16x32_bf16 a[48:51], v[80:83], a[220:223], a[48:51]
    v_accvgpr_read_b32 v251, a16
    v_accvgpr_read_b32 v252, a20
    v_cvt_pk_bf16_f32 v34, v251, v252
    v_mfma_f32_16x16x32_bf16 a[52:55], v[84:87], a[220:223], a[52:55]
    v_accvgpr_read_b32 v253, a24
    v_accvgpr_read_b32 v254, a28
    v_cvt_pk_bf16_f32 v35, v253, v254
    v_accvgpr_read_b32 v251, a1
    v_mfma_f32_16x16x32_bf16 a[56:59], v[88:91], a[220:223], a[56:59]
    v_accvgpr_read_b32 v252, a5
    v_cvt_pk_bf16_f32 v36, v251, v252
    v_accvgpr_read_b32 v253, a9
    v_accvgpr_read_b32 v254, a13
    v_mfma_f32_16x16x32_bf16 a[60:63], v[92:95], a[220:223], a[60:63]
    v_cvt_pk_bf16_f32 v37, v253, v254
    v_accvgpr_read_b32 v251, a17
    v_accvgpr_read_b32 v252, a21
    v_mfma_f32_16x16x32_bf16 a[64:67], v[64:67], a[224:227], a[64:67]
    v_mfma_f32_16x16x32_bf16 a[68:71], v[68:71], a[224:227], a[68:71]
    s_add_u32 s73, s62, 14336
    s_add_u32 m0, s92, 14336
    s_nop 0
    buffer_load_dwordx4 v246, s[28:31], s73 offen nt lds
    v_cvt_pk_bf16_f32 v38, v251, v252
    v_mfma_f32_16x16x32_bf16 a[72:75], v[72:75], a[224:227], a[72:75]
    v_accvgpr_read_b32 v253, a25
    v_accvgpr_read_b32 v254, a29
    v_cvt_pk_bf16_f32 v39, v253, v254
    v_mfma_f32_16x16x32_bf16 a[76:79], v[76:79], a[224:227], a[76:79]
    v_accvgpr_read_b32 v251, a2
    v_accvgpr_read_b32 v252, a6
    v_cvt_pk_bf16_f32 v40, v251, v252
    v_mfma_f32_16x16x32_bf16 a[80:83], v[80:83], a[224:227], a[80:83]
    v_accvgpr_read_b32 v253, a10
    v_accvgpr_read_b32 v254, a14
    v_cvt_pk_bf16_f32 v41, v253, v254
    v_accvgpr_read_b32 v251, a18
    v_mfma_f32_16x16x32_bf16 a[84:87], v[84:87], a[224:227], a[84:87]
    v_accvgpr_read_b32 v252, a22
    v_cvt_pk_bf16_f32 v42, v251, v252
    v_accvgpr_read_b32 v253, a26
    v_mfma_f32_16x16x32_bf16 a[88:91], v[88:91], a[224:227], a[88:91]
    v_accvgpr_read_b32 v254, a30
    v_cvt_pk_bf16_f32 v43, v253, v254
    v_accvgpr_read_b32 v251, a3
    v_mfma_f32_16x16x32_bf16 a[92:95], v[92:95], a[224:227], a[92:95]
    v_accvgpr_read_b32 v252, a7
    v_cvt_pk_bf16_f32 v44, v251, v252
    v_accvgpr_read_b32 v253, a11
    v_mfma_f32_16x16x32_bf16 a[96:99], v[64:67], a[228:231], a[96:99]
    v_mfma_f32_16x16x32_bf16 a[100:103], v[68:71], a[228:231], a[100:103]
    s_add_u32 s73, s62, 15360
    s_add_u32 m0, s92, 15360
    s_nop 0
    buffer_load_dwordx4 v245, s[28:31], s73 offen nt lds
    v_accvgpr_read_b32 v254, a15
    v_mfma_f32_16x16x32_bf16 a[104:107], v[72:75], a[228:231], a[104:107]
    v_cvt_pk_bf16_f32 v45, v253, v254
    v_accvgpr_read_b32 v251, a19
    v_accvgpr_read_b32 v252, a23
    v_mfma_f32_16x16x32_bf16 a[108:111], v[76:79], a[228:231], a[108:111]
    v_cvt_pk_bf16_f32 v46, v251, v252
    v_accvgpr_read_b32 v253, a27
    v_accvgpr_read_b32 v254, a31
    v_mfma_f32_16x16x32_bf16 a[112:115], v[80:83], a[228:231], a[112:115]
    v_cvt_pk_bf16_f32 v47, v253, v254
    v_accvgpr_read_b32 v251, a32
    v_accvgpr_read_b32 v252, a36
    v_cvt_pk_bf16_f32 v48, v251, v252
    v_mfma_f32_16x16x32_bf16 a[116:119], v[84:87], a[228:231], a[116:119]
    v_accvgpr_read_b32 v253, a40
    v_accvgpr_read_b32 v254, a44
    v_cvt_pk_bf16_f32 v49, v253, v254
    v_mfma_f32_16x16x32_bf16 a[120:123], v[88:91], a[228:231], a[120:123]
    v_accvgpr_read_b32 v251, a48
    v_accvgpr_read_b32 v252, a52
    v_cvt_pk_bf16_f32 v50, v251, v252
    v_mfma_f32_16x16x32_bf16 a[124:127], v[92:95], a[228:231], a[124:127]
    v_accvgpr_read_b32 v253, a56
    v_accvgpr_read_b32 v254, a60
    v_cvt_pk_bf16_f32 v51, v253, v254
    v_mfma_f32_16x16x32_bf16 a[128:131], v[64:67], a[232:235], a[128:131]
    v_mfma_f32_16x16x32_bf16 a[132:135], v[68:71], a[232:235], a[132:135]
    v_accvgpr_read_b32 v251, a33
    v_accvgpr_read_b32 v252, a37
    v_cvt_pk_bf16_f32 v52, v251, v252
    v_mfma_f32_16x16x32_bf16 a[136:139], v[72:75], a[232:235], a[136:139]
    v_accvgpr_read_b32 v253, a41
    v_accvgpr_read_b32 v254, a45
    v_cvt_pk_bf16_f32 v53, v253, v254
    v_mfma_f32_16x16x32_bf16 a[140:143], v[76:79], a[232:235], a[140:143]
    v_accvgpr_read_b32 v251, a49
    v_accvgpr_read_b32 v252, a53
    v_cvt_pk_bf16_f32 v54, v251, v252
    v_mfma_f32_16x16x32_bf16 a[144:147], v[80:83], a[232:235], a[144:147]
    v_accvgpr_read_b32 v253, a57
    v_accvgpr_read_b32 v254, a61
    v_cvt_pk_bf16_f32 v55, v253, v254
    v_mfma_f32_16x16x32_bf16 a[148:151], v[84:87], a[232:235], a[148:151]
    v_accvgpr_read_b32 v251, a34
    v_accvgpr_read_b32 v252, a38
    v_cvt_pk_bf16_f32 v56, v251, v252
    v_mfma_f32_16x16x32_bf16 a[152:155], v[88:91], a[232:235], a[152:155]
    v_accvgpr_read_b32 v253, a42
    v_accvgpr_read_b32 v254, a46
    v_cvt_pk_bf16_f32 v57, v253, v254
    v_mfma_f32_16x16x32_bf16 a[156:159], v[92:95], a[232:235], a[156:159]
    v_accvgpr_read_b32 v251, a50
    v_accvgpr_read_b32 v252, a54
    v_mfma_f32_16x16x32_bf16 a[160:163], v[64:67], a[236:239], a[160:163]
    v_mfma_f32_16x16x32_bf16 a[164:167], v[68:71], a[236:239], a[164:167]
    v_cvt_pk_bf16_f32 v58, v251, v252
    v_accvgpr_read_b32 v253, a58
    v_accvgpr_read_b32 v254, a62
    v_mfma_f32_16x16x32_bf16 a[168:171], v[72:75], a[236:239], a[168:171]
    v_cvt_pk_bf16_f32 v59, v253, v254
    v_accvgpr_read_b32 v251, a35
    v_mfma_f32_16x16x32_bf16 a[172:175], v[76:79], a[236:239], a[172:175]
    v_accvgpr_read_b32 v252, a39
    v_cvt_pk_bf16_f32 v60, v251, v252
    v_mfma_f32_16x16x32_bf16 a[176:179], v[80:83], a[236:239], a[176:179]
    v_accvgpr_read_b32 v253, a43
    v_accvgpr_read_b32 v254, a47
    v_cvt_pk_bf16_f32 v61, v253, v254
    v_mfma_f32_16x16x32_bf16 a[180:183], v[84:87], a[236:239], a[180:183]
    v_accvgpr_read_b32 v251, a51
    v_accvgpr_read_b32 v252, a55
    v_mfma_f32_16x16x32_bf16 a[184:187], v[88:91], a[236:239], a[184:187]
    v_cvt_pk_bf16_f32 v62, v251, v252
    v_accvgpr_read_b32 v253, a59
    v_mfma_f32_16x16x32_bf16 a[188:191], v[92:95], a[236:239], a[188:191]
    v_accvgpr_read_b32 v254, a63
    v_cvt_pk_bf16_f32 v63, v253, v254
    s_lshl_b32 s72, s3, 13
    v_add_u32 v241, s72, v248
    s_nop 7
join:
    s_memrealtime s[76:77]
    s_lshl_b32 s75, s66, 2
    s_waitcnt lgkmcnt(0)
    s_or_b32 s80, s76, 1
    v_mov_b32 v238, s80
    v_mov_b32 v239, 0
    s_mov_b64 exec, s[70:71]
    buffer_atomic_cmpswap v[238:239], off, s[48:51], s75 sc0 sc1
    s_mov_b64 exec, -1
    s_lshl_b32 s89, s66, 3
    s_lshl_b32 s90, s3, 1
    s_add_u32 s89, s89, s90
    s_lshl_b32 s89, s89, 3
    s_add_u32 s89, s89, s63
    s_mul_i32 s89, s89, 12288
    s_add_u32 s90, s89, 98304
    s_lshl_b32 s86, s66, 2
    s_add_u32 s86, s86, s3
    s_lshl_b32 s86, s86, 7
    s_add_u32 s86, s86, 67108864
    s_lshl_b32 s69, s63, 3
    s_add_u32 s69, s69, s86
    s_mov_b32 s81, s63
    s_mov_b32 s82, s3
    s_lshl_b32 s72, s66, 2
    s_lshr_b32 s73, s81, 1
    s_add_u32 s73, s73, s72
    s_lshl_b32 s73, s73, 7
    s_add_u32 s87, s73, 67108864
    s_lshl_b32 s72, s66, 3
    s_add_u32 s72, s72, s81
    s_mul_i32 s72, s72, 96
    s_mul_i32 s73, s82, 3
    s_add_u32 s72, s72, s73
    s_lshl_b32 s88, s72, 10
    s_mul_i32 s93, s64, 196608
    s_lshl_b32 s72, s65, 10
    s_add_u32 s93, s93, s72
    s_lshr_b32 s72, s81, 1
    s_lshl_b32 s72, s72, 8
    s_add_u32 s93, s93, s72
    s_lshl_b32 s72, s82, 6
    s_add_u32 s93, s93, s72
    s_and_b32 s72, s81, 1
    s_lshl_b32 s72, s72, 15
    s_add_u32 s93, s93, s72
    v_mov_b32 v224, 0x3f803f80
    v_mov_b32 v225, 0x3f803f80
    v_mov_b32 v226, 0x3f803f80
    v_mov_b32 v227, 0x3f803f80
    v_mfma_f32_16x16x32_bf16 v[64:67], v[128:131], v[32:35], 0
    s_add_u32 s73, s62, 16384
    v_mfma_f32_16x16x32_bf16 v[64:67], v[132:135], v[36:39], v[64:67]
    s_add_u32 m0, s4, 36864
    v_mfma_f32_16x16x32_bf16 v[64:67], v[136:139], v[40:43], v[64:67]
    buffer_load_dwordx4 v246, s[28:31], s73 offen nt lds
    v_mfma_f32_16x16x32_bf16 v[64:67], v[140:143], v[44:47], v[64:67]
    s_add_u32 s73, s62, 17408
    v_mfma_f32_16x16x32_bf16 v[68:71], v[144:147], v[32:35], 0
    s_add_u32 m0, s4, 37888
    v_mfma_f32_16x16x32_bf16 v[68:71], v[148:151], v[36:39], v[68:71]
    buffer_load_dwordx4 v245, s[28:31], s73 offen nt lds
    v_mfma_f32_16x16x32_bf16 v[68:71], v[152:155], v[40:43], v[68:71]
    s_add_u32 s73, s62, 18432
    v_mfma_f32_16x16x32_bf16 v[68:71], v[156:159], v[44:47], v[68:71]
    s_add_u32 m0, s4, 38912
    v_mfma_f32_16x16x32_bf16 v[72:75], v[160:163], v[32:35], 0
    buffer_load_dwordx4 v246, s[28:31], s73 offen nt lds
    v_mfma_f32_16x16x32_bf16 v[72:75], v[164:167], v[36:39], v[72:75]
    s_add_u32 s73, s62, 19456
    v_mfma_f32_16x16x32_bf16 v[72:75], v[168:171], v[40:43], v[72:75]
    s_add_u32 m0, s4, 39936
    v_mfma_f32_16x16x32_bf16 v[72:75], v[172:175], v[44:47], v[72:75]
    buffer_load_dwordx4 v245, s[28:31], s73 offen nt lds
    v_mfma_f32_16x16x32_bf16 v[76:79], v[176:179], v[32:35], 0
    s_add_u32 s73, s62, 20480
    v_mfma_f32_16x16x32_bf16 v[76:79], v[180:183], v[36:39], v[76:79]
    s_add_u32 m0, s4, 40960
    v_mfma_f32_16x16x32_bf16 v[76:79], v[184:187], v[40:43], v[76:79]
    buffer_load_dwordx4 v246, s[28:31], s73 offen nt lds
    v_mfma_f32_16x16x32_bf16 v[76:79], v[188:191], v[44:47], v[76:79]
    s_add_u32 s73, s62, 21504
    v_mfma_f32_16x16x32_bf16 v[80:83], v[192:195], v[32:35], 0
    s_add_u32 m0, s4, 41984
    v_mfma_f32_16x16x32_bf16 v[80:83], v[196:199], v[36:39], v[80:83]
    buffer_load_dwordx4 v245, s[28:31], s73 offen nt lds
    v_mfma_f32_16x16x32_bf16 v[80:83], v[200:203], v[40:43], v[80:83]
    s_add_u32 s73, s62, 22528
    v_mfma_f32_16x16x32_bf16 v[80:83], v[204:207], v[44:47], v[80:83]
    s_add_u32 m0, s4, 43008
    v_mfma_f32_16x16x32_bf16 v[84:87], v[208:211], v[32:35], 0
    buffer_load_dwordx4 v246, s[28:31], s73 offen nt lds
    v_mfma_f32_16x16x32_bf16 v[84:87], v[212:215], v[36:39], v[84:87]
    s_add_u32 s73, s62, 23552
    v_mfma_f32_16x16x32_bf16 v[84:87], v[216:219], v[40:43], v[84:87]
    s_add_u32 m0, s4, 44032
    v_mfma_f32_16x16x32_bf16 v[84:87], v[220:223], v[44:47], v[84:87]
    buffer_load_dwordx4 v245, s[28:31], s73 offen nt lds
    v_mfma_f32_16x16x32_bf16 v[88:91], v[128:131], v[48:51], 0
    v_max3_f32 v124, v64, v65, v66
    v_max3_f32 v127, v67, v68, v69
    v_max3_f32 v124, v124, v70, v71
    v_max3_f32 v127, v127, v72, v73
    v_max3_f32 v124, v124, v74, v75
    v_max3_f32 v127, v127, v76, v77
    v_mfma_f32_16x16x32_bf16 v[88:91], v[132:135], v[52:55], v[88:91]
    v_max3_f32 v124, v124, v78, v79
    v_max3_f32 v127, v127, v80, v81
    v_max3_f32 v124, v124, v82, v83
    v_max3_f32 v127, v127, v84, v85
    v_max3_f32 v124, v124, v86, v87
    v_max_f32 v124, v124, v127
    v_mfma_f32_16x16x32_bf16 v[88:91], v[136:139], v[56:59], v[88:91]
    v_mov_b32 v125, v124
    s_nop 1
    v_permlane32_swap_b32 v124, v125
    v_max_f32 v124, v124, v125
    v_mov_b32 v125, v124
    s_nop 1
    v_permlane16_swap_b32 v124, v125
    v_max_f32 v124, v124, v125
    v_mfma_f32_16x16x32_bf16 v[88:91], v[140:143], v[60:63], v[88:91]
    v_mul_f32 v124, s68, v124
    v_fma_f32 v64, v64, s68, -v124
    v_fma_f32 v65, v65, s68, -v124
    v_fma_f32 v66, v66, s68, -v124
    v_fma_f32 v67, v67, s68, -v124
    v_fma_f32 v68, v68, s68, -v124
    v_mfma_f32_16x16x32_bf16 v[92:95], v[144:147], v[48:51], 0
    v_fma_f32 v69, v69, s68, -v124
    v_fma_f32 v70, v70, s68, -v124
    v_fma_f32 v71, v71, s68, -v124
    v_fma_f32 v72, v72, s68, -v124
    v_fma_f32 v73, v73, s68, -v124
    v_fma_f32 v74, v74, s68, -v124
    v_mfma_f32_16x16x32_bf16 v[92:95], v[148:151], v[52:55], v[92:95]
    v_fma_f32 v75, v75, s68, -v124
    v_fma_f32 v76, v76, s68, -v124
    v_fma_f32 v77, v77, s68, -v124
    v_fma_f32 v78, v78, s68, -v124
    v_fma_f32 v79, v79, s68, -v124
    v_fma_f32 v80, v80, s68, -v124
    v_mfma_f32_16x16x32_bf16 v[92:95], v[152:155], v[56:59], v[92:95]
    v_fma_f32 v81, v81, s68, -v124
    v_fma_f32 v82, v82, s68, -v124
    v_fma_f32 v83, v83, s68, -v124
    v_fma_f32 v84, v84, s68, -v124
    v_fma_f32 v85, v85, s68, -v124
    v_fma_f32 v86, v86, s68, -v124
    v_mfma_f32_16x16x32_bf16 v[92:95], v[156:159], v[60:63], v[92:95]
    v_fma_f32 v87, v87, s68, -v124
    v_exp_f32 v64, v64
    v_exp_f32 v65, v65
    v_exp_f32 v66, v66
    v_exp_f32 v67, v67
    v_exp_f32 v68, v68
    v_mfma_f32_16x16x32_bf16 v[96:99], v[160:163], v[48:51], 0
    v_exp_f32 v69, v69
    v_exp_f32 v70, v70
    v_exp_f32 v71, v71
    v_exp_f32 v72, v72
    v_exp_f32 v73, v73
    v_exp_f32 v74, v74
    v_mfma_f32_16x16x32_bf16 v[96:99], v[164:167], v[52:55], v[96:99]
    v_exp_f32 v75, v75
    v_exp_f32 v76, v76
    v_exp_f32 v77, v77
    v_exp_f32 v78, v78
    v_exp_f32 v79, v79
    v_exp_f32 v80, v80
    v_mfma_f32_16x16x32_bf16 v[96:99], v[168:171], v[56:59], v[96:99]
    v_exp_f32 v81, v81
    v_exp_f32 v82, v82
    v_exp_f32 v83, v83
    v_exp_f32 v84, v84
    v_exp_f32 v85, v85
    v_exp_f32 v86, v86
    v_mfma_f32_16x16x32_bf16 v[96:99], v[172:175], v[60:63], v[96:99]
    v_exp_f32 v87, v87
    v_cvt_pk_bf16_f32 v112, v64, v65
    v_cvt_pk_bf16_f32 v113, v66, v67
    v_cvt_pk_bf16_f32 v114, v68, v69
    v_cvt_pk_bf16_f32 v115, v70, v71
    v_mfma_f32_16x16x32_bf16 v[100:103], v[176:179], v[48:51], 0
    v_cvt_pk_bf16_f32 v116, v72, v73
    v_cvt_pk_bf16_f32 v117, v74, v75
    v_cvt_pk_bf16_f32 v118, v76, v77
    v_cvt_pk_bf16_f32 v119, v78, v79
    v_cvt_pk_bf16_f32 v120, v80, v81
    v_cvt_pk_bf16_f32 v121, v82, v83
    v_mfma_f32_16x16x32_bf16 v[100:103], v[180:183], v[52:55], v[100:103]
    v_cvt_pk_bf16_f32 v122, v84, v85
    v_cvt_pk_bf16_f32 v123, v86, v87
    v_accvgpr_write_b32 a0, v112
    v_accvgpr_write_b32 a1, v113
    v_accvgpr_write_b32 a2, v114
    v_accvgpr_write_b32 a3, v115
    v_mfma_f32_16x16x32_bf16 v[100:103], v[184:187], v[56:59], v[100:103]
    v_accvgpr_write_b32 a4, v116
    v_accvgpr_write_b32 a5, v117
    v_accvgpr_write_b32 a6, v118
    v_accvgpr_write_b32 a7, v119
    v_accvgpr_write_b32 a8, v120
    v_accvgpr_write_b32 a9, v121
    v_mfma_f32_16x16x32_bf16 v[100:103], v[188:191], v[60:63], v[100:103]
    v_accvgpr_write_b32 a10, v122
    v_accvgpr_write_b32 a11, v123
    v_mfma_f32_16x16x32_bf16 a[12:15], v[224:227], v[112:115], 0
    v_mfma_f32_16x16x32_bf16 a[12:15], v[224:227], v[116:119], a[12:15]
    v_mfma_f32_16x16x32_bf16 a[12:15], v[224:227], v[120:123], a[12:15]
    v_accvgpr_read_b32 v251, a64
    v_mfma_f32_16x16x32_bf16 v[104:107], v[192:195], v[48:51], 0
    v_accvgpr_read_b32 v252, a68
    v_cvt_pk_bf16_f32 v32, v251, v252
    v_accvgpr_read_b32 v253, a72
    v_accvgpr_read_b32 v254, a76
    v_cvt_pk_bf16_f32 v33, v253, v254
    v_accvgpr_read_b32 v251, a80
    v_mfma_f32_16x16x32_bf16 v[104:107], v[196:199], v[52:55], v[104:107]
    v_accvgpr_read_b32 v252, a84
    v_cvt_pk_bf16_f32 v34, v251, v252
    v_accvgpr_read_b32 v253, a88
    v_accvgpr_read_b32 v254, a92
    v_cvt_pk_bf16_f32 v35, v253, v254
    v_accvgpr_read_b32 v251, a65
    v_mfma_f32_16x16x32_bf16 v[104:107], v[200:203], v[56:59], v[104:107]
    v_accvgpr_read_b32 v252, a69
    v_cvt_pk_bf16_f32 v36, v251, v252
    v_accvgpr_read_b32 v253, a73
    v_accvgpr_read_b32 v254, a77
    v_cvt_pk_bf16_f32 v37, v253, v254
    v_accvgpr_read_b32 v251, a81
    v_mfma_f32_16x16x32_bf16 v[104:107], v[204:207], v[60:63], v[104:107]
    v_accvgpr_read_b32 v252, a85
    v_cvt_pk_bf16_f32 v38, v251, v252
    v_accvgpr_read_b32 v253, a89
    v_accvgpr_read_b32 v254, a93
    v_cvt_pk_bf16_f32 v39, v253, v254
    v_accvgpr_read_b32 v251, a66
    v_mfma_f32_16x16x32_bf16 v[108:111], v[208:211], v[48:51], 0
    v_accvgpr_read_b32 v252, a70
    v_cvt_pk_bf16_f32 v40, v251, v252
    v_accvgpr_read_b32 v253, a74
    v_accvgpr_read_b32 v254, a78
    v_cvt_pk_bf16_f32 v41, v253, v254
    v_accvgpr_read_b32 v251, a82
    v_mfma_f32_16x16x32_bf16 v[108:111], v[212:215], v[52:55], v[108:111]
    v_accvgpr_read_b32 v252, a86
    v_cvt_pk_bf16_f32 v42, v251, v252
    v_accvgpr_read_b32 v253, a90
    v_accvgpr_read_b32 v254, a94
    v_cvt_pk_bf16_f32 v43, v253, v254
    v_accvgpr_read_b32 v251, a67
    v_mfma_f32_16x16x32_bf16 v[108:111], v[216:219], v[56:59], v[108:111]
    v_accvgpr_read_b32 v252, a71
    v_cvt_pk_bf16_f32 v44, v251, v252
    v_accvgpr_read_b32 v253, a75
    v_accvgpr_read_b32 v254, a79
    v_cvt_pk_bf16_f32 v45, v253, v254
    v_accvgpr_read_b32 v251, a83
    v_mfma_f32_16x16x32_bf16 v[108:111], v[220:223], v[60:63], v[108:111]
    v_accvgpr_read_b32 v252, a87
    v_cvt_pk_bf16_f32 v46, v251, v252
    v_accvgpr_read_b32 v253, a91
    v_accvgpr_read_b32 v254, a95
    v_cvt_pk_bf16_f32 v47, v253, v254
    v_mfma_f32_16x16x32_bf16 v[64:67], v[128:131], v[32:35], 0
    v_max3_f32 v124, v88, v89, v90
    v_max3_f32 v127, v91, v92, v93
    v_max3_f32 v124, v124, v94, v95
    v_max3_f32 v127, v127, v96, v97
    v_max3_f32 v124, v124, v98, v99
    v_max3_f32 v127, v127, v100, v101
    v_mfma_f32_16x16x32_bf16 v[64:67], v[132:135], v[36:39], v[64:67]
    v_max3_f32 v124, v124, v102, v103
    v_max3_f32 v127, v127, v104, v105
    v_max3_f32 v124, v124, v106, v107
    v_max3_f32 v127, v127, v108, v109
    v_max3_f32 v124, v124, v110, v111
    v_max_f32 v124, v124, v127
    v_mfma_f32_16x16x32_bf16 v[64:67], v[136:139], v[40:43], v[64:67]
    v_mov_b32 v125, v124
    s_nop 1
    v_permlane32_swap_b32 v124, v125
    v_max_f32 v124, v124, v125
    v_mov_b32 v125, v124
    s_nop 1
    v_permlane16_swap_b32 v124, v125
    v_max_f32 v124, v124, v125
    v_mfma_f32_16x16x32_bf16 v[64:67], v[140:143], v[44:47], v[64:67]
    v_mul_f32 v124, s68, v124
    v_fma_f32 v88, v88, s68, -v124
    v_fma_f32 v89, v89, s68, -v124
    v_fma_f32 v90, v90, s68, -v124
    v_fma_f32 v91, v91, s68, -v124
    v_fma_f32 v92, v92, s68, -v124
    v_mfma_f32_16x16x32_bf16 v[68:71], v[144:147], v[32:35], 0
    v_fma_f32 v93, v93, s68, -v124
    v_fma_f32 v94, v94, s68, -v124
    v_fma_f32 v95, v95, s68, -v124
    v_fma_f32 v96, v96, s68, -v124
    v_fma_f32 v97, v97, s68, -v124
    v_fma_f32 v98, v98, s68, -v124
    v_mfma_f32_16x16x32_bf16 v[68:71], v[148:151], v[36:39], v[68:71]
    v_fma_f32 v99, v99, s68, -v124
    v_fma_f32 v100, v100, s68, -v124
    v_fma_f32 v101, v101, s68, -v124
    v_fma_f32 v102, v102, s68, -v124
    v_fma_f32 v103, v103, s68, -v124
    v_fma_f32 v104, v104, s68, -v124
    v_mfma_f32_16x16x32_bf16 v[68:71], v[152:155], v[40:43], v[68:71]
    v_fma_f32 v105, v105, s68, -v124
    v_fma_f32 v106, v106, s68, -v124
    v_fma_f32 v107, v107, s68, -v124
    v_fma_f32 v108, v108, s68, -v124
    v_fma_f32 v109, v109, s68, -v124
    v_fma_f32 v110, v110, s68, -v124
    v_mfma_f32_16x16x32_bf16 v[68:71], v[156:159], v[44:47], v[68:71]
    v_fma_f32 v111, v111, s68, -v124
    v_exp_f32 v88, v88
    v_exp_f32 v89, v89
    v_exp_f32 v90, v90
    v_exp_f32 v91, v91
    v_exp_f32 v92, v92
    v_mfma_f32_16x16x32_bf16 v[72:75], v[160:163], v[32:35], 0
    v_exp_f32 v93, v93
    v_exp_f32 v94, v94
    v_exp_f32 v95, v95
    v_exp_f32 v96, v96
    v_exp_f32 v97, v97
    v_exp_f32 v98, v98
    v_mfma_f32_16x16x32_bf16 v[72:75], v[164:167], v[36:39], v[72:75]
    v_exp_f32 v99, v99
    v_exp_f32 v100, v100
    v_exp_f32 v101, v101
    v_exp_f32 v102, v102
    v_exp_f32 v103, v103
    v_exp_f32 v104, v104
    v_mfma_f32_16x16x32_bf16 v[72:75], v[168:171], v[40:43], v[72:75]
    v_exp_f32 v105, v105
    v_exp_f32 v106, v106
    v_exp_f32 v107, v107
    v_exp_f32 v108, v108
    v_exp_f32 v109, v109
    v_exp_f32 v110, v110
    v_mfma_f32_16x16x32_bf16 v[72:75], v[172:175], v[44:47], v[72:75]
    v_exp_f32 v111, v111
    v_cvt_pk_bf16_f32 v112, v88, v89
    v_cvt_pk_bf16_f32 v113, v90, v91
    v_cvt_pk_bf16_f32 v114, v92, v93
    v_cvt_pk_bf16_f32 v115, v94, v95
    v_mfma_f32_16x16x32_bf16 v[76:79], v[176:179], v[32:35], 0
    v_cvt_pk_bf16_f32 v116, v96, v97
    v_cvt_pk_bf16_f32 v117, v98, v99
    v_cvt_pk_bf16_f32 v118, v100, v101
    v_cvt_pk_bf16_f32 v119, v102, v103
    v_cvt_pk_bf16_f32 v120, v104, v105
    v_cvt_pk_bf16_f32 v121, v106, v107
    v_mfma_f32_16x16x32_bf16 v[76:79], v[180:183], v[36:39], v[76:79]
    v_cvt_pk_bf16_f32 v122, v108, v109
    v_cvt_pk_bf16_f32 v123, v110, v111
    v_accvgpr_write_b32 a32, v112
    v_accvgpr_write_b32 a33, v113
    v_accvgpr_write_b32 a34, v114
    v_accvgpr_write_b32 a35, v115
    v_mfma_f32_16x16x32_bf16 v[76:79], v[184:187], v[40:43], v[76:79]
    v_accvgpr_write_b32 a36, v116
    v_accvgpr_write_b32 a37, v117
    v_accvgpr_write_b32 a38, v118
    v_accvgpr_write_b32 a39, v119
    v_accvgpr_write_b32 a40, v120
    v_accvgpr_write_b32 a41, v121
    v_mfma_f32_16x16x32_bf16 v[76:79], v[188:191], v[44:47], v[76:79]
    v_accvgpr_write_b32 a42, v122
    v_accvgpr_write_b32 a43, v123
    v_mfma_f32_16x16x32_bf16 a[44:47], v[224:227], v[112:115], 0
    v_mfma_f32_16x16x32_bf16 a[44:47], v[224:227], v[116:119], a[44:47]
    v_mfma_f32_16x16x32_bf16 a[44:47], v[224:227], v[120:123], a[44:47]
    v_accvgpr_read_b32 v251, a96
    v_mfma_f32_16x16x32_bf16 v[80:83], v[192:195], v[32:35], 0
    v_accvgpr_read_b32 v252, a100
    v_cvt_pk_bf16_f32 v48, v251, v252
    v_accvgpr_read_b32 v253, a104
    v_accvgpr_read_b32 v254, a108
    v_cvt_pk_bf16_f32 v49, v253, v254
    v_accvgpr_read_b32 v251, a112
    v_mfma_f32_16x16x32_bf16 v[80:83], v[196:199], v[36:39], v[80:83]
    v_accvgpr_read_b32 v252, a116
    v_cvt_pk_bf16_f32 v50, v251, v252
    v_accvgpr_read_b32 v253, a120
    v_accvgpr_read_b32 v254, a124
    v_cvt_pk_bf16_f32 v51, v253, v254
    v_accvgpr_read_b32 v251, a97
    v_mfma_f32_16x16x32_bf16 v[80:83], v[200:203], v[40:43], v[80:83]
    v_accvgpr_read_b32 v252, a101
    v_cvt_pk_bf16_f32 v52, v251, v252
    v_accvgpr_read_b32 v253, a105
    v_accvgpr_read_b32 v254, a109
    v_cvt_pk_bf16_f32 v53, v253, v254
    v_accvgpr_read_b32 v251, a113
    v_mfma_f32_16x16x32_bf16 v[80:83], v[204:207], v[44:47], v[80:83]
    v_accvgpr_read_b32 v252, a117
    v_cvt_pk_bf16_f32 v54, v251, v252
    v_accvgpr_read_b32 v253, a121
    v_accvgpr_read_b32 v254, a125
    v_cvt_pk_bf16_f32 v55, v253, v254
    v_accvgpr_read_b32 v251, a98
    v_mfma_f32_16x16x32_bf16 v[84:87], v[208:211], v[32:35], 0
    v_accvgpr_read_b32 v252, a102
    v_cvt_pk_bf16_f32 v56, v251, v252
    v_accvgpr_read_b32 v253, a106
    v_accvgpr_read_b32 v254, a110
    v_cvt_pk_bf16_f32 v57, v253, v254
    v_accvgpr_read_b32 v251, a114
    v_mfma_f32_16x16x32_bf16 v[84:87], v[212:215], v[36:39], v[84:87]
    v_accvgpr_read_b32 v252, a118
    v_cvt_pk_bf16_f32 v58, v251, v252
    v_accvgpr_read_b32 v253, a122
    v_accvgpr_read_b32 v254, a126
    v_cvt_pk_bf16_f32 v59, v253, v254
    v_accvgpr_read_b32 v251, a99
    v_mfma_f32_16x16x32_bf16 v[84:87], v[216:219], v[40:43], v[84:87]
    v_accvgpr_read_b32 v252, a103
    v_cvt_pk_bf16_f32 v60, v251, v252
    v_accvgpr_read_b32 v253, a107
    v_accvgpr_read_b32 v254, a111
    v_cvt_pk_bf16_f32 v61, v253, v254
    v_accvgpr_read_b32 v251, a115
    v_mfma_f32_16x16x32_bf16 v[84:87], v[220:223], v[44:47], v[84:87]
    v_accvgpr_read_b32 v252, a119
    v_cvt_pk_bf16_f32 v62, v251, v252
    v_accvgpr_read_b32 v253, a123
    v_accvgpr_read_b32 v254, a127
    v_cvt_pk_bf16_f32 v63, v253, v254
    v_mfma_f32_16x16x32_bf16 v[88:91], v[128:131], v[48:51], 0
    s_lshl_b32 s75, s64, 2
    v_max3_f32 v124, v64, v65, v66
    v_max3_f32 v127, v67, v68, v69
    v_max3_f32 v124, v124, v70, v71
    v_max3_f32 v127, v127, v72, v73
    v_max3_f32 v124, v124, v74, v75
    v_max3_f32 v127, v127, v76, v77
    v_mfma_f32_16x16x32_bf16 v[88:91], v[132:135], v[52:55], v[88:91]
    v_max3_f32 v124, v124, v78, v79
    v_max3_f32 v127, v127, v80, v81
    v_max3_f32 v124, v124, v82, v83
    v_max3_f32 v127, v127, v84, v85
    v_max3_f32 v124, v124, v86, v87
    v_max_f32 v124, v124, v127
    v_mfma_f32_16x16x32_bf16 v[88:91], v[136:139], v[56:59], v[88:91]
    v_mov_b32 v125, v124
    s_nop 1
    v_permlane32_swap_b32 v124, v125
    v_max_f32 v124, v124, v125
    v_mov_b32 v125, v124
    s_nop 1
    v_permlane16_swap_b32 v124, v125
    v_max_f32 v124, v124, v125
    v_mfma_f32_16x16x32_bf16 v[88:91], v[140:143], v[60:63], v[88:91]
    v_mul_f32 v124, s68, v124
    v_fma_f32 v64, v64, s68, -v124
    s_add_u32 s75, s75, s3
    v_fma_f32 v65, v65, s68, -v124
    v_fma_f32 v66, v66, s68, -v124
    v_fma_f32 v67, v67, s68, -v124
    v_mfma_f32_16x16x32_bf16 v[92:95], v[144:147], v[48:51], 0
    v_fma_f32 v68, v68, s68, -v124
    v_fma_f32 v69, v69, s68, -v124
    v_fma_f32 v70, v70, s68, -v124
    v_fma_f32 v71, v71, s68, -v124
    v_fma_f32 v72, v72, s68, -v124
    v_fma_f32 v73, v73, s68, -v124
    v_fma_f32 v74, v74, s68, -v124
    v_mfma_f32_16x16x32_bf16 v[92:95], v[148:151], v[52:55], v[92:95]
    v_fma_f32 v75, v75, s68, -v124
    v_fma_f32 v76, v76, s68, -v124
    v_fma_f32 v77, v77, s68, -v124
    v_fma_f32 v78, v78, s68, -v124
    v_fma_f32 v79, v79, s68, -v124
    v_fma_f32 v80, v80, s68, -v124
    v_mfma_f32_16x16x32_bf16 v[92:95], v[152:155], v[56:59], v[92:95]
    v_fma_f32 v81, v81, s68, -v124
    v_fma_f32 v82, v82, s68, -v124
    v_fma_f32 v83, v83, s68, -v124
    v_fma_f32 v84, v84, s68, -v124
    s_lshl_b32 s75, s75, 13
    v_fma_f32 v85, v85, s68, -v124
    v_mfma_f32_16x16x32_bf16 v[92:95], v[156:159], v[60:63], v[92:95]
    v_fma_f32 v86, v86, s68, -v124
    v_fma_f32 v87, v87, s68, -v124
    v_exp_f32 v64, v64
    v_exp_f32 v65, v65
    v_exp_f32 v66, v66
    v_exp_f32 v67, v67
    v_mfma_f32_16x16x32_bf16 v[96:99], v[160:163], v[48:51], 0
    v_exp_f32 v68, v68
    v_exp_f32 v69, v69
    v_exp_f32 v70, v70
    v_exp_f32 v71, v71
    v_exp_f32 v72, v72
    v_exp_f32 v73, v73
    v_mfma_f32_16x16x32_bf16 v[96:99], v[164:167], v[52:55], v[96:99]
    v_exp_f32 v74, v74
    v_exp_f32 v75, v75
    v_exp_f32 v76, v76
    v_exp_f32 v77, v77
    v_exp_f32 v78, v78
    v_exp_f32 v79, v79
    v_exp_f32 v80, v80
    v_mfma_f32_16x16x32_bf16 v[96:99], v[168:171], v[56:59], v[96:99]
    s_lshl_b32 s76, s63, 19
    v_exp_f32 v81, v81
    v_exp_f32 v82, v82
    v_exp_f32 v83, v83
    v_exp_f32 v84, v84
    v_exp_f32 v85, v85
    v_mfma_f32_16x16x32_bf16 v[96:99], v[172:175], v[60:63], v[96:99]
    v_exp_f32 v86, v86
    v_exp_f32 v87, v87
    v_cvt_pk_bf16_f32 v112, v64, v65
    v_cvt_pk_bf16_f32 v113, v66, v67
    v_cvt_pk_bf16_f32 v114, v68, v69
    v_cvt_pk_bf16_f32 v115, v70, v71
    v_mfma_f32_16x16x32_bf16 v[100:103], v[176:179], v[48:51], 0
    v_cvt_pk_bf16_f32 v116, v72, v73
    v_cvt_pk_bf16_f32 v117, v74, v75
    v_cvt_pk_bf16_f32 v118, v76, v77
    v_cvt_pk_bf16_f32 v119, v78, v79
    v_cvt_pk_bf16_f32 v120, v80, v81
    v_cvt_pk_bf16_f32 v121, v82, v83
    v_mfma_f32_16x16x32_bf16 v[100:103], v[180:183], v[52:55], v[100:103]
    v_cvt_pk_bf16_f32 v122, v84, v85
    v_cvt_pk_bf16_f32 v123, v86, v87
    v_accvgpr_write_b32 a64, v112
    s_add_u32 s75, s75, s76
    v_accvgpr_write_b32 a65, v113
    v_accvgpr_write_b32 a66, v114
    v_mfma_f32_16x16x32_bf16 v[100:103], v[184:187], v[56:59], v[100:103]
    v_accvgpr_write_b32 a67, v115
    v_accvgpr_write_b32 a68, v116
    v_accvgpr_write_b32 a69, v117
    v_accvgpr_write_b32 a70, v118
    v_accvgpr_write_b32 a71, v119
    v_accvgpr_write_b32 a72, v120
    v_accvgpr_write_b32 a73, v121
    v_mfma_f32_16x16x32_bf16 v[100:103], v[188:191], v[60:63], v[100:103]
    v_accvgpr_write_b32 a74, v122
    v_accvgpr_write_b32 a75, v123
    v_mfma_f32_16x16x32_bf16 a[76:79], v[224:227], v[112:115], 0
    v_mfma_f32_16x16x32_bf16 a[76:79], v[224:227], v[116:119], a[76:79]
    v_mfma_f32_16x16x32_bf16 a[76:79], v[224:227], v[120:123], a[76:79]
    v_accvgpr_read_b32 v251, a128
    v_mfma_f32_16x16x32_bf16 v[104:107], v[192:195], v[48:51], 0
    v_accvgpr_read_b32 v252, a132
    v_cvt_pk_bf16_f32 v32, v251, v252
    v_accvgpr_read_b32 v253, a136
    v_accvgpr_read_b32 v254, a140
    v_cvt_pk_bf16_f32 v33, v253, v254
    v_lshlrev_b32 v255, 3, v248
    v_mfma_f32_16x16x32_bf16 v[104:107], v[196:199], v[52:55], v[104:107]
    v_accvgpr_read_b32 v251, a144
    v_accvgpr_read_b32 v252, a148
    v_cvt_pk_bf16_f32 v34, v251, v252
    v_accvgpr_read_b32 v253, a152
    v_accvgpr_read_b32 v254, a156
    v_cvt_pk_bf16_f32 v35, v253, v254
    v_mfma_f32_16x16x32_bf16 v[104:107], v[200:203], v[56:59], v[104:107]
    v_accvgpr_read_b32 v251, a129
    v_accvgpr_read_b32 v252, a133
    v_cvt_pk_bf16_f32 v36, v251, v252
    v_accvgpr_read_b32 v253, a137
    v_accvgpr_read_b32 v254, a141
    v_cvt_pk_bf16_f32 v37, v253, v254
    v_mfma_f32_16x16x32_bf16 v[104:107], v[204:207], v[60:63], v[104:107]
    v_accvgpr_read_b32 v251, a145
    v_accvgpr_read_b32 v252, a149
    v_cvt_pk_bf16_f32 v38, v251, v252
    v_accvgpr_read_b32 v253, a153
    v_accvgpr_read_b32 v254, a157
    v_cvt_pk_bf16_f32 v39, v253, v254
    v_accvgpr_read_b32 v251, a130
    v_mfma_f32_16x16x32_bf16 v[108:111], v[208:211], v[48:51], 0
    v_accvgpr_read_b32 v252, a134
    buffer_load_dword v255, v255, s[40:43], s75 offen
    v_cvt_pk_bf16_f32 v40, v251, v252
    v_accvgpr_read_b32 v253, a138
    v_accvgpr_read_b32 v254, a142
    v_cvt_pk_bf16_f32 v41, v253, v254
    v_mfma_f32_16x16x32_bf16 v[108:111], v[212:215], v[52:55], v[108:111]
    v_accvgpr_read_b32 v251, a146
    v_accvgpr_read_b32 v252, a150
    v_cvt_pk_bf16_f32 v42, v251, v252
    v_accvgpr_read_b32 v253, a154
    v_accvgpr_read_b32 v254, a158
    v_cvt_pk_bf16_f32 v43, v253, v254
    v_mfma_f32_16x16x32_bf16 v[108:111], v[216:219], v[56:59], v[108:111]
    v_accvgpr_read_b32 v251, a131
    v_accvgpr_read_b32 v252, a135
    v_cvt_pk_bf16_f32 v44, v251, v252
    v_accvgpr_read_b32 v253, a139
    v_accvgpr_read_b32 v254, a143
    v_cvt_pk_bf16_f32 v45, v253, v254
    v_mfma_f32_16x16x32_bf16 v[108:111], v[220:223], v[60:63], v[108:111]
    v_accvgpr_read_b32 v251, a147
    v_accvgpr_read_b32 v252, a151
    v_cvt_pk_bf16_f32 v46, v251, v252
    v_accvgpr_read_b32 v253, a155
    v_accvgpr_read_b32 v254, a159
    v_cvt_pk_bf16_f32 v47, v253, v254
    v_mfma_f32_16x16x32_bf16 v[64:67], v[128:131], v[32:35], 0
    buffer_load_dword v240, off, s[36:39], s87
    v_max3_f32 v124, v88, v89, v90
    v_max3_f32 v127, v91, v92, v93
    v_max3_f32 v124, v124, v94, v95
    v_max3_f32 v127, v127, v96, v97
    v_max3_f32 v124, v124, v98, v99
    v_max3_f32 v127, v127, v100, v101
    v_max3_f32 v124, v124, v102, v103
    v_mfma_f32_16x16x32_bf16 v[64:67], v[132:135], v[36:39], v[64:67]
    v_max3_f32 v127, v127, v104, v105
    v_max3_f32 v124, v124, v106, v107
    v_max3_f32 v127, v127, v108, v109
    v_max3_f32 v124, v124, v110, v111
    v_max_f32 v124, v124, v127
    v_mov_b32 v125, v124
    s_nop 1
    v_permlane32_swap_b32 v124, v125
    v_mfma_f32_16x16x32_bf16 v[64:67], v[136:139], v[40:43], v[64:67]
    v_max_f32 v124, v124, v125
    v_mov_b32 v125, v124
    s_nop 1
    v_permlane16_swap_b32 v124, v125
    v_max_f32 v124, v124, v125
    v_mul_f32 v124, s68, v124
    v_fma_f32 v88, v88, s68, -v124
    v_fma_f32 v89, v89, s68, -v124
    v_mfma_f32_16x16x32_bf16 v[64:67], v[140:143], v[44:47], v[64:67]
    v_fma_f32 v90, v90, s68, -v124
    v_fma_f32 v91, v91, s68, -v124
    v_fma_f32 v92, v92, s68, -v124
    v_fma_f32 v93, v93, s68, -v124
    v_fma_f32 v94, v94, s68, -v124
    v_fma_f32 v95, v95, s68, -v124
    v_fma_f32 v96, v96, s68, -v124
    v_mfma_f32_16x16x32_bf16 v[68:71], v[144:147], v[32:35], 0
    v_fma_f32 v97, v97, s68, -v124
    v_fma_f32 v98, v98, s68, -v124
    v_fma_f32 v99, v99, s68, -v124
    v_fma_f32 v100, v100, s68, -v124
    v_fma_f32 v101, v101, s68, -v124
    buffer_load_dword v240, off, s[36:39], s89
    v_fma_f32 v102, v102, s68, -v124
    v_mfma_f32_16x16x32_bf16 v[68:71], v[148:151], v[36:39], v[68:71]
    v_fma_f32 v103, v103, s68, -v124
    v_fma_f32 v104, v104, s68, -v124
    v_fma_f32 v105, v105, s68, -v124
    v_fma_f32 v106, v106, s68, -v124
    v_fma_f32 v107, v107, s68, -v124
    v_fma_f32 v108, v108, s68, -v124
    v_fma_f32 v109, v109, s68, -v124
    v_mfma_f32_16x16x32_bf16 v[68:71], v[152:155], v[40:43], v[68:71]
    v_fma_f32 v110, v110, s68, -v124
    v_fma_f32 v111, v111, s68, -v124
    v_exp_f32 v88, v88
    v_exp_f32 v89, v89
    v_exp_f32 v90, v90
    v_exp_f32 v91, v91
    v_exp_f32 v92, v92
    v_exp_f32 v93, v93
    v_mfma_f32_16x16x32_bf16 v[68:71], v[156:159], v[44:47], v[68:71]
    v_exp_f32 v94, v94
    v_exp_f32 v95, v95
    v_exp_f32 v96, v96
    v_exp_f32 v97, v97
    v_exp_f32 v98, v98
    v_exp_f32 v99, v99
    v_exp_f32 v100, v100
    v_mfma_f32_16x16x32_bf16 v[72:75], v[160:163], v[32:35], 0
    v_exp_f32 v101, v101
    v_exp_f32 v102, v102
    v_exp_f32 v103, v103
    v_exp_f32 v104, v104
    v_exp_f32 v105, v105
    v_exp_f32 v106, v106
    v_exp_f32 v107, v107
    v_mfma_f32_16x16x32_bf16 v[72:75], v[164:167], v[36:39], v[72:75]
    v_exp_f32 v108, v108
    v_exp_f32 v109, v109
    v_exp_f32 v110, v110
    buffer_load_dword v240, off, s[36:39], s90
    v_exp_f32 v111, v111
    v_cvt_pk_bf16_f32 v112, v88, v89
    v_cvt_pk_bf16_f32 v113, v90, v91
    v_mfma_f32_16x16x32_bf16 v[72:75], v[168:171], v[40:43], v[72:75]
    v_cvt_pk_bf16_f32 v114, v92, v93
    v_cvt_pk_bf16_f32 v115, v94, v95
    v_cvt_pk_bf16_f32 v116, v96, v97
    v_cvt_pk_bf16_f32 v117, v98, v99
    v_cvt_pk_bf16_f32 v118, v100, v101
    v_cvt_pk_bf16_f32 v119, v102, v103
    v_cvt_pk_bf16_f32 v120, v104, v105
    v_mfma_f32_16x16x32_bf16 v[72:75], v[172:175], v[44:47], v[72:75]
    v_cvt_pk_bf16_f32 v121, v106, v107
    v_cvt_pk_bf16_f32 v122, v108, v109
    v_cvt_pk_bf16_f32 v123, v110, v111
    v_accvgpr_write_b32 a96, v112
    v_accvgpr_write_b32 a97, v113
    v_accvgpr_write_b32 a98, v114
    v_accvgpr_write_b32 a99, v115
    v_mfma_f32_16x16x32_bf16 v[76:79], v[176:179], v[32:35], 0
    v_accvgpr_write_b32 a100, v116
    v_accvgpr_write_b32 a101, v117
    v_accvgpr_write_b32 a102, v118
    v_accvgpr_write_b32 a103, v119
    v_accvgpr_write_b32 a104, v120
    v_accvgpr_write_b32 a105, v121
    v_accvgpr_write_b32 a106, v122
    v_accvgpr_write_b32 a107, v123
    v_mfma_f32_16x16x32_bf16 v[76:79], v[180:183], v[36:39], v[76:79]
    v_mfma_f32_16x16x32_bf16 a[108:111], v[224:227], v[112:115], 0
    v_mfma_f32_16x16x32_bf16 a[108:111], v[224:227], v[116:119], a[108:111]
    v_mfma_f32_16x16x32_bf16 a[108:111], v[224:227], v[120:123], a[108:111]
    v_accvgpr_read_b32 v251, a160
    v_accvgpr_read_b32 v252, a164
    v_cvt_pk_bf16_f32 v48, v251, v252
    v_accvgpr_read_b32 v253, a168
    v_mfma_f32_16x16x32_bf16 v[76:79], v[184:187], v[40:43], v[76:79]
    v_accvgpr_read_b32 v254, a172
    buffer_load_dword v240, off, s[36:39], s88
    v_cvt_pk_bf16_f32 v49, v253, v254
    v_accvgpr_read_b32 v251, a176
    v_accvgpr_read_b32 v252, a180
    v_cvt_pk_bf16_f32 v50, v251, v252
    v_accvgpr_read_b32 v253, a184
    v_mfma_f32_16x16x32_bf16 v[76:79], v[188:191], v[44:47], v[76:79]
    v_accvgpr_read_b32 v254, a188
    v_cvt_pk_bf16_f32 v51, v253, v254
    v_accvgpr_read_b32 v251, a161
    v_accvgpr_read_b32 v252, a165
    v_cvt_pk_bf16_f32 v52, v251, v252
    v_accvgpr_read_b32 v253, a169
    v_accvgpr_read_b32 v254, a173
    v_mfma_f32_16x16x32_bf16 v[80:83], v[192:195], v[32:35], 0
    v_cvt_pk_bf16_f32 v53, v253, v254
    v_accvgpr_read_b32 v251, a177
    v_accvgpr_read_b32 v252, a181
    v_cvt_pk_bf16_f32 v54, v251, v252
    v_accvgpr_read_b32 v253, a185
    v_accvgpr_read_b32 v254, a189
    v_cvt_pk_bf16_f32 v55, v253, v254
    v_mfma_f32_16x16x32_bf16 v[80:83], v[196:199], v[36:39], v[80:83]
    v_accvgpr_read_b32 v251, a162
    v_accvgpr_read_b32 v252, a166
    v_cvt_pk_bf16_f32 v56, v251, v252
    v_accvgpr_read_b32 v253, a170
    v_accvgpr_read_b32 v254, a174
    v_cvt_pk_bf16_f32 v57, v253, v254
    v_accvgpr_read_b32 v251, a178
    v_mfma_f32_16x16x32_bf16 v[80:83], v[200:203], v[40:43], v[80:83]
    v_accvgpr_read_b32 v252, a182
    v_cvt_pk_bf16_f32 v58, v251, v252
    v_accvgpr_read_b32 v253, a186
    v_accvgpr_read_b32 v254, a190
    v_cvt_pk_bf16_f32 v59, v253, v254
    v_accvgpr_read_b32 v251, a163
    v_accvgpr_read_b32 v252, a167
    buffer_load_dword v240, off, s[44:47], s93
    v_mfma_f32_16x16x32_bf16 v[80:83], v[204:207], v[44:47], v[80:83]
    v_cvt_pk_bf16_f32 v60, v251, v252
    v_accvgpr_read_b32 v253, a171
    v_accvgpr_read_b32 v254, a175
    v_cvt_pk_bf16_f32 v61, v253, v254
    v_accvgpr_read_b32 v251, a179
    v_accvgpr_read_b32 v252, a183
    v_cvt_pk_bf16_f32 v62, v251, v252
    v_mfma_f32_16x16x32_bf16 v[84:87], v[208:211], v[32:35], 0
    v_accvgpr_read_b32 v253, a187
    v_accvgpr_read_b32 v254, a191
    v_cvt_pk_bf16_f32 v63, v253, v254
    v_lshrrev_b32 v8, 6, v248
    v_and_b32 v9, 7, v8
    v_lshlrev_b32 v9, 4, v9
    v_lshl_add_u32 v0, v8, 8, v9
    v_mfma_f32_16x16x32_bf16 v[84:87], v[212:215], v[36:39], v[84:87]
    v_and_b32 v8, 32, v248
    v_lshl_add_u32 v0, v8, 2, v0
    v_and_b32 v8, 16, v248
    v_lshrrev_b32 v8, 1, v8
    v_add_u32 v0, v8, v0
    v_add_u32 v8, s4, v0
    v_add_u32 v0, s92, v0
    v_mfma_f32_16x16x32_bf16 v[84:87], v[216:219], v[40:43], v[84:87]
    v_xor_b32 v1, 16, v0
    v_xor_b32 v9, 16, v8
    v_xor_b32 v2, 32, v0
    v_xor_b32 v10, 32, v8
    v_xor_b32 v3, 48, v0
    v_xor_b32 v11, 48, v8
    v_xor_b32 v4, 64, v0
    v_mfma_f32_16x16x32_bf16 v[84:87], v[220:223], v[44:47], v[84:87]
    v_xor_b32 v12, 64, v8
    v_xor_b32 v5, 80, v0
    v_xor_b32 v13, 80, v8
    v_xor_b32 v6, 96, v0
    v_xor_b32 v14, 96, v8
    v_xor_b32 v7, 112, v0
    v_xor_b32 v15, 112, v8
    v_mfma_f32_16x16x32_bf16 v[88:91], v[128:131], v[48:51], 0
    v_max3_f32 v124, v64, v65, v66
    v_max3_f32 v127, v67, v68, v69
    v_max3_f32 v124, v124, v70, v71
    v_max3_f32 v127, v127, v72, v73
    v_mfma_f32_16x16x32_bf16 v[88:91], v[132:135], v[52:55], v[88:91]
    v_max3_f32 v124, v124, v74, v75
    v_max3_f32 v127, v127, v76, v77
    v_max3_f32 v124, v124, v78, v79
    v_max3_f32 v127, v127, v80, v81
    v_mfma_f32_16x16x32_bf16 v[88:91], v[136:139], v[56:59], v[88:91]
    v_max3_f32 v124, v124, v82, v83
    v_max3_f32 v127, v127, v84, v85
    v_max3_f32 v124, v124, v86, v87
    v_max_f32 v124, v124, v127
    v_mfma_f32_16x16x32_bf16 v[88:91], v[140:143], v[60:63], v[88:91]
    v_mov_b32 v125, v124
    s_nop 1
    v_permlane32_swap_b32 v124, v125
    v_max_f32 v124, v124, v125
    v_mov_b32 v125, v124
    v_mfma_f32_16x16x32_bf16 v[92:95], v[144:147], v[48:51], 0
    s_nop 0
    v_permlane16_swap_b32 v124, v125
    v_max_f32 v124, v124, v125
    v_mul_f32 v124, s68, v124
    v_fma_f32 v64, v64, s68, -v124
    v_mfma_f32_16x16x32_bf16 v[92:95], v[148:151], v[52:55], v[92:95]
    v_fma_f32 v65, v65, s68, -v124
    v_fma_f32 v66, v66, s68, -v124
    v_fma_f32 v67, v67, s68, -v124
    v_fma_f32 v68, v68, s68, -v124
    v_mfma_f32_16x16x32_bf16 v[92:95], v[152:155], v[56:59], v[92:95]
    v_fma_f32 v69, v69, s68, -v124
    v_fma_f32 v70, v70, s68, -v124
    v_fma_f32 v71, v71, s68, -v124
    v_fma_f32 v72, v72, s68, -v124
    v_mfma_f32_16x16x32_bf16 v[92:95], v[156:159], v[60:63], v[92:95]
    v_fma_f32 v73, v73, s68, -v124
    v_fma_f32 v74, v74, s68, -v124
    v_fma_f32 v75, v75, s68, -v124
    v_fma_f32 v76, v76, s68, -v124
    s_waitcnt vmcnt(6)
    v_mfma_f32_16x16x32_bf16 v[96:99], v[160:163], v[48:51], 0
    ds_read_b64_tr_b16 v[128:129], v0 offset:0
    v_fma_f32 v77, v77, s68, -v124
    v_fma_f32 v78, v78, s68, -v124
    ds_read_b64_tr_b16 v[130:131], v0 offset:4096
    v_fma_f32 v79, v79, s68, -v124
    v_fma_f32 v80, v80, s68, -v124
    v_mfma_f32_16x16x32_bf16 v[96:99], v[164:167], v[52:55], v[96:99]
    ds_read_b64_tr_b16 v[132:133], v1 offset:0
    v_fma_f32 v81, v81, s68, -v124
    v_fma_f32 v82, v82, s68, -v124
    ds_read_b64_tr_b16 v[134:135], v1 offset:4096
    v_fma_f32 v83, v83, s68, -v124
    v_fma_f32 v84, v84, s68, -v124
    v_mfma_f32_16x16x32_bf16 v[96:99], v[168:171], v[56:59], v[96:99]
    ds_read_b64_tr_b16 v[136:137], v2 offset:0
    v_fma_f32 v85, v85, s68, -v124
    v_fma_f32 v86, v86, s68, -v124
    ds_read_b64_tr_b16 v[138:139], v2 offset:4096
    v_fma_f32 v87, v87, s68, -v124
    v_exp_f32 v64, v64
    v_mfma_f32_16x16x32_bf16 v[96:99], v[172:175], v[60:63], v[96:99]
    ds_read_b64_tr_b16 v[140:141], v3 offset:0
    v_exp_f32 v65, v65
    v_exp_f32 v66, v66
    ds_read_b64_tr_b16 v[142:143], v3 offset:4096
    v_exp_f32 v67, v67
    v_exp_f32 v68, v68
    v_mfma_f32_16x16x32_bf16 v[100:103], v[176:179], v[48:51], 0
    ds_read_b64_tr_b16 v[144:145], v4 offset:0
    v_exp_f32 v69, v69
    v_exp_f32 v70, v70
    ds_read_b64_tr_b16 v[146:147], v4 offset:4096
    v_exp_f32 v71, v71
    v_exp_f32 v72, v72
    v_mfma_f32_16x16x32_bf16 v[100:103], v[180:183], v[52:55], v[100:103]
    ds_read_b64_tr_b16 v[148:149], v5 offset:0
    v_exp_f32 v73, v73
    v_exp_f32 v74, v74
    ds_read_b64_tr_b16 v[150:151], v5 offset:4096
    v_exp_f32 v75, v75
    v_exp_f32 v76, v76
    v_mfma_f32_16x16x32_bf16 v[100:103], v[184:187], v[56:59], v[100:103]
    ds_read_b64_tr_b16 v[152:153], v6 offset:0
    v_exp_f32 v77, v77
    v_exp_f32 v78, v78
    ds_read_b64_tr_b16 v[154:155], v6 offset:4096
    v_exp_f32 v79, v79
    v_exp_f32 v80, v80
    v_mfma_f32_16x16x32_bf16 v[100:103], v[188:191], v[60:63], v[100:103]
    ds_read_b64_tr_b16 v[156:157], v7 offset:0
    v_exp_f32 v81, v81
    v_exp_f32 v82, v82
    ds_read_b64_tr_b16 v[158:159], v7 offset:4096
    v_exp_f32 v83, v83
    v_exp_f32 v84, v84
    v_mfma_f32_16x16x32_bf16 v[104:107], v[192:195], v[48:51], 0
    ds_read_b64_tr_b16 v[160:161], v0 offset:8192
    v_exp_f32 v85, v85
    ds_read_b64_tr_b16 v[162:163], v0 offset:12288
    v_exp_f32 v86, v86
    ds_read_b64_tr_b16 v[164:165], v1 offset:8192
    v_exp_f32 v87, v87
    v_mfma_f32_16x16x32_bf16 v[104:107], v[196:199], v[52:55], v[104:107]
    ds_read_b64_tr_b16 v[166:167], v1 offset:12288
    v_cvt_pk_bf16_f32 v112, v64, v65
    ds_read_b64_tr_b16 v[168:169], v2 offset:8192
    v_cvt_pk_bf16_f32 v113, v66, v67
    ds_read_b64_tr_b16 v[170:171], v2 offset:12288
    v_cvt_pk_bf16_f32 v114, v68, v69
    v_mfma_f32_16x16x32_bf16 v[104:107], v[200:203], v[56:59], v[104:107]
    ds_read_b64_tr_b16 v[172:173], v3 offset:8192
    v_cvt_pk_bf16_f32 v115, v70, v71
    ds_read_b64_tr_b16 v[174:175], v3 offset:12288
    v_cvt_pk_bf16_f32 v116, v72, v73
    ds_read_b64_tr_b16 v[176:177], v4 offset:8192
    v_cvt_pk_bf16_f32 v117, v74, v75
    v_mfma_f32_16x16x32_bf16 v[104:107], v[204:207], v[60:63], v[104:107]
    ds_read_b64_tr_b16 v[178:179], v4 offset:12288
    v_cvt_pk_bf16_f32 v118, v76, v77
    ds_read_b64_tr_b16 v[180:181], v5 offset:8192
    v_cvt_pk_bf16_f32 v119, v78, v79
    ds_read_b64_tr_b16 v[182:183], v5 offset:12288
    v_mfma_f32_16x16x32_bf16 v[108:111], v[208:211], v[48:51], 0
    v_cvt_pk_bf16_f32 v120, v80, v81
    ds_read_b64_tr_b16 v[184:185], v6 offset:8192
    v_cvt_pk_bf16_f32 v121, v82, v83
    ds_read_b64_tr_b16 v[186:187], v6 offset:12288
    v_cvt_pk_bf16_f32 v122, v84, v85
    ds_read_b64_tr_b16 v[188:189], v7 offset:8192
    v_mfma_f32_16x16x32_bf16 v[108:111], v[212:215], v[52:55], v[108:111]
    v_cvt_pk_bf16_f32 v123, v86, v87
    ds_read_b64_tr_b16 v[190:191], v7 offset:12288
    v_accvgpr_write_b32 a128, v112
    v_accvgpr_write_b32 a129, v113
    v_accvgpr_write_b32 a130, v114
    v_accvgpr_write_b32 a131, v115
    v_mfma_f32_16x16x32_bf16 v[108:111], v[216:219], v[56:59], v[108:111]
    v_accvgpr_write_b32 a132, v116
    v_accvgpr_write_b32 a133, v117
    v_accvgpr_write_b32 a134, v118
    v_accvgpr_write_b32 a135, v119
    v_accvgpr_write_b32 a136, v120
    v_accvgpr_write_b32 a137, v121
    v_mfma_f32_16x16x32_bf16 v[108:111], v[220:223], v[60:63], v[108:111]
    v_accvgpr_write_b32 a138, v122
    v_accvgpr_write_b32 a139, v123
    v_mfma_f32_16x16x32_bf16 a[140:143], v[224:227], v[112:115], 0
    v_mfma_f32_16x16x32_bf16 a[140:143], v[224:227], v[116:119], a[140:143]
    v_mfma_f32_16x16x32_bf16 a[140:143], v[224:227], v[120:123], a[140:143]
    ds_read_b64_tr_b16 v[192:193], v8 offset:36864
    ds_read_b64_tr_b16 v[194:195], v8 offset:40960
    ds_read_b64_tr_b16 v[196:197], v9 offset:36864
    ds_read_b64_tr_b16 v[198:199], v9 offset:40960
    ds_read_b64_tr_b16 v[200:201], v10 offset:36864
    ds_read_b64_tr_b16 v[202:203], v10 offset:40960
    ds_read_b64_tr_b16 v[204:205], v11 offset:36864
    ds_read_b64_tr_b16 v[206:207], v11 offset:40960
    s_waitcnt lgkmcnt(15)
    v_mfma_f32_16x16x32_bf16 v[16:19], v[128:131], a[0:3], 0
    ds_read_b64_tr_b16 v[208:209], v12 offset:36864
    v_max3_f32 v124, v88, v89, v90
    v_max3_f32 v127, v91, v92, v93
    v_max3_f32 v124, v124, v94, v95
    v_max3_f32 v127, v127, v96, v97
    v_mfma_f32_16x16x32_bf16 v[20:23], v[132:135], a[0:3], 0
    ds_read_b64_tr_b16 v[210:211], v12 offset:40960
    v_max3_f32 v124, v124, v98, v99
    v_max3_f32 v127, v127, v100, v101
    v_max3_f32 v124, v124, v102, v103
    v_max3_f32 v127, v127, v104, v105
    v_mfma_f32_16x16x32_bf16 v[24:27], v[136:139], a[0:3], 0
    ds_read_b64_tr_b16 v[212:213], v13 offset:36864
    v_max3_f32 v124, v124, v106, v107
    v_max3_f32 v127, v127, v108, v109
    v_max3_f32 v124, v124, v110, v111
    v_max_f32 v124, v124, v127
    v_mfma_f32_16x16x32_bf16 v[28:31], v[140:143], a[0:3], 0
    ds_read_b64_tr_b16 v[214:215], v13 offset:40960
    v_mov_b32 v125, v124
    s_nop 1
    v_permlane32_swap_b32 v124, v125
    v_max_f32 v124, v124, v125
    v_mov_b32 v125, v124
    v_mfma_f32_16x16x32_bf16 v[32:35], v[144:147], a[0:3], 0
    ds_read_b64_tr_b16 v[216:217], v14 offset:36864
    v_permlane16_swap_b32 v124, v125
    v_max_f32 v124, v124, v125
    v_mul_f32 v124, s68, v124
    v_fma_f32 v88, v88, s68, -v124
    v_mfma_f32_16x16x32_bf16 v[36:39], v[148:151], a[0:3], 0
    ds_read_b64_tr_b16 v[218:219], v14 offset:40960
    v_fma_f32 v89, v89, s68, -v124
    v_fma_f32 v90, v90, s68, -v124
    v_fma_f32 v91, v91, s68, -v124
    v_fma_f32 v92, v92, s68, -v124
    v_mfma_f32_16x16x32_bf16 v[40:43], v[152:155], a[0:3], 0
    ds_read_b64_tr_b16 v[220:221], v15 offset:36864
    v_fma_f32 v93, v93, s68, -v124
    v_fma_f32 v94, v94, s68, -v124
    v_fma_f32 v95, v95, s68, -v124
    v_fma_f32 v96, v96, s68, -v124
    v_mfma_f32_16x16x32_bf16 v[44:47], v[156:159], a[0:3], 0
    ds_read_b64_tr_b16 v[222:223], v15 offset:40960
    v_fma_f32 v97, v97, s68, -v124
    v_fma_f32 v98, v98, s68, -v124
    v_fma_f32 v99, v99, s68, -v124
    v_fma_f32 v100, v100, s68, -v124
    s_waitcnt lgkmcnt(15)
    v_mfma_f32_16x16x32_bf16 v[16:19], v[160:163], a[4:7], v[16:19]
    v_fma_f32 v101, v101, s68, -v124
    v_fma_f32 v102, v102, s68, -v124
    v_fma_f32 v103, v103, s68, -v124
    v_fma_f32 v104, v104, s68, -v124
    v_mfma_f32_16x16x32_bf16 v[20:23], v[164:167], a[4:7], v[20:23]
    v_fma_f32 v105, v105, s68, -v124
    v_fma_f32 v106, v106, s68, -v124
    v_fma_f32 v107, v107, s68, -v124
    v_fma_f32 v108, v108, s68, -v124
    v_mfma_f32_16x16x32_bf16 v[24:27], v[168:171], a[4:7], v[24:27]
    v_fma_f32 v109, v109, s68, -v124
    v_fma_f32 v110, v110, s68, -v124
    v_fma_f32 v111, v111, s68, -v124
    v_exp_f32 v88, v88
    v_mfma_f32_16x16x32_bf16 v[28:31], v[172:175], a[4:7], v[28:31]
    v_exp_f32 v89, v89
    v_exp_f32 v90, v90
    v_exp_f32 v91, v91
    v_exp_f32 v92, v92
    v_mfma_f32_16x16x32_bf16 v[32:35], v[176:179], a[4:7], v[32:35]
    v_exp_f32 v93, v93
    v_exp_f32 v94, v94
    v_exp_f32 v95, v95
    v_exp_f32 v96, v96
    v_mfma_f32_16x16x32_bf16 v[36:39], v[180:183], a[4:7], v[36:39]
    v_exp_f32 v97, v97
    v_exp_f32 v98, v98
    v_exp_f32 v99, v99
    v_exp_f32 v100, v100
    v_mfma_f32_16x16x32_bf16 v[40:43], v[184:187], a[4:7], v[40:43]
    v_exp_f32 v101, v101
    v_exp_f32 v102, v102
    v_exp_f32 v103, v103
    v_exp_f32 v104, v104
    v_mfma_f32_16x16x32_bf16 v[44:47], v[188:191], a[4:7], v[44:47]
    v_exp_f32 v105, v105
    v_exp_f32 v106, v106
    v_exp_f32 v107, v107
    v_exp_f32 v108, v108
    s_waitcnt lgkmcnt(0)
    v_mfma_f32_16x16x32_bf16 v[16:19], v[192:195], a[8:11], v[16:19]
    v_exp_f32 v109, v109
    v_exp_f32 v110, v110
    v_exp_f32 v111, v111
    v_cvt_pk_bf16_f32 v112, v88, v89
    v_mfma_f32_16x16x32_bf16 v[20:23], v[196:199], a[8:11], v[20:23]
    v_cvt_pk_bf16_f32 v113, v90, v91
    v_cvt_pk_bf16_f32 v114, v92, v93
    v_cvt_pk_bf16_f32 v115, v94, v95
    v_cvt_pk_bf16_f32 v116, v96, v97
    v_mfma_f32_16x16x32_bf16 v[24:27], v[200:203], a[8:11], v[24:27]
    v_cvt_pk_bf16_f32 v117, v98, v99
    v_cvt_pk_bf16_f32 v118, v100, v101
    v_cvt_pk_bf16_f32 v119, v102, v103
    v_cvt_pk_bf16_f32 v120, v104, v105
    v_mfma_f32_16x16x32_bf16 v[28:31], v[204:207], a[8:11], v[28:31]
    v_cvt_pk_bf16_f32 v121, v106, v107
    v_cvt_pk_bf16_f32 v122, v108, v109
    v_cvt_pk_bf16_f32 v123, v110, v111
    v_mfma_f32_16x16x32_bf16 v[32:35], v[208:211], a[8:11], v[32:35]
    v_accvgpr_write_b32 a160, v112
    v_accvgpr_write_b32 a161, v113
    v_accvgpr_write_b32 a162, v114
    v_accvgpr_write_b32 a163, v115
    v_mfma_f32_16x16x32_bf16 v[36:39], v[212:215], a[8:11], v[36:39]
    v_accvgpr_write_b32 a164, v116
    v_accvgpr_write_b32 a165, v117
    v_accvgpr_write_b32 a166, v118
    v_accvgpr_write_b32 a167, v119
    v_mfma_f32_16x16x32_bf16 v[40:43], v[216:219], a[8:11], v[40:43]
    v_accvgpr_write_b32 a168, v120
    v_accvgpr_write_b32 a169, v121
    v_accvgpr_write_b32 a170, v122
    v_accvgpr_write_b32 a171, v123
    v_mfma_f32_16x16x32_bf16 v[44:47], v[220:223], a[8:11], v[44:47]
    v_mfma_f32_16x16x32_bf16 a[172:175], v[224:227], v[112:115], 0
    v_mfma_f32_16x16x32_bf16 a[172:175], v[224:227], v[116:119], a[172:175]
    v_mfma_f32_16x16x32_bf16 a[172:175], v[224:227], v[120:123], a[172:175]
    v_mov_b32 v252, 34816
    v_mfma_f32_16x16x32_bf16 v[96:99], v[128:131], a[32:35], 0
    v_accvgpr_read_b32 v253, a12
    v_rcp_f32 v253, v253
    s_nop 0
    v_mul_f32 v16, v16, v253
    v_mfma_f32_16x16x32_bf16 v[96:99], v[160:163], a[36:39], v[96:99]
    v_mul_f32 v17, v17, v253
    v_mul_f32 v18, v18, v253
    v_mfma_f32_16x16x32_bf16 v[96:99], v[192:195], a[40:43], v[96:99]
    v_mul_f32 v19, v19, v253
    v_mul_f32 v20, v20, v253
    v_mfma_f32_16x16x32_bf16 v[100:103], v[132:135], a[32:35], 0
    v_mul_f32 v21, v21, v253
    v_mul_f32 v22, v22, v253
    v_mfma_f32_16x16x32_bf16 v[100:103], v[164:167], a[36:39], v[100:103]
    v_mul_f32 v23, v23, v253
    v_cvt_pk_bf16_f32 v228, v16, v17
    v_cvt_pk_bf16_f32 v229, v18, v19
    v_mfma_f32_16x16x32_bf16 v[100:103], v[196:199], a[40:43], v[100:103]
    v_cvt_pk_bf16_f32 v230, v20, v21
    v_cvt_pk_bf16_f32 v231, v22, v23
    v_mfma_f32_16x16x32_bf16 v[104:107], v[136:139], a[32:35], 0
    ds_write_b128 v249, v[228:231] offset:0
    v_mul_f32 v24, v24, v253
    v_mfma_f32_16x16x32_bf16 v[104:107], v[168:171], a[36:39], v[104:107]
    v_mul_f32 v25, v25, v253
    v_mul_f32 v26, v26, v253
    v_mfma_f32_16x16x32_bf16 v[104:107], v[200:203], a[40:43], v[104:107]
    v_mul_f32 v27, v27, v253
    v_mul_f32 v28, v28, v253
    v_mul_f32 v29, v29, v253
    v_mfma_f32_16x16x32_bf16 v[108:111], v[140:143], a[32:35], 0
    v_mul_f32 v30, v30, v253
    v_mul_f32 v31, v31, v253
    v_mfma_f32_16x16x32_bf16 v[108:111], v[172:175], a[36:39], v[108:111]
    v_cvt_pk_bf16_f32 v232, v24, v25
    v_cvt_pk_bf16_f32 v233, v26, v27
    v_mfma_f32_16x16x32_bf16 v[108:111], v[204:207], a[40:43], v[108:111]
    v_cvt_pk_bf16_f32 v234, v28, v29
    v_cvt_pk_bf16_f32 v235, v30, v31
    v_mfma_f32_16x16x32_bf16 v[112:115], v[144:147], a[32:35], 0
    ds_write_b128 v249, v[232:235] offset:6144
    v_mul_f32 v32, v32, v253
    v_mul_f32 v33, v33, v253
    v_mfma_f32_16x16x32_bf16 v[112:115], v[176:179], a[36:39], v[112:115]
    v_mul_f32 v34, v34, v253
    v_mul_f32 v35, v35, v253
    v_mfma_f32_16x16x32_bf16 v[112:115], v[208:211], a[40:43], v[112:115]
    v_mul_f32 v36, v36, v253
    v_mul_f32 v37, v37, v253
    v_mfma_f32_16x16x32_bf16 v[116:119], v[148:151], a[32:35], 0
    v_mul_f32 v38, v38, v253
    v_mul_f32 v39, v39, v253
    v_mfma_f32_16x16x32_bf16 v[116:119], v[180:183], a[36:39], v[116:119]
    v_cvt_pk_bf16_f32 v228, v32, v33
    v_cvt_pk_bf16_f32 v229, v34, v35
    v_cvt_pk_bf16_f32 v230, v36, v37
    v_mfma_f32_16x16x32_bf16 v[116:119], v[212:215], a[40:43], v[116:119]
    v_cvt_pk_bf16_f32 v231, v38, v39
    ds_write_b128 v249, v[228:231] offset:12288
    v_mfma_f32_16x16x32_bf16 v[120:123], v[152:155], a[32:35], 0
    v_mul_f32 v40, v40, v253
    v_mul_f32 v41, v41, v253
    v_mfma_f32_16x16x32_bf16 v[120:123], v[184:187], a[36:39], v[120:123]
    v_mul_f32 v42, v42, v253
    v_mul_f32 v43, v43, v253
    v_mfma_f32_16x16x32_bf16 v[120:123], v[216:219], a[40:43], v[120:123]
    v_mul_f32 v44, v44, v253
    v_mul_f32 v45, v45, v253
    v_mul_f32 v46, v46, v253
    v_mfma_f32_16x16x32_bf16 v[124:127], v[156:159], a[32:35], 0
    v_mul_f32 v47, v47, v253
    v_cvt_pk_bf16_f32 v232, v40, v41
    v_mfma_f32_16x16x32_bf16 v[124:127], v[188:191], a[36:39], v[124:127]
    v_cvt_pk_bf16_f32 v233, v42, v43
    v_cvt_pk_bf16_f32 v234, v44, v45
    v_mfma_f32_16x16x32_bf16 v[124:127], v[220:223], a[40:43], v[124:127]
    v_cvt_pk_bf16_f32 v235, v46, v47
    ds_write_b128 v241, v[232:235] offset:2048
    v_mfma_f32_16x16x32_bf16 v[64:67], v[128:131], a[64:67], 0
    s_mov_b32 s74, 0
    v_accvgpr_read_b32 v253, a44
    v_rcp_f32 v253, v253
    v_mfma_f32_16x16x32_bf16 v[64:67], v[160:163], a[68:71], v[64:67]
    v_mul_f32 v96, v96, v253
    v_mul_f32 v97, v97, v253
    v_mul_f32 v98, v98, v253
    v_mfma_f32_16x16x32_bf16 v[64:67], v[192:195], a[72:75], v[64:67]
    buffer_load_dwordx4 v[32:35], v247, s[40:43], s74 offen offset:0
    v_mul_f32 v99, v99, v253
    v_mfma_f32_16x16x32_bf16 v[68:71], v[132:135], a[64:67], 0
    v_mul_f32 v100, v100, v253
    v_mul_f32 v101, v101, v253
    v_mul_f32 v102, v102, v253
    v_mfma_f32_16x16x32_bf16 v[68:71], v[164:167], a[68:71], v[68:71]
    v_mul_f32 v103, v103, v253
    buffer_load_dwordx4 v[36:39], v247, s[40:43], s74 offen offset:1024
    v_cvt_pk_bf16_f32 v228, v96, v97
    v_mfma_f32_16x16x32_bf16 v[68:71], v[196:199], a[72:75], v[68:71]
    v_cvt_pk_bf16_f32 v229, v98, v99
    v_cvt_pk_bf16_f32 v230, v100, v101
    v_mfma_f32_16x16x32_bf16 v[72:75], v[136:139], a[64:67], 0
    v_cvt_pk_bf16_f32 v231, v102, v103
    ds_write_b128 v249, v[228:231] offset:1024
    buffer_load_dwordx4 v[40:43], v247, s[40:43], s74 offen offset:2048
    v_mfma_f32_16x16x32_bf16 v[72:75], v[168:171], a[68:71], v[72:75]
    v_mul_f32 v104, v104, v253
    v_mul_f32 v105, v105, v253
    v_mul_f32 v106, v106, v253
    v_mfma_f32_16x16x32_bf16 v[72:75], v[200:203], a[72:75], v[72:75]
    v_mul_f32 v107, v107, v253
    v_mul_f32 v108, v108, v253
    v_mfma_f32_16x16x32_bf16 v[76:79], v[140:143], a[64:67], 0
    buffer_load_dwordx4 v[44:47], v247, s[40:43], s74 offen offset:3072
    v_mul_f32 v109, v109, v253
    v_mul_f32 v110, v110, v253
    v_mfma_f32_16x16x32_bf16 v[76:79], v[172:175], a[68:71], v[76:79]
    v_mul_f32 v111, v111, v253
    v_cvt_pk_bf16_f32 v232, v104, v105
    v_cvt_pk_bf16_f32 v233, v106, v107
    v_mfma_f32_16x16x32_bf16 v[76:79], v[204:207], a[72:75], v[76:79]
    s_mov_b32 s74, 8192
    v_cvt_pk_bf16_f32 v234, v108, v109
    v_mfma_f32_16x16x32_bf16 v[80:83], v[144:147], a[64:67], 0
    v_cvt_pk_bf16_f32 v235, v110, v111
    ds_write_b128 v249, v[232:235] offset:7168
    v_mul_f32 v112, v112, v253
    v_mfma_f32_16x16x32_bf16 v[80:83], v[176:179], a[68:71], v[80:83]
    v_mul_f32 v113, v113, v253
    buffer_load_dwordx4 v[48:51], v247, s[40:43], s74 offen offset:0
    v_mul_f32 v114, v114, v253
    v_mfma_f32_16x16x32_bf16 v[80:83], v[208:211], a[72:75], v[80:83]
    v_mul_f32 v115, v115, v253
    v_mul_f32 v116, v116, v253
    v_mfma_f32_16x16x32_bf16 v[84:87], v[148:151], a[64:67], 0
    v_mul_f32 v117, v117, v253
    v_mul_f32 v118, v118, v253
    buffer_load_dwordx4 v[52:55], v247, s[40:43], s74 offen offset:1024
    v_mfma_f32_16x16x32_bf16 v[84:87], v[180:183], a[68:71], v[84:87]
    v_mul_f32 v119, v119, v253
    v_cvt_pk_bf16_f32 v228, v112, v113
    v_cvt_pk_bf16_f32 v229, v114, v115
    v_mfma_f32_16x16x32_bf16 v[84:87], v[212:215], a[72:75], v[84:87]
    v_cvt_pk_bf16_f32 v230, v116, v117
    v_cvt_pk_bf16_f32 v231, v118, v119
    v_mfma_f32_16x16x32_bf16 v[88:91], v[152:155], a[64:67], 0
    buffer_load_dwordx4 v[56:59], v247, s[40:43], s74 offen offset:2048
    ds_write_b128 v249, v[228:231] offset:13312
    v_mul_f32 v120, v120, v253
    v_mfma_f32_16x16x32_bf16 v[88:91], v[184:187], a[68:71], v[88:91]
    v_mul_f32 v121, v121, v253
    v_mul_f32 v122, v122, v253
    v_mul_f32 v123, v123, v253
    v_mfma_f32_16x16x32_bf16 v[88:91], v[216:219], a[72:75], v[88:91]
    buffer_load_dwordx4 v[60:63], v247, s[40:43], s74 offen offset:3072
    v_mul_f32 v124, v124, v253
    v_mfma_f32_16x16x32_bf16 v[92:95], v[156:159], a[64:67], 0
    v_mul_f32 v125, v125, v253
    v_mul_f32 v126, v126, v253
    v_mul_f32 v127, v127, v253
    v_mfma_f32_16x16x32_bf16 v[92:95], v[188:191], a[68:71], v[92:95]
    v_cvt_pk_bf16_f32 v232, v120, v121
    v_cvt_pk_bf16_f32 v233, v122, v123
    v_cvt_pk_bf16_f32 v234, v124, v125
    v_mfma_f32_16x16x32_bf16 v[92:95], v[220:223], a[72:75], v[92:95]
    v_cvt_pk_bf16_f32 v235, v126, v127
    ds_write_b128 v241, v[232:235] offset:3072
    v_mfma_f32_16x16x32_bf16 v[96:99], v[128:131], a[96:99], 0
    s_mov_b32 s74, 16384
    v_accvgpr_read_b32 v253, a76
    v_rcp_f32 v253, v253
    v_mfma_f32_16x16x32_bf16 v[96:99], v[160:163], a[100:103], v[96:99]
    v_mul_f32 v64, v64, v253
    v_mul_f32 v65, v65, v253
    v_mul_f32 v66, v66, v253
    v_mfma_f32_16x16x32_bf16 v[96:99], v[192:195], a[104:107], v[96:99]
    buffer_load_dwordx4 v[0:3], v247, s[40:43], s74 offen offset:0
    v_mul_f32 v67, v67, v253
    v_mfma_f32_16x16x32_bf16 v[100:103], v[132:135], a[96:99], 0
    v_mul_f32 v68, v68, v253
    v_mul_f32 v69, v69, v253
    v_mul_f32 v70, v70, v253
    v_mfma_f32_16x16x32_bf16 v[100:103], v[164:167], a[100:103], v[100:103]
    v_mul_f32 v71, v71, v253
    buffer_load_dwordx4 v[4:7], v247, s[40:43], s74 offen offset:1024
    v_cvt_pk_bf16_f32 v228, v64, v65
    v_mfma_f32_16x16x32_bf16 v[100:103], v[196:199], a[104:107], v[100:103]
    v_cvt_pk_bf16_f32 v229, v66, v67
    v_cvt_pk_bf16_f32 v230, v68, v69
    v_mfma_f32_16x16x32_bf16 v[104:107], v[136:139], a[96:99], 0
    v_cvt_pk_bf16_f32 v231, v70, v71
    ds_write_b128 v249, v[228:231] offset:2048
    buffer_load_dwordx4 v[8:11], v247, s[40:43], s74 offen offset:2048
    v_mfma_f32_16x16x32_bf16 v[104:107], v[168:171], a[100:103], v[104:107]
    v_mul_f32 v72, v72, v253
    v_mul_f32 v73, v73, v253
    v_mul_f32 v74, v74, v253
    v_mfma_f32_16x16x32_bf16 v[104:107], v[200:203], a[104:107], v[104:107]
    v_mul_f32 v75, v75, v253
    v_mul_f32 v76, v76, v253
    v_mfma_f32_16x16x32_bf16 v[108:111], v[140:143], a[96:99], 0
    buffer_load_dwordx4 v[12:15], v247, s[40:43], s74 offen offset:3072
    v_mul_f32 v77, v77, v253
    v_mul_f32 v78, v78, v253
    v_mfma_f32_16x16x32_bf16 v[108:111], v[172:175], a[100:103], v[108:111]
    v_mul_f32 v79, v79, v253
    v_cvt_pk_bf16_f32 v232, v72, v73
    v_cvt_pk_bf16_f32 v233, v74, v75
    v_mfma_f32_16x16x32_bf16 v[108:111], v[204:207], a[104:107], v[108:111]
    s_mov_b32 s74, 24576
    v_cvt_pk_bf16_f32 v234, v76, v77
    v_mfma_f32_16x16x32_bf16 v[112:115], v[144:147], a[96:99], 0
    v_cvt_pk_bf16_f32 v235, v78, v79
    ds_write_b128 v249, v[232:235] offset:8192
    v_mul_f32 v80, v80, v253
    v_mfma_f32_16x16x32_bf16 v[112:115], v[176:179], a[100:103], v[112:115]
    v_mul_f32 v81, v81, v253
    buffer_load_dwordx4 v[16:19], v247, s[40:43], s74 offen offset:0
    v_mul_f32 v82, v82, v253
    v_mfma_f32_16x16x32_bf16 v[112:115], v[208:211], a[104:107], v[112:115]
    v_mul_f32 v83, v83, v253
    v_mul_f32 v84, v84, v253
    v_mfma_f32_16x16x32_bf16 v[116:119], v[148:151], a[96:99], 0
    v_mul_f32 v85, v85, v253
    v_mul_f32 v86, v86, v253
    buffer_load_dwordx4 v[20:23], v247, s[40:43], s74 offen offset:1024
    v_mfma_f32_16x16x32_bf16 v[116:119], v[180:183], a[100:103], v[116:119]
    v_mul_f32 v87, v87, v253
    v_cvt_pk_bf16_f32 v228, v80, v81
    v_cvt_pk_bf16_f32 v229, v82, v83
    v_mfma_f32_16x16x32_bf16 v[116:119], v[212:215], a[104:107], v[116:119]
    v_cvt_pk_bf16_f32 v230, v84, v85
    v_cvt_pk_bf16_f32 v231, v86, v87
    v_mfma_f32_16x16x32_bf16 v[120:123], v[152:155], a[96:99], 0
    buffer_load_dwordx4 v[24:27], v247, s[40:43], s74 offen offset:2048
    ds_write_b128 v249, v[228:231] offset:14336
    v_mul_f32 v88, v88, v253
    v_mfma_f32_16x16x32_bf16 v[120:123], v[184:187], a[100:103], v[120:123]
    v_mul_f32 v89, v89, v253
    v_mul_f32 v90, v90, v253
    v_mul_f32 v91, v91, v253
    v_mfma_f32_16x16x32_bf16 v[120:123], v[216:219], a[104:107], v[120:123]
    buffer_load_dwordx4 v[28:31], v247, s[40:43], s74 offen offset:3072
    v_mul_f32 v92, v92, v253
    v_mfma_f32_16x16x32_bf16 v[124:127], v[156:159], a[96:99], 0
    v_mul_f32 v93, v93, v253
    v_mul_f32 v94, v94, v253
    v_mul_f32 v95, v95, v253
    v_mfma_f32_16x16x32_bf16 v[124:127], v[188:191], a[100:103], v[124:127]
    v_cvt_pk_bf16_f32 v232, v88, v89
    v_cvt_pk_bf16_f32 v233, v90, v91
    v_cvt_pk_bf16_f32 v234, v92, v93
    v_mfma_f32_16x16x32_bf16 v[124:127], v[220:223], a[104:107], v[124:127]
    v_cvt_pk_bf16_f32 v235, v94, v95
    ds_write_b128 v241, v[232:235] offset:4096
    v_mfma_f32_16x16x32_bf16 v[64:67], v[128:131], a[128:131], 0
    v_accvgpr_read_b32 v253, a108
    v_rcp_f32 v253, v253
    s_nop 0
    v_mul_f32 v96, v96, v253
    v_mfma_f32_16x16x32_bf16 v[64:67], v[160:163], a[132:135], v[64:67]
    v_mul_f32 v97, v97, v253
    v_mul_f32 v98, v98, v253
    v_mfma_f32_16x16x32_bf16 v[64:67], v[192:195], a[136:139], v[64:67]
    v_mul_f32 v99, v99, v253
    v_mul_f32 v100, v100, v253
    v_mfma_f32_16x16x32_bf16 v[68:71], v[132:135], a[128:131], 0
    v_mul_f32 v101, v101, v253
    v_mul_f32 v102, v102, v253
    v_mfma_f32_16x16x32_bf16 v[68:71], v[164:167], a[132:135], v[68:71]
    v_mul_f32 v103, v103, v253
    v_cvt_pk_bf16_f32 v228, v96, v97
    v_cvt_pk_bf16_f32 v229, v98, v99
    v_mfma_f32_16x16x32_bf16 v[68:71], v[196:199], a[136:139], v[68:71]
    v_cvt_pk_bf16_f32 v230, v100, v101
    v_cvt_pk_bf16_f32 v231, v102, v103
    v_mfma_f32_16x16x32_bf16 v[72:75], v[136:139], a[128:131], 0
    ds_write_b128 v249, v[228:231] offset:3072
    v_mul_f32 v104, v104, v253
    v_mfma_f32_16x16x32_bf16 v[72:75], v[168:171], a[132:135], v[72:75]
    v_mul_f32 v105, v105, v253
    v_mul_f32 v106, v106, v253
    v_mfma_f32_16x16x32_bf16 v[72:75], v[200:203], a[136:139], v[72:75]
    v_mul_f32 v107, v107, v253
    v_mul_f32 v108, v108, v253
    v_mul_f32 v109, v109, v253
    v_mfma_f32_16x16x32_bf16 v[76:79], v[140:143], a[128:131], 0
    v_mul_f32 v110, v110, v253
    v_mul_f32 v111, v111, v253
    v_mfma_f32_16x16x32_bf16 v[76:79], v[172:175], a[132:135], v[76:79]
    v_cvt_pk_bf16_f32 v232, v104, v105
    v_cvt_pk_bf16_f32 v233, v106, v107
    v_mfma_f32_16x16x32_bf16 v[76:79], v[204:207], a[136:139], v[76:79]
    v_cvt_pk_bf16_f32 v234, v108, v109
    v_cvt_pk_bf16_f32 v235, v110, v111
    v_mfma_f32_16x16x32_bf16 v[80:83], v[144:147], a[128:131], 0
    ds_write_b128 v249, v[232:235] offset:9216
    v_mul_f32 v112, v112, v253
    v_mul_f32 v113, v113, v253
    v_mfma_f32_16x16x32_bf16 v[80:83], v[176:179], a[132:135], v[80:83]
    v_mul_f32 v114, v114, v253
    v_mul_f32 v115, v115, v253
    v_mfma_f32_16x16x32_bf16 v[80:83], v[208:211], a[136:139], v[80:83]
    v_mul_f32 v116, v116, v253
    v_mul_f32 v117, v117, v253
    v_mfma_f32_16x16x32_bf16 v[84:87], v[148:151], a[128:131], 0
    v_mul_f32 v118, v118, v253
    v_mul_f32 v119, v119, v253
    v_mfma_f32_16x16x32_bf16 v[84:87], v[180:183], a[132:135], v[84:87]
    v_cvt_pk_bf16_f32 v228, v112, v113
    v_cvt_pk_bf16_f32 v229, v114, v115
    v_cvt_pk_bf16_f32 v230, v116, v117
    v_mfma_f32_16x16x32_bf16 v[84:87], v[212:215], a[136:139], v[84:87]
    v_cvt_pk_bf16_f32 v231, v118, v119
    ds_write_b128 v249, v[228:231] offset:15360
    v_mfma_f32_16x16x32_bf16 v[88:91], v[152:155], a[128:131], 0
    v_mul_f32 v120, v120, v253
    v_mul_f32 v121, v121, v253
    v_mfma_f32_16x16x32_bf16 v[88:91], v[184:187], a[132:135], v[88:91]
    v_mul_f32 v122, v122, v253
    v_mul_f32 v123, v123, v253
    v_mfma_f32_16x16x32_bf16 v[88:91], v[216:219], a[136:139], v[88:91]
    v_mul_f32 v124, v124, v253
    v_mul_f32 v125, v125, v253
    v_mul_f32 v126, v126, v253
    v_mfma_f32_16x16x32_bf16 v[92:95], v[156:159], a[128:131], 0
    v_mul_f32 v127, v127, v253
    v_cvt_pk_bf16_f32 v232, v120, v121
    v_mfma_f32_16x16x32_bf16 v[92:95], v[188:191], a[132:135], v[92:95]
    v_cvt_pk_bf16_f32 v233, v122, v123
    v_cvt_pk_bf16_f32 v234, v124, v125
    v_mfma_f32_16x16x32_bf16 v[92:95], v[220:223], a[136:139], v[92:95]
    v_cvt_pk_bf16_f32 v235, v126, v127
    ds_write_b128 v241, v[232:235] offset:5120
    v_mfma_f32_16x16x32_bf16 v[96:99], v[128:131], a[160:163], 0
    v_accvgpr_read_b32 v253, a140
    v_rcp_f32 v253, v253
    s_nop 0
    v_mul_f32 v64, v64, v253
    v_mfma_f32_16x16x32_bf16 v[96:99], v[160:163], a[164:167], v[96:99]
    v_mul_f32 v65, v65, v253
    v_mul_f32 v66, v66, v253
    v_mfma_f32_16x16x32_bf16 v[96:99], v[192:195], a[168:171], v[96:99]
    v_mul_f32 v67, v67, v253
    v_mul_f32 v68, v68, v253
    v_mfma_f32_16x16x32_bf16 v[100:103], v[132:135], a[160:163], 0
    v_mul_f32 v69, v69, v253
    v_mul_f32 v70, v70, v253
    v_mfma_f32_16x16x32_bf16 v[100:103], v[164:167], a[164:167], v[100:103]
    v_mul_f32 v71, v71, v253
    v_cvt_pk_bf16_f32 v228, v64, v65
    v_cvt_pk_bf16_f32 v229, v66, v67
    v_mfma_f32_16x16x32_bf16 v[100:103], v[196:199], a[168:171], v[100:103]
    v_cvt_pk_bf16_f32 v230, v68, v69
    v_cvt_pk_bf16_f32 v231, v70, v71
    v_mfma_f32_16x16x32_bf16 v[104:107], v[136:139], a[160:163], 0
    ds_write_b128 v249, v[228:231] offset:4096
    v_mul_f32 v72, v72, v253
    v_mfma_f32_16x16x32_bf16 v[104:107], v[168:171], a[164:167], v[104:107]
    v_mul_f32 v73, v73, v253
    v_mul_f32 v74, v74, v253
    v_mfma_f32_16x16x32_bf16 v[104:107], v[200:203], a[168:171], v[104:107]
    v_mul_f32 v75, v75, v253
    v_mul_f32 v76, v76, v253
    v_mul_f32 v77, v77, v253
    v_mfma_f32_16x16x32_bf16 v[108:111], v[140:143], a[160:163], 0
    v_mul_f32 v78, v78, v253
    v_mul_f32 v79, v79, v253
    v_mfma_f32_16x16x32_bf16 v[108:111], v[172:175], a[164:167], v[108:111]
    v_cvt_pk_bf16_f32 v232, v72, v73
    v_cvt_pk_bf16_f32 v233, v74, v75
    v_mfma_f32_16x16x32_bf16 v[108:111], v[204:207], a[168:171], v[108:111]
    v_cvt_pk_bf16_f32 v234, v76, v77
    v_cvt_pk_bf16_f32 v235, v78, v79
    v_mfma_f32_16x16x32_bf16 v[112:115], v[144:147], a[160:163], 0
    ds_write_b128 v249, v[232:235] offset:10240
    v_mul_f32 v80, v80, v253
    v_mul_f32 v81, v81, v253
    v_mfma_f32_16x16x32_bf16 v[112:115], v[176:179], a[164:167], v[112:115]
    v_mul_f32 v82, v82, v253
    v_mul_f32 v83, v83, v253
    v_mfma_f32_16x16x32_bf16 v[112:115], v[208:211], a[168:171], v[112:115]
    v_mul_f32 v84, v84, v253
    v_mul_f32 v85, v85, v253
    v_mfma_f32_16x16x32_bf16 v[116:119], v[148:151], a[160:163], 0
    v_mul_f32 v86, v86, v253
    v_mul_f32 v87, v87, v253
    v_mfma_f32_16x16x32_bf16 v[116:119], v[180:183], a[164:167], v[116:119]
    v_cvt_pk_bf16_f32 v228, v80, v81
    v_cvt_pk_bf16_f32 v229, v82, v83
    v_cvt_pk_bf16_f32 v230, v84, v85
    v_mfma_f32_16x16x32_bf16 v[116:119], v[212:215], a[168:171], v[116:119]
    v_cvt_pk_bf16_f32 v231, v86, v87
    ds_write_b128 v241, v[228:231] offset:0
    v_mfma_f32_16x16x32_bf16 v[120:123], v[152:155], a[160:163], 0
    v_mul_f32 v88, v88, v253
    v_mul_f32 v89, v89, v253
    v_mfma_f32_16x16x32_bf16 v[120:123], v[184:187], a[164:167], v[120:123]
    v_mul_f32 v90, v90, v253
    v_mul_f32 v91, v91, v253
    v_mfma_f32_16x16x32_bf16 v[120:123], v[216:219], a[168:171], v[120:123]
    v_mul_f32 v92, v92, v253
    v_mul_f32 v93, v93, v253
    v_mul_f32 v94, v94, v253
    v_mfma_f32_16x16x32_bf16 v[124:127], v[156:159], a[160:163], 0
    v_mul_f32 v95, v95, v253
    v_cvt_pk_bf16_f32 v232, v88, v89
    v_mfma_f32_16x16x32_bf16 v[124:127], v[188:191], a[164:167], v[124:127]
    v_cvt_pk_bf16_f32 v233, v90, v91
    v_cvt_pk_bf16_f32 v234, v92, v93
    v_mfma_f32_16x16x32_bf16 v[124:127], v[220:223], a[168:171], v[124:127]
    v_cvt_pk_bf16_f32 v235, v94, v95
    ds_write_b128 v241, v[232:235] offset:6144
    v_readfirstlane_b32 s72, v238
    s_cmp_eq_u32 s72, 0
    s_cselect_b32 s72, s80, s72
    v_mov_b32 v251, s72
    s_mov_b64 exec, s[70:71]
    ds_write_b32 v252, v251 offset:4
    ds_write_b32 v252, v239 offset:8
    s_mov_b64 exec, -1
    v_accvgpr_read_b32 v253, a172
    v_rcp_f32 v253, v253
    s_nop 0
    v_mul_f32 v96, v96, v253
    v_mul_f32 v97, v97, v253
    v_mul_f32 v98, v98, v253
    v_mul_f32 v99, v99, v253
    v_mul_f32 v100, v100, v253
    v_mul_f32 v101, v101, v253
    v_mul_f32 v102, v102, v253
    v_mul_f32 v103, v103, v253
    v_cvt_pk_bf16_f32 v228, v96, v97
    v_cvt_pk_bf16_f32 v229, v98, v99
    v_cvt_pk_bf16_f32 v230, v100, v101
    v_cvt_pk_bf16_f32 v231, v102, v103
    ds_write_b128 v249, v[228:231] offset:5120
    v_mul_f32 v104, v104, v253
    v_mul_f32 v105, v105, v253
    v_mul_f32 v106, v106, v253
    v_mul_f32 v107, v107, v253
    v_mul_f32 v108, v108, v253
    v_mul_f32 v109, v109, v253
    v_mul_f32 v110, v110, v253
    v_mul_f32 v111, v111, v253
    v_cvt_pk_bf16_f32 v232, v104, v105
    v_cvt_pk_bf16_f32 v233, v106, v107
    v_cvt_pk_bf16_f32 v234, v108, v109
    v_cvt_pk_bf16_f32 v235, v110, v111
    ds_write_b128 v249, v[232:235] offset:11264
    v_mul_f32 v112, v112, v253
    v_mul_f32 v113, v113, v253
    v_mul_f32 v114, v114, v253
    v_mul_f32 v115, v115, v253
    v_mul_f32 v116, v116, v253
    v_mul_f32 v117, v117, v253
    v_mul_f32 v118, v118, v253
    v_mul_f32 v119, v119, v253
    v_cvt_pk_bf16_f32 v228, v112, v113
    v_cvt_pk_bf16_f32 v229, v114, v115
    v_cvt_pk_bf16_f32 v230, v116, v117
    v_cvt_pk_bf16_f32 v231, v118, v119
    ds_write_b128 v241, v[228:231] offset:1024
    v_mul_f32 v120, v120, v253
    v_mul_f32 v121, v121, v253
    v_mul_f32 v122, v122, v253
    v_mul_f32 v123, v123, v253
    v_mul_f32 v124, v124, v253
    v_mul_f32 v125, v125, v253
    v_mul_f32 v126, v126, v253
    v_mul_f32 v127, v127, v253
    v_cvt_pk_bf16_f32 v232, v120, v121
    v_cvt_pk_bf16_f32 v233, v122, v123
    v_cvt_pk_bf16_f32 v234, v124, v125
    v_cvt_pk_bf16_f32 v235, v126, v127
    ds_write_b128 v241, v[232:235] offset:7168
    s_waitcnt lgkmcnt(0)
    s_barrier
    ds_read_b32 v238, v252 offset:4
    ds_read_b128 a[192:195], v250 offset:0
    ds_read_b128 a[196:199], v250 offset:1024
    ds_read_b128 a[200:203], v250 offset:2048
    ds_read_b128 a[204:207], v250 offset:3072
    ds_read_b128 a[208:211], v250 offset:4096
    ds_read_b128 a[212:215], v250 offset:5120
    s_waitcnt lgkmcnt(6)
    v_readfirstlane_b32 s80, v238
    s_waitcnt vmcnt(8)
    v_perm_b32 v96, v36, v32, s60
    v_perm_b32 v97, v44, v40, s60
    v_perm_b32 v98, v52, v48, s60
    v_perm_b32 v99, v60, v56, s60
    s_waitcnt lgkmcnt(0)
    s_nop 0
    v_mfma_f32_16x16x32_bf16 a[0:3], v[96:99], a[192:195], 0
    v_perm_b32 v100, v36, v32, s61
    v_perm_b32 v101, v44, v40, s61
    v_mfma_f32_16x16x32_bf16 a[32:35], v[96:99], a[196:199], 0
    v_perm_b32 v102, v52, v48, s61
    v_perm_b32 v103, v60, v56, s61
    v_mfma_f32_16x16x32_bf16 a[64:67], v[96:99], a[200:203], 0
    s_mov_b32 s74, 32768
    buffer_load_dwordx4 v[64:67], v247, s[40:43], s74 offen offset:0
    v_mfma_f32_16x16x32_bf16 a[96:99], v[96:99], a[204:207], 0
    s_xor_b32 s72, s80, 0x5a3c96e1
    v_mfma_f32_16x16x32_bf16 a[128:131], v[96:99], a[208:211], 0
    v_mov_b32 v232, s80
    v_mov_b32 v233, s72
    v_mfma_f32_16x16x32_bf16 a[160:163], v[96:99], a[212:215], 0
    v_lshrrev_b32 v112, 4, v248
    v_mfma_f32_16x16x32_bf16 a[4:7], v[100:103], a[192:195], 0
    v_perm_b32 v104, v37, v33, s60
    v_perm_b32 v105, v45, v41, s60
    v_mfma_f32_16x16x32_bf16 a[36:39], v[100:103], a[196:199], 0
    v_perm_b32 v106, v53, v49, s60
    v_perm_b32 v107, v61, v57, s60
    v_mfma_f32_16x16x32_bf16 a[68:71], v[100:103], a[200:203], 0
    buffer_load_dwordx4 v[68:71], v247, s[40:43], s74 offen offset:1024
    v_mfma_f32_16x16x32_bf16 a[100:103], v[100:103], a[204:207], 0
    v_and_b32 v113, 15, v112
    v_lshrrev_b32 v114, 4, v112
    v_mfma_f32_16x16x32_bf16 a[132:135], v[100:103], a[208:211], 0
    v_lshrrev_b32 v115, 2, v113
    v_and_b32 v116, 1, v113
    v_mfma_f32_16x16x32_bf16 a[164:167], v[100:103], a[212:215], 0
    v_lshlrev_b32 v116, 4, v116
    v_mfma_f32_16x16x32_bf16 a[8:11], v[104:107], a[192:195], 0
    v_perm_b32 v108, v37, v33, s61
    v_perm_b32 v109, v45, v41, s61
    v_mfma_f32_16x16x32_bf16 a[40:43], v[104:107], a[196:199], 0
    v_perm_b32 v110, v53, v49, s61
    v_perm_b32 v111, v61, v57, s61
    v_mfma_f32_16x16x32_bf16 a[72:75], v[104:107], a[200:203], 0
    buffer_load_dwordx4 v[72:75], v247, s[40:43], s74 offen offset:2048
    buffer_load_dwordx4 v[76:79], v247, s[40:43], s74 offen offset:3072
    v_mfma_f32_16x16x32_bf16 a[104:107], v[104:107], a[204:207], 0
    v_mov_b32 v117, 0x3f80
    v_lshlrev_b32 v117, v116, v117
    v_mfma_f32_16x16x32_bf16 a[136:139], v[104:107], a[208:211], 0
    v_cmp_eq_u32 vcc, v115, v114
    s_nop 1
    v_mfma_f32_16x16x32_bf16 a[168:171], v[104:107], a[212:215], 0
    v_cndmask_b32 v117, 0, v117, vcc
    v_mfma_f32_16x16x32_bf16 a[12:15], v[108:111], a[192:195], 0
    v_perm_b32 v96, v38, v34, s60
    v_perm_b32 v97, v46, v42, s60
    v_mfma_f32_16x16x32_bf16 a[44:47], v[108:111], a[196:199], 0
    v_perm_b32 v98, v54, v50, s60
    v_perm_b32 v99, v62, v58, s60
    v_mfma_f32_16x16x32_bf16 a[76:79], v[108:111], a[200:203], 0
    s_mov_b32 s74, 40960
    buffer_load_dwordx4 v[80:83], v247, s[40:43], s74 offen offset:0
    v_mfma_f32_16x16x32_bf16 a[108:111], v[108:111], a[204:207], 0
    ds_read_b128 a[216:219], v250 offset:6144
    ds_read_b128 a[220:223], v250 offset:7168
    v_mfma_f32_16x16x32_bf16 a[140:143], v[108:111], a[208:211], 0
    v_and_b32 v116, 2, v113
    v_cmp_eq_u32 vcc, 0, v116
    v_mfma_f32_16x16x32_bf16 a[172:175], v[108:111], a[212:215], 0
    v_mov_b32 v224, 0
    v_mov_b32 v225, 0
    v_mfma_f32_16x16x32_bf16 a[16:19], v[96:99], a[192:195], 0
    v_perm_b32 v100, v38, v34, s61
    v_perm_b32 v101, v46, v42, s61
    v_mfma_f32_16x16x32_bf16 a[48:51], v[96:99], a[196:199], 0
    v_perm_b32 v102, v54, v50, s61
    v_perm_b32 v103, v62, v58, s61
    v_mfma_f32_16x16x32_bf16 a[80:83], v[96:99], a[200:203], 0
    buffer_load_dwordx4 v[84:87], v247, s[40:43], s74 offen offset:1024
    ds_read_b128 a[224:227], v250 offset:8192
    v_mfma_f32_16x16x32_bf16 a[112:115], v[96:99], a[204:207], 0
    ds_read_b128 a[228:231], v250 offset:9216
    v_mov_b32 v228, 0
    v_mfma_f32_16x16x32_bf16 a[144:147], v[96:99], a[208:211], 0
    v_mov_b32 v229, 0
    v_cndmask_b32 v226, 0, v117, vcc
    v_mfma_f32_16x16x32_bf16 a[176:179], v[96:99], a[212:215], 0
    v_cndmask_b32 v227, v117, 0, vcc
    v_mfma_f32_16x16x32_bf16 a[20:23], v[100:103], a[192:195], 0
    v_perm_b32 v104, v39, v35, s60
    v_perm_b32 v105, v47, v43, s60
    v_mfma_f32_16x16x32_bf16 a[52:55], v[100:103], a[196:199], 0
    v_perm_b32 v106, v55, v51, s60
    v_perm_b32 v107, v63, v59, s60
    v_mfma_f32_16x16x32_bf16 a[84:87], v[100:103], a[200:203], 0
    buffer_load_dwordx4 v[88:91], v247, s[40:43], s74 offen offset:2048
    buffer_load_dwordx4 v[92:95], v247, s[40:43], s74 offen offset:3072
    v_mfma_f32_16x16x32_bf16 a[116:119], v[100:103], a[204:207], 0
    ds_read_b128 a[232:235], v250 offset:10240
    ds_read_b128 a[236:239], v250 offset:11264
    v_mfma_f32_16x16x32_bf16 a[148:151], v[100:103], a[208:211], 0
    v_mul_u32_u24 v240, 0xc00, v114
    v_lshl_add_u32 v240, v113, 4, v240
    v_mfma_f32_16x16x32_bf16 a[180:183], v[100:103], a[212:215], 0
    v_lshlrev_b32 v230, 4, v114
    v_lshl_add_u32 v230, v113, 11, v230
    v_mfma_f32_16x16x32_bf16 a[24:27], v[104:107], a[192:195], 0
    v_perm_b32 v108, v39, v35, s61
    v_perm_b32 v109, v47, v43, s61
    v_mfma_f32_16x16x32_bf16 a[56:59], v[104:107], a[196:199], 0
    v_perm_b32 v110, v55, v51, s61
    v_perm_b32 v111, v63, v59, s61
    v_mfma_f32_16x16x32_bf16 a[88:91], v[104:107], a[200:203], 0
    s_mov_b32 s74, 49152
    v_mfma_f32_16x16x32_bf16 a[120:123], v[104:107], a[204:207], 0
    buffer_load_dwordx4 v[128:131], v247, s[40:43], s74 offen offset:0
    v_lshrrev_b32 v231, 1, v248
    v_mfma_f32_16x16x32_bf16 a[152:155], v[104:107], a[208:211], 0
    s_mul_i32 s72, s3, 3072
    v_add_u32 v242, s72, v248
    v_mfma_f32_16x16x32_bf16 a[184:187], v[104:107], a[212:215], 0
    v_mov_b32 v243, 34816
    v_mfma_f32_16x16x32_bf16 a[28:31], v[108:111], a[192:195], 0
    s_waitcnt vmcnt(9)
    v_perm_b32 v96, v4, v0, s60
    v_mfma_f32_16x16x32_bf16 a[60:63], v[108:111], a[196:199], 0
    v_perm_b32 v97, v12, v8, s60
    v_perm_b32 v98, v20, v16, s60
    v_mfma_f32_16x16x32_bf16 a[92:95], v[108:111], a[200:203], 0
    v_perm_b32 v99, v28, v24, s60
    buffer_load_dwordx4 v[132:135], v247, s[40:43], s74 offen offset:1024
    v_mfma_f32_16x16x32_bf16 a[124:127], v[108:111], a[204:207], 0
    buffer_load_dwordx4 v[136:139], v247, s[40:43], s74 offen offset:2048
    s_mov_b64 s[20:21], s[36:37]
    s_lshl_b32 s72, s3, 1
    s_add_u32 s72, s72, 0
    s_cmp_lg_u32 s72, s63
    s_cselect_b32 s22, s38, 0
    s_mov_b64 s[24:25], s[36:37]
    s_lshl_b32 s72, s3, 1
    s_add_u32 s72, s72, 1
    s_cmp_lg_u32 s72, s63
    s_cselect_b32 s26, s38, 0
    v_mfma_f32_16x16x32_bf16 a[156:159], v[108:111], a[208:211], 0
    s_mov_b32 s84, 0
    s_mov_b32 s83, 0
    v_mfma_f32_16x16x32_bf16 a[188:191], v[108:111], a[212:215], 0
    s_mov_b32 s85, 0
    s_waitcnt lgkmcnt(0)
    v_mfma_f32_16x16x32_bf16 a[0:3], v[96:99], a[216:219], a[0:3]
    v_perm_b32 v100, v4, v0, s61
    v_mfma_f32_16x16x32_bf16 a[32:35], v[96:99], a[220:223], a[32:35]
    v_perm_b32 v101, v12, v8, s61
    v_mfma_f32_16x16x32_bf16 a[64:67], v[96:99], a[224:227], a[64:67]
    v_perm_b32 v102, v20, v16, s61
    v_mfma_f32_16x16x32_bf16 a[96:99], v[96:99], a[228:231], a[96:99]
    v_perm_b32 v103, v28, v24, s61
    v_mfma_f32_16x16x32_bf16 a[128:131], v[96:99], a[232:235], a[128:131]
    buffer_load_dwordx4 v[140:143], v247, s[40:43], s74 offen offset:3072
    v_mfma_f32_16x16x32_bf16 a[160:163], v[96:99], a[236:239], a[160:163]
    v_mfma_f32_16x16x32_bf16 a[4:7], v[100:103], a[216:219], a[4:7]
    v_perm_b32 v104, v5, v1, s60
    v_mfma_f32_16x16x32_bf16 a[36:39], v[100:103], a[220:223], a[36:39]
    v_perm_b32 v105, v13, v9, s60
    v_mfma_f32_16x16x32_bf16 a[68:71], v[100:103], a[224:227], a[68:71]
    v_perm_b32 v106, v21, v17, s60
    v_mfma_f32_16x16x32_bf16 a[100:103], v[100:103], a[228:231], a[100:103]
    v_perm_b32 v107, v29, v25, s60
    v_mfma_f32_16x16x32_bf16 a[132:135], v[100:103], a[232:235], a[132:135]
    s_mov_b32 s74, 57344
    v_mfma_f32_16x16x32_bf16 a[164:167], v[100:103], a[236:239], a[164:167]
    buffer_load_dwordx4 v[144:147], v247, s[40:43], s74 offen offset:0
    v_mfma_f32_16x16x32_bf16 a[8:11], v[104:107], a[216:219], a[8:11]
    v_perm_b32 v108, v5, v1, s61
    v_mfma_f32_16x16x32_bf16 a[40:43], v[104:107], a[220:223], a[40:43]
    v_perm_b32 v109, v13, v9, s61
    v_mfma_f32_16x16x32_bf16 a[72:75], v[104:107], a[224:227], a[72:75]
    v_perm_b32 v110, v21, v17, s61
    v_mfma_f32_16x16x32_bf16 a[104:107], v[104:107], a[228:231], a[104:107]
    v_perm_b32 v111, v29, v25, s61
    v_mfma_f32_16x16x32_bf16 a[136:139], v[104:107], a[232:235], a[136:139]
    buffer_load_dwordx4 v[148:151], v247, s[40:43], s74 offen offset:1024
    v_mfma_f32_16x16x32_bf16 a[168:171], v[104:107], a[236:239], a[168:171]
    buffer_load_dwordx4 v[152:155], v247, s[40:43], s74 offen offset:2048
    v_mfma_f32_16x16x32_bf16 a[12:15], v[108:111], a[216:219], a[12:15]
    v_perm_b32 v96, v6, v2, s60
    v_perm_b32 v97, v14, v10, s60
    v_mfma_f32_16x16x32_bf16 a[44:47], v[108:111], a[220:223], a[44:47]
    v_perm_b32 v98, v22, v18, s60
    v_mfma_f32_16x16x32_bf16 a[76:79], v[108:111], a[224:227], a[76:79]
    v_perm_b32 v99, v30, v26, s60
    v_mfma_f32_16x16x32_bf16 a[108:111], v[108:111], a[228:231], a[108:111]
    buffer_load_dwordx4 v[156:159], v247, s[40:43], s74 offen offset:3072
    v_mfma_f32_16x16x32_bf16 a[140:143], v[108:111], a[232:235], a[140:143]
    ds_read_b128 a[192:195], v250 offset:12288
    v_mfma_f32_16x16x32_bf16 a[172:175], v[108:111], a[236:239], a[172:175]
    ds_read_b128 a[196:199], v250 offset:13312
    v_mfma_f32_16x16x32_bf16 a[16:19], v[96:99], a[216:219], a[16:19]
    v_perm_b32 v100, v6, v2, s61
    v_perm_b32 v101, v14, v10, s61
    v_mfma_f32_16x16x32_bf16 a[48:51], v[96:99], a[220:223], a[48:51]
    v_perm_b32 v102, v22, v18, s61
    v_mfma_f32_16x16x32_bf16 a[80:83], v[96:99], a[224:227], a[80:83]
    v_perm_b32 v103, v30, v26, s61
    v_mfma_f32_16x16x32_bf16 a[112:115], v[96:99], a[228:231], a[112:115]
    s_mov_b32 s74, 131072
    buffer_load_dwordx4 v[160:163], v247, s[40:43], s74 offen offset:0
    v_mfma_f32_16x16x32_bf16 a[144:147], v[96:99], a[232:235], a[144:147]
    ds_read_b128 a[200:203], v250 offset:14336
    v_mfma_f32_16x16x32_bf16 a[176:179], v[96:99], a[236:239], a[176:179]
    ds_read_b128 a[204:207], v250 offset:15360
    v_mfma_f32_16x16x32_bf16 a[20:23], v[100:103], a[216:219], a[20:23]
    v_perm_b32 v104, v7, v3, s60
    v_perm_b32 v105, v15, v11, s60
    v_mfma_f32_16x16x32_bf16 a[52:55], v[100:103], a[220:223], a[52:55]
    v_perm_b32 v106, v23, v19, s60
    v_mfma_f32_16x16x32_bf16 a[84:87], v[100:103], a[224:227], a[84:87]
    v_perm_b32 v107, v31, v27, s60
    v_mfma_f32_16x16x32_bf16 a[116:119], v[100:103], a[228:231], a[116:119]
    buffer_load_dwordx4 v[164:167], v247, s[40:43], s74 offen offset:1024
    buffer_load_dwordx4 v[168:171], v247, s[40:43], s74 offen offset:2048
    v_mfma_f32_16x16x32_bf16 a[148:151], v[100:103], a[232:235], a[148:151]
    ds_read_b128 a[208:211], v248 offset:0
    v_mfma_f32_16x16x32_bf16 a[180:183], v[100:103], a[236:239], a[180:183]
    ds_read_b128 a[212:215], v248 offset:1024
    v_mfma_f32_16x16x32_bf16 a[24:27], v[104:107], a[216:219], a[24:27]
    v_perm_b32 v108, v7, v3, s61
    v_mfma_f32_16x16x32_bf16 a[56:59], v[104:107], a[220:223], a[56:59]
    v_perm_b32 v109, v15, v11, s61
    v_mfma_f32_16x16x32_bf16 a[88:91], v[104:107], a[224:227], a[88:91]
    v_perm_b32 v110, v23, v19, s61
    v_mfma_f32_16x16x32_bf16 a[120:123], v[104:107], a[228:231], a[120:123]
    v_perm_b32 v111, v31, v27, s61
    v_mfma_f32_16x16x32_bf16 a[152:155], v[104:107], a[232:235], a[152:155]
    buffer_load_dwordx4 v[172:175], v247, s[40:43], s74 offen offset:3072
    v_mfma_f32_16x16x32_bf16 a[184:187], v[104:107], a[236:239], a[184:187]
    v_mfma_f32_16x16x32_bf16 a[28:31], v[108:111], a[216:219], a[28:31]
    s_waitcnt vmcnt(12)
    v_perm_b32 v96, v68, v64, s60
    v_mfma_f32_16x16x32_bf16 a[60:63], v[108:111], a[220:223], a[60:63]
    v_perm_b32 v97, v76, v72, s60
    v_mfma_f32_16x16x32_bf16 a[92:95], v[108:111], a[224:227], a[92:95]
    v_perm_b32 v98, v84, v80, s60
    v_mfma_f32_16x16x32_bf16 a[124:127], v[108:111], a[228:231], a[124:127]
    v_perm_b32 v99, v92, v88, s60
    s_mov_b32 s74, 139264
    v_mfma_f32_16x16x32_bf16 a[156:159], v[108:111], a[232:235], a[156:159]
    buffer_load_dwordx4 v[176:179], v247, s[40:43], s74 offen offset:0
    v_mfma_f32_16x16x32_bf16 a[188:191], v[108:111], a[236:239], a[188:191]
    buffer_load_dwordx4 v[180:183], v247, s[40:43], s74 offen offset:1024
    s_waitcnt lgkmcnt(0)
    v_mfma_f32_16x16x32_bf16 a[0:3], v[96:99], a[192:195], a[0:3]
    v_perm_b32 v100, v68, v64, s61
    v_mfma_f32_16x16x32_bf16 a[32:35], v[96:99], a[196:199], a[32:35]
    v_perm_b32 v101, v76, v72, s61
    v_mfma_f32_16x16x32_bf16 a[64:67], v[96:99], a[200:203], a[64:67]
    v_perm_b32 v102, v84, v80, s61
    v_mfma_f32_16x16x32_bf16 a[96:99], v[96:99], a[204:207], a[96:99]
    v_perm_b32 v103, v92, v88, s61
    v_mfma_f32_16x16x32_bf16 a[128:131], v[96:99], a[208:211], a[128:131]
    buffer_load_dwordx4 v[184:187], v247, s[40:43], s74 offen offset:2048
    v_mfma_f32_16x16x32_bf16 a[160:163], v[96:99], a[212:215], a[160:163]
    v_mfma_f32_16x16x32_bf16 a[4:7], v[100:103], a[192:195], a[4:7]
    v_perm_b32 v104, v69, v65, s60
    v_mfma_f32_16x16x32_bf16 a[36:39], v[100:103], a[196:199], a[36:39]
    v_perm_b32 v105, v77, v73, s60
    v_mfma_f32_16x16x32_bf16 a[68:71], v[100:103], a[200:203], a[68:71]
    v_perm_b32 v106, v85, v81, s60
    v_mfma_f32_16x16x32_bf16 a[100:103], v[100:103], a[204:207], a[100:103]
    v_perm_b32 v107, v93, v89, s60
    v_mfma_f32_16x16x32_bf16 a[132:135], v[100:103], a[208:211], a[132:135]
    buffer_load_dwordx4 v[188:191], v247, s[40:43], s74 offen offset:3072
    v_mfma_f32_16x16x32_bf16 a[164:167], v[100:103], a[212:215], a[164:167]
    v_mfma_f32_16x16x32_bf16 a[8:11], v[104:107], a[192:195], a[8:11]
    v_perm_b32 v108, v69, v65, s61
    v_perm_b32 v109, v77, v73, s61
    v_mfma_f32_16x16x32_bf16 a[40:43], v[104:107], a[196:199], a[40:43]
    v_perm_b32 v110, v85, v81, s61
    v_mfma_f32_16x16x32_bf16 a[72:75], v[104:107], a[200:203], a[72:75]
    v_perm_b32 v111, v93, v89, s61
    v_mfma_f32_16x16x32_bf16 a[104:107], v[104:107], a[204:207], a[104:107]
    s_mov_b32 s74, 147456
    v_mfma_f32_16x16x32_bf16 a[136:139], v[104:107], a[208:211], a[136:139]
    buffer_load_dwordx4 v[32:35], v247, s[40:43], s74 offen offset:0
    v_mfma_f32_16x16x32_bf16 a[168:171], v[104:107], a[212:215], a[168:171]
    buffer_load_dwordx4 v[36:39], v247, s[40:43], s74 offen offset:1024
    v_mfma_f32_16x16x32_bf16 a[12:15], v[108:111], a[192:195], a[12:15]
    v_perm_b32 v96, v70, v66, s60
    v_perm_b32 v97, v78, v74, s60
    v_mfma_f32_16x16x32_bf16 a[44:47], v[108:111], a[196:199], a[44:47]
    v_perm_b32 v98, v86, v82, s60
    v_mfma_f32_16x16x32_bf16 a[76:79], v[108:111], a[200:203], a[76:79]
    v_perm_b32 v99, v94, v90, s60
    v_mfma_f32_16x16x32_bf16 a[108:111], v[108:111], a[204:207], a[108:111]
    buffer_load_dwordx4 v[40:43], v247, s[40:43], s74 offen offset:2048
    v_mfma_f32_16x16x32_bf16 a[140:143], v[108:111], a[208:211], a[140:143]
    ds_read_b128 a[216:219], v248 offset:2048
    v_mfma_f32_16x16x32_bf16 a[172:175], v[108:111], a[212:215], a[172:175]
    ds_read_b128 a[220:223], v248 offset:3072
    v_mfma_f32_16x16x32_bf16 a[16:19], v[96:99], a[192:195], a[16:19]
    v_perm_b32 v100, v70, v66, s61
    v_perm_b32 v101, v78, v74, s61
    v_mfma_f32_16x16x32_bf16 a[48:51], v[96:99], a[196:199], a[48:51]
    v_perm_b32 v102, v86, v82, s61
    v_mfma_f32_16x16x32_bf16 a[80:83], v[96:99], a[200:203], a[80:83]
    v_perm_b32 v103, v94, v90, s61
    v_mfma_f32_16x16x32_bf16 a[112:115], v[96:99], a[204:207], a[112:115]
    buffer_load_dwordx4 v[44:47], v247, s[40:43], s74 offen offset:3072
    v_mfma_f32_16x16x32_bf16 a[144:147], v[96:99], a[208:211], a[144:147]
    ds_read_b128 a[224:227], v248 offset:4096
    v_mfma_f32_16x16x32_bf16 a[176:179], v[96:99], a[212:215], a[176:179]
    ds_read_b128 a[228:231], v248 offset:5120
    v_mfma_f32_16x16x32_bf16 a[20:23], v[100:103], a[192:195], a[20:23]
    v_perm_b32 v104, v71, v67, s60
    v_perm_b32 v105, v79, v75, s60
    v_mfma_f32_16x16x32_bf16 a[52:55], v[100:103], a[196:199], a[52:55]
    v_perm_b32 v106, v87, v83, s60
    v_mfma_f32_16x16x32_bf16 a[84:87], v[100:103], a[200:203], a[84:87]
    v_perm_b32 v107, v95, v91, s60
    s_mov_b32 s74, 155648
    v_mfma_f32_16x16x32_bf16 a[116:119], v[100:103], a[204:207], a[116:119]
    buffer_load_dwordx4 v[48:51], v247, s[40:43], s74 offen offset:0
    v_mfma_f32_16x16x32_bf16 a[148:151], v[100:103], a[208:211], a[148:151]
    buffer_load_dwordx4 v[52:55], v247, s[40:43], s74 offen offset:1024
    ds_read_b128 a[232:235], v248 offset:6144
    v_mfma_f32_16x16x32_bf16 a[180:183], v[100:103], a[212:215], a[180:183]
    ds_read_b128 a[236:239], v248 offset:7168
    v_mfma_f32_16x16x32_bf16 a[24:27], v[104:107], a[192:195], a[24:27]
    v_perm_b32 v108, v71, v67, s61
    v_mfma_f32_16x16x32_bf16 a[56:59], v[104:107], a[196:199], a[56:59]
    v_perm_b32 v109, v79, v75, s61
    v_mfma_f32_16x16x32_bf16 a[88:91], v[104:107], a[200:203], a[88:91]
    v_perm_b32 v110, v87, v83, s61
    v_mfma_f32_16x16x32_bf16 a[120:123], v[104:107], a[204:207], a[120:123]
    v_perm_b32 v111, v95, v91, s61
    v_mfma_f32_16x16x32_bf16 a[152:155], v[104:107], a[208:211], a[152:155]
    buffer_load_dwordx4 v[56:59], v247, s[40:43], s74 offen offset:2048
    v_mfma_f32_16x16x32_bf16 a[184:187], v[104:107], a[212:215], a[184:187]
    v_mfma_f32_16x16x32_bf16 a[28:31], v[108:111], a[192:195], a[28:31]
    s_waitcnt vmcnt(15)
    v_perm_b32 v96, v132, v128, s60
    v_mfma_f32_16x16x32_bf16 a[60:63], v[108:111], a[196:199], a[60:63]
    v_perm_b32 v97, v140, v136, s60
    v_mfma_f32_16x16x32_bf16 a[92:95], v[108:111], a[200:203], a[92:95]
    v_perm_b32 v98, v148, v144, s60
    v_mfma_f32_16x16x32_bf16 a[124:127], v[108:111], a[204:207], a[124:127]
    v_perm_b32 v99, v156, v152, s60
    buffer_load_dwordx4 v[60:63], v247, s[40:43], s74 offen offset:3072
    v_mfma_f32_16x16x32_bf16 a[156:159], v[108:111], a[208:211], a[156:159]
    s_mov_b32 s74, 163840
    v_mfma_f32_16x16x32_bf16 a[188:191], v[108:111], a[212:215], a[188:191]
    buffer_load_dwordx4 v[0:3], v247, s[40:43], s74 offen offset:0
    s_waitcnt lgkmcnt(0)
    v_mfma_f32_16x16x32_bf16 a[0:3], v[96:99], a[216:219], a[0:3]
    v_perm_b32 v100, v132, v128, s61
    v_mfma_f32_16x16x32_bf16 a[32:35], v[96:99], a[220:223], a[32:35]
    v_perm_b32 v101, v140, v136, s61
    v_mfma_f32_16x16x32_bf16 a[64:67], v[96:99], a[224:227], a[64:67]
    v_perm_b32 v102, v148, v144, s61
    v_mfma_f32_16x16x32_bf16 a[96:99], v[96:99], a[228:231], a[96:99]
    v_perm_b32 v103, v156, v152, s61
    v_mfma_f32_16x16x32_bf16 a[128:131], v[96:99], a[232:235], a[128:131]
    buffer_load_dwordx4 v[4:7], v247, s[40:43], s74 offen offset:1024
    v_mfma_f32_16x16x32_bf16 a[160:163], v[96:99], a[236:239], a[160:163]
    v_mfma_f32_16x16x32_bf16 a[4:7], v[100:103], a[216:219], a[4:7]
    v_perm_b32 v104, v133, v129, s60
    v_mfma_f32_16x16x32_bf16 a[36:39], v[100:103], a[220:223], a[36:39]
    v_perm_b32 v105, v141, v137, s60
    v_mfma_f32_16x16x32_bf16 a[68:71], v[100:103], a[224:227], a[68:71]
    v_perm_b32 v106, v149, v145, s60
    v_mfma_f32_16x16x32_bf16 a[100:103], v[100:103], a[228:231], a[100:103]
    v_perm_b32 v107, v157, v153, s60
    v_mfma_f32_16x16x32_bf16 a[132:135], v[100:103], a[232:235], a[132:135]
    buffer_load_dwordx4 v[8:11], v247, s[40:43], s74 offen offset:2048
    v_mfma_f32_16x16x32_bf16 a[164:167], v[100:103], a[236:239], a[164:167]
    v_mfma_f32_16x16x32_bf16 a[8:11], v[104:107], a[216:219], a[8:11]
    v_perm_b32 v108, v133, v129, s61
    v_perm_b32 v109, v141, v137, s61
    v_mfma_f32_16x16x32_bf16 a[40:43], v[104:107], a[220:223], a[40:43]
    v_perm_b32 v110, v149, v145, s61
    v_mfma_f32_16x16x32_bf16 a[72:75], v[104:107], a[224:227], a[72:75]
    v_perm_b32 v111, v157, v153, s61
    v_mfma_f32_16x16x32_bf16 a[104:107], v[104:107], a[228:231], a[104:107]
    buffer_load_dwordx4 v[12:15], v247, s[40:43], s74 offen offset:3072
    v_mfma_f32_16x16x32_bf16 a[136:139], v[104:107], a[232:235], a[136:139]
    s_mov_b32 s74, 172032
    v_mfma_f32_16x16x32_bf16 a[168:171], v[104:107], a[236:239], a[168:171]
    buffer_load_dwordx4 v[16:19], v247, s[40:43], s74 offen offset:0
    v_mfma_f32_16x16x32_bf16 a[12:15], v[108:111], a[216:219], a[12:15]
    v_perm_b32 v96, v134, v130, s60
    v_perm_b32 v97, v142, v138, s60
    v_mfma_f32_16x16x32_bf16 a[44:47], v[108:111], a[220:223], a[44:47]
    v_perm_b32 v98, v150, v146, s60
    v_mfma_f32_16x16x32_bf16 a[76:79], v[108:111], a[224:227], a[76:79]
    v_perm_b32 v99, v158, v154, s60
    v_mfma_f32_16x16x32_bf16 a[108:111], v[108:111], a[228:231], a[108:111]
    buffer_load_dwordx4 v[20:23], v247, s[40:43], s74 offen offset:1024
    v_mfma_f32_16x16x32_bf16 a[140:143], v[108:111], a[232:235], a[140:143]
    ds_read_b128 a[192:195], v250 offset:16384
    v_mfma_f32_16x16x32_bf16 a[172:175], v[108:111], a[236:239], a[172:175]
    ds_read_b128 a[196:199], v250 offset:17408
    v_mfma_f32_16x16x32_bf16 a[16:19], v[96:99], a[216:219], a[16:19]
    v_perm_b32 v100, v134, v130, s61
    v_perm_b32 v101, v142, v138, s61
    v_mfma_f32_16x16x32_bf16 a[48:51], v[96:99], a[220:223], a[48:51]
    v_perm_b32 v102, v150, v146, s61
    v_mfma_f32_16x16x32_bf16 a[80:83], v[96:99], a[224:227], a[80:83]
    v_perm_b32 v103, v158, v154, s61
    v_mfma_f32_16x16x32_bf16 a[112:115], v[96:99], a[228:231], a[112:115]
    buffer_load_dwordx4 v[24:27], v247, s[40:43], s74 offen offset:2048
    v_mfma_f32_16x16x32_bf16 a[144:147], v[96:99], a[232:235], a[144:147]
    ds_read_b128 a[200:203], v250 offset:18432
    v_mfma_f32_16x16x32_bf16 a[176:179], v[96:99], a[236:239], a[176:179]
    ds_read_b128 a[204:207], v250 offset:19456
    v_mfma_f32_16x16x32_bf16 a[20:23], v[100:103], a[216:219], a[20:23]
    v_perm_b32 v104, v135, v131, s60
    v_perm_b32 v105, v143, v139, s60
    v_mfma_f32_16x16x32_bf16 a[52:55], v[100:103], a[220:223], a[52:55]
    v_perm_b32 v106, v151, v147, s60
    v_mfma_f32_16x16x32_bf16 a[84:87], v[100:103], a[224:227], a[84:87]
    v_perm_b32 v107, v159, v155, s60
    buffer_load_dwordx4 v[28:31], v247, s[40:43], s74 offen offset:3072
    v_mfma_f32_16x16x32_bf16 a[116:119], v[100:103], a[228:231], a[116:119]
    s_mov_b32 s74, 180224
    v_mfma_f32_16x16x32_bf16 a[148:151], v[100:103], a[232:235], a[148:151]
    buffer_load_dwordx4 v[64:67], v247, s[40:43], s74 offen offset:0
    ds_read_b128 a[208:211], v250 offset:20480
    v_mfma_f32_16x16x32_bf16 a[180:183], v[100:103], a[236:239], a[180:183]
    ds_read_b128 a[212:215], v250 offset:21504
    v_mfma_f32_16x16x32_bf16 a[24:27], v[104:107], a[216:219], a[24:27]
    v_perm_b32 v108, v135, v131, s61
    v_mfma_f32_16x16x32_bf16 a[56:59], v[104:107], a[220:223], a[56:59]
    v_perm_b32 v109, v143, v139, s61
    v_mfma_f32_16x16x32_bf16 a[88:91], v[104:107], a[224:227], a[88:91]
    v_perm_b32 v110, v151, v147, s61
    v_mfma_f32_16x16x32_bf16 a[120:123], v[104:107], a[228:231], a[120:123]
    v_perm_b32 v111, v159, v155, s61
    v_mfma_f32_16x16x32_bf16 a[152:155], v[104:107], a[232:235], a[152:155]
    buffer_load_dwordx4 v[68:71], v247, s[40:43], s74 offen offset:1024
    v_mfma_f32_16x16x32_bf16 a[184:187], v[104:107], a[236:239], a[184:187]
    v_mfma_f32_16x16x32_bf16 a[28:31], v[108:111], a[216:219], a[28:31]
    s_waitcnt vmcnt(18)
    v_perm_b32 v96, v164, v160, s60
    v_mfma_f32_16x16x32_bf16 a[60:63], v[108:111], a[220:223], a[60:63]
    v_perm_b32 v97, v172, v168, s60
    v_mfma_f32_16x16x32_bf16 a[92:95], v[108:111], a[224:227], a[92:95]
    v_perm_b32 v98, v180, v176, s60
    v_mfma_f32_16x16x32_bf16 a[124:127], v[108:111], a[228:231], a[124:127]
    v_perm_b32 v99, v188, v184, s60
    v_mfma_f32_16x16x32_bf16 a[156:159], v[108:111], a[232:235], a[156:159]
    buffer_load_dwordx4 v[72:75], v247, s[40:43], s74 offen offset:2048
    v_mfma_f32_16x16x32_bf16 a[188:191], v[108:111], a[236:239], a[188:191]
    buffer_load_dwordx4 v[76:79], v247, s[40:43], s74 offen offset:3072
    s_waitcnt lgkmcnt(0)
    v_mfma_f32_16x16x32_bf16 a[0:3], v[96:99], a[192:195], a[0:3]
    v_perm_b32 v100, v164, v160, s61
    v_mfma_f32_16x16x32_bf16 a[32:35], v[96:99], a[196:199], a[32:35]
    v_perm_b32 v101, v172, v168, s61
    v_mfma_f32_16x16x32_bf16 a[64:67], v[96:99], a[200:203], a[64:67]
    v_perm_b32 v102, v180, v176, s61
    v_mfma_f32_16x16x32_bf16 a[96:99], v[96:99], a[204:207], a[96:99]
    v_perm_b32 v103, v188, v184, s61
    v_mfma_f32_16x16x32_bf16 a[128:131], v[96:99], a[208:211], a[128:131]
    s_mov_b32 s74, 188416
    v_mfma_f32_16x16x32_bf16 a[160:163], v[96:99], a[212:215], a[160:163]
    buffer_load_dwordx4 v[80:83], v247, s[40:43], s74 offen offset:0
    v_mfma_f32_16x16x32_bf16 a[4:7], v[100:103], a[192:195], a[4:7]
    v_perm_b32 v104, v165, v161, s60
    v_mfma_f32_16x16x32_bf16 a[36:39], v[100:103], a[196:199], a[36:39]
    v_perm_b32 v105, v173, v169, s60
    v_mfma_f32_16x16x32_bf16 a[68:71], v[100:103], a[200:203], a[68:71]
    v_perm_b32 v106, v181, v177, s60
    v_mfma_f32_16x16x32_bf16 a[100:103], v[100:103], a[204:207], a[100:103]
    v_perm_b32 v107, v189, v185, s60
    v_mfma_f32_16x16x32_bf16 a[132:135], v[100:103], a[208:211], a[132:135]
    buffer_load_dwordx4 v[84:87], v247, s[40:43], s74 offen offset:1024
    v_mfma_f32_16x16x32_bf16 a[164:167], v[100:103], a[212:215], a[164:167]
    v_mfma_f32_16x16x32_bf16 a[8:11], v[104:107], a[192:195], a[8:11]
    v_perm_b32 v108, v165, v161, s61
    v_mfma_f32_16x16x32_bf16 a[40:43], v[104:107], a[196:199], a[40:43]
    v_perm_b32 v109, v173, v169, s61
    v_mfma_f32_16x16x32_bf16 a[72:75], v[104:107], a[200:203], a[72:75]
    v_perm_b32 v110, v181, v177, s61
    v_mfma_f32_16x16x32_bf16 a[104:107], v[104:107], a[204:207], a[104:107]
    v_perm_b32 v111, v189, v185, s61
    v_mfma_f32_16x16x32_bf16 a[136:139], v[104:107], a[208:211], a[136:139]
    buffer_load_dwordx4 v[88:91], v247, s[40:43], s74 offen offset:2048
    v_mfma_f32_16x16x32_bf16 a[168:171], v[104:107], a[212:215], a[168:171]
    buffer_load_dwordx4 v[92:95], v247, s[40:43], s74 offen offset:3072
    v_mfma_f32_16x16x32_bf16 a[12:15], v[108:111], a[192:195], a[12:15]
    v_perm_b32 v96, v166, v162, s60
    v_perm_b32 v97, v174, v170, s60
    v_mfma_f32_16x16x32_bf16 a[44:47], v[108:111], a[196:199], a[44:47]
    v_perm_b32 v98, v182, v178, s60
    v_mfma_f32_16x16x32_bf16 a[76:79], v[108:111], a[200:203], a[76:79]
    v_perm_b32 v99, v190, v186, s60
    v_mfma_f32_16x16x32_bf16 a[108:111], v[108:111], a[204:207], a[108:111]
    s_mov_b32 s74, 262144
    buffer_load_dwordx4 v[128:131], v247, s[40:43], s74 offen offset:0
    v_mfma_f32_16x16x32_bf16 a[140:143], v[108:111], a[208:211], a[140:143]
    ds_read_b128 a[216:219], v250 offset:22528
    v_mfma_f32_16x16x32_bf16 a[172:175], v[108:111], a[212:215], a[172:175]
    ds_read_b128 a[220:223], v250 offset:23552
    v_mfma_f32_16x16x32_bf16 a[16:19], v[96:99], a[192:195], a[16:19]
    v_perm_b32 v100, v166, v162, s61
    v_perm_b32 v101, v174, v170, s61
    v_mfma_f32_16x16x32_bf16 a[48:51], v[96:99], a[196:199], a[48:51]
    v_perm_b32 v102, v182, v178, s61
    v_mfma_f32_16x16x32_bf16 a[80:83], v[96:99], a[200:203], a[80:83]
    v_perm_b32 v103, v190, v186, s61
    v_mfma_f32_16x16x32_bf16 a[112:115], v[96:99], a[204:207], a[112:115]
    buffer_load_dwordx4 v[132:135], v247, s[40:43], s74 offen offset:1024
    v_mfma_f32_16x16x32_bf16 a[144:147], v[96:99], a[208:211], a[144:147]
    ds_read_b128 a[224:227], v250 offset:24576
    v_mfma_f32_16x16x32_bf16 a[176:179], v[96:99], a[212:215], a[176:179]
    ds_read_b128 a[228:231], v250 offset:25600
    v_mfma_f32_16x16x32_bf16 a[20:23], v[100:103], a[192:195], a[20:23]
    v_perm_b32 v104, v167, v163, s60
    v_perm_b32 v105, v175, v171, s60
    v_mfma_f32_16x16x32_bf16 a[52:55], v[100:103], a[196:199], a[52:55]
    v_perm_b32 v106, v183, v179, s60
    v_mfma_f32_16x16x32_bf16 a[84:87], v[100:103], a[200:203], a[84:87]
    v_perm_b32 v107, v191, v187, s60
    v_mfma_f32_16x16x32_bf16 a[116:119], v[100:103], a[204:207], a[116:119]
    buffer_load_dwordx4 v[136:139], v247, s[40:43], s74 offen offset:2048
    buffer_load_dwordx4 v[140:143], v247, s[40:43], s74 offen offset:3072
    v_mfma_f32_16x16x32_bf16 a[148:151], v[100:103], a[208:211], a[148:151]
    ds_read_b128 a[232:235], v250 offset:26624
    v_mfma_f32_16x16x32_bf16 a[180:183], v[100:103], a[212:215], a[180:183]
    ds_read_b128 a[236:239], v250 offset:27648
    v_mfma_f32_16x16x32_bf16 a[24:27], v[104:107], a[192:195], a[24:27]
    v_perm_b32 v108, v167, v163, s61
    v_mfma_f32_16x16x32_bf16 a[56:59], v[104:107], a[196:199], a[56:59]
    v_perm_b32 v109, v175, v171, s61
    v_mfma_f32_16x16x32_bf16 a[88:91], v[104:107], a[200:203], a[88:91]
    v_perm_b32 v110, v183, v179, s61
    v_mfma_f32_16x16x32_bf16 a[120:123], v[104:107], a[204:207], a[120:123]
    v_perm_b32 v111, v191, v187, s61
    v_mfma_f32_16x16x32_bf16 a[152:155], v[104:107], a[208:211], a[152:155]
    s_mov_b32 s74, 270336
    v_mfma_f32_16x16x32_bf16 a[184:187], v[104:107], a[212:215], a[184:187]
    buffer_load_dwordx4 v[144:147], v247, s[40:43], s74 offen offset:0
    v_mfma_f32_16x16x32_bf16 a[28:31], v[108:111], a[192:195], a[28:31]
    s_waitcnt vmcnt(21)
    v_perm_b32 v96, v36, v32, s60
    v_mfma_f32_16x16x32_bf16 a[60:63], v[108:111], a[196:199], a[60:63]
    v_perm_b32 v97, v44, v40, s60
    v_mfma_f32_16x16x32_bf16 a[92:95], v[108:111], a[200:203], a[92:95]
    v_perm_b32 v98, v52, v48, s60
    v_mfma_f32_16x16x32_bf16 a[124:127], v[108:111], a[204:207], a[124:127]
    v_perm_b32 v99, v60, v56, s60
    v_mfma_f32_16x16x32_bf16 a[156:159], v[108:111], a[208:211], a[156:159]
    buffer_load_dwordx4 v[148:151], v247, s[40:43], s74 offen offset:1024
    v_mfma_f32_16x16x32_bf16 a[188:191], v[108:111], a[212:215], a[188:191]
    buffer_load_dwordx4 v[152:155], v247, s[40:43], s74 offen offset:2048
    s_waitcnt lgkmcnt(0)
    v_mfma_f32_16x16x32_bf16 a[0:3], v[96:99], a[216:219], a[0:3]
    v_perm_b32 v100, v36, v32, s61
    v_mfma_f32_16x16x32_bf16 a[32:35], v[96:99], a[220:223], a[32:35]
    v_perm_b32 v101, v44, v40, s61
    v_mfma_f32_16x16x32_bf16 a[64:67], v[96:99], a[224:227], a[64:67]
    v_perm_b32 v102, v52, v48, s61
    v_mfma_f32_16x16x32_bf16 a[96:99], v[96:99], a[228:231], a[96:99]
    v_perm_b32 v103, v60, v56, s61
    v_mfma_f32_16x16x32_bf16 a[128:131], v[96:99], a[232:235], a[128:131]
    buffer_load_dwordx4 v[156:159], v247, s[40:43], s74 offen offset:3072
    v_mfma_f32_16x16x32_bf16 a[160:163], v[96:99], a[236:239], a[160:163]
    v_mfma_f32_16x16x32_bf16 a[4:7], v[100:103], a[216:219], a[4:7]
    v_perm_b32 v104, v37, v33, s60
    v_mfma_f32_16x16x32_bf16 a[36:39], v[100:103], a[220:223], a[36:39]
    v_perm_b32 v105, v45, v41, s60
    v_mfma_f32_16x16x32_bf16 a[68:71], v[100:103], a[224:227], a[68:71]
    v_perm_b32 v106, v53, v49, s60
    v_mfma_f32_16x16x32_bf16 a[100:103], v[100:103], a[228:231], a[100:103]
    v_perm_b32 v107, v61, v57, s60
    v_mfma_f32_16x16x32_bf16 a[132:135], v[100:103], a[232:235], a[132:135]
    s_mov_b32 s74, 278528
    v_mfma_f32_16x16x32_bf16 a[164:167], v[100:103], a[236:239], a[164:167]
    buffer_load_dwordx4 v[160:163], v247, s[40:43], s74 offen offset:0
    v_mfma_f32_16x16x32_bf16 a[8:11], v[104:107], a[216:219], a[8:11]
    v_perm_b32 v108, v37, v33, s61
    v_mfma_f32_16x16x32_bf16 a[40:43], v[104:107], a[220:223], a[40:43]
    v_perm_b32 v109, v45, v41, s61
    v_mfma_f32_16x16x32_bf16 a[72:75], v[104:107], a[224:227], a[72:75]
    v_perm_b32 v110, v53, v49, s61
    v_mfma_f32_16x16x32_bf16 a[104:107], v[104:107], a[228:231], a[104:107]
    v_perm_b32 v111, v61, v57, s61
    v_mfma_f32_16x16x32_bf16 a[136:139], v[104:107], a[232:235], a[136:139]
    buffer_load_dwordx4 v[164:167], v247, s[40:43], s74 offen offset:1024
    v_mfma_f32_16x16x32_bf16 a[168:171], v[104:107], a[236:239], a[168:171]
    buffer_load_dwordx4 v[168:171], v247, s[40:43], s74 offen offset:2048
    v_mfma_f32_16x16x32_bf16 a[12:15], v[108:111], a[216:219], a[12:15]
    v_perm_b32 v96, v38, v34, s60
    v_perm_b32 v97, v46, v42, s60
    v_mfma_f32_16x16x32_bf16 a[44:47], v[108:111], a[220:223], a[44:47]
    v_perm_b32 v98, v54, v50, s60
    v_mfma_f32_16x16x32_bf16 a[76:79], v[108:111], a[224:227], a[76:79]
    v_perm_b32 v99, v62, v58, s60
    v_mfma_f32_16x16x32_bf16 a[108:111], v[108:111], a[228:231], a[108:111]
    buffer_load_dwordx4 v[172:175], v247, s[40:43], s74 offen offset:3072
    v_mfma_f32_16x16x32_bf16 a[140:143], v[108:111], a[232:235], a[140:143]
    ds_read_b128 a[192:195], v250 offset:28672
    v_mfma_f32_16x16x32_bf16 a[172:175], v[108:111], a[236:239], a[172:175]
    ds_read_b128 a[196:199], v250 offset:29696
    v_mfma_f32_16x16x32_bf16 a[16:19], v[96:99], a[216:219], a[16:19]
    v_perm_b32 v100, v38, v34, s61
    v_perm_b32 v101, v46, v42, s61
    v_mfma_f32_16x16x32_bf16 a[48:51], v[96:99], a[220:223], a[48:51]
    v_perm_b32 v102, v54, v50, s61
    v_mfma_f32_16x16x32_bf16 a[80:83], v[96:99], a[224:227], a[80:83]
    v_perm_b32 v103, v62, v58, s61
    v_mfma_f32_16x16x32_bf16 a[112:115], v[96:99], a[228:231], a[112:115]
    s_mov_b32 s74, 286720
    buffer_load_dwordx4 v[176:179], v247, s[40:43], s74 offen offset:0
    v_mfma_f32_16x16x32_bf16 a[144:147], v[96:99], a[232:235], a[144:147]
    ds_read_b128 a[200:203], v250 offset:30720
    v_mfma_f32_16x16x32_bf16 a[176:179], v[96:99], a[236:239], a[176:179]
    ds_read_b128 a[204:207], v250 offset:31744
    v_mfma_f32_16x16x32_bf16 a[20:23], v[100:103], a[216:219], a[20:23]
    v_perm_b32 v104, v39, v35, s60
    v_perm_b32 v105, v47, v43, s60
    v_mfma_f32_16x16x32_bf16 a[52:55], v[100:103], a[220:223], a[52:55]
    v_perm_b32 v106, v55, v51, s60
    v_mfma_f32_16x16x32_bf16 a[84:87], v[100:103], a[224:227], a[84:87]
    v_perm_b32 v107, v63, v59, s60
    v_mfma_f32_16x16x32_bf16 a[116:119], v[100:103], a[228:231], a[116:119]
    buffer_load_dwordx4 v[180:183], v247, s[40:43], s74 offen offset:1024
    buffer_load_dwordx4 v[184:187], v247, s[40:43], s74 offen offset:2048
    v_mfma_f32_16x16x32_bf16 a[148:151], v[100:103], a[232:235], a[148:151]
    ds_read_b128 a[208:211], v248 offset:8192
    v_mfma_f32_16x16x32_bf16 a[180:183], v[100:103], a[236:239], a[180:183]
    ds_read_b128 a[212:215], v248 offset:9216
    v_mfma_f32_16x16x32_bf16 a[24:27], v[104:107], a[216:219], a[24:27]
    v_perm_b32 v108, v39, v35, s61
    v_mfma_f32_16x16x32_bf16 a[56:59], v[104:107], a[220:223], a[56:59]
    v_perm_b32 v109, v47, v43, s61
    v_mfma_f32_16x16x32_bf16 a[88:91], v[104:107], a[224:227], a[88:91]
    v_perm_b32 v110, v55, v51, s61
    v_mfma_f32_16x16x32_bf16 a[120:123], v[104:107], a[228:231], a[120:123]
    v_perm_b32 v111, v63, v59, s61
    v_mfma_f32_16x16x32_bf16 a[152:155], v[104:107], a[232:235], a[152:155]
    buffer_load_dwordx4 v[188:191], v247, s[40:43], s74 offen offset:3072
    v_mfma_f32_16x16x32_bf16 a[184:187], v[104:107], a[236:239], a[184:187]
    v_mfma_f32_16x16x32_bf16 a[28:31], v[108:111], a[216:219], a[28:31]
    s_waitcnt vmcnt(24)
    v_perm_b32 v96, v4, v0, s60
    v_mfma_f32_16x16x32_bf16 a[60:63], v[108:111], a[220:223], a[60:63]
    v_perm_b32 v97, v12, v8, s60
    v_mfma_f32_16x16x32_bf16 a[92:95], v[108:111], a[224:227], a[92:95]
    v_perm_b32 v98, v20, v16, s60
    v_mfma_f32_16x16x32_bf16 a[124:127], v[108:111], a[228:231], a[124:127]
    v_perm_b32 v99, v28, v24, s60
    s_mov_b32 s74, 294912
    v_mfma_f32_16x16x32_bf16 a[156:159], v[108:111], a[232:235], a[156:159]
    buffer_load_dwordx4 v[32:35], v247, s[40:43], s74 offen offset:0
    v_mfma_f32_16x16x32_bf16 a[188:191], v[108:111], a[236:239], a[188:191]
    buffer_load_dwordx4 v[36:39], v247, s[40:43], s74 offen offset:1024
    s_waitcnt lgkmcnt(0)
    v_mfma_f32_16x16x32_bf16 a[0:3], v[96:99], a[192:195], a[0:3]
    v_perm_b32 v100, v4, v0, s61
    v_mfma_f32_16x16x32_bf16 a[32:35], v[96:99], a[196:199], a[32:35]
    v_perm_b32 v101, v12, v8, s61
    v_mfma_f32_16x16x32_bf16 a[64:67], v[96:99], a[200:203], a[64:67]
    v_perm_b32 v102, v20, v16, s61
    v_mfma_f32_16x16x32_bf16 a[96:99], v[96:99], a[204:207], a[96:99]
    v_perm_b32 v103, v28, v24, s61
    v_mfma_f32_16x16x32_bf16 a[128:131], v[96:99], a[208:211], a[128:131]
    buffer_load_dwordx4 v[40:43], v247, s[40:43], s74 offen offset:2048
    v_mfma_f32_16x16x32_bf16 a[160:163], v[96:99], a[212:215], a[160:163]
    v_mfma_f32_16x16x32_bf16 a[4:7], v[100:103], a[192:195], a[4:7]
    v_perm_b32 v104, v5, v1, s60
    v_mfma_f32_16x16x32_bf16 a[36:39], v[100:103], a[196:199], a[36:39]
    v_perm_b32 v105, v13, v9, s60
    v_mfma_f32_16x16x32_bf16 a[68:71], v[100:103], a[200:203], a[68:71]
    v_perm_b32 v106, v21, v17, s60
    v_mfma_f32_16x16x32_bf16 a[100:103], v[100:103], a[204:207], a[100:103]
    v_perm_b32 v107, v29, v25, s60
    v_mfma_f32_16x16x32_bf16 a[132:135], v[100:103], a[208:211], a[132:135]
    buffer_load_dwordx4 v[44:47], v247, s[40:43], s74 offen offset:3072
    v_mfma_f32_16x16x32_bf16 a[164:167], v[100:103], a[212:215], a[164:167]
    v_mfma_f32_16x16x32_bf16 a[8:11], v[104:107], a[192:195], a[8:11]
    v_perm_b32 v108, v5, v1, s61
    v_perm_b32 v109, v13, v9, s61
    v_mfma_f32_16x16x32_bf16 a[40:43], v[104:107], a[196:199], a[40:43]
    v_perm_b32 v110, v21, v17, s61
    v_mfma_f32_16x16x32_bf16 a[72:75], v[104:107], a[200:203], a[72:75]
    v_perm_b32 v111, v29, v25, s61
    v_mfma_f32_16x16x32_bf16 a[104:107], v[104:107], a[204:207], a[104:107]
    s_mov_b32 s74, 303104
    v_mfma_f32_16x16x32_bf16 a[136:139], v[104:107], a[208:211], a[136:139]
    buffer_load_dwordx4 v[48:51], v247, s[40:43], s74 offen offset:0
    v_mfma_f32_16x16x32_bf16 a[168:171], v[104:107], a[212:215], a[168:171]
    buffer_load_dwordx4 v[52:55], v247, s[40:43], s74 offen offset:1024
    v_mfma_f32_16x16x32_bf16 a[12:15], v[108:111], a[192:195], a[12:15]
    v_perm_b32 v96, v6, v2, s60
    v_perm_b32 v97, v14, v10, s60
    v_mfma_f32_16x16x32_bf16 a[44:47], v[108:111], a[196:199], a[44:47]
    v_perm_b32 v98, v22, v18, s60
    v_mfma_f32_16x16x32_bf16 a[76:79], v[108:111], a[200:203], a[76:79]
    v_perm_b32 v99, v30, v26, s60
    v_mfma_f32_16x16x32_bf16 a[108:111], v[108:111], a[204:207], a[108:111]
    buffer_load_dwordx4 v[56:59], v247, s[40:43], s74 offen offset:2048
    v_mfma_f32_16x16x32_bf16 a[140:143], v[108:111], a[208:211], a[140:143]
    ds_read_b128 a[216:219], v248 offset:10240
    v_mfma_f32_16x16x32_bf16 a[172:175], v[108:111], a[212:215], a[172:175]
    ds_read_b128 a[220:223], v248 offset:11264
    v_mfma_f32_16x16x32_bf16 a[16:19], v[96:99], a[192:195], a[16:19]
    v_perm_b32 v100, v6, v2, s61
    v_perm_b32 v101, v14, v10, s61
    v_mfma_f32_16x16x32_bf16 a[48:51], v[96:99], a[196:199], a[48:51]
    v_perm_b32 v102, v22, v18, s61
    v_mfma_f32_16x16x32_bf16 a[80:83], v[96:99], a[200:203], a[80:83]
    v_perm_b32 v103, v30, v26, s61
    v_mfma_f32_16x16x32_bf16 a[112:115], v[96:99], a[204:207], a[112:115]
    buffer_load_dwordx4 v[60:63], v247, s[40:43], s74 offen offset:3072
    v_mfma_f32_16x16x32_bf16 a[144:147], v[96:99], a[208:211], a[144:147]
    ds_read_b128 a[224:227], v248 offset:12288
    v_mfma_f32_16x16x32_bf16 a[176:179], v[96:99], a[212:215], a[176:179]
    ds_read_b128 a[228:231], v248 offset:13312
    v_mfma_f32_16x16x32_bf16 a[20:23], v[100:103], a[192:195], a[20:23]
    v_perm_b32 v104, v7, v3, s60
    v_mfma_f32_16x16x32_bf16 a[52:55], v[100:103], a[196:199], a[52:55]
    v_perm_b32 v105, v15, v11, s60
    v_mfma_f32_16x16x32_bf16 a[84:87], v[100:103], a[200:203], a[84:87]
    v_perm_b32 v106, v23, v19, s60
    v_mfma_f32_16x16x32_bf16 a[116:119], v[100:103], a[204:207], a[116:119]
    v_perm_b32 v107, v31, v27, s60
    v_mfma_f32_16x16x32_bf16 a[148:151], v[100:103], a[208:211], a[148:151]
    ds_read_b128 a[232:235], v248 offset:14336
    v_mfma_f32_16x16x32_bf16 a[180:183], v[100:103], a[212:215], a[180:183]
    ds_read_b128 a[236:239], v248 offset:15360
    v_mfma_f32_16x16x32_bf16 a[24:27], v[104:107], a[192:195], a[24:27]
    v_perm_b32 v108, v7, v3, s61
    v_mfma_f32_16x16x32_bf16 a[56:59], v[104:107], a[196:199], a[56:59]
    v_perm_b32 v109, v15, v11, s61
    v_mfma_f32_16x16x32_bf16 a[88:91], v[104:107], a[200:203], a[88:91]
    v_mfma_f32_16x16x32_bf16 a[120:123], v[104:107], a[204:207], a[120:123]
    v_perm_b32 v110, v23, v19, s61
    v_mfma_f32_16x16x32_bf16 a[152:155], v[104:107], a[208:211], a[152:155]
    v_perm_b32 v111, v31, v27, s61
    v_mfma_f32_16x16x32_bf16 a[184:187], v[104:107], a[212:215], a[184:187]
    s_nop 0
    v_mfma_f32_16x16x32_bf16 a[28:31], v[108:111], a[192:195], a[28:31]
    s_waitcnt vmcnt(24)
    v_perm_b32 v96, v68, v64, s60
    v_mfma_f32_16x16x32_bf16 a[60:63], v[108:111], a[196:199], a[60:63]
    v_perm_b32 v97, v76, v72, s60
    v_mfma_f32_16x16x32_bf16 a[92:95], v[108:111], a[200:203], a[92:95]
    v_perm_b32 v98, v84, v80, s60
    v_mfma_f32_16x16x32_bf16 a[124:127], v[108:111], a[204:207], a[124:127]
    v_perm_b32 v99, v92, v88, s60
    s_mov_b32 s74, 311296
    v_mfma_f32_16x16x32_bf16 a[156:159], v[108:111], a[208:211], a[156:159]
    buffer_load_dwordx4 v[0:3], v247, s[40:43], s74 offen offset:0
    v_mfma_f32_16x16x32_bf16 a[188:191], v[108:111], a[212:215], a[188:191]
    buffer_load_dwordx4 v[4:7], v247, s[40:43], s74 offen offset:1024
    s_waitcnt lgkmcnt(0)
    v_mfma_f32_16x16x32_bf16 a[0:3], v[96:99], a[216:219], a[0:3]
    v_perm_b32 v100, v68, v64, s61
    v_mfma_f32_16x16x32_bf16 a[32:35], v[96:99], a[220:223], a[32:35]
    v_perm_b32 v101, v76, v72, s61
    v_mfma_f32_16x16x32_bf16 a[64:67], v[96:99], a[224:227], a[64:67]
    v_perm_b32 v102, v84, v80, s61
    v_mfma_f32_16x16x32_bf16 a[96:99], v[96:99], a[228:231], a[96:99]
    v_perm_b32 v103, v92, v88, s61
    v_mfma_f32_16x16x32_bf16 a[128:131], v[96:99], a[232:235], a[128:131]
    buffer_load_dwordx4 v[8:11], v247, s[40:43], s74 offen offset:2048
    v_mfma_f32_16x16x32_bf16 a[160:163], v[96:99], a[236:239], a[160:163]
    v_mfma_f32_16x16x32_bf16 a[4:7], v[100:103], a[216:219], a[4:7]
    v_perm_b32 v104, v69, v65, s60
    v_mfma_f32_16x16x32_bf16 a[36:39], v[100:103], a[220:223], a[36:39]
    v_perm_b32 v105, v77, v73, s60
    v_mfma_f32_16x16x32_bf16 a[68:71], v[100:103], a[224:227], a[68:71]
    v_perm_b32 v106, v85, v81, s60
    v_mfma_f32_16x16x32_bf16 a[100:103], v[100:103], a[228:231], a[100:103]
    v_perm_b32 v107, v93, v89, s60
    v_mfma_f32_16x16x32_bf16 a[132:135], v[100:103], a[232:235], a[132:135]
    buffer_load_dwordx4 v[12:15], v247, s[40:43], s74 offen offset:3072
    v_mfma_f32_16x16x32_bf16 a[164:167], v[100:103], a[236:239], a[164:167]
    v_mfma_f32_16x16x32_bf16 a[8:11], v[104:107], a[216:219], a[8:11]
    v_perm_b32 v108, v69, v65, s61
    v_perm_b32 v109, v77, v73, s61
    v_mfma_f32_16x16x32_bf16 a[40:43], v[104:107], a[220:223], a[40:43]
    v_perm_b32 v110, v85, v81, s61
    v_mfma_f32_16x16x32_bf16 a[72:75], v[104:107], a[224:227], a[72:75]
    v_perm_b32 v111, v93, v89, s61
    v_mfma_f32_16x16x32_bf16 a[104:107], v[104:107], a[228:231], a[104:107]
    s_mov_b32 s74, 319488
    v_mfma_f32_16x16x32_bf16 a[136:139], v[104:107], a[232:235], a[136:139]
    buffer_load_dwordx4 v[16:19], v247, s[40:43], s74 offen offset:0
    v_mfma_f32_16x16x32_bf16 a[168:171], v[104:107], a[236:239], a[168:171]
    buffer_load_dwordx4 v[20:23], v247, s[40:43], s74 offen offset:1024
    v_mfma_f32_16x16x32_bf16 a[12:15], v[108:111], a[216:219], a[12:15]
    v_perm_b32 v96, v70, v66, s60
    v_perm_b32 v97, v78, v74, s60
    v_mfma_f32_16x16x32_bf16 a[44:47], v[108:111], a[220:223], a[44:47]
    v_perm_b32 v98, v86, v82, s60
    v_mfma_f32_16x16x32_bf16 a[76:79], v[108:111], a[224:227], a[76:79]
    v_perm_b32 v99, v94, v90, s60
    v_mfma_f32_16x16x32_bf16 a[108:111], v[108:111], a[228:231], a[108:111]
    buffer_load_dwordx4 v[24:27], v247, s[40:43], s74 offen offset:2048
    v_mfma_f32_16x16x32_bf16 a[140:143], v[108:111], a[232:235], a[140:143]
    ds_read_b128 a[192:195], v250 offset:32768
    v_mfma_f32_16x16x32_bf16 a[172:175], v[108:111], a[236:239], a[172:175]
    ds_read_b128 a[196:199], v250 offset:33792
    v_mfma_f32_16x16x32_bf16 a[16:19], v[96:99], a[216:219], a[16:19]
    v_perm_b32 v100, v70, v66, s61
    v_perm_b32 v101, v78, v74, s61
    v_mfma_f32_16x16x32_bf16 a[48:51], v[96:99], a[220:223], a[48:51]
    v_perm_b32 v102, v86, v82, s61
    v_mfma_f32_16x16x32_bf16 a[80:83], v[96:99], a[224:227], a[80:83]
    v_perm_b32 v103, v94, v90, s61
    v_mfma_f32_16x16x32_bf16 a[112:115], v[96:99], a[228:231], a[112:115]
    buffer_load_dwordx4 v[28:31], v247, s[40:43], s74 offen offset:3072
    v_mfma_f32_16x16x32_bf16 a[144:147], v[96:99], a[232:235], a[144:147]
    ds_read_b128 a[200:203], v250 offset:34816
    v_mfma_f32_16x16x32_bf16 a[176:179], v[96:99], a[236:239], a[176:179]
    ds_read_b128 a[204:207], v250 offset:35840
    v_mfma_f32_16x16x32_bf16 a[20:23], v[100:103], a[216:219], a[20:23]
    v_perm_b32 v104, v71, v67, s60
    v_mfma_f32_16x16x32_bf16 a[52:55], v[100:103], a[220:223], a[52:55]
    v_perm_b32 v105, v79, v75, s60
    v_mfma_f32_16x16x32_bf16 a[84:87], v[100:103], a[224:227], a[84:87]
    v_perm_b32 v106, v87, v83, s60
    v_mfma_f32_16x16x32_bf16 a[116:119], v[100:103], a[228:231], a[116:119]
    v_perm_b32 v107, v95, v91, s60
    v_mfma_f32_16x16x32_bf16 a[148:151], v[100:103], a[232:235], a[148:151]
    ds_read_b128 a[208:211], v250 offset:36864
    v_mfma_f32_16x16x32_bf16 a[180:183], v[100:103], a[236:239], a[180:183]
    ds_read_b128 a[212:215], v250 offset:37888
    v_mfma_f32_16x16x32_bf16 a[24:27], v[104:107], a[216:219], a[24:27]
    v_perm_b32 v108, v71, v67, s61
    v_mfma_f32_16x16x32_bf16 a[56:59], v[104:107], a[220:223], a[56:59]
    v_perm_b32 v109, v79, v75, s61
    v_mfma_f32_16x16x32_bf16 a[88:91], v[104:107], a[224:227], a[88:91]
    v_mfma_f32_16x16x32_bf16 a[120:123], v[104:107], a[228:231], a[120:123]
    v_perm_b32 v110, v87, v83, s61
    v_mfma_f32_16x16x32_bf16 a[152:155], v[104:107], a[232:235], a[152:155]
    v_perm_b32 v111, v95, v91, s61
    v_mfma_f32_16x16x32_bf16 a[184:187], v[104:107], a[236:239], a[184:187]
    s_nop 0
    v_mfma_f32_16x16x32_bf16 a[28:31], v[108:111], a[216:219], a[28:31]
    s_waitcnt vmcnt(24)
    v_perm_b32 v96, v132, v128, s60
    v_mfma_f32_16x16x32_bf16 a[60:63], v[108:111], a[220:223], a[60:63]
    v_perm_b32 v97, v140, v136, s60
    v_mfma_f32_16x16x32_bf16 a[92:95], v[108:111], a[224:227], a[92:95]
    v_perm_b32 v98, v148, v144, s60
    v_mfma_f32_16x16x32_bf16 a[124:127], v[108:111], a[228:231], a[124:127]
    v_perm_b32 v99, v156, v152, s60
    s_mov_b32 s74, 393216
    v_mfma_f32_16x16x32_bf16 a[156:159], v[108:111], a[232:235], a[156:159]
    buffer_load_dwordx4 v[64:67], v247, s[40:43], s74 offen offset:0
    v_mfma_f32_16x16x32_bf16 a[188:191], v[108:111], a[236:239], a[188:191]
    buffer_load_dwordx4 v[68:71], v247, s[40:43], s74 offen offset:1024
    s_waitcnt lgkmcnt(0)
    v_mfma_f32_16x16x32_bf16 a[0:3], v[96:99], a[192:195], a[0:3]
    v_perm_b32 v100, v132, v128, s61
    v_perm_b32 v101, v140, v136, s61
    v_perm_b32 v102, v148, v144, s61
    v_mfma_f32_16x16x32_bf16 a[32:35], v[96:99], a[196:199], a[32:35]
    v_perm_b32 v103, v156, v152, s61
    s_waitcnt vmcnt(18)
    v_mfma_f32_16x16x32_bf16 a[64:67], v[96:99], a[200:203], a[64:67]
    v_perm_b32 v192, v164, v160, s60
    v_perm_b32 v193, v172, v168, s60
    v_perm_b32 v194, v180, v176, s60
    v_mfma_f32_16x16x32_bf16 a[96:99], v[96:99], a[204:207], a[96:99]
    v_perm_b32 v195, v188, v184, s60
    v_perm_b32 v196, v164, v160, s61
    v_mfma_f32_16x16x32_bf16 a[128:131], v[96:99], a[208:211], a[128:131]
    v_perm_b32 v197, v172, v168, s61
    v_perm_b32 v198, v180, v176, s61
    v_perm_b32 v199, v188, v184, s61
    v_mfma_f32_16x16x32_bf16 a[160:163], v[96:99], a[212:215], a[160:163]
    buffer_load_dwordx4 v[72:75], v247, s[40:43], s74 offen offset:2048
    buffer_load_dwordx4 v[76:79], v247, s[40:43], s74 offen offset:3072
    v_mfma_f32_16x16x32_bf16 a[4:7], v[100:103], a[192:195], a[4:7]
    v_perm_b32 v104, v133, v129, s60
    v_perm_b32 v105, v141, v137, s60
    v_perm_b32 v106, v149, v145, s60
    v_mfma_f32_16x16x32_bf16 a[36:39], v[100:103], a[196:199], a[36:39]
    v_perm_b32 v107, v157, v153, s60
    v_perm_b32 v200, v165, v161, s60
    v_perm_b32 v201, v173, v169, s60
    v_mfma_f32_16x16x32_bf16 a[68:71], v[100:103], a[200:203], a[68:71]
    v_perm_b32 v202, v181, v177, s60
    v_perm_b32 v203, v189, v185, s60
    v_mfma_f32_16x16x32_bf16 a[100:103], v[100:103], a[204:207], a[100:103]
    v_perm_b32 v204, v165, v161, s61
    v_perm_b32 v205, v173, v169, s61
    v_perm_b32 v206, v181, v177, s61
    v_mfma_f32_16x16x32_bf16 a[132:135], v[100:103], a[208:211], a[132:135]
    v_perm_b32 v207, v189, v185, s61
    v_perm_b32 v208, v166, v162, s60
    s_mov_b32 s74, 401408
    v_mfma_f32_16x16x32_bf16 a[164:167], v[100:103], a[212:215], a[164:167]
    buffer_load_dwordx4 v[80:83], v247, s[40:43], s74 offen offset:0
    buffer_load_dwordx4 v[84:87], v247, s[40:43], s74 offen offset:1024
    v_mfma_f32_16x16x32_bf16 a[8:11], v[104:107], a[192:195], a[8:11]
    v_perm_b32 v108, v133, v129, s61
    v_perm_b32 v109, v141, v137, s61
    v_perm_b32 v110, v149, v145, s61
    v_mfma_f32_16x16x32_bf16 a[40:43], v[104:107], a[196:199], a[40:43]
    v_perm_b32 v111, v157, v153, s61
    v_perm_b32 v209, v174, v170, s60
    v_mfma_f32_16x16x32_bf16 a[72:75], v[104:107], a[200:203], a[72:75]
    v_perm_b32 v210, v182, v178, s60
    v_perm_b32 v211, v190, v186, s60
    v_perm_b32 v212, v166, v162, s61
    v_mfma_f32_16x16x32_bf16 a[104:107], v[104:107], a[204:207], a[104:107]
    v_perm_b32 v213, v174, v170, s61
    v_perm_b32 v214, v182, v178, s61
    v_mfma_f32_16x16x32_bf16 a[136:139], v[104:107], a[208:211], a[136:139]
    v_perm_b32 v215, v190, v186, s61
    v_perm_b32 v216, v167, v163, s60
    v_perm_b32 v217, v175, v171, s60
    v_mfma_f32_16x16x32_bf16 a[168:171], v[104:107], a[212:215], a[168:171]
    buffer_load_dwordx4 v[88:91], v247, s[40:43], s74 offen offset:2048
    buffer_load_dwordx4 v[92:95], v247, s[40:43], s74 offen offset:3072
    v_mfma_f32_16x16x32_bf16 a[12:15], v[108:111], a[192:195], a[12:15]
    v_perm_b32 v96, v134, v130, s60
    v_perm_b32 v97, v142, v138, s60
    v_mfma_f32_16x16x32_bf16 a[44:47], v[108:111], a[196:199], a[44:47]
    v_perm_b32 v98, v150, v146, s60
    v_perm_b32 v99, v158, v154, s60
    v_mfma_f32_16x16x32_bf16 a[76:79], v[108:111], a[200:203], a[76:79]
    v_perm_b32 v218, v183, v179, s60
    v_perm_b32 v219, v191, v187, s60
    v_mfma_f32_16x16x32_bf16 a[108:111], v[108:111], a[204:207], a[108:111]
    v_perm_b32 v220, v167, v163, s61
    v_perm_b32 v221, v175, v171, s61
    v_mfma_f32_16x16x32_bf16 a[140:143], v[108:111], a[208:211], a[140:143]
    v_perm_b32 v222, v183, v179, s61
    v_perm_b32 v223, v191, v187, s61
    v_mfma_f32_16x16x32_bf16 a[172:175], v[108:111], a[212:215], a[172:175]
    ds_read_b128 a[216:219], v250 offset:38912
    ds_read_b128 a[220:223], v250 offset:39936
    v_mfma_f32_16x16x32_bf16 a[16:19], v[96:99], a[192:195], a[16:19]
    v_perm_b32 v100, v134, v130, s61
    v_perm_b32 v101, v142, v138, s61
    v_mfma_f32_16x16x32_bf16 a[48:51], v[96:99], a[196:199], a[48:51]
    v_perm_b32 v102, v150, v146, s61
    v_mfma_f32_16x16x32_bf16 a[80:83], v[96:99], a[200:203], a[80:83]
    v_perm_b32 v103, v158, v154, s61
    s_mov_b32 s74, 409600
    v_mfma_f32_16x16x32_bf16 a[112:115], v[96:99], a[204:207], a[112:115]
    buffer_load_dwordx4 v[160:163], v247, s[40:43], s74 offen offset:0
    v_mfma_f32_16x16x32_bf16 a[144:147], v[96:99], a[208:211], a[144:147]
    buffer_load_dwordx4 v[164:167], v247, s[40:43], s74 offen offset:1024
    ds_read_b128 a[224:227], v250 offset:40960
    v_mfma_f32_16x16x32_bf16 a[176:179], v[96:99], a[212:215], a[176:179]
    ds_read_b128 a[228:231], v250 offset:41984
    v_mfma_f32_16x16x32_bf16 a[20:23], v[100:103], a[192:195], a[20:23]
    v_perm_b32 v104, v135, v131, s60
    v_perm_b32 v105, v143, v139, s60
    v_mfma_f32_16x16x32_bf16 a[52:55], v[100:103], a[196:199], a[52:55]
    v_perm_b32 v106, v151, v147, s60
    v_mfma_f32_16x16x32_bf16 a[84:87], v[100:103], a[200:203], a[84:87]
    v_perm_b32 v107, v159, v155, s60
    v_mfma_f32_16x16x32_bf16 a[116:119], v[100:103], a[204:207], a[116:119]
    buffer_load_dwordx4 v[168:171], v247, s[40:43], s74 offen offset:2048
    buffer_load_dwordx4 v[172:175], v247, s[40:43], s74 offen offset:3072
    v_mfma_f32_16x16x32_bf16 a[148:151], v[100:103], a[208:211], a[148:151]
    ds_read_b128 a[232:235], v250 offset:43008
    v_mfma_f32_16x16x32_bf16 a[180:183], v[100:103], a[212:215], a[180:183]
    ds_read_b128 a[236:239], v250 offset:44032
    v_mfma_f32_16x16x32_bf16 a[24:27], v[104:107], a[192:195], a[24:27]
    v_perm_b32 v108, v135, v131, s61
    v_perm_b32 v109, v143, v139, s61
    v_mfma_f32_16x16x32_bf16 a[56:59], v[104:107], a[196:199], a[56:59]
    v_perm_b32 v110, v151, v147, s61
    v_mfma_f32_16x16x32_bf16 a[88:91], v[104:107], a[200:203], a[88:91]
    v_perm_b32 v111, v159, v155, s61
    v_mfma_f32_16x16x32_bf16 a[120:123], v[104:107], a[204:207], a[120:123]
    s_mov_b32 s74, 417792
    v_mfma_f32_16x16x32_bf16 a[152:155], v[104:107], a[208:211], a[152:155]
    buffer_load_dwordx4 v[176:179], v247, s[40:43], s74 offen offset:0
    v_mfma_f32_16x16x32_bf16 a[184:187], v[104:107], a[212:215], a[184:187]
    buffer_load_dwordx4 v[180:183], v247, s[40:43], s74 offen offset:1024
    v_mfma_f32_16x16x32_bf16 a[28:31], v[108:111], a[192:195], a[28:31]
    buffer_load_dwordx4 v[184:187], v247, s[40:43], s74 offen offset:2048
    v_mfma_f32_16x16x32_bf16 a[60:63], v[108:111], a[196:199], a[60:63]
    v_mfma_f32_16x16x32_bf16 a[92:95], v[108:111], a[200:203], a[92:95]
    v_mfma_f32_16x16x32_bf16 a[124:127], v[108:111], a[204:207], a[124:127]
    buffer_load_dwordx4 v[188:191], v247, s[40:43], s74 offen offset:3072
    v_mfma_f32_16x16x32_bf16 a[156:159], v[108:111], a[208:211], a[156:159]
    v_mfma_f32_16x16x32_bf16 a[188:191], v[108:111], a[212:215], a[188:191]
    s_waitcnt lgkmcnt(0)
    v_mfma_f32_16x16x32_bf16 a[0:3], v[192:195], a[216:219], a[0:3]
    s_waitcnt vmcnt(24)
    v_perm_b32 v96, v36, v32, s60
    v_mfma_f32_16x16x32_bf16 a[32:35], v[192:195], a[220:223], a[32:35]
    v_perm_b32 v97, v44, v40, s60
    v_perm_b32 v98, v52, v48, s60
    v_mfma_f32_16x16x32_bf16 a[64:67], v[192:195], a[224:227], a[64:67]
    v_perm_b32 v99, v60, v56, s60
    v_perm_b32 v100, v36, v32, s61
    v_mfma_f32_16x16x32_bf16 a[96:99], v[192:195], a[228:231], a[96:99]
    v_perm_b32 v101, v44, v40, s61
    v_perm_b32 v102, v52, v48, s61
    v_mfma_f32_16x16x32_bf16 a[128:131], v[192:195], a[232:235], a[128:131]
    v_perm_b32 v103, v60, v56, s61
    s_mov_b32 s74, 425984
    v_mfma_f32_16x16x32_bf16 a[160:163], v[192:195], a[236:239], a[160:163]
    buffer_load_dwordx4 v[128:131], v247, s[40:43], s74 offen offset:0
    buffer_load_dwordx4 v[132:135], v247, s[40:43], s74 offen offset:1024
    v_mfma_f32_16x16x32_bf16 a[4:7], v[196:199], a[216:219], a[4:7]
    v_perm_b32 v104, v37, v33, s60
    v_perm_b32 v105, v45, v41, s60
    v_mfma_f32_16x16x32_bf16 a[36:39], v[196:199], a[220:223], a[36:39]
    v_perm_b32 v106, v53, v49, s60
    v_perm_b32 v107, v61, v57, s60
    v_mfma_f32_16x16x32_bf16 a[68:71], v[196:199], a[224:227], a[68:71]
    v_perm_b32 v108, v37, v33, s61
    v_perm_b32 v109, v45, v41, s61
    v_mfma_f32_16x16x32_bf16 a[100:103], v[196:199], a[228:231], a[100:103]
    v_perm_b32 v110, v53, v49, s61
    v_perm_b32 v111, v61, v57, s61
    v_mfma_f32_16x16x32_bf16 a[132:135], v[196:199], a[232:235], a[132:135]
    v_perm_b32 v112, v38, v34, s60
    buffer_load_dwordx4 v[136:139], v247, s[40:43], s74 offen offset:2048
    v_mfma_f32_16x16x32_bf16 a[164:167], v[196:199], a[236:239], a[164:167]
    buffer_load_dwordx4 v[140:143], v247, s[40:43], s74 offen offset:3072
    v_mfma_f32_16x16x32_bf16 a[8:11], v[200:203], a[216:219], a[8:11]
    v_perm_b32 v113, v46, v42, s60
    v_perm_b32 v114, v54, v50, s60
    v_mfma_f32_16x16x32_bf16 a[40:43], v[200:203], a[220:223], a[40:43]
    v_perm_b32 v115, v62, v58, s60
    v_perm_b32 v116, v38, v34, s61
    v_mfma_f32_16x16x32_bf16 a[72:75], v[200:203], a[224:227], a[72:75]
    v_perm_b32 v117, v46, v42, s61
    v_perm_b32 v118, v54, v50, s61
    v_mfma_f32_16x16x32_bf16 a[104:107], v[200:203], a[228:231], a[104:107]
    v_perm_b32 v119, v62, v58, s61
    v_perm_b32 v120, v39, v35, s60
    v_mfma_f32_16x16x32_bf16 a[136:139], v[200:203], a[232:235], a[136:139]
    v_perm_b32 v121, v47, v43, s60
    s_mov_b32 s74, 434176
    v_mfma_f32_16x16x32_bf16 a[168:171], v[200:203], a[236:239], a[168:171]
    buffer_load_dwordx4 v[144:147], v247, s[40:43], s74 offen offset:0
    buffer_load_dwordx4 v[148:151], v247, s[40:43], s74 offen offset:1024
    v_mfma_f32_16x16x32_bf16 a[12:15], v[204:207], a[216:219], a[12:15]
    v_perm_b32 v122, v55, v51, s60
    v_perm_b32 v123, v63, v59, s60
    v_mfma_f32_16x16x32_bf16 a[44:47], v[204:207], a[220:223], a[44:47]
    v_perm_b32 v124, v39, v35, s61
    v_perm_b32 v125, v47, v43, s61
    v_mfma_f32_16x16x32_bf16 a[76:79], v[204:207], a[224:227], a[76:79]
    v_perm_b32 v126, v55, v51, s61
    v_mfma_f32_16x16x32_bf16 a[108:111], v[204:207], a[228:231], a[108:111]
    v_perm_b32 v127, v63, v59, s61
    buffer_load_dwordx4 v[152:155], v247, s[40:43], s74 offen offset:2048
    v_mfma_f32_16x16x32_bf16 a[140:143], v[204:207], a[232:235], a[140:143]
    buffer_load_dwordx4 v[156:159], v247, s[40:43], s74 offen offset:3072
    ds_read_b128 a[192:195], v250 offset:45056
    v_mfma_f32_16x16x32_bf16 a[172:175], v[204:207], a[236:239], a[172:175]
    ds_read_b128 a[196:199], v250 offset:46080
    v_mfma_f32_16x16x32_bf16 a[16:19], v[208:211], a[216:219], a[16:19]
    s_mov_b32 s74, 442368
    v_mfma_f32_16x16x32_bf16 a[48:51], v[208:211], a[220:223], a[48:51]
    buffer_load_dwordx4 v[32:35], v247, s[40:43], s74 offen offset:0
    v_mfma_f32_16x16x32_bf16 a[80:83], v[208:211], a[224:227], a[80:83]
    buffer_load_dwordx4 v[36:39], v247, s[40:43], s74 offen offset:1024
    v_mfma_f32_16x16x32_bf16 a[112:115], v[208:211], a[228:231], a[112:115]
    ds_read_b128 a[200:203], v248 offset:18432
    v_mfma_f32_16x16x32_bf16 a[144:147], v[208:211], a[232:235], a[144:147]
    ds_read_b128 a[204:207], v248 offset:19456
    v_mfma_f32_16x16x32_bf16 a[176:179], v[208:211], a[236:239], a[176:179]
    v_mfma_f32_16x16x32_bf16 a[20:23], v[212:215], a[216:219], a[20:23]
    buffer_load_dwordx4 v[40:43], v247, s[40:43], s74 offen offset:2048
    v_mfma_f32_16x16x32_bf16 a[52:55], v[212:215], a[220:223], a[52:55]
    buffer_load_dwordx4 v[44:47], v247, s[40:43], s74 offen offset:3072
    v_mfma_f32_16x16x32_bf16 a[84:87], v[212:215], a[224:227], a[84:87]
    v_mfma_f32_16x16x32_bf16 a[116:119], v[212:215], a[228:231], a[116:119]
    ds_read_b128 a[208:211], v250 offset:49152
    v_mfma_f32_16x16x32_bf16 a[148:151], v[212:215], a[232:235], a[148:151]
    ds_read_b128 a[212:215], v250 offset:50176
    v_mfma_f32_16x16x32_bf16 a[180:183], v[212:215], a[236:239], a[180:183]
    v_mfma_f32_16x16x32_bf16 a[24:27], v[216:219], a[216:219], a[24:27]
    s_mov_b32 s74, 450560
    v_mfma_f32_16x16x32_bf16 a[56:59], v[216:219], a[220:223], a[56:59]
    v_mfma_f32_16x16x32_bf16 a[88:91], v[216:219], a[224:227], a[88:91]
    buffer_load_dwordx4 v[48:51], v247, s[40:43], s74 offen offset:0
    v_mfma_f32_16x16x32_bf16 a[120:123], v[216:219], a[228:231], a[120:123]
    v_mfma_f32_16x16x32_bf16 a[152:155], v[216:219], a[232:235], a[152:155]
    buffer_load_dwordx4 v[52:55], v247, s[40:43], s74 offen offset:1024
    v_mfma_f32_16x16x32_bf16 a[184:187], v[216:219], a[236:239], a[184:187]
    v_mfma_f32_16x16x32_bf16 a[28:31], v[220:223], a[216:219], a[28:31]
    buffer_load_dwordx4 v[56:59], v247, s[40:43], s74 offen offset:2048
    v_mfma_f32_16x16x32_bf16 a[60:63], v[220:223], a[220:223], a[60:63]
    v_mfma_f32_16x16x32_bf16 a[92:95], v[220:223], a[224:227], a[92:95]
    v_mfma_f32_16x16x32_bf16 a[124:127], v[220:223], a[228:231], a[124:127]
    buffer_load_dwordx4 v[60:63], v247, s[40:43], s74 offen offset:3072
    v_mfma_f32_16x16x32_bf16 a[156:159], v[220:223], a[232:235], a[156:159]
    v_mfma_f32_16x16x32_bf16 a[188:191], v[220:223], a[236:239], a[188:191]
    s_waitcnt lgkmcnt(5)
    v_mfma_f32_16x16x32_bf16 a[0:3], v[96:99], a[192:195], a[0:3]
    ds_read_b128 a[216:219], v250 offset:55296
    s_waitcnt vmcnt(32)
    v_perm_b32 v192, v4, v0, s60
    v_perm_b32 v193, v12, v8, s60
    v_mfma_f32_16x16x32_bf16 a[4:7], v[100:103], a[192:195], a[4:7]
    v_perm_b32 v194, v20, v16, s60
    v_perm_b32 v195, v28, v24, s60
    v_mfma_f32_16x16x32_bf16 a[8:11], v[104:107], a[192:195], a[8:11]
    v_perm_b32 v196, v4, v0, s61
    v_perm_b32 v197, v12, v8, s61
    v_mfma_f32_16x16x32_bf16 a[12:15], v[108:111], a[192:195], a[12:15]
    v_perm_b32 v198, v20, v16, s61
    v_perm_b32 v199, v28, v24, s61
    v_mfma_f32_16x16x32_bf16 a[16:19], v[112:115], a[192:195], a[16:19]
    v_perm_b32 v200, v5, v1, s60
    v_perm_b32 v201, v13, v9, s60
    v_mfma_f32_16x16x32_bf16 a[20:23], v[116:119], a[192:195], a[20:23]
    v_perm_b32 v202, v21, v17, s60
    v_perm_b32 v203, v29, v25, s60
    v_perm_b32 v204, v5, v1, s61
    v_mfma_f32_16x16x32_bf16 a[24:27], v[120:123], a[192:195], a[24:27]
    v_perm_b32 v205, v13, v9, s61
    v_perm_b32 v206, v21, v17, s61
    v_mfma_f32_16x16x32_bf16 a[28:31], v[124:127], a[192:195], a[28:31]
    v_perm_b32 v207, v29, v25, s61
    v_perm_b32 v208, v6, v2, s60
    s_waitcnt lgkmcnt(5)
    v_mfma_f32_16x16x32_bf16 a[32:35], v[96:99], a[196:199], a[32:35]
    ds_read_b128 a[220:223], v250 offset:56320
    v_perm_b32 v209, v14, v10, s60
    v_perm_b32 v210, v22, v18, s60
    v_mfma_f32_16x16x32_bf16 a[36:39], v[100:103], a[196:199], a[36:39]
    v_perm_b32 v211, v30, v26, s60
    v_perm_b32 v212, v6, v2, s61
    v_mfma_f32_16x16x32_bf16 a[40:43], v[104:107], a[196:199], a[40:43]
    v_perm_b32 v213, v14, v10, s61
    v_perm_b32 v214, v22, v18, s61
    v_perm_b32 v215, v30, v26, s61
    v_mfma_f32_16x16x32_bf16 a[44:47], v[108:111], a[196:199], a[44:47]
    v_perm_b32 v216, v7, v3, s60
    v_perm_b32 v217, v15, v11, s60
    v_mfma_f32_16x16x32_bf16 a[48:51], v[112:115], a[196:199], a[48:51]
    v_perm_b32 v218, v23, v19, s60
    v_perm_b32 v219, v31, v27, s60
    v_mfma_f32_16x16x32_bf16 a[52:55], v[116:119], a[196:199], a[52:55]
    v_perm_b32 v220, v7, v3, s61
    v_perm_b32 v221, v15, v11, s61
    v_mfma_f32_16x16x32_bf16 a[56:59], v[120:123], a[196:199], a[56:59]
    v_perm_b32 v222, v23, v19, s61
    v_perm_b32 v223, v31, v27, s61
    v_mfma_f32_16x16x32_bf16 a[60:63], v[124:127], a[196:199], a[60:63]
    s_waitcnt lgkmcnt(5)
    v_mfma_f32_16x16x32_bf16 a[0:3], v[192:195], a[200:203], a[0:3]
    ds_read_b128 a[224:227], v250 offset:61440
    s_waitcnt vmcnt(24)
    v_perm_b32 v0, v68, v64, s60
    v_perm_b32 v1, v76, v72, s60
    v_mfma_f32_16x16x32_bf16 a[4:7], v[196:199], a[200:203], a[4:7]
    v_perm_b32 v2, v84, v80, s60
    v_perm_b32 v3, v92, v88, s60
    v_mfma_f32_16x16x32_bf16 a[8:11], v[200:203], a[200:203], a[8:11]
    v_perm_b32 v4, v68, v64, s61
    v_perm_b32 v5, v76, v72, s61
    v_mfma_f32_16x16x32_bf16 a[12:15], v[204:207], a[200:203], a[12:15]
    v_perm_b32 v6, v84, v80, s61
    v_perm_b32 v7, v92, v88, s61
    v_mfma_f32_16x16x32_bf16 a[16:19], v[208:211], a[200:203], a[16:19]
    v_perm_b32 v8, v69, v65, s60
    v_perm_b32 v9, v77, v73, s60
    v_mfma_f32_16x16x32_bf16 a[20:23], v[212:215], a[200:203], a[20:23]
    v_perm_b32 v10, v85, v81, s60
    v_perm_b32 v11, v93, v89, s60
    v_perm_b32 v12, v69, v65, s61
    v_mfma_f32_16x16x32_bf16 a[24:27], v[216:219], a[200:203], a[24:27]
    v_perm_b32 v13, v77, v73, s61
    v_perm_b32 v14, v85, v81, s61
    v_mfma_f32_16x16x32_bf16 a[28:31], v[220:223], a[200:203], a[28:31]
    v_perm_b32 v15, v93, v89, s61
    v_perm_b32 v16, v70, v66, s60
    s_waitcnt lgkmcnt(5)
    v_mfma_f32_16x16x32_bf16 a[32:35], v[192:195], a[204:207], a[32:35]
    ds_read_b128 a[228:231], v250 offset:62464
    v_perm_b32 v17, v78, v74, s60
    v_perm_b32 v18, v86, v82, s60
    v_mfma_f32_16x16x32_bf16 a[36:39], v[196:199], a[204:207], a[36:39]
    v_perm_b32 v19, v94, v90, s60
    v_perm_b32 v20, v70, v66, s61
    v_mfma_f32_16x16x32_bf16 a[40:43], v[200:203], a[204:207], a[40:43]
    v_perm_b32 v21, v78, v74, s61
    v_perm_b32 v22, v86, v82, s61
    v_perm_b32 v23, v94, v90, s61
    v_mfma_f32_16x16x32_bf16 a[44:47], v[204:207], a[204:207], a[44:47]
    v_perm_b32 v24, v71, v67, s60
    v_perm_b32 v25, v79, v75, s60
    v_mfma_f32_16x16x32_bf16 a[48:51], v[208:211], a[204:207], a[48:51]
    v_perm_b32 v26, v87, v83, s60
    v_perm_b32 v27, v95, v91, s60
    v_mfma_f32_16x16x32_bf16 a[52:55], v[212:215], a[204:207], a[52:55]
    v_perm_b32 v28, v71, v67, s61
    v_perm_b32 v29, v79, v75, s61
    v_mfma_f32_16x16x32_bf16 a[56:59], v[216:219], a[204:207], a[56:59]
    v_perm_b32 v30, v87, v83, s61
    v_perm_b32 v31, v95, v91, s61
    v_mfma_f32_16x16x32_bf16 a[60:63], v[220:223], a[204:207], a[60:63]
    s_waitcnt lgkmcnt(5)
    v_mfma_f32_16x16x32_bf16 a[0:3], v[0:3], a[208:211], a[0:3]
    ds_read_b128 a[232:235], v248 offset:26624
    s_waitcnt vmcnt(16)
    v_perm_b32 v64, v164, v160, s60
    v_perm_b32 v65, v172, v168, s60
    v_mfma_f32_16x16x32_bf16 a[4:7], v[4:7], a[208:211], a[4:7]
    v_perm_b32 v66, v180, v176, s60
    v_perm_b32 v67, v188, v184, s60
    v_mfma_f32_16x16x32_bf16 a[8:11], v[8:11], a[208:211], a[8:11]
    v_perm_b32 v68, v164, v160, s61
    v_perm_b32 v69, v172, v168, s61
    v_mfma_f32_16x16x32_bf16 a[12:15], v[12:15], a[208:211], a[12:15]
    v_perm_b32 v70, v180, v176, s61
    v_perm_b32 v71, v188, v184, s61
    v_mfma_f32_16x16x32_bf16 a[16:19], v[16:19], a[208:211], a[16:19]
    v_perm_b32 v72, v165, v161, s60
    v_perm_b32 v73, v173, v169, s60
    v_mfma_f32_16x16x32_bf16 a[20:23], v[20:23], a[208:211], a[20:23]
    v_perm_b32 v74, v181, v177, s60
    v_perm_b32 v75, v189, v185, s60
    v_perm_b32 v76, v165, v161, s61
    v_mfma_f32_16x16x32_bf16 a[24:27], v[24:27], a[208:211], a[24:27]
    v_perm_b32 v77, v173, v169, s61
    v_perm_b32 v78, v181, v177, s61
    v_mfma_f32_16x16x32_bf16 a[28:31], v[28:31], a[208:211], a[28:31]
    v_perm_b32 v79, v189, v185, s61
    v_perm_b32 v80, v166, v162, s60
    s_waitcnt lgkmcnt(5)
    v_mfma_f32_16x16x32_bf16 a[32:35], v[0:3], a[212:215], a[32:35]
    ds_read_b128 a[236:239], v248 offset:27648
    v_perm_b32 v81, v174, v170, s60
    v_perm_b32 v82, v182, v178, s60
    v_mfma_f32_16x16x32_bf16 a[36:39], v[4:7], a[212:215], a[36:39]
    v_perm_b32 v83, v190, v186, s60
    v_perm_b32 v84, v166, v162, s61
    v_mfma_f32_16x16x32_bf16 a[40:43], v[8:11], a[212:215], a[40:43]
    v_perm_b32 v85, v174, v170, s61
    v_perm_b32 v86, v182, v178, s61
    v_perm_b32 v87, v190, v186, s61
    v_mfma_f32_16x16x32_bf16 a[44:47], v[12:15], a[212:215], a[44:47]
    v_perm_b32 v88, v167, v163, s60
    v_perm_b32 v89, v175, v171, s60
    v_mfma_f32_16x16x32_bf16 a[48:51], v[16:19], a[212:215], a[48:51]
    v_perm_b32 v90, v183, v179, s60
    v_perm_b32 v91, v191, v187, s60
    v_mfma_f32_16x16x32_bf16 a[52:55], v[20:23], a[212:215], a[52:55]
    v_perm_b32 v92, v167, v163, s61
    v_perm_b32 v93, v175, v171, s61
    v_mfma_f32_16x16x32_bf16 a[56:59], v[24:27], a[212:215], a[56:59]
    v_perm_b32 v94, v183, v179, s61
    v_perm_b32 v95, v191, v187, s61
    v_mfma_f32_16x16x32_bf16 a[60:63], v[28:31], a[212:215], a[60:63]
    s_waitcnt lgkmcnt(5)
    v_mfma_f32_16x16x32_bf16 a[0:3], v[64:67], a[216:219], a[0:3]
    ds_read_b128 a[192:195], v250 offset:47104
    s_waitcnt vmcnt(8)
    v_perm_b32 v160, v132, v128, s60
    v_perm_b32 v161, v140, v136, s60
    v_mfma_f32_16x16x32_bf16 a[4:7], v[68:71], a[216:219], a[4:7]
    v_perm_b32 v162, v148, v144, s60
    v_perm_b32 v163, v156, v152, s60
    v_mfma_f32_16x16x32_bf16 a[8:11], v[72:75], a[216:219], a[8:11]
    v_perm_b32 v164, v132, v128, s61
    v_perm_b32 v165, v140, v136, s61
    v_mfma_f32_16x16x32_bf16 a[12:15], v[76:79], a[216:219], a[12:15]
    v_perm_b32 v166, v148, v144, s61
    v_perm_b32 v167, v156, v152, s61
    v_mfma_f32_16x16x32_bf16 a[16:19], v[80:83], a[216:219], a[16:19]
    v_perm_b32 v168, v133, v129, s60
    v_perm_b32 v169, v141, v137, s60
    v_mfma_f32_16x16x32_bf16 a[20:23], v[84:87], a[216:219], a[20:23]
    v_perm_b32 v170, v149, v145, s60
    v_perm_b32 v171, v157, v153, s60
    v_perm_b32 v172, v133, v129, s61
    v_mfma_f32_16x16x32_bf16 a[24:27], v[88:91], a[216:219], a[24:27]
    v_perm_b32 v173, v141, v137, s61
    v_perm_b32 v174, v149, v145, s61
    v_mfma_f32_16x16x32_bf16 a[28:31], v[92:95], a[216:219], a[28:31]
    v_perm_b32 v175, v157, v153, s61
    v_perm_b32 v176, v134, v130, s60
    s_waitcnt lgkmcnt(5)
    v_mfma_f32_16x16x32_bf16 a[32:35], v[64:67], a[220:223], a[32:35]
    ds_read_b128 a[196:199], v248 offset:20480
    v_perm_b32 v177, v142, v138, s60
    v_perm_b32 v178, v150, v146, s60
    v_mfma_f32_16x16x32_bf16 a[36:39], v[68:71], a[220:223], a[36:39]
    v_perm_b32 v179, v158, v154, s60
    v_perm_b32 v180, v134, v130, s61
    v_mfma_f32_16x16x32_bf16 a[40:43], v[72:75], a[220:223], a[40:43]
    v_perm_b32 v181, v142, v138, s61
    v_perm_b32 v182, v150, v146, s61
    v_perm_b32 v183, v158, v154, s61
    v_mfma_f32_16x16x32_bf16 a[44:47], v[76:79], a[220:223], a[44:47]
    v_perm_b32 v184, v135, v131, s60
    v_perm_b32 v185, v143, v139, s60
    v_mfma_f32_16x16x32_bf16 a[48:51], v[80:83], a[220:223], a[48:51]
    v_perm_b32 v186, v151, v147, s60
    v_perm_b32 v187, v159, v155, s60
    v_mfma_f32_16x16x32_bf16 a[52:55], v[84:87], a[220:223], a[52:55]
    v_perm_b32 v188, v135, v131, s61
    v_perm_b32 v189, v143, v139, s61
    v_mfma_f32_16x16x32_bf16 a[56:59], v[88:91], a[220:223], a[56:59]
    v_perm_b32 v190, v151, v147, s61
    v_perm_b32 v191, v159, v155, s61
    v_mfma_f32_16x16x32_bf16 a[60:63], v[92:95], a[220:223], a[60:63]
    s_waitcnt lgkmcnt(5)
    v_mfma_f32_16x16x32_bf16 a[0:3], v[160:163], a[224:227], a[0:3]
    ds_read_b128 a[200:203], v250 offset:51200
    s_waitcnt vmcnt(0)
    v_perm_b32 v128, v36, v32, s60
    v_perm_b32 v129, v44, v40, s60
    v_mfma_f32_16x16x32_bf16 a[4:7], v[164:167], a[224:227], a[4:7]
    v_perm_b32 v130, v52, v48, s60
    v_perm_b32 v131, v60, v56, s60
    v_mfma_f32_16x16x32_bf16 a[8:11], v[168:171], a[224:227], a[8:11]
    v_perm_b32 v132, v36, v32, s61
    v_perm_b32 v133, v44, v40, s61
    v_mfma_f32_16x16x32_bf16 a[12:15], v[172:175], a[224:227], a[12:15]
    v_perm_b32 v134, v52, v48, s61
    v_perm_b32 v135, v60, v56, s61
    v_mfma_f32_16x16x32_bf16 a[16:19], v[176:179], a[224:227], a[16:19]
    v_perm_b32 v136, v37, v33, s60
    v_perm_b32 v137, v45, v41, s60
    v_mfma_f32_16x16x32_bf16 a[20:23], v[180:183], a[224:227], a[20:23]
    v_perm_b32 v138, v53, v49, s60
    v_perm_b32 v139, v61, v57, s60
    v_perm_b32 v140, v37, v33, s61
    v_mfma_f32_16x16x32_bf16 a[24:27], v[184:187], a[224:227], a[24:27]
    v_perm_b32 v141, v45, v41, s61
    v_perm_b32 v142, v53, v49, s61
    v_mfma_f32_16x16x32_bf16 a[28:31], v[188:191], a[224:227], a[28:31]
    v_perm_b32 v143, v61, v57, s61
    v_perm_b32 v144, v38, v34, s60
    s_waitcnt lgkmcnt(5)
    v_mfma_f32_16x16x32_bf16 a[32:35], v[160:163], a[228:231], a[32:35]
    ds_read_b128 a[204:207], v250 offset:57344
    v_perm_b32 v145, v46, v42, s60
    v_perm_b32 v146, v54, v50, s60
    v_mfma_f32_16x16x32_bf16 a[36:39], v[164:167], a[228:231], a[36:39]
    v_perm_b32 v147, v62, v58, s60
    v_perm_b32 v148, v38, v34, s61
    v_mfma_f32_16x16x32_bf16 a[40:43], v[168:171], a[228:231], a[40:43]
    v_perm_b32 v149, v46, v42, s61
    v_perm_b32 v150, v54, v50, s61
    v_perm_b32 v151, v62, v58, s61
    v_mfma_f32_16x16x32_bf16 a[44:47], v[172:175], a[228:231], a[44:47]
    v_perm_b32 v152, v39, v35, s60
    v_perm_b32 v153, v47, v43, s60
    v_mfma_f32_16x16x32_bf16 a[48:51], v[176:179], a[228:231], a[48:51]
    v_perm_b32 v154, v55, v51, s60
    v_perm_b32 v155, v63, v59, s60
    v_mfma_f32_16x16x32_bf16 a[52:55], v[180:183], a[228:231], a[52:55]
    v_perm_b32 v156, v39, v35, s61
    v_perm_b32 v157, v47, v43, s61
    v_mfma_f32_16x16x32_bf16 a[56:59], v[184:187], a[228:231], a[56:59]
    v_perm_b32 v158, v55, v51, s61
    v_perm_b32 v159, v63, v59, s61
    v_mfma_f32_16x16x32_bf16 a[60:63], v[188:191], a[228:231], a[60:63]
    s_waitcnt lgkmcnt(5)
    v_mfma_f32_16x16x32_bf16 a[0:3], v[128:131], a[232:235], a[0:3]
    ds_read_b128 a[208:211], v250 offset:63488
    v_mfma_f32_16x16x32_bf16 a[4:7], v[132:135], a[232:235], a[4:7]
    v_mfma_f32_16x16x32_bf16 a[8:11], v[136:139], a[232:235], a[8:11]
    v_mfma_f32_16x16x32_bf16 a[12:15], v[140:143], a[232:235], a[12:15]
    v_mfma_f32_16x16x32_bf16 a[16:19], v[144:147], a[232:235], a[16:19]
    v_mfma_f32_16x16x32_bf16 a[20:23], v[148:151], a[232:235], a[20:23]
    v_mfma_f32_16x16x32_bf16 a[24:27], v[152:155], a[232:235], a[24:27]
    v_mfma_f32_16x16x32_bf16 a[28:31], v[156:159], a[232:235], a[28:31]
    s_waitcnt lgkmcnt(5)
    v_mfma_f32_16x16x32_bf16 a[32:35], v[128:131], a[236:239], a[32:35]
    ds_read_b128 a[212:215], v248 offset:28672
    v_accvgpr_read_b32 v251, a0
    v_accvgpr_read_b32 v252, a4
    v_cvt_pk_bf16_f32 v32, v251, v252
    v_mfma_f32_16x16x32_bf16 a[36:39], v[132:135], a[236:239], a[36:39]
    v_accvgpr_read_b32 v253, a8
    v_accvgpr_read_b32 v254, a12
    v_mfma_f32_16x16x32_bf16 a[40:43], v[136:139], a[236:239], a[40:43]
    v_cvt_pk_bf16_f32 v33, v253, v254
    v_accvgpr_read_b32 v251, a16
    v_accvgpr_read_b32 v252, a20
    v_mfma_f32_16x16x32_bf16 a[44:47], v[140:143], a[236:239], a[44:47]
    v_cvt_pk_bf16_f32 v34, v251, v252
    v_accvgpr_read_b32 v253, a24
    v_mfma_f32_16x16x32_bf16 a[48:51], v[144:147], a[236:239], a[48:51]
    v_accvgpr_read_b32 v254, a28
    v_cvt_pk_bf16_f32 v35, v253, v254
    s_add_u32 s78, s89, 0
    v_mfma_f32_16x16x32_bf16 a[52:55], v[148:151], a[236:239], a[52:55]
    buffer_store_dwordx4 v[32:35], v240, s[20:23], s78 offen sc1
    v_accvgpr_read_b32 v251, a1
    v_mfma_f32_16x16x32_bf16 a[56:59], v[152:155], a[236:239], a[56:59]
    v_accvgpr_read_b32 v252, a5
    v_cvt_pk_bf16_f32 v36, v251, v252
    v_accvgpr_read_b32 v253, a9
    v_mfma_f32_16x16x32_bf16 a[60:63], v[156:159], a[236:239], a[60:63]
    v_accvgpr_read_b32 v254, a13
    v_cvt_pk_bf16_f32 v37, v253, v254
    s_waitcnt lgkmcnt(5)
    v_mfma_f32_16x16x32_bf16 a[64:67], v[96:99], a[192:195], a[64:67]
    ds_read_b128 a[216:219], v250 offset:48128
    v_accvgpr_read_b32 v251, a17
    v_accvgpr_read_b32 v252, a21
    v_mfma_f32_16x16x32_bf16 a[68:71], v[100:103], a[192:195], a[68:71]
    v_cvt_pk_bf16_f32 v38, v251, v252
    v_accvgpr_read_b32 v253, a25
    v_mfma_f32_16x16x32_bf16 a[72:75], v[104:107], a[192:195], a[72:75]
    v_accvgpr_read_b32 v254, a29
    v_cvt_pk_bf16_f32 v39, v253, v254
    v_mfma_f32_16x16x32_bf16 a[76:79], v[108:111], a[192:195], a[76:79]
    s_add_u32 s78, s89, 256
    buffer_store_dwordx4 v[36:39], v240, s[20:23], s78 offen sc1
    v_mfma_f32_16x16x32_bf16 a[80:83], v[112:115], a[192:195], a[80:83]
    v_accvgpr_read_b32 v251, a2
    v_accvgpr_read_b32 v252, a6
    v_mfma_f32_16x16x32_bf16 a[84:87], v[116:119], a[192:195], a[84:87]
    v_cvt_pk_bf16_f32 v40, v251, v252
    v_accvgpr_read_b32 v253, a10
    v_mfma_f32_16x16x32_bf16 a[88:91], v[120:123], a[192:195], a[88:91]
    v_accvgpr_read_b32 v254, a14
    v_cvt_pk_bf16_f32 v41, v253, v254
    v_mfma_f32_16x16x32_bf16 a[92:95], v[124:127], a[192:195], a[92:95]
    v_accvgpr_read_b32 v251, a18
    v_accvgpr_read_b32 v252, a22
    s_waitcnt lgkmcnt(5)
    v_mfma_f32_16x16x32_bf16 a[64:67], v[192:195], a[196:199], a[64:67]
    ds_read_b128 a[220:223], v248 offset:21504
    v_cvt_pk_bf16_f32 v42, v251, v252
    v_accvgpr_read_b32 v253, a26
    v_mfma_f32_16x16x32_bf16 a[68:71], v[196:199], a[196:199], a[68:71]
    v_accvgpr_read_b32 v254, a30
    v_cvt_pk_bf16_f32 v43, v253, v254
    v_mfma_f32_16x16x32_bf16 a[72:75], v[200:203], a[196:199], a[72:75]
    s_add_u32 s78, s89, 512
    buffer_store_dwordx4 v[40:43], v240, s[20:23], s78 offen sc1
    v_mfma_f32_16x16x32_bf16 a[76:79], v[204:207], a[196:199], a[76:79]
    v_accvgpr_read_b32 v251, a3
    v_mfma_f32_16x16x32_bf16 a[80:83], v[208:211], a[196:199], a[80:83]
    v_accvgpr_read_b32 v252, a7
    v_cvt_pk_bf16_f32 v44, v251, v252
    v_mfma_f32_16x16x32_bf16 a[84:87], v[212:215], a[196:199], a[84:87]
    v_accvgpr_read_b32 v253, a11
    v_accvgpr_read_b32 v254, a15
    v_mfma_f32_16x16x32_bf16 a[88:91], v[216:219], a[196:199], a[88:91]
    v_cvt_pk_bf16_f32 v45, v253, v254
    v_accvgpr_read_b32 v251, a19
    v_mfma_f32_16x16x32_bf16 a[92:95], v[220:223], a[196:199], a[92:95]
    v_accvgpr_read_b32 v252, a23
    v_cvt_pk_bf16_f32 v46, v251, v252
    s_waitcnt lgkmcnt(5)
    v_mfma_f32_16x16x32_bf16 a[64:67], v[0:3], a[200:203], a[64:67]
    ds_read_b128 a[224:227], v250 offset:52224
    v_accvgpr_read_b32 v253, a27
    v_accvgpr_read_b32 v254, a31
    v_mfma_f32_16x16x32_bf16 a[68:71], v[4:7], a[200:203], a[68:71]
    v_cvt_pk_bf16_f32 v47, v253, v254
    s_add_u32 s78, s89, 768
    v_mfma_f32_16x16x32_bf16 a[72:75], v[8:11], a[200:203], a[72:75]
    buffer_store_dwordx4 v[44:47], v240, s[20:23], s78 offen sc1
    v_accvgpr_read_b32 v251, a32
    v_mfma_f32_16x16x32_bf16 a[76:79], v[12:15], a[200:203], a[76:79]
    v_accvgpr_read_b32 v252, a36
    v_cvt_pk_bf16_f32 v48, v251, v252
    v_mfma_f32_16x16x32_bf16 a[80:83], v[16:19], a[200:203], a[80:83]
    v_accvgpr_read_b32 v253, a40
    v_accvgpr_read_b32 v254, a44
    v_mfma_f32_16x16x32_bf16 a[84:87], v[20:23], a[200:203], a[84:87]
    v_cvt_pk_bf16_f32 v49, v253, v254
    v_accvgpr_read_b32 v251, a48
    v_mfma_f32_16x16x32_bf16 a[88:91], v[24:27], a[200:203], a[88:91]
    v_accvgpr_read_b32 v252, a52
    v_cvt_pk_bf16_f32 v50, v251, v252
    v_mfma_f32_16x16x32_bf16 a[92:95], v[28:31], a[200:203], a[92:95]
    v_accvgpr_read_b32 v253, a56
    s_waitcnt lgkmcnt(5)
    v_mfma_f32_16x16x32_bf16 a[64:67], v[64:67], a[204:207], a[64:67]
    ds_read_b128 a[228:231], v250 offset:58368
    v_accvgpr_read_b32 v254, a60
    v_cvt_pk_bf16_f32 v51, v253, v254
    v_mfma_f32_16x16x32_bf16 a[68:71], v[68:71], a[204:207], a[68:71]
    s_add_u32 s78, s90, 0
    buffer_store_dwordx4 v[48:51], v240, s[24:27], s78 offen sc1
    v_mfma_f32_16x16x32_bf16 a[72:75], v[72:75], a[204:207], a[72:75]
    v_accvgpr_read_b32 v251, a33
    v_accvgpr_read_b32 v252, a37
    v_mfma_f32_16x16x32_bf16 a[76:79], v[76:79], a[204:207], a[76:79]
    v_cvt_pk_bf16_f32 v52, v251, v252
    v_accvgpr_read_b32 v253, a41
    v_mfma_f32_16x16x32_bf16 a[80:83], v[80:83], a[204:207], a[80:83]
    v_accvgpr_read_b32 v254, a45
    v_cvt_pk_bf16_f32 v53, v253, v254
    v_mfma_f32_16x16x32_bf16 a[84:87], v[84:87], a[204:207], a[84:87]
    v_accvgpr_read_b32 v251, a49
    v_accvgpr_read_b32 v252, a53
    v_mfma_f32_16x16x32_bf16 a[88:91], v[88:91], a[204:207], a[88:91]
    v_cvt_pk_bf16_f32 v54, v251, v252
    v_accvgpr_read_b32 v253, a57
    v_mfma_f32_16x16x32_bf16 a[92:95], v[92:95], a[204:207], a[92:95]
    v_accvgpr_read_b32 v254, a61
    v_cvt_pk_bf16_f32 v55, v253, v254
    s_waitcnt lgkmcnt(5)
    v_mfma_f32_16x16x32_bf16 a[64:67], v[160:163], a[208:211], a[64:67]
    ds_read_b128 a[232:235], v250 offset:64512
    s_add_u32 s78, s90, 256
    buffer_store_dwordx4 v[52:55], v240, s[24:27], s78 offen sc1
    v_mfma_f32_16x16x32_bf16 a[68:71], v[164:167], a[208:211], a[68:71]
    v_accvgpr_read_b32 v251, a34
    v_accvgpr_read_b32 v252, a38
    v_mfma_f32_16x16x32_bf16 a[72:75], v[168:171], a[208:211], a[72:75]
    v_cvt_pk_bf16_f32 v56, v251, v252
    v_accvgpr_read_b32 v253, a42
    v_mfma_f32_16x16x32_bf16 a[76:79], v[172:175], a[208:211], a[76:79]
    v_accvgpr_read_b32 v254, a46
    v_mfma_f32_16x16x32_bf16 a[80:83], v[176:179], a[208:211], a[80:83]
    v_cvt_pk_bf16_f32 v57, v253, v254
    v_accvgpr_read_b32 v251, a50
    v_mfma_f32_16x16x32_bf16 a[84:87], v[180:183], a[208:211], a[84:87]
    v_accvgpr_read_b32 v252, a54
    v_cvt_pk_bf16_f32 v58, v251, v252
    v_mfma_f32_16x16x32_bf16 a[88:91], v[184:187], a[208:211], a[88:91]
    v_accvgpr_read_b32 v253, a58
    v_accvgpr_read_b32 v254, a62
    v_mfma_f32_16x16x32_bf16 a[92:95], v[188:191], a[208:211], a[92:95]
    v_cvt_pk_bf16_f32 v59, v253, v254
    s_add_u32 s78, s90, 512
    s_waitcnt lgkmcnt(5)
    v_mfma_f32_16x16x32_bf16 a[64:67], v[128:131], a[212:215], a[64:67]
    ds_read_b128 a[236:239], v248 offset:29696
    buffer_store_dwordx4 v[56:59], v240, s[24:27], s78 offen sc1
    v_accvgpr_read_b32 v251, a35
    v_mfma_f32_16x16x32_bf16 a[68:71], v[132:135], a[212:215], a[68:71]
    v_accvgpr_read_b32 v252, a39
    v_cvt_pk_bf16_f32 v60, v251, v252
    v_mfma_f32_16x16x32_bf16 a[72:75], v[136:139], a[212:215], a[72:75]
    v_accvgpr_read_b32 v253, a43
    v_accvgpr_read_b32 v254, a47
    v_mfma_f32_16x16x32_bf16 a[76:79], v[140:143], a[212:215], a[76:79]
    v_cvt_pk_bf16_f32 v61, v253, v254
    v_accvgpr_read_b32 v251, a51
    v_mfma_f32_16x16x32_bf16 a[80:83], v[144:147], a[212:215], a[80:83]
    v_accvgpr_read_b32 v252, a55
    v_cvt_pk_bf16_f32 v62, v251, v252
    v_mfma_f32_16x16x32_bf16 a[84:87], v[148:151], a[212:215], a[84:87]
    v_accvgpr_read_b32 v253, a59
    v_accvgpr_read_b32 v254, a63
    v_mfma_f32_16x16x32_bf16 a[88:91], v[152:155], a[212:215], a[88:91]
    v_cvt_pk_bf16_f32 v63, v253, v254
    s_add_u32 s78, s90, 768
    v_mfma_f32_16x16x32_bf16 a[92:95], v[156:159], a[212:215], a[92:95]
    buffer_store_dwordx4 v[60:63], v240, s[24:27], s78 offen sc1
    s_waitcnt lgkmcnt(5)
    v_mfma_f32_16x16x32_bf16 a[96:99], v[96:99], a[216:219], a[96:99]
    ds_read_b128 a[192:195], v248 offset:16384
    v_accvgpr_read_b32 v251, a64
    v_accvgpr_read_b32 v252, a68
    v_mfma_f32_16x16x32_bf16 a[100:103], v[100:103], a[216:219], a[100:103]
    v_cvt_pk_bf16_f32 v32, v251, v252
    v_mfma_f32_16x16x32_bf16 a[104:107], v[104:107], a[216:219], a[104:107]
    v_accvgpr_read_b32 v253, a72
    v_mfma_f32_16x16x32_bf16 a[108:111], v[108:111], a[216:219], a[108:111]
    v_accvgpr_read_b32 v254, a76
    v_mfma_f32_16x16x32_bf16 a[112:115], v[112:115], a[216:219], a[112:115]
    v_cvt_pk_bf16_f32 v33, v253, v254
    v_mfma_f32_16x16x32_bf16 a[116:119], v[116:119], a[216:219], a[116:119]
    v_accvgpr_read_b32 v251, a80
    v_mfma_f32_16x16x32_bf16 a[120:123], v[120:123], a[216:219], a[120:123]
    v_accvgpr_read_b32 v252, a84
    v_cvt_pk_bf16_f32 v34, v251, v252
    v_mfma_f32_16x16x32_bf16 a[124:127], v[124:127], a[216:219], a[124:127]
    v_accvgpr_read_b32 v253, a88
    s_waitcnt lgkmcnt(5)
    v_mfma_f32_16x16x32_bf16 a[96:99], v[192:195], a[220:223], a[96:99]
    ds_read_b128 a[196:199], v248 offset:22528
    v_accvgpr_read_b32 v254, a92
    v_mfma_f32_16x16x32_bf16 a[100:103], v[196:199], a[220:223], a[100:103]
    v_cvt_pk_bf16_f32 v35, v253, v254
    v_mfma_f32_16x16x32_bf16 a[104:107], v[200:203], a[220:223], a[104:107]
    s_add_u32 s78, s89, 1024
    v_mfma_f32_16x16x32_bf16 a[108:111], v[204:207], a[220:223], a[108:111]
    buffer_store_dwordx4 v[32:35], v240, s[20:23], s78 offen sc1
    v_mfma_f32_16x16x32_bf16 a[112:115], v[208:211], a[220:223], a[112:115]
    v_accvgpr_read_b32 v251, a65
    v_accvgpr_read_b32 v252, a69
    v_mfma_f32_16x16x32_bf16 a[116:119], v[212:215], a[220:223], a[116:119]
    v_cvt_pk_bf16_f32 v36, v251, v252
    v_mfma_f32_16x16x32_bf16 a[120:123], v[216:219], a[220:223], a[120:123]
    v_accvgpr_read_b32 v253, a73
    v_mfma_f32_16x16x32_bf16 a[124:127], v[220:223], a[220:223], a[124:127]
    v_accvgpr_read_b32 v254, a77
    s_waitcnt lgkmcnt(5)
    v_mfma_f32_16x16x32_bf16 a[96:99], v[0:3], a[224:227], a[96:99]
    ds_read_b128 a[200:203], v250 offset:53248
    v_cvt_pk_bf16_f32 v37, v253, v254
    v_mfma_f32_16x16x32_bf16 a[100:103], v[4:7], a[224:227], a[100:103]
    v_accvgpr_read_b32 v251, a81
    v_mfma_f32_16x16x32_bf16 a[104:107], v[8:11], a[224:227], a[104:107]
    v_accvgpr_read_b32 v252, a85
    v_cvt_pk_bf16_f32 v38, v251, v252
    v_mfma_f32_16x16x32_bf16 a[108:111], v[12:15], a[224:227], a[108:111]
    v_accvgpr_read_b32 v253, a89
    v_mfma_f32_16x16x32_bf16 a[112:115], v[16:19], a[224:227], a[112:115]
    v_accvgpr_read_b32 v254, a93
    v_mfma_f32_16x16x32_bf16 a[116:119], v[20:23], a[224:227], a[116:119]
    v_cvt_pk_bf16_f32 v39, v253, v254
    v_mfma_f32_16x16x32_bf16 a[120:123], v[24:27], a[224:227], a[120:123]
    s_add_u32 s78, s89, 1280
    v_mfma_f32_16x16x32_bf16 a[124:127], v[28:31], a[224:227], a[124:127]
    buffer_store_dwordx4 v[36:39], v240, s[20:23], s78 offen sc1
    s_waitcnt lgkmcnt(5)
    v_mfma_f32_16x16x32_bf16 a[96:99], v[64:67], a[228:231], a[96:99]
    ds_read_b128 a[204:207], v250 offset:59392
    v_accvgpr_read_b32 v251, a66
    v_accvgpr_read_b32 v252, a70
    v_mfma_f32_16x16x32_bf16 a[100:103], v[68:71], a[228:231], a[100:103]
    v_cvt_pk_bf16_f32 v40, v251, v252
    v_mfma_f32_16x16x32_bf16 a[104:107], v[72:75], a[228:231], a[104:107]
    v_accvgpr_read_b32 v253, a74
    v_mfma_f32_16x16x32_bf16 a[108:111], v[76:79], a[228:231], a[108:111]
    v_accvgpr_read_b32 v254, a78
    v_mfma_f32_16x16x32_bf16 a[112:115], v[80:83], a[228:231], a[112:115]
    v_cvt_pk_bf16_f32 v41, v253, v254
    v_mfma_f32_16x16x32_bf16 a[116:119], v[84:87], a[228:231], a[116:119]
    v_accvgpr_read_b32 v251, a82
    v_mfma_f32_16x16x32_bf16 a[120:123], v[88:91], a[228:231], a[120:123]
    v_accvgpr_read_b32 v252, a86
    v_cvt_pk_bf16_f32 v42, v251, v252
    v_mfma_f32_16x16x32_bf16 a[124:127], v[92:95], a[228:231], a[124:127]
    v_accvgpr_read_b32 v253, a90
    s_waitcnt lgkmcnt(5)
    v_mfma_f32_16x16x32_bf16 a[96:99], v[160:163], a[232:235], a[96:99]
    ds_read_b128 a[208:211], v248 offset:24576
    v_accvgpr_read_b32 v254, a94
    v_mfma_f32_16x16x32_bf16 a[100:103], v[164:167], a[232:235], a[100:103]
    v_cvt_pk_bf16_f32 v43, v253, v254
    v_mfma_f32_16x16x32_bf16 a[104:107], v[168:171], a[232:235], a[104:107]
    s_add_u32 s78, s89, 1536
    v_mfma_f32_16x16x32_bf16 a[108:111], v[172:175], a[232:235], a[108:111]
    buffer_store_dwordx4 v[40:43], v240, s[20:23], s78 offen sc1
    v_mfma_f32_16x16x32_bf16 a[112:115], v[176:179], a[232:235], a[112:115]
    v_accvgpr_read_b32 v251, a67
    v_accvgpr_read_b32 v252, a71
    v_mfma_f32_16x16x32_bf16 a[116:119], v[180:183], a[232:235], a[116:119]
    v_cvt_pk_bf16_f32 v44, v251, v252
    v_mfma_f32_16x16x32_bf16 a[120:123], v[184:187], a[232:235], a[120:123]
    v_accvgpr_read_b32 v253, a75
    v_mfma_f32_16x16x32_bf16 a[124:127], v[188:191], a[232:235], a[124:127]
    v_accvgpr_read_b32 v254, a79
    s_waitcnt lgkmcnt(5)
    v_mfma_f32_16x16x32_bf16 a[96:99], v[128:131], a[236:239], a[96:99]
    ds_read_b128 a[212:215], v248 offset:30720
    v_cvt_pk_bf16_f32 v45, v253, v254
    v_mfma_f32_16x16x32_bf16 a[100:103], v[132:135], a[236:239], a[100:103]
    v_accvgpr_read_b32 v251, a83
    v_mfma_f32_16x16x32_bf16 a[104:107], v[136:139], a[236:239], a[104:107]
    v_accvgpr_read_b32 v252, a87
    v_cvt_pk_bf16_f32 v46, v251, v252
    v_mfma_f32_16x16x32_bf16 a[108:111], v[140:143], a[236:239], a[108:111]
    v_accvgpr_read_b32 v253, a91
    v_mfma_f32_16x16x32_bf16 a[112:115], v[144:147], a[236:239], a[112:115]
    v_accvgpr_read_b32 v254, a95
    v_mfma_f32_16x16x32_bf16 a[116:119], v[148:151], a[236:239], a[116:119]
    v_cvt_pk_bf16_f32 v47, v253, v254
    v_mfma_f32_16x16x32_bf16 a[120:123], v[152:155], a[236:239], a[120:123]
    s_add_u32 s78, s89, 1792
    v_mfma_f32_16x16x32_bf16 a[124:127], v[156:159], a[236:239], a[124:127]
    buffer_store_dwordx4 v[44:47], v240, s[20:23], s78 offen sc1
    s_waitcnt lgkmcnt(5)
    v_mfma_f32_16x16x32_bf16 a[128:131], v[96:99], a[192:195], a[128:131]
    ds_read_b128 a[216:219], v248 offset:17408
    v_accvgpr_read_b32 v251, a96
    v_accvgpr_read_b32 v252, a100
    v_mfma_f32_16x16x32_bf16 a[132:135], v[100:103], a[192:195], a[132:135]
    v_cvt_pk_bf16_f32 v48, v251, v252
    v_mfma_f32_16x16x32_bf16 a[136:139], v[104:107], a[192:195], a[136:139]
    v_accvgpr_read_b32 v253, a104
    v_mfma_f32_16x16x32_bf16 a[140:143], v[108:111], a[192:195], a[140:143]
    v_accvgpr_read_b32 v254, a108
    v_mfma_f32_16x16x32_bf16 a[144:147], v[112:115], a[192:195], a[144:147]
    v_cvt_pk_bf16_f32 v49, v253, v254
    v_mfma_f32_16x16x32_bf16 a[148:151], v[116:119], a[192:195], a[148:151]
    v_accvgpr_read_b32 v251, a112
    v_mfma_f32_16x16x32_bf16 a[152:155], v[120:123], a[192:195], a[152:155]
    v_accvgpr_read_b32 v252, a116
    v_cvt_pk_bf16_f32 v50, v251, v252
    v_mfma_f32_16x16x32_bf16 a[156:159], v[124:127], a[192:195], a[156:159]
    v_accvgpr_read_b32 v253, a120
    s_waitcnt lgkmcnt(5)
    v_mfma_f32_16x16x32_bf16 a[128:131], v[192:195], a[196:199], a[128:131]
    ds_read_b128 a[220:223], v248 offset:23552
    v_accvgpr_read_b32 v254, a124
    v_mfma_f32_16x16x32_bf16 a[132:135], v[196:199], a[196:199], a[132:135]
    v_cvt_pk_bf16_f32 v51, v253, v254
    v_mfma_f32_16x16x32_bf16 a[136:139], v[200:203], a[196:199], a[136:139]
    s_add_u32 s78, s90, 1024
    v_mfma_f32_16x16x32_bf16 a[140:143], v[204:207], a[196:199], a[140:143]
    buffer_store_dwordx4 v[48:51], v240, s[24:27], s78 offen sc1
    v_mfma_f32_16x16x32_bf16 a[144:147], v[208:211], a[196:199], a[144:147]
    v_accvgpr_read_b32 v251, a97
    v_accvgpr_read_b32 v252, a101
    v_mfma_f32_16x16x32_bf16 a[148:151], v[212:215], a[196:199], a[148:151]
    v_cvt_pk_bf16_f32 v52, v251, v252
    v_mfma_f32_16x16x32_bf16 a[152:155], v[216:219], a[196:199], a[152:155]
    v_accvgpr_read_b32 v253, a105
    v_mfma_f32_16x16x32_bf16 a[156:159], v[220:223], a[196:199], a[156:159]
    v_accvgpr_read_b32 v254, a109
    s_waitcnt lgkmcnt(5)
    v_mfma_f32_16x16x32_bf16 a[128:131], v[0:3], a[200:203], a[128:131]
    ds_read_b128 a[224:227], v250 offset:54272
    v_cvt_pk_bf16_f32 v53, v253, v254
    v_mfma_f32_16x16x32_bf16 a[132:135], v[4:7], a[200:203], a[132:135]
    v_accvgpr_read_b32 v251, a113
    v_mfma_f32_16x16x32_bf16 a[136:139], v[8:11], a[200:203], a[136:139]
    v_accvgpr_read_b32 v252, a117
    v_cvt_pk_bf16_f32 v54, v251, v252
    v_mfma_f32_16x16x32_bf16 a[140:143], v[12:15], a[200:203], a[140:143]
    v_accvgpr_read_b32 v253, a121
    v_mfma_f32_16x16x32_bf16 a[144:147], v[16:19], a[200:203], a[144:147]
    v_accvgpr_read_b32 v254, a125
    v_mfma_f32_16x16x32_bf16 a[148:151], v[20:23], a[200:203], a[148:151]
    v_cvt_pk_bf16_f32 v55, v253, v254
    v_mfma_f32_16x16x32_bf16 a[152:155], v[24:27], a[200:203], a[152:155]
    s_add_u32 s78, s90, 1280
    v_mfma_f32_16x16x32_bf16 a[156:159], v[28:31], a[200:203], a[156:159]
    buffer_store_dwordx4 v[52:55], v240, s[24:27], s78 offen sc1
    s_waitcnt lgkmcnt(5)
    v_mfma_f32_16x16x32_bf16 a[128:131], v[64:67], a[204:207], a[128:131]
    ds_read_b128 a[228:231], v250 offset:60416
    v_accvgpr_read_b32 v251, a98
    v_accvgpr_read_b32 v252, a102
    v_mfma_f32_16x16x32_bf16 a[132:135], v[68:71], a[204:207], a[132:135]
    v_cvt_pk_bf16_f32 v56, v251, v252
    v_mfma_f32_16x16x32_bf16 a[136:139], v[72:75], a[204:207], a[136:139]
    v_accvgpr_read_b32 v253, a106
    v_mfma_f32_16x16x32_bf16 a[140:143], v[76:79], a[204:207], a[140:143]
    v_accvgpr_read_b32 v254, a110
    v_mfma_f32_16x16x32_bf16 a[144:147], v[80:83], a[204:207], a[144:147]
    v_cvt_pk_bf16_f32 v57, v253, v254
    v_mfma_f32_16x16x32_bf16 a[148:151], v[84:87], a[204:207], a[148:151]
    v_accvgpr_read_b32 v251, a114
    v_mfma_f32_16x16x32_bf16 a[152:155], v[88:91], a[204:207], a[152:155]
    v_accvgpr_read_b32 v252, a118
    v_cvt_pk_bf16_f32 v58, v251, v252
    v_mfma_f32_16x16x32_bf16 a[156:159], v[92:95], a[204:207], a[156:159]
    v_accvgpr_read_b32 v253, a122
    s_waitcnt lgkmcnt(5)
    v_mfma_f32_16x16x32_bf16 a[128:131], v[160:163], a[208:211], a[128:131]
    ds_read_b128 a[232:235], v248 offset:25600
    v_accvgpr_read_b32 v254, a126
    v_mfma_f32_16x16x32_bf16 a[132:135], v[164:167], a[208:211], a[132:135]
    v_cvt_pk_bf16_f32 v59, v253, v254
    v_mfma_f32_16x16x32_bf16 a[136:139], v[168:171], a[208:211], a[136:139]
    s_add_u32 s78, s90, 1536
    v_mfma_f32_16x16x32_bf16 a[140:143], v[172:175], a[208:211], a[140:143]
    buffer_store_dwordx4 v[56:59], v240, s[24:27], s78 offen sc1
    v_mfma_f32_16x16x32_bf16 a[144:147], v[176:179], a[208:211], a[144:147]
    v_accvgpr_read_b32 v251, a99
    v_accvgpr_read_b32 v252, a103
    v_mfma_f32_16x16x32_bf16 a[148:151], v[180:183], a[208:211], a[148:151]
    v_cvt_pk_bf16_f32 v60, v251, v252
    v_mfma_f32_16x16x32_bf16 a[152:155], v[184:187], a[208:211], a[152:155]
    v_accvgpr_read_b32 v253, a107
    v_mfma_f32_16x16x32_bf16 a[156:159], v[188:191], a[208:211], a[156:159]
    v_accvgpr_read_b32 v254, a111
    s_waitcnt lgkmcnt(5)
    v_mfma_f32_16x16x32_bf16 a[128:131], v[128:131], a[212:215], a[128:131]
    ds_read_b128 a[236:239], v248 offset:31744
    v_cvt_pk_bf16_f32 v61, v253, v254
    v_mfma_f32_16x16x32_bf16 a[132:135], v[132:135], a[212:215], a[132:135]
    v_accvgpr_read_b32 v251, a115
    v_mfma_f32_16x16x32_bf16 a[136:139], v[136:139], a[212:215], a[136:139]
    v_accvgpr_read_b32 v252, a119
    v_cvt_pk_bf16_f32 v62, v251, v252
    v_mfma_f32_16x16x32_bf16 a[140:143], v[140:143], a[212:215], a[140:143]
    v_accvgpr_read_b32 v253, a123
    v_mfma_f32_16x16x32_bf16 a[144:147], v[144:147], a[212:215], a[144:147]
    v_accvgpr_read_b32 v254, a127
    v_mfma_f32_16x16x32_bf16 a[148:151], v[148:151], a[212:215], a[148:151]
    v_cvt_pk_bf16_f32 v63, v253, v254
    v_mfma_f32_16x16x32_bf16 a[152:155], v[152:155], a[212:215], a[152:155]
    s_add_u32 s78, s90, 1792
    v_mfma_f32_16x16x32_bf16 a[156:159], v[156:159], a[212:215], a[156:159]
    buffer_store_dwordx4 v[60:63], v240, s[24:27], s78 offen sc1
    s_waitcnt lgkmcnt(5)
    v_mfma_f32_16x16x32_bf16 a[160:163], v[96:99], a[216:219], a[160:163]
    v_accvgpr_read_b32 v251, a128
    v_accvgpr_read_b32 v252, a132
    v_mfma_f32_16x16x32_bf16 a[164:167], v[100:103], a[216:219], a[164:167]
    v_cvt_pk_bf16_f32 v32, v251, v252
    v_mfma_f32_16x16x32_bf16 a[168:171], v[104:107], a[216:219], a[168:171]
    v_accvgpr_read_b32 v253, a136
    v_mfma_f32_16x16x32_bf16 a[172:175], v[108:111], a[216:219], a[172:175]
    v_accvgpr_read_b32 v254, a140
    v_mfma_f32_16x16x32_bf16 a[176:179], v[112:115], a[216:219], a[176:179]
    v_cvt_pk_bf16_f32 v33, v253, v254
    v_mfma_f32_16x16x32_bf16 a[180:183], v[116:119], a[216:219], a[180:183]
    v_accvgpr_read_b32 v251, a144
    v_mfma_f32_16x16x32_bf16 a[184:187], v[120:123], a[216:219], a[184:187]
    v_accvgpr_read_b32 v252, a148
    v_cvt_pk_bf16_f32 v34, v251, v252
    v_mfma_f32_16x16x32_bf16 a[188:191], v[124:127], a[216:219], a[188:191]
    v_accvgpr_read_b32 v253, a152
    s_waitcnt lgkmcnt(4)
    v_mfma_f32_16x16x32_bf16 a[160:163], v[192:195], a[220:223], a[160:163]
    v_accvgpr_read_b32 v254, a156
    v_mfma_f32_16x16x32_bf16 a[164:167], v[196:199], a[220:223], a[164:167]
    v_cvt_pk_bf16_f32 v35, v253, v254
    v_mfma_f32_16x16x32_bf16 a[168:171], v[200:203], a[220:223], a[168:171]
    s_add_u32 s78, s89, 2048
    v_mfma_f32_16x16x32_bf16 a[172:175], v[204:207], a[220:223], a[172:175]
    buffer_store_dwordx4 v[32:35], v240, s[20:23], s78 offen sc1
    v_mfma_f32_16x16x32_bf16 a[176:179], v[208:211], a[220:223], a[176:179]
    v_accvgpr_read_b32 v251, a129
    v_accvgpr_read_b32 v252, a133
    v_mfma_f32_16x16x32_bf16 a[180:183], v[212:215], a[220:223], a[180:183]
    v_cvt_pk_bf16_f32 v36, v251, v252
    v_mfma_f32_16x16x32_bf16 a[184:187], v[216:219], a[220:223], a[184:187]
    v_accvgpr_read_b32 v253, a137
    v_mfma_f32_16x16x32_bf16 a[188:191], v[220:223], a[220:223], a[188:191]
    v_accvgpr_read_b32 v254, a141
    s_waitcnt lgkmcnt(3)
    v_mfma_f32_16x16x32_bf16 a[160:163], v[0:3], a[224:227], a[160:163]
    v_cvt_pk_bf16_f32 v37, v253, v254
    v_mfma_f32_16x16x32_bf16 a[164:167], v[4:7], a[224:227], a[164:167]
    v_accvgpr_read_b32 v251, a145
    v_mfma_f32_16x16x32_bf16 a[168:171], v[8:11], a[224:227], a[168:171]
    v_accvgpr_read_b32 v252, a149
    v_cvt_pk_bf16_f32 v38, v251, v252
    v_mfma_f32_16x16x32_bf16 a[172:175], v[12:15], a[224:227], a[172:175]
    v_accvgpr_read_b32 v253, a153
    v_mfma_f32_16x16x32_bf16 a[176:179], v[16:19], a[224:227], a[176:179]
    v_accvgpr_read_b32 v254, a157
    v_mfma_f32_16x16x32_bf16 a[180:183], v[20:23], a[224:227], a[180:183]
    v_cvt_pk_bf16_f32 v39, v253, v254
    v_mfma_f32_16x16x32_bf16 a[184:187], v[24:27], a[224:227], a[184:187]
    s_add_u32 s78, s89, 2304
    v_mfma_f32_16x16x32_bf16 a[188:191], v[28:31], a[224:227], a[188:191]
    buffer_store_dwordx4 v[36:39], v240, s[20:23], s78 offen sc1
    s_waitcnt lgkmcnt(2)
    v_mfma_f32_16x16x32_bf16 a[160:163], v[64:67], a[228:231], a[160:163]
    v_accvgpr_read_b32 v251, a130
    v_accvgpr_read_b32 v252, a134
    v_mfma_f32_16x16x32_bf16 a[164:167], v[68:71], a[228:231], a[164:167]
    v_cvt_pk_bf16_f32 v40, v251, v252
    v_mfma_f32_16x16x32_bf16 a[168:171], v[72:75], a[228:231], a[168:171]
    v_accvgpr_read_b32 v253, a138
    v_mfma_f32_16x16x32_bf16 a[172:175], v[76:79], a[228:231], a[172:175]
    v_accvgpr_read_b32 v254, a142
    v_mfma_f32_16x16x32_bf16 a[176:179], v[80:83], a[228:231], a[176:179]
    v_cvt_pk_bf16_f32 v41, v253, v254
    v_mfma_f32_16x16x32_bf16 a[180:183], v[84:87], a[228:231], a[180:183]
    v_accvgpr_read_b32 v251, a146
    v_mfma_f32_16x16x32_bf16 a[184:187], v[88:91], a[228:231], a[184:187]
    v_accvgpr_read_b32 v252, a150
    v_cvt_pk_bf16_f32 v42, v251, v252
    v_mfma_f32_16x16x32_bf16 a[188:191], v[92:95], a[228:231], a[188:191]
    v_accvgpr_read_b32 v253, a154
    s_waitcnt lgkmcnt(1)
    v_mfma_f32_16x16x32_bf16 a[160:163], v[160:163], a[232:235], a[160:163]
    v_accvgpr_read_b32 v254, a158
    v_mfma_f32_16x16x32_bf16 a[164:167], v[164:167], a[232:235], a[164:167]
    v_cvt_pk_bf16_f32 v43, v253, v254
    v_mfma_f32_16x16x32_bf16 a[168:171], v[168:171], a[232:235], a[168:171]
    s_add_u32 s78, s89, 2560
    v_mfma_f32_16x16x32_bf16 a[172:175], v[172:175], a[232:235], a[172:175]
    buffer_store_dwordx4 v[40:43], v240, s[20:23], s78 offen sc1
    v_mfma_f32_16x16x32_bf16 a[176:179], v[176:179], a[232:235], a[176:179]
    v_accvgpr_read_b32 v251, a131
    v_accvgpr_read_b32 v252, a135
    v_mfma_f32_16x16x32_bf16 a[180:183], v[180:183], a[232:235], a[180:183]
    v_cvt_pk_bf16_f32 v44, v251, v252
    v_mfma_f32_16x16x32_bf16 a[184:187], v[184:187], a[232:235], a[184:187]
    v_accvgpr_read_b32 v253, a139
    v_mfma_f32_16x16x32_bf16 a[188:191], v[188:191], a[232:235], a[188:191]
    v_accvgpr_read_b32 v254, a143
    s_waitcnt lgkmcnt(0)
    v_mfma_f32_16x16x32_bf16 a[160:163], v[128:131], a[236:239], a[160:163]
    v_cvt_pk_bf16_f32 v45, v253, v254
    v_mfma_f32_16x16x32_bf16 a[164:167], v[132:135], a[236:239], a[164:167]
    v_accvgpr_read_b32 v251, a147
    v_mfma_f32_16x16x32_bf16 a[168:171], v[136:139], a[236:239], a[168:171]
    v_accvgpr_read_b32 v252, a151
    v_cvt_pk_bf16_f32 v46, v251, v252
    v_mfma_f32_16x16x32_bf16 a[172:175], v[140:143], a[236:239], a[172:175]
    v_accvgpr_read_b32 v253, a155
    v_mfma_f32_16x16x32_bf16 a[176:179], v[144:147], a[236:239], a[176:179]
    v_accvgpr_read_b32 v254, a159
    v_mfma_f32_16x16x32_bf16 a[180:183], v[148:151], a[236:239], a[180:183]
    v_cvt_pk_bf16_f32 v47, v253, v254
    v_mfma_f32_16x16x32_bf16 a[184:187], v[152:155], a[236:239], a[184:187]
    s_add_u32 s78, s89, 2816
    v_mfma_f32_16x16x32_bf16 a[188:191], v[156:159], a[236:239], a[188:191]
    buffer_store_dwordx4 v[44:47], v240, s[20:23], s78 offen sc1
    v_accvgpr_read_b32 v251, a160
    v_accvgpr_read_b32 v252, a164
    v_cvt_pk_bf16_f32 v48, v251, v252
    v_accvgpr_read_b32 v253, a168
    v_accvgpr_read_b32 v254, a172
    v_cvt_pk_bf16_f32 v49, v253, v254
    v_accvgpr_read_b32 v251, a176
    v_accvgpr_read_b32 v252, a180
    v_cvt_pk_bf16_f32 v50, v251, v252
    v_accvgpr_read_b32 v253, a184
    v_accvgpr_read_b32 v254, a188
    v_cvt_pk_bf16_f32 v51, v253, v254
    s_add_u32 s78, s90, 2048
    buffer_store_dwordx4 v[48:51], v240, s[24:27], s78 offen sc1
    v_accvgpr_read_b32 v251, a161
    v_accvgpr_read_b32 v252, a165
    v_cvt_pk_bf16_f32 v52, v251, v252
    v_accvgpr_read_b32 v253, a169
    v_accvgpr_read_b32 v254, a173
    v_cvt_pk_bf16_f32 v53, v253, v254
    v_accvgpr_read_b32 v251, a177
    v_accvgpr_read_b32 v252, a181
    v_cvt_pk_bf16_f32 v54, v251, v252
    v_accvgpr_read_b32 v253, a185
    v_accvgpr_read_b32 v254, a189
    v_cvt_pk_bf16_f32 v55, v253, v254
    s_add_u32 s78, s90, 2304
    buffer_store_dwordx4 v[52:55], v240, s[24:27], s78 offen sc1
    v_accvgpr_read_b32 v251, a162
    v_accvgpr_read_b32 v252, a166
    v_cvt_pk_bf16_f32 v56, v251, v252
    v_accvgpr_read_b32 v253, a170
    v_accvgpr_read_b32 v254, a174
    v_cvt_pk_bf16_f32 v57, v253, v254
    v_accvgpr_read_b32 v251, a178
    v_accvgpr_read_b32 v252, a182
    v_cvt_pk_bf16_f32 v58, v251, v252
    v_accvgpr_read_b32 v253, a186
    v_accvgpr_read_b32 v254, a190
    v_cvt_pk_bf16_f32 v59, v253, v254
    s_add_u32 s78, s90, 2560
    buffer_store_dwordx4 v[56:59], v240, s[24:27], s78 offen sc1
    v_accvgpr_read_b32 v251, a163
    v_accvgpr_read_b32 v252, a167
    v_cvt_pk_bf16_f32 v60, v251, v252
    v_accvgpr_read_b32 v253, a171
    v_accvgpr_read_b32 v254, a175
    v_cvt_pk_bf16_f32 v61, v253, v254
    v_accvgpr_read_b32 v251, a179
    v_accvgpr_read_b32 v252, a183
    v_cvt_pk_bf16_f32 v62, v251, v252
    v_accvgpr_read_b32 v253, a187
    v_accvgpr_read_b32 v254, a191
    v_cvt_pk_bf16_f32 v63, v253, v254
    s_add_u32 s78, s90, 2816
    buffer_store_dwordx4 v[60:63], v240, s[24:27], s78 offen sc1
slow:
    v_mov_b32 v32, 0
    v_mov_b32 v33, 0
    v_mov_b32 v34, 0
    v_mov_b32 v35, 0
    v_mov_b32 v36, 0
    v_mov_b32 v37, 0
    v_mov_b32 v38, 0
    v_mov_b32 v39, 0
    v_mov_b32 v40, 0
    v_mov_b32 v41, 0
    v_mov_b32 v42, 0
    v_mov_b32 v43, 0
    v_mov_b32 v44, 0
    v_mov_b32 v45, 0
    v_mov_b32 v46, 0
    v_mov_b32 v47, 0
    v_mov_b32 v48, 0
    v_mov_b32 v49, 0
    v_mov_b32 v50, 0
    v_mov_b32 v51, 0
    v_mov_b32 v52, 0
    v_mov_b32 v53, 0
    v_mov_b32 v54, 0
    v_mov_b32 v55, 0
    s_mov_b32 s85, 0
    s_mov_b32 s78, 0
    s_lshl_b32 s85, 1, s63
    s_mov_b32 s8, 1
    s_cmp_eq_u32 s26, 0
    s_cbranch_scc1 self1
    s_cmp_eq_u32 s22, 0
    s_cbranch_scc1 self0
pub:
    s_waitcnt vmcnt(0)
    s_mov_b64 exec, 1
    buffer_store_dwordx2 v[232:233], off, s[36:39], s69 sc1
    s_mov_b64 exec, -1
pub2:
    s_branch poll
self0:
    v_accvgpr_read_b32 v251, a0
    v_accvgpr_read_b32 v252, a4
    v_cvt_pk_bf16_f32 v96, v251, v252
    v_accvgpr_read_b32 v253, a8
    v_accvgpr_read_b32 v254, a12
    v_cvt_pk_bf16_f32 v97, v253, v254
    v_accvgpr_read_b32 v251, a16
    v_accvgpr_read_b32 v252, a20
    v_cvt_pk_bf16_f32 v98, v251, v252
    v_accvgpr_read_b32 v253, a24
    v_accvgpr_read_b32 v254, a28
    v_cvt_pk_bf16_f32 v99, v253, v254
    ds_write_b128 v240, v[96:99] offset:49152
    v_accvgpr_read_b32 v251, a1
    v_accvgpr_read_b32 v252, a5
    v_cvt_pk_bf16_f32 v100, v251, v252
    v_accvgpr_read_b32 v253, a9
    v_accvgpr_read_b32 v254, a13
    v_cvt_pk_bf16_f32 v101, v253, v254
    v_accvgpr_read_b32 v251, a17
    v_accvgpr_read_b32 v252, a21
    v_cvt_pk_bf16_f32 v102, v251, v252
    v_accvgpr_read_b32 v253, a25
    v_accvgpr_read_b32 v254, a29
    v_cvt_pk_bf16_f32 v103, v253, v254
    ds_write_b128 v240, v[100:103] offset:49408
    v_accvgpr_read_b32 v251, a2
    v_accvgpr_read_b32 v252, a6
    v_cvt_pk_bf16_f32 v104, v251, v252
    v_accvgpr_read_b32 v253, a10
    v_accvgpr_read_b32 v254, a14
    v_cvt_pk_bf16_f32 v105, v253, v254
    v_accvgpr_read_b32 v251, a18
    v_accvgpr_read_b32 v252, a22
    v_cvt_pk_bf16_f32 v106, v251, v252
    v_accvgpr_read_b32 v253, a26
    v_accvgpr_read_b32 v254, a30
    v_cvt_pk_bf16_f32 v107, v253, v254
    ds_write_b128 v240, v[104:107] offset:49664
    v_accvgpr_read_b32 v251, a3
    v_accvgpr_read_b32 v252, a7
    v_cvt_pk_bf16_f32 v108, v251, v252
    v_accvgpr_read_b32 v253, a11
    v_accvgpr_read_b32 v254, a15
    v_cvt_pk_bf16_f32 v109, v253, v254
    v_accvgpr_read_b32 v251, a19
    v_accvgpr_read_b32 v252, a23
    v_cvt_pk_bf16_f32 v110, v251, v252
    v_accvgpr_read_b32 v253, a27
    v_accvgpr_read_b32 v254, a31
    v_cvt_pk_bf16_f32 v111, v253, v254
    ds_write_b128 v240, v[108:111] offset:49920
    v_accvgpr_read_b32 v251, a64
    v_accvgpr_read_b32 v252, a68
    v_cvt_pk_bf16_f32 v112, v251, v252
    v_accvgpr_read_b32 v253, a72
    v_accvgpr_read_b32 v254, a76
    v_cvt_pk_bf16_f32 v113, v253, v254
    v_accvgpr_read_b32 v251, a80
    v_accvgpr_read_b32 v252, a84
    v_cvt_pk_bf16_f32 v114, v251, v252
    v_accvgpr_read_b32 v253, a88
    v_accvgpr_read_b32 v254, a92
    v_cvt_pk_bf16_f32 v115, v253, v254
    ds_write_b128 v240, v[112:115] offset:50176
    v_accvgpr_read_b32 v251, a65
    v_accvgpr_read_b32 v252, a69
    v_cvt_pk_bf16_f32 v116, v251, v252
    v_accvgpr_read_b32 v253, a73
    v_accvgpr_read_b32 v254, a77
    v_cvt_pk_bf16_f32 v117, v253, v254
    v_accvgpr_read_b32 v251, a81
    v_accvgpr_read_b32 v252, a85
    v_cvt_pk_bf16_f32 v118, v251, v252
    v_accvgpr_read_b32 v253, a89
    v_accvgpr_read_b32 v254, a93
    v_cvt_pk_bf16_f32 v119, v253, v254
    ds_write_b128 v240, v[116:119] offset:50432
    v_accvgpr_read_b32 v251, a66
    v_accvgpr_read_b32 v252, a70
    v_cvt_pk_bf16_f32 v120, v251, v252
    v_accvgpr_read_b32 v253, a74
    v_accvgpr_read_b32 v254, a78
    v_cvt_pk_bf16_f32 v121, v253, v254
    v_accvgpr_read_b32 v251, a82
    v_accvgpr_read_b32 v252, a86
    v_cvt_pk_bf16_f32 v122, v251, v252
    v_accvgpr_read_b32 v253, a90
    v_accvgpr_read_b32 v254, a94
    v_cvt_pk_bf16_f32 v123, v253, v254
    ds_write_b128 v240, v[120:123] offset:50688
    v_accvgpr_read_b32 v251, a67
    v_accvgpr_read_b32 v252, a71
    v_cvt_pk_bf16_f32 v124, v251, v252
    v_accvgpr_read_b32 v253, a75
    v_accvgpr_read_b32 v254, a79
    v_cvt_pk_bf16_f32 v125, v253, v254
    v_accvgpr_read_b32 v251, a83
    v_accvgpr_read_b32 v252, a87
    v_cvt_pk_bf16_f32 v126, v251, v252
    v_accvgpr_read_b32 v253, a91
    v_accvgpr_read_b32 v254, a95
    v_cvt_pk_bf16_f32 v127, v253, v254
    ds_write_b128 v240, v[124:127] offset:50944
    v_accvgpr_read_b32 v251, a128
    v_accvgpr_read_b32 v252, a132
    v_cvt_pk_bf16_f32 v96, v251, v252
    v_accvgpr_read_b32 v253, a136
    v_accvgpr_read_b32 v254, a140
    v_cvt_pk_bf16_f32 v97, v253, v254
    v_accvgpr_read_b32 v251, a144
    v_accvgpr_read_b32 v252, a148
    v_cvt_pk_bf16_f32 v98, v251, v252
    v_accvgpr_read_b32 v253, a152
    v_accvgpr_read_b32 v254, a156
    v_cvt_pk_bf16_f32 v99, v253, v254
    ds_write_b128 v240, v[96:99] offset:51200
    v_accvgpr_read_b32 v251, a129
    v_accvgpr_read_b32 v252, a133
    v_cvt_pk_bf16_f32 v100, v251, v252
    v_accvgpr_read_b32 v253, a137
    v_accvgpr_read_b32 v254, a141
    v_cvt_pk_bf16_f32 v101, v253, v254
    v_accvgpr_read_b32 v251, a145
    v_accvgpr_read_b32 v252, a149
    v_cvt_pk_bf16_f32 v102, v251, v252
    v_accvgpr_read_b32 v253, a153
    v_accvgpr_read_b32 v254, a157
    v_cvt_pk_bf16_f32 v103, v253, v254
    ds_write_b128 v240, v[100:103] offset:51456
    v_accvgpr_read_b32 v251, a130
    v_accvgpr_read_b32 v252, a134
    v_cvt_pk_bf16_f32 v104, v251, v252
    v_accvgpr_read_b32 v253, a138
    v_accvgpr_read_b32 v254, a142
    v_cvt_pk_bf16_f32 v105, v253, v254
    v_accvgpr_read_b32 v251, a146
    v_accvgpr_read_b32 v252, a150
    v_cvt_pk_bf16_f32 v106, v251, v252
    v_accvgpr_read_b32 v253, a154
    v_accvgpr_read_b32 v254, a158
    v_cvt_pk_bf16_f32 v107, v253, v254
    ds_write_b128 v240, v[104:107] offset:51712
    v_accvgpr_read_b32 v251, a131
    v_accvgpr_read_b32 v252, a135
    v_cvt_pk_bf16_f32 v108, v251, v252
    v_accvgpr_read_b32 v253, a139
    v_accvgpr_read_b32 v254, a143
    v_cvt_pk_bf16_f32 v109, v253, v254
    v_accvgpr_read_b32 v251, a147
    v_accvgpr_read_b32 v252, a151
    v_cvt_pk_bf16_f32 v110, v251, v252
    v_accvgpr_read_b32 v253, a155
    v_accvgpr_read_b32 v254, a159
    v_cvt_pk_bf16_f32 v111, v253, v254
    ds_write_b128 v240, v[108:111] offset:51968
    ds_write_b32 v243, v232 offset:8
    s_branch pub
self1:
    s_waitcnt vmcnt(0)
    s_mov_b64 exec, 1
    buffer_store_dwordx2 v[232:233], off, s[36:39], s69 sc1
    s_mov_b64 exec, -1
    v_accvgpr_read_b32 v251, a32
    v_accvgpr_read_b32 v252, a36
    v_cvt_pk_bf16_f32 v112, v251, v252
    v_accvgpr_read_b32 v253, a40
    v_accvgpr_read_b32 v254, a44
    v_cvt_pk_bf16_f32 v113, v253, v254
    v_accvgpr_read_b32 v251, a48
    v_accvgpr_read_b32 v252, a52
    v_cvt_pk_bf16_f32 v114, v251, v252
    v_accvgpr_read_b32 v253, a56
    v_accvgpr_read_b32 v254, a60
    v_cvt_pk_bf16_f32 v115, v253, v254
    ds_write_b128 v240, v[112:115] offset:49152
    v_accvgpr_read_b32 v251, a33
    v_accvgpr_read_b32 v252, a37
    v_cvt_pk_bf16_f32 v116, v251, v252
    v_accvgpr_read_b32 v253, a41
    v_accvgpr_read_b32 v254, a45
    v_cvt_pk_bf16_f32 v117, v253, v254
    v_accvgpr_read_b32 v251, a49
    v_accvgpr_read_b32 v252, a53
    v_cvt_pk_bf16_f32 v118, v251, v252
    v_accvgpr_read_b32 v253, a57
    v_accvgpr_read_b32 v254, a61
    v_cvt_pk_bf16_f32 v119, v253, v254
    ds_write_b128 v240, v[116:119] offset:49408
    v_accvgpr_read_b32 v251, a34
    v_accvgpr_read_b32 v252, a38
    v_cvt_pk_bf16_f32 v120, v251, v252
    v_accvgpr_read_b32 v253, a42
    v_accvgpr_read_b32 v254, a46
    v_cvt_pk_bf16_f32 v121, v253, v254
    v_accvgpr_read_b32 v251, a50
    v_accvgpr_read_b32 v252, a54
    v_cvt_pk_bf16_f32 v122, v251, v252
    v_accvgpr_read_b32 v253, a58
    v_accvgpr_read_b32 v254, a62
    v_cvt_pk_bf16_f32 v123, v253, v254
    ds_write_b128 v240, v[120:123] offset:49664
    v_accvgpr_read_b32 v251, a35
    v_accvgpr_read_b32 v252, a39
    v_cvt_pk_bf16_f32 v124, v251, v252
    v_accvgpr_read_b32 v253, a43
    v_accvgpr_read_b32 v254, a47
    v_cvt_pk_bf16_f32 v125, v253, v254
    v_accvgpr_read_b32 v251, a51
    v_accvgpr_read_b32 v252, a55
    v_cvt_pk_bf16_f32 v126, v251, v252
    v_accvgpr_read_b32 v253, a59
    v_accvgpr_read_b32 v254, a63
    v_cvt_pk_bf16_f32 v127, v253, v254
    ds_write_b128 v240, v[124:127] offset:49920
    v_accvgpr_read_b32 v251, a96
    v_accvgpr_read_b32 v252, a100
    v_cvt_pk_bf16_f32 v96, v251, v252
    v_accvgpr_read_b32 v253, a104
    v_accvgpr_read_b32 v254, a108
    v_cvt_pk_bf16_f32 v97, v253, v254
    v_accvgpr_read_b32 v251, a112
    v_accvgpr_read_b32 v252, a116
    v_cvt_pk_bf16_f32 v98, v251, v252
    v_accvgpr_read_b32 v253, a120
    v_accvgpr_read_b32 v254, a124
    v_cvt_pk_bf16_f32 v99, v253, v254
    ds_write_b128 v240, v[96:99] offset:50176
    v_accvgpr_read_b32 v251, a97
    v_accvgpr_read_b32 v252, a101
    v_cvt_pk_bf16_f32 v100, v251, v252
    v_accvgpr_read_b32 v253, a105
    v_accvgpr_read_b32 v254, a109
    v_cvt_pk_bf16_f32 v101, v253, v254
    v_accvgpr_read_b32 v251, a113
    v_accvgpr_read_b32 v252, a117
    v_cvt_pk_bf16_f32 v102, v251, v252
    v_accvgpr_read_b32 v253, a121
    v_accvgpr_read_b32 v254, a125
    v_cvt_pk_bf16_f32 v103, v253, v254
    ds_write_b128 v240, v[100:103] offset:50432
    v_accvgpr_read_b32 v251, a98
    v_accvgpr_read_b32 v252, a102
    v_cvt_pk_bf16_f32 v104, v251, v252
    v_accvgpr_read_b32 v253, a106
    v_accvgpr_read_b32 v254, a110
    v_cvt_pk_bf16_f32 v105, v253, v254
    v_accvgpr_read_b32 v251, a114
    v_accvgpr_read_b32 v252, a118
    v_cvt_pk_bf16_f32 v106, v251, v252
    v_accvgpr_read_b32 v253, a122
    v_accvgpr_read_b32 v254, a126
    v_cvt_pk_bf16_f32 v107, v253, v254
    ds_write_b128 v240, v[104:107] offset:50688
    v_accvgpr_read_b32 v251, a99
    v_accvgpr_read_b32 v252, a103
    v_cvt_pk_bf16_f32 v108, v251, v252
    v_accvgpr_read_b32 v253, a107
    v_accvgpr_read_b32 v254, a111
    v_cvt_pk_bf16_f32 v109, v253, v254
    v_accvgpr_read_b32 v251, a115
    v_accvgpr_read_b32 v252, a119
    v_cvt_pk_bf16_f32 v110, v251, v252
    v_accvgpr_read_b32 v253, a123
    v_accvgpr_read_b32 v254, a127
    v_cvt_pk_bf16_f32 v111, v253, v254
    ds_write_b128 v240, v[108:111] offset:50944
    v_accvgpr_read_b32 v251, a160
    v_accvgpr_read_b32 v252, a164
    v_cvt_pk_bf16_f32 v112, v251, v252
    v_accvgpr_read_b32 v253, a168
    v_accvgpr_read_b32 v254, a172
    v_cvt_pk_bf16_f32 v113, v253, v254
    v_accvgpr_read_b32 v251, a176
    v_accvgpr_read_b32 v252, a180
    v_cvt_pk_bf16_f32 v114, v251, v252
    v_accvgpr_read_b32 v253, a184
    v_accvgpr_read_b32 v254, a188
    v_cvt_pk_bf16_f32 v115, v253, v254
    ds_write_b128 v240, v[112:115] offset:51200
    v_accvgpr_read_b32 v251, a161
    v_accvgpr_read_b32 v252, a165
    v_cvt_pk_bf16_f32 v116, v251, v252
    v_accvgpr_read_b32 v253, a169
    v_accvgpr_read_b32 v254, a173
    v_cvt_pk_bf16_f32 v117, v253, v254
    v_accvgpr_read_b32 v251, a177
    v_accvgpr_read_b32 v252, a181
    v_cvt_pk_bf16_f32 v118, v251, v252
    v_accvgpr_read_b32 v253, a185
    v_accvgpr_read_b32 v254, a189
    v_cvt_pk_bf16_f32 v119, v253, v254
    ds_write_b128 v240, v[116:119] offset:51456
    v_accvgpr_read_b32 v251, a162
    v_accvgpr_read_b32 v252, a166
    v_cvt_pk_bf16_f32 v120, v251, v252
    v_accvgpr_read_b32 v253, a170
    v_accvgpr_read_b32 v254, a174
    v_cvt_pk_bf16_f32 v121, v253, v254
    v_accvgpr_read_b32 v251, a178
    v_accvgpr_read_b32 v252, a182
    v_cvt_pk_bf16_f32 v122, v251, v252
    v_accvgpr_read_b32 v253, a186
    v_accvgpr_read_b32 v254, a190
    v_cvt_pk_bf16_f32 v123, v253, v254
    ds_write_b128 v240, v[120:123] offset:51712
    v_accvgpr_read_b32 v251, a163
    v_accvgpr_read_b32 v252, a167
    v_cvt_pk_bf16_f32 v124, v251, v252
    v_accvgpr_read_b32 v253, a171
    v_accvgpr_read_b32 v254, a175
    v_cvt_pk_bf16_f32 v125, v253, v254
    v_accvgpr_read_b32 v251, a179
    v_accvgpr_read_b32 v252, a183
    v_cvt_pk_bf16_f32 v126, v251, v252
    v_accvgpr_read_b32 v253, a187
    v_accvgpr_read_b32 v254, a191
    v_cvt_pk_bf16_f32 v127, v253, v254
    ds_write_b128 v240, v[124:127] offset:51968
    ds_write_b32 v243, v232 offset:8
    s_branch pub2
job:
    s_lshl_b32 s72, s66, 2
    s_lshr_b32 s73, s81, 1
    s_add_u32 s73, s73, s72
    s_lshl_b32 s73, s73, 7
    s_add_u32 s87, s73, 67108864
    s_lshl_b32 s72, s66, 3
    s_add_u32 s72, s72, s81
    s_mul_i32 s72, s72, 96
    s_mul_i32 s73, s82, 3
    s_add_u32 s72, s72, s73
    s_lshl_b32 s88, s72, 10
    s_mul_i32 s93, s64, 196608
    s_lshl_b32 s72, s65, 10
    s_add_u32 s93, s93, s72
    s_lshr_b32 s72, s81, 1
    s_lshl_b32 s72, s72, 8
    s_add_u32 s93, s93, s72
    s_lshl_b32 s72, s82, 6
    s_add_u32 s93, s93, s72
    s_and_b32 s72, s81, 1
    s_lshl_b32 s72, s72, 15
    s_add_u32 s93, s93, s72
    v_mov_b32 v32, 0
    v_mov_b32 v33, 0
    v_mov_b32 v34, 0
    v_mov_b32 v35, 0
    v_mov_b32 v36, 0
    v_mov_b32 v37, 0
    v_mov_b32 v38, 0
    v_mov_b32 v39, 0
    v_mov_b32 v40, 0
    v_mov_b32 v41, 0
    v_mov_b32 v42, 0
    v_mov_b32 v43, 0
    v_mov_b32 v44, 0
    v_mov_b32 v45, 0
    v_mov_b32 v46, 0
    v_mov_b32 v47, 0
    v_mov_b32 v48, 0
    v_mov_b32 v49, 0
    v_mov_b32 v50, 0
    v_mov_b32 v51, 0
    v_mov_b32 v52, 0
    v_mov_b32 v53, 0
    v_mov_b32 v54, 0
    v_mov_b32 v55, 0
    s_mov_b32 s85, 0
    s_mov_b32 s78, 0
poll:
    s_mov_b64 exec, 0xffff
    buffer_load_dwordx2 v[234:235], v231, s[36:39], s87 offen sc1
    s_waitcnt vmcnt(0)
process:
    v_cmp_eq_u32 vcc, v234, v232
    v_cmp_eq_u32 s[94:95], v235, v233
    s_mov_b64 exec, -1
    s_and_b32 s94, s94, vcc_lo
    s_and_b32 s95, s94, 0xff
    s_cmp_eq_u32 s95, 0xff
    s_or_b32 s72, s95, s85
    s_bcnt1_i32_b32 s72, s72
    s_cmp_gt_u32 s72, 5
    s_cselect_b32 s95, s95, 0
    s_andn2_b32 s79, s95, s85
    s_cbranch_scc0 noload
    s_bitcmp1_b32 s79, 0
    s_cbranch_scc0 nold0
    s_add_u32 s72, s88, 0
    buffer_load_dwordx4 v[128:131], v248, s[36:39], s72 offen offset:0 sc1
    buffer_load_dwordx4 v[160:163], v248, s[36:39], s72 offen offset:1024 sc1
    buffer_load_dwordx4 v[0:3], v248, s[36:39], s72 offen offset:2048 sc1
nold0:
    s_bitcmp1_b32 s79, 1
    s_cbranch_scc0 nold1
    s_add_u32 s72, s88, 12288
    buffer_load_dwordx4 v[132:135], v248, s[36:39], s72 offen offset:0 sc1
    buffer_load_dwordx4 v[164:167], v248, s[36:39], s72 offen offset:1024 sc1
    buffer_load_dwordx4 v[4:7], v248, s[36:39], s72 offen offset:2048 sc1
nold1:
    s_bitcmp1_b32 s79, 2
    s_cbranch_scc0 nold2
    s_add_u32 s72, s88, 24576
    buffer_load_dwordx4 v[136:139], v248, s[36:39], s72 offen offset:0 sc1
    buffer_load_dwordx4 v[168:171], v248, s[36:39], s72 offen offset:1024 sc1
    buffer_load_dwordx4 v[8:11], v248, s[36:39], s72 offen offset:2048 sc1
nold2:
    s_bitcmp1_b32 s79, 3
    s_cbranch_scc0 nold3
    s_add_u32 s72, s88, 36864
    buffer_load_dwordx4 v[140:143], v248, s[36:39], s72 offen offset:0 sc1
    buffer_load_dwordx4 v[172:175], v248, s[36:39], s72 offen offset:1024 sc1
    buffer_load_dwordx4 v[12:15], v248, s[36:39], s72 offen offset:2048 sc1
nold3:
    s_bitcmp1_b32 s79, 4
    s_cbranch_scc0 nold4
    s_add_u32 s72, s88, 49152
    buffer_load_dwordx4 v[144:147], v248, s[36:39], s72 offen offset:0 sc1
    buffer_load_dwordx4 v[176:179], v248, s[36:39], s72 offen offset:1024 sc1
    buffer_load_dwordx4 v[16:19], v248, s[36:39], s72 offen offset:2048 sc1
nold4:
    s_bitcmp1_b32 s79, 5
    s_cbranch_scc0 nold5
    s_add_u32 s72, s88, 61440
    buffer_load_dwordx4 v[148:151], v248, s[36:39], s72 offen offset:0 sc1
    buffer_load_dwordx4 v[180:183], v248, s[36:39], s72 offen offset:1024 sc1
    buffer_load_dwordx4 v[20:23], v248, s[36:39], s72 offen offset:2048 sc1
nold5:
    s_bitcmp1_b32 s79, 6
    s_cbranch_scc0 nold6
    s_add_u32 s72, s88, 73728
    buffer_load_dwordx4 v[152:155], v248, s[36:39], s72 offen offset:0 sc1
    buffer_load_dwordx4 v[184:187], v248, s[36:39], s72 offen offset:1024 sc1
    buffer_load_dwordx4 v[24:27], v248, s[36:39], s72 offen offset:2048 sc1
nold6:
    s_bitcmp1_b32 s79, 7
    s_cbranch_scc0 nold7
    s_add_u32 s72, s88, 86016
    buffer_load_dwordx4 v[156:159], v248, s[36:39], s72 offen offset:0 sc1
    buffer_load_dwordx4 v[188:191], v248, s[36:39], s72 offen offset:1024 sc1
    buffer_load_dwordx4 v[28:31], v248, s[36:39], s72 offen offset:2048 sc1
nold7:
noload:
    s_cmp_eq_u32 s8, 0
    s_cbranch_scc1 noself
    s_mov_b32 s8, 0
selfw:
    ds_read_b32 v251, v243 offset:8
    ds_read_b128 v[96:99], v242 offset:49152
    ds_read_b128 v[100:103], v242 offset:50176
    ds_read_b128 v[104:107], v242 offset:51200
    s_waitcnt lgkmcnt(0)
    v_readfirstlane_b32 s72, v251
    s_cmp_eq_u32 s72, s80
    s_cbranch_scc0 selfw
    v_mfma_f32_16x16x32_bf16 v[32:35], v[226:229], v[96:99], v[32:35]
    v_mfma_f32_16x16x32_bf16 v[36:39], v[224:227], v[96:99], v[36:39]
    v_mfma_f32_16x16x32_bf16 v[40:43], v[226:229], v[100:103], v[40:43]
    v_mfma_f32_16x16x32_bf16 v[44:47], v[224:227], v[100:103], v[44:47]
    v_mfma_f32_16x16x32_bf16 v[48:51], v[226:229], v[104:107], v[48:51]
    v_mfma_f32_16x16x32_bf16 v[52:55], v[224:227], v[104:107], v[52:55]
noself:
    s_cmp_eq_u32 s78, 0
    s_cbranch_scc1 noacc
    s_bitcmp1_b32 s78, 0
    s_cbranch_scc0 noac0
    v_mfma_f32_16x16x32_bf16 v[32:35], v[226:229], v[128:131], v[32:35]
    v_mfma_f32_16x16x32_bf16 v[36:39], v[224:227], v[128:131], v[36:39]
    v_mfma_f32_16x16x32_bf16 v[40:43], v[226:229], v[160:163], v[40:43]
    v_mfma_f32_16x16x32_bf16 v[44:47], v[224:227], v[160:163], v[44:47]
    v_mfma_f32_16x16x32_bf16 v[48:51], v[226:229], v[0:3], v[48:51]
    v_mfma_f32_16x16x32_bf16 v[52:55], v[224:227], v[0:3], v[52:55]
noac0:
    s_bitcmp1_b32 s78, 1
    s_cbranch_scc0 noac1
    v_mfma_f32_16x16x32_bf16 v[32:35], v[226:229], v[132:135], v[32:35]
    v_mfma_f32_16x16x32_bf16 v[36:39], v[224:227], v[132:135], v[36:39]
    v_mfma_f32_16x16x32_bf16 v[40:43], v[226:229], v[164:167], v[40:43]
    v_mfma_f32_16x16x32_bf16 v[44:47], v[224:227], v[164:167], v[44:47]
    v_mfma_f32_16x16x32_bf16 v[48:51], v[226:229], v[4:7], v[48:51]
    v_mfma_f32_16x16x32_bf16 v[52:55], v[224:227], v[4:7], v[52:55]
noac1:
    s_bitcmp1_b32 s78, 2
    s_cbranch_scc0 noac2
    v_mfma_f32_16x16x32_bf16 v[32:35], v[226:229], v[136:139], v[32:35]
    v_mfma_f32_16x16x32_bf16 v[36:39], v[224:227], v[136:139], v[36:39]
    v_mfma_f32_16x16x32_bf16 v[40:43], v[226:229], v[168:171], v[40:43]
    v_mfma_f32_16x16x32_bf16 v[44:47], v[224:227], v[168:171], v[44:47]
    v_mfma_f32_16x16x32_bf16 v[48:51], v[226:229], v[8:11], v[48:51]
    v_mfma_f32_16x16x32_bf16 v[52:55], v[224:227], v[8:11], v[52:55]
noac2:
    s_bitcmp1_b32 s78, 3
    s_cbranch_scc0 noac3
    v_mfma_f32_16x16x32_bf16 v[32:35], v[226:229], v[140:143], v[32:35]
    v_mfma_f32_16x16x32_bf16 v[36:39], v[224:227], v[140:143], v[36:39]
    v_mfma_f32_16x16x32_bf16 v[40:43], v[226:229], v[172:175], v[40:43]
    v_mfma_f32_16x16x32_bf16 v[44:47], v[224:227], v[172:175], v[44:47]
    v_mfma_f32_16x16x32_bf16 v[48:51], v[226:229], v[12:15], v[48:51]
    v_mfma_f32_16x16x32_bf16 v[52:55], v[224:227], v[12:15], v[52:55]
noac3:
    s_bitcmp1_b32 s78, 4
    s_cbranch_scc0 noac4
    v_mfma_f32_16x16x32_bf16 v[32:35], v[226:229], v[144:147], v[32:35]
    v_mfma_f32_16x16x32_bf16 v[36:39], v[224:227], v[144:147], v[36:39]
    v_mfma_f32_16x16x32_bf16 v[40:43], v[226:229], v[176:179], v[40:43]
    v_mfma_f32_16x16x32_bf16 v[44:47], v[224:227], v[176:179], v[44:47]
    v_mfma_f32_16x16x32_bf16 v[48:51], v[226:229], v[16:19], v[48:51]
    v_mfma_f32_16x16x32_bf16 v[52:55], v[224:227], v[16:19], v[52:55]
noac4:
    s_bitcmp1_b32 s78, 5
    s_cbranch_scc0 noac5
    v_mfma_f32_16x16x32_bf16 v[32:35], v[226:229], v[148:151], v[32:35]
    v_mfma_f32_16x16x32_bf16 v[36:39], v[224:227], v[148:151], v[36:39]
    v_mfma_f32_16x16x32_bf16 v[40:43], v[226:229], v[180:183], v[40:43]
    v_mfma_f32_16x16x32_bf16 v[44:47], v[224:227], v[180:183], v[44:47]
    v_mfma_f32_16x16x32_bf16 v[48:51], v[226:229], v[20:23], v[48:51]
    v_mfma_f32_16x16x32_bf16 v[52:55], v[224:227], v[20:23], v[52:55]
noac5:
    s_bitcmp1_b32 s78, 6
    s_cbranch_scc0 noac6
    v_mfma_f32_16x16x32_bf16 v[32:35], v[226:229], v[152:155], v[32:35]
    v_mfma_f32_16x16x32_bf16 v[36:39], v[224:227], v[152:155], v[36:39]
    v_mfma_f32_16x16x32_bf16 v[40:43], v[226:229], v[184:187], v[40:43]
    v_mfma_f32_16x16x32_bf16 v[44:47], v[224:227], v[184:187], v[44:47]
    v_mfma_f32_16x16x32_bf16 v[48:51], v[226:229], v[24:27], v[48:51]
    v_mfma_f32_16x16x32_bf16 v[52:55], v[224:227], v[24:27], v[52:55]
noac6:
    s_bitcmp1_b32 s78, 7
    s_cbranch_scc0 noac7
    v_mfma_f32_16x16x32_bf16 v[32:35], v[226:229], v[156:159], v[32:35]
    v_mfma_f32_16x16x32_bf16 v[36:39], v[224:227], v[156:159], v[36:39]
    v_mfma_f32_16x16x32_bf16 v[40:43], v[226:229], v[188:191], v[40:43]
    v_mfma_f32_16x16x32_bf16 v[44:47], v[224:227], v[188:191], v[44:47]
    v_mfma_f32_16x16x32_bf16 v[48:51], v[226:229], v[28:31], v[48:51]
    v_mfma_f32_16x16x32_bf16 v[52:55], v[224:227], v[28:31], v[52:55]
noac7:
noacc:
    s_or_b32 s85, s85, s79
    s_mov_b32 s78, s79
    s_cmp_lg_u32 s85, 0xff
    s_cbranch_scc1 more
    s_cmp_eq_u32 s78, 0
    s_cbranch_scc1 finish
    s_waitcnt vmcnt(0)
    s_mov_b32 s79, 0
    s_branch noload
more:
    s_cmp_lg_u32 s79, 0
    s_cbranch_scc1 poll
    s_sleep 2
    s_memrealtime s[76:77]
    s_waitcnt lgkmcnt(0)
    s_sub_u32 s76, s76, s80
    s_cmp_lt_i32 s76, 40000
    s_cbranch_scc1 poll
giveup:
    s_cmp_lg_u32 s84, 0
    s_cbranch_scc1 giveup2
    s_mul_i32 s72, s63, 12288
    s_add_u32 s72, s72, s88
    buffer_store_dwordx4 v[96:99], v248, s[36:39], s72 offen offset:0 sc1
    buffer_store_dwordx4 v[100:103], v248, s[36:39], s72 offen offset:1024 sc1
    buffer_store_dwordx4 v[104:107], v248, s[36:39], s72 offen offset:2048 sc1
    s_waitcnt vmcnt(0)
giveup2:
    s_and_b32 s72, s81, 1
    s_lshl_b32 s72, s72, 2
    s_add_u32 s72, s72, s82
    s_lshl_b32 s72, s72, 3
    s_add_u32 s72, s72, 64
    s_add_u32 s72, s72, s87
    s_mov_b64 exec, 1
    buffer_store_dwordx2 v[232:233], off, s[36:39], s72 sc1
    s_mov_b64 exec, -1
    s_waitcnt vmcnt(0)
    s_mov_b64 exec, 0xffff
    buffer_load_dwordx2 v[234:235], v231, s[36:39], s87 offen sc1
    s_waitcnt vmcnt(0)
    v_cmp_eq_u32 vcc, v234, v232
    v_cmp_eq_u32 s[94:95], v235, v233
    s_mov_b64 exec, -1
    s_and_b32 s94, s94, vcc_lo
    s_and_b32 s95, s94, 0xff
    s_cmp_eq_u32 s95, 0xff
    s_cbranch_scc1 process
    s_branch after
finish:
    s_nop 9
    v_cvt_pk_bf16_f32 v64, v32, v33
    v_cvt_pk_bf16_f32 v65, v34, v35
    v_cvt_pk_bf16_f32 v66, v36, v37
    v_cvt_pk_bf16_f32 v67, v38, v39
    s_add_u32 s75, s93, 0
    buffer_store_dwordx4 v[64:67], v230, s[44:47], s75 offen
    v_cvt_pk_bf16_f32 v68, v40, v41
    v_cvt_pk_bf16_f32 v69, v42, v43
    v_cvt_pk_bf16_f32 v70, v44, v45
    v_cvt_pk_bf16_f32 v71, v46, v47
    s_add_u32 s75, s93, 65536
    buffer_store_dwordx4 v[68:71], v230, s[44:47], s75 offen
    v_cvt_pk_bf16_f32 v72, v48, v49
    v_cvt_pk_bf16_f32 v73, v50, v51
    v_cvt_pk_bf16_f32 v74, v52, v53
    v_cvt_pk_bf16_f32 v75, v54, v55
    s_add_u32 s75, s93, 131072
    buffer_store_dwordx4 v[72:75], v230, s[44:47], s75 offen
after:
    s_nop 7
    s_cmp_lg_u32 s84, 0
    s_cbranch_scc1 next
    s_mov_b32 s84, 1
    s_waitcnt vmcnt(3)
    s_memrealtime s[76:77]
    s_waitcnt lgkmcnt(0)
    s_sub_u32 s76, s76, s80
    s_cmp_lt_i32 s76, 20000
    s_cbranch_scc1 k_end
    s_mov_b64 exec, 0xffff
    buffer_load_dwordx2 v[234:235], v231, s[36:39], s86 offen sc1
    s_waitcnt vmcnt(0)
    v_cmp_eq_u32 vcc, v234, v232
    v_cmp_eq_u32 s[94:95], v235, v233
    s_mov_b64 exec, -1
    s_and_b32 s94, s94, vcc_lo
    s_and_b32 s95, s94, 0xff
    s_cmp_eq_u32 s95, 0xff
    s_lshr_b32 s83, s94, 8
    s_and_b32 s83, s83, 0xff
    s_cmp_eq_u32 s95, 0xff
    s_cselect_b32 s83, s83, 0
next:
    s_cmp_eq_u32 s83, 0
    s_cbranch_scc1 k_end
    s_ff1_i32_b32 s72, s83
    s_bitset0_b32 s83, s72
    s_and_b32 s82, s72, 3
    s_lshr_b32 s72, s72, 2
    s_lshl_b32 s81, s3, 1
    s_add_u32 s81, s81, s72
    s_waitcnt vmcnt(0)
    s_branch job
k_end:
    s_endpgm
cls1:
    s_add_u32 s72, s82, 0
    s_and_b32 s72, s72, 0x3ff
    s_add_u32 s72, s72, s86
    s_add_u32 m0, s89, 0
    s_nop 0
    buffer_load_dwordx4 v251, s[20:23], s72 offen lds
    s_add_u32 s72, s82, 0
    s_and_b32 s72, s72, 0x3ff
    s_add_u32 s72, s72, s87
    s_add_u32 m0, s90, 0
    s_nop 0
    buffer_load_dwordx4 v252, s[20:23], s72 offen lds
    s_add_u32 s72, s82, 0
    s_and_b32 s72, s72, 0x3ff
    s_add_u32 s72, s72, s88
    s_add_u32 m0, s91, 0
    s_nop 0
    buffer_load_dwordx4 v253, s[20:23], s72 offen lds
    buffer_load_dwordx4 v[192:195], v240, s[32:35], 0 offen
    buffer_load_dwordx4 v[196:199], v240, s[32:35], s52 offen
    buffer_load_dwordx4 v[200:203], v240, s[32:35], s53 offen
    buffer_load_dwordx4 v[204:207], v240, s[32:35], s54 offen
    buffer_load_dwordx4 v[208:211], v240, s[32:35], s55 offen
    buffer_load_dwordx4 v[212:215], v240, s[32:35], s56 offen
    buffer_load_dwordx4 v[216:219], v240, s[32:35], s57 offen
    buffer_load_dwordx4 v[220:223], v240, s[32:35], s58 offen
    s_add_u32 s72, s82, 128
    s_and_b32 s72, s72, 0x3ff
    s_add_u32 s72, s72, s86
    s_add_u32 m0, s89, 12288
    s_nop 0
    buffer_load_dwordx4 v251, s[20:23], s72 offen lds
    s_add_u32 s72, s82, 128
    s_and_b32 s72, s72, 0x3ff
    s_add_u32 s72, s72, s87
    s_add_u32 m0, s90, 12288
    s_nop 0
    buffer_load_dwordx4 v252, s[20:23], s72 offen lds
    s_add_u32 s72, s82, 128
    s_and_b32 s72, s72, 0x3ff
    s_add_u32 s72, s72, s88
    s_add_u32 m0, s91, 12288
    s_nop 0
    buffer_load_dwordx4 v253, s[20:23], s72 offen lds
    v_add_u32 v240, s81, v240
    v_and_b32 v240, 0x3fffff, v240
    buffer_load_dwordx4 v[32:35], v240, s[32:35], 0 offen
    buffer_load_dwordx4 v[36:39], v240, s[32:35], s52 offen
    buffer_load_dwordx4 v[40:43], v240, s[32:35], s53 offen
    buffer_load_dwordx4 v[44:47], v240, s[32:35], s54 offen
    buffer_load_dwordx4 v[48:51], v240, s[32:35], s55 offen
    buffer_load_dwordx4 v[52:55], v240, s[32:35], s56 offen
    buffer_load_dwordx4 v[56:59], v240, s[32:35], s57 offen
    buffer_load_dwordx4 v[60:63], v240, s[32:35], s58 offen
    buffer_load_dword v254, v112, s[32:35], 0 offen
    s_waitcnt vmcnt(9)
    s_barrier
    ds_read_b128 a[192:195], v241 offset:0
    ds_read_b128 a[196:199], v241 offset:2048
    ds_read_b128 a[200:203], v241 offset:4096
    ds_read_b128 a[204:207], v241 offset:6144
    ds_read_b128 a[208:211], v241 offset:8192
    ds_read_b128 a[212:215], v241 offset:10240
    v_perm_b32 v96, v196, v192, s60
    v_perm_b32 v97, v204, v200, s60
    v_perm_b32 v98, v212, v208, s60
    v_perm_b32 v99, v220, v216, s60
    s_waitcnt lgkmcnt(0)
    s_nop 0
    v_mfma_f32_16x16x32_bf16 a[0:3], v[96:99], a[192:195], 0
    v_perm_b32 v100, v196, v192, s61
    v_perm_b32 v101, v204, v200, s61
    v_mfma_f32_16x16x32_bf16 a[32:35], v[96:99], a[196:199], 0
    v_perm_b32 v102, v212, v208, s61
    v_mfma_f32_16x16x32_bf16 a[64:67], v[96:99], a[200:203], 0
    v_perm_b32 v103, v220, v216, s61
    v_mfma_f32_16x16x32_bf16 a[96:99], v[96:99], a[204:207], 0
    v_add_u32 v240, s80, v240
    v_mfma_f32_16x16x32_bf16 a[128:131], v[96:99], a[208:211], 0
    v_and_b32 v240, 0x3fffff, v240
    v_mfma_f32_16x16x32_bf16 a[160:163], v[96:99], a[212:215], 0
    buffer_load_dwordx4 v[64:67], v240, s[32:35], 0 offen
    v_mfma_f32_16x16x32_bf16 a[4:7], v[100:103], a[192:195], 0
    v_perm_b32 v104, v197, v193, s60
    v_mfma_f32_16x16x32_bf16 a[36:39], v[100:103], a[196:199], 0
    v_perm_b32 v105, v205, v201, s60
    v_mfma_f32_16x16x32_bf16 a[68:71], v[100:103], a[200:203], 0
    v_perm_b32 v106, v213, v209, s60
    v_mfma_f32_16x16x32_bf16 a[100:103], v[100:103], a[204:207], 0
    v_perm_b32 v107, v221, v217, s60
    v_mfma_f32_16x16x32_bf16 a[132:135], v[100:103], a[208:211], 0
    buffer_load_dwordx4 v[68:71], v240, s[32:35], s52 offen
    v_mfma_f32_16x16x32_bf16 a[164:167], v[100:103], a[212:215], 0
    buffer_load_dwordx4 v[72:75], v240, s[32:35], s53 offen
    v_mfma_f32_16x16x32_bf16 a[8:11], v[104:107], a[192:195], 0
    v_perm_b32 v108, v197, v193, s61
    v_mfma_f32_16x16x32_bf16 a[40:43], v[104:107], a[196:199], 0
    v_perm_b32 v109, v205, v201, s61
    v_mfma_f32_16x16x32_bf16 a[72:75], v[104:107], a[200:203], 0
    v_perm_b32 v110, v213, v209, s61
    v_mfma_f32_16x16x32_bf16 a[104:107], v[104:107], a[204:207], 0
    v_perm_b32 v111, v221, v217, s61
    v_mfma_f32_16x16x32_bf16 a[136:139], v[104:107], a[208:211], 0
    buffer_load_dwordx4 v[76:79], v240, s[32:35], s54 offen
    v_mfma_f32_16x16x32_bf16 a[168:171], v[104:107], a[212:215], 0
    buffer_load_dwordx4 v[80:83], v240, s[32:35], s55 offen
    v_mfma_f32_16x16x32_bf16 a[12:15], v[108:111], a[192:195], 0
    v_perm_b32 v96, v198, v194, s60
    v_perm_b32 v97, v206, v202, s60
    v_mfma_f32_16x16x32_bf16 a[44:47], v[108:111], a[196:199], 0
    v_perm_b32 v98, v214, v210, s60
    v_mfma_f32_16x16x32_bf16 a[76:79], v[108:111], a[200:203], 0
    v_perm_b32 v99, v222, v218, s60
    v_mfma_f32_16x16x32_bf16 a[108:111], v[108:111], a[204:207], 0
    buffer_load_dwordx4 v[84:87], v240, s[32:35], s56 offen
    buffer_load_dwordx4 v[88:91], v240, s[32:35], s57 offen
    v_mfma_f32_16x16x32_bf16 a[140:143], v[108:111], a[208:211], 0
    ds_read_b128 a[216:219], v242 offset:0
    v_mfma_f32_16x16x32_bf16 a[172:175], v[108:111], a[212:215], 0
    ds_read_b128 a[220:223], v242 offset:2048
    v_mfma_f32_16x16x32_bf16 a[16:19], v[96:99], a[192:195], 0
    v_perm_b32 v100, v198, v194, s61
    v_perm_b32 v101, v206, v202, s61
    v_mfma_f32_16x16x32_bf16 a[48:51], v[96:99], a[196:199], 0
    v_perm_b32 v102, v214, v210, s61
    v_mfma_f32_16x16x32_bf16 a[80:83], v[96:99], a[200:203], 0
    v_perm_b32 v103, v222, v218, s61
    v_mfma_f32_16x16x32_bf16 a[112:115], v[96:99], a[204:207], 0
    buffer_load_dwordx4 v[92:95], v240, s[32:35], s58 offen
    v_mfma_f32_16x16x32_bf16 a[144:147], v[96:99], a[208:211], 0
    ds_read_b128 a[224:227], v242 offset:4096
    v_mfma_f32_16x16x32_bf16 a[176:179], v[96:99], a[212:215], 0
    ds_read_b128 a[228:231], v242 offset:6144
    v_mfma_f32_16x16x32_bf16 a[20:23], v[100:103], a[192:195], 0
    v_perm_b32 v104, v199, v195, s60
    v_perm_b32 v105, v207, v203, s60
    v_mfma_f32_16x16x32_bf16 a[52:55], v[100:103], a[196:199], 0
    v_perm_b32 v106, v215, v211, s60
    v_perm_b32 v107, v223, v219, s60
    v_mfma_f32_16x16x32_bf16 a[84:87], v[100:103], a[200:203], 0
    s_add_u32 s72, s82, 256
    s_and_b32 s72, s72, 0x3ff
    v_mfma_f32_16x16x32_bf16 a[116:119], v[100:103], a[204:207], 0
    s_add_u32 s72, s72, s86
    s_add_u32 m0, s89, 24576
    v_mfma_f32_16x16x32_bf16 a[148:151], v[100:103], a[208:211], 0
    buffer_load_dwordx4 v251, s[20:23], s72 offen lds
    ds_read_b128 a[232:235], v242 offset:8192
    v_mfma_f32_16x16x32_bf16 a[180:183], v[100:103], a[212:215], 0
    ds_read_b128 a[236:239], v242 offset:10240
    v_mfma_f32_16x16x32_bf16 a[24:27], v[104:107], a[192:195], 0
    v_perm_b32 v108, v199, v195, s61
    v_perm_b32 v109, v207, v203, s61
    v_mfma_f32_16x16x32_bf16 a[56:59], v[104:107], a[196:199], 0
    v_perm_b32 v110, v215, v211, s61
    v_mfma_f32_16x16x32_bf16 a[88:91], v[104:107], a[200:203], 0
    v_perm_b32 v111, v223, v219, s61
    s_add_u32 s72, s82, 256
    v_mfma_f32_16x16x32_bf16 a[120:123], v[104:107], a[204:207], 0
    s_and_b32 s72, s72, 0x3ff
    v_mfma_f32_16x16x32_bf16 a[152:155], v[104:107], a[208:211], 0
    s_add_u32 s72, s72, s87
    s_add_u32 m0, s90, 24576
    v_mfma_f32_16x16x32_bf16 a[184:187], v[104:107], a[212:215], 0
    buffer_load_dwordx4 v252, s[20:23], s72 offen lds
    v_mfma_f32_16x16x32_bf16 a[28:31], v[108:111], a[192:195], 0
    s_waitcnt vmcnt(11)
    v_perm_b32 v96, v36, v32, s60
    v_mfma_f32_16x16x32_bf16 a[60:63], v[108:111], a[196:199], 0
    v_perm_b32 v97, v44, v40, s60
    v_perm_b32 v98, v52, v48, s60
    v_mfma_f32_16x16x32_bf16 a[92:95], v[108:111], a[200:203], 0
    v_perm_b32 v99, v60, v56, s60
    v_mfma_f32_16x16x32_bf16 a[124:127], v[108:111], a[204:207], 0
    s_add_u32 s72, s82, 256
    s_and_b32 s72, s72, 0x3ff
    v_mfma_f32_16x16x32_bf16 a[156:159], v[108:111], a[208:211], 0
    s_add_u32 s72, s72, s88
    s_add_u32 m0, s91, 24576
    v_mfma_f32_16x16x32_bf16 a[188:191], v[108:111], a[212:215], 0
    buffer_load_dwordx4 v253, s[20:23], s72 offen lds
    s_waitcnt lgkmcnt(0)
    v_mfma_f32_16x16x32_bf16 a[0:3], v[96:99], a[216:219], a[0:3]
    v_perm_b32 v100, v36, v32, s61
    v_mfma_f32_16x16x32_bf16 a[32:35], v[96:99], a[220:223], a[32:35]
    v_perm_b32 v101, v44, v40, s61
    v_mfma_f32_16x16x32_bf16 a[64:67], v[96:99], a[224:227], a[64:67]
    v_mfma_f32_16x16x32_bf16 a[96:99], v[96:99], a[228:231], a[96:99]
    v_perm_b32 v102, v52, v48, s61
    v_mfma_f32_16x16x32_bf16 a[128:131], v[96:99], a[232:235], a[128:131]
    v_perm_b32 v103, v60, v56, s61
    v_mfma_f32_16x16x32_bf16 a[160:163], v[96:99], a[236:239], a[160:163]
    s_nop 0
    v_mfma_f32_16x16x32_bf16 a[4:7], v[100:103], a[216:219], a[4:7]
    v_perm_b32 v104, v37, v33, s60
    v_perm_b32 v105, v45, v41, s60
    v_mfma_f32_16x16x32_bf16 a[36:39], v[100:103], a[220:223], a[36:39]
    v_perm_b32 v106, v53, v49, s60
    v_mfma_f32_16x16x32_bf16 a[68:71], v[100:103], a[224:227], a[68:71]
    v_perm_b32 v107, v61, v57, s60
    s_add_u32 s72, s82, 384
    v_mfma_f32_16x16x32_bf16 a[100:103], v[100:103], a[228:231], a[100:103]
    s_and_b32 s72, s72, 0x3ff
    v_mfma_f32_16x16x32_bf16 a[132:135], v[100:103], a[232:235], a[132:135]
    s_add_u32 s72, s72, s86
    s_add_u32 m0, s89, 36864
    v_mfma_f32_16x16x32_bf16 a[164:167], v[100:103], a[236:239], a[164:167]
    buffer_load_dwordx4 v251, s[20:23], s72 offen lds
    v_mfma_f32_16x16x32_bf16 a[8:11], v[104:107], a[216:219], a[8:11]
    v_perm_b32 v108, v37, v33, s61
    v_perm_b32 v109, v45, v41, s61
    v_mfma_f32_16x16x32_bf16 a[40:43], v[104:107], a[220:223], a[40:43]
    v_perm_b32 v110, v53, v49, s61
    v_mfma_f32_16x16x32_bf16 a[72:75], v[104:107], a[224:227], a[72:75]
    v_perm_b32 v111, v61, v57, s61
    s_add_u32 s72, s82, 384
    v_mfma_f32_16x16x32_bf16 a[104:107], v[104:107], a[228:231], a[104:107]
    s_and_b32 s72, s72, 0x3ff
    v_mfma_f32_16x16x32_bf16 a[136:139], v[104:107], a[232:235], a[136:139]
    s_add_u32 s72, s72, s87
    s_add_u32 m0, s90, 36864
    v_mfma_f32_16x16x32_bf16 a[168:171], v[104:107], a[236:239], a[168:171]
    buffer_load_dwordx4 v252, s[20:23], s72 offen lds
    v_mfma_f32_16x16x32_bf16 a[12:15], v[108:111], a[216:219], a[12:15]
    v_perm_b32 v96, v38, v34, s60
    v_perm_b32 v97, v46, v42, s60
    v_mfma_f32_16x16x32_bf16 a[44:47], v[108:111], a[220:223], a[44:47]
    v_perm_b32 v98, v54, v50, s60
    v_perm_b32 v99, v62, v58, s60
    v_mfma_f32_16x16x32_bf16 a[76:79], v[108:111], a[224:227], a[76:79]
    s_add_u32 s72, s82, 384
    s_and_b32 s72, s72, 0x3ff
    v_mfma_f32_16x16x32_bf16 a[108:111], v[108:111], a[228:231], a[108:111]
    s_add_u32 s72, s72, s88
    s_add_u32 m0, s91, 36864
    v_mfma_f32_16x16x32_bf16 a[140:143], v[108:111], a[232:235], a[140:143]
    buffer_load_dwordx4 v253, s[20:23], s72 offen lds
    ds_read_b128 a[192:195], v241 offset:12288
    v_mfma_f32_16x16x32_bf16 a[172:175], v[108:111], a[236:239], a[172:175]
    ds_read_b128 a[196:199], v241 offset:14336
    v_mfma_f32_16x16x32_bf16 a[16:19], v[96:99], a[216:219], a[16:19]
    v_perm_b32 v100, v38, v34, s61
    v_perm_b32 v101, v46, v42, s61
    v_mfma_f32_16x16x32_bf16 a[48:51], v[96:99], a[220:223], a[48:51]
    v_perm_b32 v102, v54, v50, s61
    v_perm_b32 v103, v62, v58, s61
    v_mfma_f32_16x16x32_bf16 a[80:83], v[96:99], a[224:227], a[80:83]
    v_add_u32 v240, s81, v240
    v_mfma_f32_16x16x32_bf16 a[112:115], v[96:99], a[228:231], a[112:115]
    v_and_b32 v240, 0x3fffff, v240
    buffer_load_dwordx4 v[0:3], v240, s[32:35], 0 offen
    v_mfma_f32_16x16x32_bf16 a[144:147], v[96:99], a[232:235], a[144:147]
    buffer_load_dwordx4 v[4:7], v240, s[32:35], s52 offen
    ds_read_b128 a[200:203], v241 offset:16384
    v_mfma_f32_16x16x32_bf16 a[176:179], v[96:99], a[236:239], a[176:179]
    ds_read_b128 a[204:207], v241 offset:18432
    v_mfma_f32_16x16x32_bf16 a[20:23], v[100:103], a[216:219], a[20:23]
    v_perm_b32 v104, v39, v35, s60
    v_perm_b32 v105, v47, v43, s60
    v_mfma_f32_16x16x32_bf16 a[52:55], v[100:103], a[220:223], a[52:55]
    v_perm_b32 v106, v55, v51, s60
    v_mfma_f32_16x16x32_bf16 a[84:87], v[100:103], a[224:227], a[84:87]
    v_perm_b32 v107, v63, v59, s60
    v_mfma_f32_16x16x32_bf16 a[116:119], v[100:103], a[228:231], a[116:119]
    buffer_load_dwordx4 v[8:11], v240, s[32:35], s53 offen
    buffer_load_dwordx4 v[12:15], v240, s[32:35], s54 offen
    v_mfma_f32_16x16x32_bf16 a[148:151], v[100:103], a[232:235], a[148:151]
    ds_read_b128 a[208:211], v241 offset:20480
    v_mfma_f32_16x16x32_bf16 a[180:183], v[100:103], a[236:239], a[180:183]
    ds_read_b128 a[212:215], v241 offset:22528
    v_mfma_f32_16x16x32_bf16 a[24:27], v[104:107], a[216:219], a[24:27]
    v_perm_b32 v108, v39, v35, s61
    v_mfma_f32_16x16x32_bf16 a[56:59], v[104:107], a[220:223], a[56:59]
    v_perm_b32 v109, v47, v43, s61
    v_mfma_f32_16x16x32_bf16 a[88:91], v[104:107], a[224:227], a[88:91]
    v_perm_b32 v110, v55, v51, s61
    v_mfma_f32_16x16x32_bf16 a[120:123], v[104:107], a[228:231], a[120:123]
    v_perm_b32 v111, v63, v59, s61
    v_mfma_f32_16x16x32_bf16 a[152:155], v[104:107], a[232:235], a[152:155]
    buffer_load_dwordx4 v[16:19], v240, s[32:35], s55 offen
    v_mfma_f32_16x16x32_bf16 a[184:187], v[104:107], a[236:239], a[184:187]
    v_mfma_f32_16x16x32_bf16 a[28:31], v[108:111], a[216:219], a[28:31]
    s_waitcnt vmcnt(11)
    v_perm_b32 v96, v68, v64, s60
    v_mfma_f32_16x16x32_bf16 a[60:63], v[108:111], a[220:223], a[60:63]
    v_perm_b32 v97, v76, v72, s60
    v_mfma_f32_16x16x32_bf16 a[92:95], v[108:111], a[224:227], a[92:95]
    v_perm_b32 v98, v84, v80, s60
    v_mfma_f32_16x16x32_bf16 a[124:127], v[108:111], a[228:231], a[124:127]
    v_perm_b32 v99, v92, v88, s60
    v_mfma_f32_16x16x32_bf16 a[156:159], v[108:111], a[232:235], a[156:159]
    buffer_load_dwordx4 v[20:23], v240, s[32:35], s56 offen
    v_mfma_f32_16x16x32_bf16 a[188:191], v[108:111], a[236:239], a[188:191]
    buffer_load_dwordx4 v[24:27], v240, s[32:35], s57 offen
    s_waitcnt lgkmcnt(0)
    v_mfma_f32_16x16x32_bf16 a[0:3], v[96:99], a[192:195], a[0:3]
    v_perm_b32 v100, v68, v64, s61
    v_perm_b32 v101, v76, v72, s61
    v_mfma_f32_16x16x32_bf16 a[32:35], v[96:99], a[196:199], a[32:35]
    v_perm_b32 v102, v84, v80, s61
    v_mfma_f32_16x16x32_bf16 a[64:67], v[96:99], a[200:203], a[64:67]
    v_perm_b32 v103, v92, v88, s61
    v_mfma_f32_16x16x32_bf16 a[96:99], v[96:99], a[204:207], a[96:99]
    buffer_load_dwordx4 v[28:31], v240, s[32:35], s58 offen
    v_add_u32 v240, s80, v240
    v_mfma_f32_16x16x32_bf16 a[128:131], v[96:99], a[208:211], a[128:131]
    v_and_b32 v240, 0x3fffff, v240
    v_mfma_f32_16x16x32_bf16 a[160:163], v[96:99], a[212:215], a[160:163]
    buffer_load_dwordx4 v[128:131], v240, s[32:35], 0 offen
    v_mfma_f32_16x16x32_bf16 a[4:7], v[100:103], a[192:195], a[4:7]
    v_perm_b32 v104, v69, v65, s60
    v_mfma_f32_16x16x32_bf16 a[36:39], v[100:103], a[196:199], a[36:39]
    v_perm_b32 v105, v77, v73, s60
    v_mfma_f32_16x16x32_bf16 a[68:71], v[100:103], a[200:203], a[68:71]
    v_perm_b32 v106, v85, v81, s60
    v_mfma_f32_16x16x32_bf16 a[100:103], v[100:103], a[204:207], a[100:103]
    v_perm_b32 v107, v93, v89, s60
    v_mfma_f32_16x16x32_bf16 a[132:135], v[100:103], a[208:211], a[132:135]
    buffer_load_dwordx4 v[132:135], v240, s[32:35], s52 offen
    v_mfma_f32_16x16x32_bf16 a[164:167], v[100:103], a[212:215], a[164:167]
    buffer_load_dwordx4 v[136:139], v240, s[32:35], s53 offen
    v_mfma_f32_16x16x32_bf16 a[8:11], v[104:107], a[192:195], a[8:11]
    v_perm_b32 v108, v69, v65, s61
    v_mfma_f32_16x16x32_bf16 a[40:43], v[104:107], a[196:199], a[40:43]
    v_perm_b32 v109, v77, v73, s61
    v_mfma_f32_16x16x32_bf16 a[72:75], v[104:107], a[200:203], a[72:75]
    v_perm_b32 v110, v85, v81, s61
    v_mfma_f32_16x16x32_bf16 a[104:107], v[104:107], a[204:207], a[104:107]
    v_perm_b32 v111, v93, v89, s61
    v_mfma_f32_16x16x32_bf16 a[136:139], v[104:107], a[208:211], a[136:139]
    buffer_load_dwordx4 v[140:143], v240, s[32:35], s54 offen
    v_mfma_f32_16x16x32_bf16 a[168:171], v[104:107], a[212:215], a[168:171]
    v_mfma_f32_16x16x32_bf16 a[12:15], v[108:111], a[192:195], a[12:15]
    v_perm_b32 v96, v70, v66, s60
    v_perm_b32 v97, v78, v74, s60
    v_mfma_f32_16x16x32_bf16 a[44:47], v[108:111], a[196:199], a[44:47]
    v_perm_b32 v98, v86, v82, s60
    v_mfma_f32_16x16x32_bf16 a[76:79], v[108:111], a[200:203], a[76:79]
    v_perm_b32 v99, v94, v90, s60
    v_mfma_f32_16x16x32_bf16 a[108:111], v[108:111], a[204:207], a[108:111]
    buffer_load_dwordx4 v[144:147], v240, s[32:35], s55 offen
    buffer_load_dwordx4 v[148:151], v240, s[32:35], s56 offen
    v_mfma_f32_16x16x32_bf16 a[140:143], v[108:111], a[208:211], a[140:143]
    ds_read_b128 a[216:219], v242 offset:12288
    v_mfma_f32_16x16x32_bf16 a[172:175], v[108:111], a[212:215], a[172:175]
    ds_read_b128 a[220:223], v242 offset:14336
    v_mfma_f32_16x16x32_bf16 a[16:19], v[96:99], a[192:195], a[16:19]
    v_perm_b32 v100, v70, v66, s61
    v_perm_b32 v101, v78, v74, s61
    v_mfma_f32_16x16x32_bf16 a[48:51], v[96:99], a[196:199], a[48:51]
    v_perm_b32 v102, v86, v82, s61
    v_mfma_f32_16x16x32_bf16 a[80:83], v[96:99], a[200:203], a[80:83]
    v_perm_b32 v103, v94, v90, s61
    v_mfma_f32_16x16x32_bf16 a[112:115], v[96:99], a[204:207], a[112:115]
    buffer_load_dwordx4 v[152:155], v240, s[32:35], s57 offen
    buffer_load_dwordx4 v[156:159], v240, s[32:35], s58 offen
    v_mfma_f32_16x16x32_bf16 a[144:147], v[96:99], a[208:211], a[144:147]
    ds_read_b128 a[224:227], v242 offset:16384
    v_mfma_f32_16x16x32_bf16 a[176:179], v[96:99], a[212:215], a[176:179]
    ds_read_b128 a[228:231], v242 offset:18432
    v_mfma_f32_16x16x32_bf16 a[20:23], v[100:103], a[192:195], a[20:23]
    v_perm_b32 v104, v71, v67, s60
    v_perm_b32 v105, v79, v75, s60
    v_mfma_f32_16x16x32_bf16 a[52:55], v[100:103], a[196:199], a[52:55]
    v_perm_b32 v106, v87, v83, s60
    v_perm_b32 v107, v95, v91, s60
    v_mfma_f32_16x16x32_bf16 a[84:87], v[100:103], a[200:203], a[84:87]
    v_add_u32 v240, s81, v240
    v_mfma_f32_16x16x32_bf16 a[116:119], v[100:103], a[204:207], a[116:119]
    v_and_b32 v240, 0x3fffff, v240
    buffer_load_dwordx4 v[160:163], v240, s[32:35], 0 offen
    v_mfma_f32_16x16x32_bf16 a[148:151], v[100:103], a[208:211], a[148:151]
    buffer_load_dwordx4 v[164:167], v240, s[32:35], s52 offen
    ds_read_b128 a[232:235], v242 offset:20480
    v_mfma_f32_16x16x32_bf16 a[180:183], v[100:103], a[212:215], a[180:183]
    ds_read_b128 a[236:239], v242 offset:22528
    v_mfma_f32_16x16x32_bf16 a[24:27], v[104:107], a[192:195], a[24:27]
    v_perm_b32 v108, v71, v67, s61
    v_mfma_f32_16x16x32_bf16 a[56:59], v[104:107], a[196:199], a[56:59]
    v_perm_b32 v109, v79, v75, s61
    v_mfma_f32_16x16x32_bf16 a[88:91], v[104:107], a[200:203], a[88:91]
    v_perm_b32 v110, v87, v83, s61
    v_mfma_f32_16x16x32_bf16 a[120:123], v[104:107], a[204:207], a[120:123]
    v_perm_b32 v111, v95, v91, s61
    v_mfma_f32_16x16x32_bf16 a[152:155], v[104:107], a[208:211], a[152:155]
    buffer_load_dwordx4 v[168:171], v240, s[32:35], s53 offen
    v_mfma_f32_16x16x32_bf16 a[184:187], v[104:107], a[212:215], a[184:187]
    v_mfma_f32_16x16x32_bf16 a[28:31], v[108:111], a[192:195], a[28:31]
    s_waitcnt vmcnt(11)
    v_perm_b32 v96, v4, v0, s60
    v_mfma_f32_16x16x32_bf16 a[60:63], v[108:111], a[196:199], a[60:63]
    v_perm_b32 v97, v12, v8, s60
    v_mfma_f32_16x16x32_bf16 a[92:95], v[108:111], a[200:203], a[92:95]
    v_perm_b32 v98, v20, v16, s60
    v_mfma_f32_16x16x32_bf16 a[124:127], v[108:111], a[204:207], a[124:127]
    v_perm_b32 v99, v28, v24, s60
    v_mfma_f32_16x16x32_bf16 a[156:159], v[108:111], a[208:211], a[156:159]
    buffer_load_dwordx4 v[172:175], v240, s[32:35], s54 offen
    v_mfma_f32_16x16x32_bf16 a[188:191], v[108:111], a[212:215], a[188:191]
    buffer_load_dwordx4 v[176:179], v240, s[32:35], s55 offen
    s_waitcnt lgkmcnt(0)
    v_mfma_f32_16x16x32_bf16 a[0:3], v[96:99], a[216:219], a[0:3]
    v_perm_b32 v100, v4, v0, s61
    v_mfma_f32_16x16x32_bf16 a[32:35], v[96:99], a[220:223], a[32:35]
    v_perm_b32 v101, v12, v8, s61
    v_mfma_f32_16x16x32_bf16 a[64:67], v[96:99], a[224:227], a[64:67]
    v_perm_b32 v102, v20, v16, s61
    v_mfma_f32_16x16x32_bf16 a[96:99], v[96:99], a[228:231], a[96:99]
    v_perm_b32 v103, v28, v24, s61
    v_mfma_f32_16x16x32_bf16 a[128:131], v[96:99], a[232:235], a[128:131]
    buffer_load_dwordx4 v[180:183], v240, s[32:35], s56 offen
    v_mfma_f32_16x16x32_bf16 a[160:163], v[96:99], a[236:239], a[160:163]
    buffer_load_dwordx4 v[184:187], v240, s[32:35], s57 offen
    v_mfma_f32_16x16x32_bf16 a[4:7], v[100:103], a[216:219], a[4:7]
    v_perm_b32 v104, v5, v1, s60
    v_perm_b32 v105, v13, v9, s60
    v_mfma_f32_16x16x32_bf16 a[36:39], v[100:103], a[220:223], a[36:39]
    v_perm_b32 v106, v21, v17, s60
    v_mfma_f32_16x16x32_bf16 a[68:71], v[100:103], a[224:227], a[68:71]
    v_perm_b32 v107, v29, v25, s60
    v_mfma_f32_16x16x32_bf16 a[100:103], v[100:103], a[228:231], a[100:103]
    buffer_load_dwordx4 v[188:191], v240, s[32:35], s58 offen
    v_add_u32 v240, s80, v240
    v_mfma_f32_16x16x32_bf16 a[132:135], v[100:103], a[232:235], a[132:135]
    v_and_b32 v240, 0x3fffff, v240
    v_mfma_f32_16x16x32_bf16 a[164:167], v[100:103], a[236:239], a[164:167]
    buffer_load_dwordx4 v[192:195], v240, s[32:35], 0 offen
    v_mfma_f32_16x16x32_bf16 a[8:11], v[104:107], a[216:219], a[8:11]
    v_perm_b32 v108, v5, v1, s61
    v_mfma_f32_16x16x32_bf16 a[40:43], v[104:107], a[220:223], a[40:43]
    v_perm_b32 v109, v13, v9, s61
    v_mfma_f32_16x16x32_bf16 a[72:75], v[104:107], a[224:227], a[72:75]
    v_perm_b32 v110, v21, v17, s61
    v_mfma_f32_16x16x32_bf16 a[104:107], v[104:107], a[228:231], a[104:107]
    v_perm_b32 v111, v29, v25, s61
    v_mfma_f32_16x16x32_bf16 a[136:139], v[104:107], a[232:235], a[136:139]
    buffer_load_dwordx4 v[196:199], v240, s[32:35], s52 offen
    v_mfma_f32_16x16x32_bf16 a[168:171], v[104:107], a[236:239], a[168:171]
    buffer_load_dwordx4 v[200:203], v240, s[32:35], s53 offen
    v_mfma_f32_16x16x32_bf16 a[12:15], v[108:111], a[216:219], a[12:15]
    v_perm_b32 v96, v6, v2, s60
    v_perm_b32 v97, v14, v10, s60
    v_mfma_f32_16x16x32_bf16 a[44:47], v[108:111], a[220:223], a[44:47]
    v_perm_b32 v98, v22, v18, s60
    v_mfma_f32_16x16x32_bf16 a[76:79], v[108:111], a[224:227], a[76:79]
    v_perm_b32 v99, v30, v26, s60
    buffer_load_dwordx4 v[204:207], v240, s[32:35], s54 offen
    v_mfma_f32_16x16x32_bf16 a[108:111], v[108:111], a[228:231], a[108:111]
    v_mfma_f32_16x16x32_bf16 a[140:143], v[108:111], a[232:235], a[140:143]
    s_barrier
    ds_read_b128 a[192:195], v241 offset:24576
    v_mfma_f32_16x16x32_bf16 a[172:175], v[108:111], a[236:239], a[172:175]
    ds_read_b128 a[196:199], v241 offset:26624
    v_mfma_f32_16x16x32_bf16 a[16:19], v[96:99], a[216:219], a[16:19]
    v_perm_b32 v100, v6, v2, s61
    v_perm_b32 v101, v14, v10, s61
    v_mfma_f32_16x16x32_bf16 a[48:51], v[96:99], a[220:223], a[48:51]
    v_perm_b32 v102, v22, v18, s61
    v_mfma_f32_16x16x32_bf16 a[80:83], v[96:99], a[224:227], a[80:83]
    v_perm_b32 v103, v30, v26, s61
    v_mfma_f32_16x16x32_bf16 a[112:115], v[96:99], a[228:231], a[112:115]
    buffer_load_dwordx4 v[208:211], v240, s[32:35], s55 offen
    buffer_load_dwordx4 v[212:215], v240, s[32:35], s56 offen
    v_mfma_f32_16x16x32_bf16 a[144:147], v[96:99], a[232:235], a[144:147]
    ds_read_b128 a[200:203], v241 offset:28672
    v_mfma_f32_16x16x32_bf16 a[176:179], v[96:99], a[236:239], a[176:179]
    ds_read_b128 a[204:207], v241 offset:30720
    v_mfma_f32_16x16x32_bf16 a[20:23], v[100:103], a[216:219], a[20:23]
    v_perm_b32 v104, v7, v3, s60
    v_perm_b32 v105, v15, v11, s60
    v_mfma_f32_16x16x32_bf16 a[52:55], v[100:103], a[220:223], a[52:55]
    v_perm_b32 v106, v23, v19, s60
    v_mfma_f32_16x16x32_bf16 a[84:87], v[100:103], a[224:227], a[84:87]
    v_perm_b32 v107, v31, v27, s60
    v_mfma_f32_16x16x32_bf16 a[116:119], v[100:103], a[228:231], a[116:119]
    buffer_load_dwordx4 v[216:219], v240, s[32:35], s57 offen
    buffer_load_dwordx4 v[220:223], v240, s[32:35], s58 offen
    v_mfma_f32_16x16x32_bf16 a[148:151], v[100:103], a[232:235], a[148:151]
    ds_read_b128 a[208:211], v241 offset:32768
    v_mfma_f32_16x16x32_bf16 a[180:183], v[100:103], a[236:239], a[180:183]
    ds_read_b128 a[212:215], v241 offset:34816
    v_mfma_f32_16x16x32_bf16 a[24:27], v[104:107], a[216:219], a[24:27]
    v_perm_b32 v108, v7, v3, s61
    v_perm_b32 v109, v15, v11, s61
    v_mfma_f32_16x16x32_bf16 a[56:59], v[104:107], a[220:223], a[56:59]
    v_perm_b32 v110, v23, v19, s61
    v_mfma_f32_16x16x32_bf16 a[88:91], v[104:107], a[224:227], a[88:91]
    v_perm_b32 v111, v31, v27, s61
    v_mfma_f32_16x16x32_bf16 a[120:123], v[104:107], a[228:231], a[120:123]
    s_add_u32 s73, s62, 0
    v_mfma_f32_16x16x32_bf16 a[152:155], v[104:107], a[232:235], a[152:155]
    s_add_u32 m0, s92, 0
    v_mfma_f32_16x16x32_bf16 a[184:187], v[104:107], a[236:239], a[184:187]
    buffer_load_dwordx4 v113, s[24:27], s73 offen nt lds
    v_mfma_f32_16x16x32_bf16 a[28:31], v[108:111], a[216:219], a[28:31]
    s_waitcnt vmcnt(17)
    v_mfma_f32_16x16x32_bf16 a[60:63], v[108:111], a[220:223], a[60:63]
    v_perm_b32 v96, v132, v128, s60
    v_mfma_f32_16x16x32_bf16 a[92:95], v[108:111], a[224:227], a[92:95]
    v_perm_b32 v97, v140, v136, s60
    v_mfma_f32_16x16x32_bf16 a[124:127], v[108:111], a[228:231], a[124:127]
    v_perm_b32 v98, v148, v144, s60
    v_mfma_f32_16x16x32_bf16 a[156:159], v[108:111], a[232:235], a[156:159]
    v_perm_b32 v99, v156, v152, s60
    v_mfma_f32_16x16x32_bf16 a[188:191], v[108:111], a[236:239], a[188:191]
    s_waitcnt lgkmcnt(0)
    v_mfma_f32_16x16x32_bf16 a[0:3], v[96:99], a[192:195], a[0:3]
    v_perm_b32 v100, v132, v128, s61
    v_perm_b32 v101, v140, v136, s61
    v_mfma_f32_16x16x32_bf16 a[32:35], v[96:99], a[196:199], a[32:35]
    v_perm_b32 v102, v148, v144, s61
    v_mfma_f32_16x16x32_bf16 a[64:67], v[96:99], a[200:203], a[64:67]
    v_perm_b32 v103, v156, v152, s61
    v_mfma_f32_16x16x32_bf16 a[96:99], v[96:99], a[204:207], a[96:99]
    s_add_u32 s73, s62, 1024
    v_mfma_f32_16x16x32_bf16 a[128:131], v[96:99], a[208:211], a[128:131]
    s_add_u32 m0, s92, 1024
    v_mfma_f32_16x16x32_bf16 a[160:163], v[96:99], a[212:215], a[160:163]
    buffer_load_dwordx4 v114, s[24:27], s73 offen nt lds
    v_mfma_f32_16x16x32_bf16 a[4:7], v[100:103], a[192:195], a[4:7]
    v_perm_b32 v104, v133, v129, s60
    v_perm_b32 v105, v141, v137, s60
    v_mfma_f32_16x16x32_bf16 a[36:39], v[100:103], a[196:199], a[36:39]
    v_perm_b32 v106, v149, v145, s60
    v_mfma_f32_16x16x32_bf16 a[68:71], v[100:103], a[200:203], a[68:71]
    v_perm_b32 v107, v157, v153, s60
    v_mfma_f32_16x16x32_bf16 a[100:103], v[100:103], a[204:207], a[100:103]
    s_add_u32 s73, s62, 2048
    v_mfma_f32_16x16x32_bf16 a[132:135], v[100:103], a[208:211], a[132:135]
    s_add_u32 m0, s92, 2048
    v_mfma_f32_16x16x32_bf16 a[164:167], v[100:103], a[212:215], a[164:167]
    buffer_load_dwordx4 v115, s[24:27], s73 offen nt lds
    v_mfma_f32_16x16x32_bf16 a[8:11], v[104:107], a[192:195], a[8:11]
    v_perm_b32 v108, v133, v129, s61
    v_perm_b32 v109, v141, v137, s61
    v_mfma_f32_16x16x32_bf16 a[40:43], v[104:107], a[196:199], a[40:43]
    v_perm_b32 v110, v149, v145, s61
    v_mfma_f32_16x16x32_bf16 a[72:75], v[104:107], a[200:203], a[72:75]
    v_perm_b32 v111, v157, v153, s61
    v_mfma_f32_16x16x32_bf16 a[104:107], v[104:107], a[204:207], a[104:107]
    s_add_u32 s73, s62, 3072
    v_mfma_f32_16x16x32_bf16 a[136:139], v[104:107], a[208:211], a[136:139]
    s_add_u32 m0, s92, 3072
    v_mfma_f32_16x16x32_bf16 a[168:171], v[104:107], a[212:215], a[168:171]
    buffer_load_dwordx4 v116, s[24:27], s73 offen nt lds
    v_mfma_f32_16x16x32_bf16 a[12:15], v[108:111], a[192:195], a[12:15]
    v_perm_b32 v96, v134, v130, s60
    v_perm_b32 v97, v142, v138, s60
    v_mfma_f32_16x16x32_bf16 a[44:47], v[108:111], a[196:199], a[44:47]
    v_perm_b32 v98, v150, v146, s60
    v_mfma_f32_16x16x32_bf16 a[76:79], v[108:111], a[200:203], a[76:79]
    v_perm_b32 v99, v158, v154, s60
    s_add_u32 s73, s62, 4096
    v_mfma_f32_16x16x32_bf16 a[108:111], v[108:111], a[204:207], a[108:111]
    s_add_u32 m0, s92, 4096
    v_mfma_f32_16x16x32_bf16 a[140:143], v[108:111], a[208:211], a[140:143]
    buffer_load_dwordx4 v113, s[24:27], s73 offen nt lds
    ds_read_b128 a[216:219], v242 offset:24576
    v_mfma_f32_16x16x32_bf16 a[172:175], v[108:111], a[212:215], a[172:175]
    ds_read_b128 a[220:223], v242 offset:26624
    v_mfma_f32_16x16x32_bf16 a[16:19], v[96:99], a[192:195], a[16:19]
    v_perm_b32 v100, v134, v130, s61
    v_perm_b32 v101, v142, v138, s61
    v_mfma_f32_16x16x32_bf16 a[48:51], v[96:99], a[196:199], a[48:51]
    v_perm_b32 v102, v150, v146, s61
    v_mfma_f32_16x16x32_bf16 a[80:83], v[96:99], a[200:203], a[80:83]
    v_perm_b32 v103, v158, v154, s61
    s_add_u32 s73, s62, 5120
    v_mfma_f32_16x16x32_bf16 a[112:115], v[96:99], a[204:207], a[112:115]
    s_add_u32 m0, s92, 5120
    v_mfma_f32_16x16x32_bf16 a[144:147], v[96:99], a[208:211], a[144:147]
    buffer_load_dwordx4 v114, s[24:27], s73 offen nt lds
    ds_read_b128 a[224:227], v242 offset:28672
    v_mfma_f32_16x16x32_bf16 a[176:179], v[96:99], a[212:215], a[176:179]
    ds_read_b128 a[228:231], v242 offset:30720
    v_mfma_f32_16x16x32_bf16 a[20:23], v[100:103], a[192:195], a[20:23]
    v_perm_b32 v104, v135, v131, s60
    v_perm_b32 v105, v143, v139, s60
    v_mfma_f32_16x16x32_bf16 a[52:55], v[100:103], a[196:199], a[52:55]
    v_perm_b32 v106, v151, v147, s60
    v_mfma_f32_16x16x32_bf16 a[84:87], v[100:103], a[200:203], a[84:87]
    v_perm_b32 v107, v159, v155, s60
    s_add_u32 s73, s62, 6144
    v_mfma_f32_16x16x32_bf16 a[116:119], v[100:103], a[204:207], a[116:119]
    s_add_u32 m0, s92, 6144
    v_mfma_f32_16x16x32_bf16 a[148:151], v[100:103], a[208:211], a[148:151]
    buffer_load_dwordx4 v115, s[24:27], s73 offen nt lds
    ds_read_b128 a[232:235], v242 offset:32768
    v_mfma_f32_16x16x32_bf16 a[180:183], v[100:103], a[212:215], a[180:183]
    ds_read_b128 a[236:239], v242 offset:34816
    v_mfma_f32_16x16x32_bf16 a[24:27], v[104:107], a[192:195], a[24:27]
    v_perm_b32 v108, v135, v131, s61
    v_mfma_f32_16x16x32_bf16 a[56:59], v[104:107], a[196:199], a[56:59]
    v_perm_b32 v109, v143, v139, s61
    v_mfma_f32_16x16x32_bf16 a[88:91], v[104:107], a[200:203], a[88:91]
    v_mfma_f32_16x16x32_bf16 a[120:123], v[104:107], a[204:207], a[120:123]
    v_perm_b32 v110, v151, v147, s61
    v_mfma_f32_16x16x32_bf16 a[152:155], v[104:107], a[208:211], a[152:155]
    v_perm_b32 v111, v159, v155, s61
    v_mfma_f32_16x16x32_bf16 a[184:187], v[104:107], a[212:215], a[184:187]
    s_nop 0
    v_mfma_f32_16x16x32_bf16 a[28:31], v[108:111], a[192:195], a[28:31]
    s_waitcnt vmcnt(15)
    v_perm_b32 v96, v164, v160, s60
    v_perm_b32 v97, v172, v168, s60
    v_mfma_f32_16x16x32_bf16 a[60:63], v[108:111], a[196:199], a[60:63]
    v_perm_b32 v98, v180, v176, s60
    v_perm_b32 v99, v188, v184, s60
    v_mfma_f32_16x16x32_bf16 a[92:95], v[108:111], a[200:203], a[92:95]
    s_add_u32 s73, s62, 7168
    s_add_u32 m0, s92, 7168
    v_mfma_f32_16x16x32_bf16 a[124:127], v[108:111], a[204:207], a[124:127]
    buffer_load_dwordx4 v116, s[24:27], s73 offen nt lds
    s_add_u32 s72, s82, 512
    v_mfma_f32_16x16x32_bf16 a[156:159], v[108:111], a[208:211], a[156:159]
    s_and_b32 s72, s72, 0x3ff
    s_add_u32 s72, s72, s86
    v_mfma_f32_16x16x32_bf16 a[188:191], v[108:111], a[212:215], a[188:191]
    s_add_u32 m0, s89, 49152
    s_nop 0
    buffer_load_dwordx4 v251, s[20:23], s72 offen lds
    s_waitcnt lgkmcnt(0)
    v_mfma_f32_16x16x32_bf16 a[0:3], v[96:99], a[216:219], a[0:3]
    v_perm_b32 v100, v164, v160, s61
    v_perm_b32 v101, v172, v168, s61
    v_mfma_f32_16x16x32_bf16 a[32:35], v[96:99], a[220:223], a[32:35]
    v_perm_b32 v102, v180, v176, s61
    v_mfma_f32_16x16x32_bf16 a[64:67], v[96:99], a[224:227], a[64:67]
    v_perm_b32 v103, v188, v184, s61
    s_add_u32 s72, s82, 512
    v_mfma_f32_16x16x32_bf16 a[96:99], v[96:99], a[228:231], a[96:99]
    s_and_b32 s72, s72, 0x3ff
    v_mfma_f32_16x16x32_bf16 a[128:131], v[96:99], a[232:235], a[128:131]
    s_add_u32 s72, s72, s87
    s_add_u32 m0, s90, 49152
    v_mfma_f32_16x16x32_bf16 a[160:163], v[96:99], a[236:239], a[160:163]
    buffer_load_dwordx4 v252, s[20:23], s72 offen lds
    v_mfma_f32_16x16x32_bf16 a[4:7], v[100:103], a[216:219], a[4:7]
    v_perm_b32 v104, v165, v161, s60
    v_perm_b32 v105, v173, v169, s60
    v_perm_b32 v106, v181, v177, s60
    v_mfma_f32_16x16x32_bf16 a[36:39], v[100:103], a[220:223], a[36:39]
    v_perm_b32 v107, v189, v185, s60
    s_add_u32 s72, s82, 512
    v_mfma_f32_16x16x32_bf16 a[68:71], v[100:103], a[224:227], a[68:71]
    s_and_b32 s72, s72, 0x3ff
    s_add_u32 s72, s72, s88
    v_mfma_f32_16x16x32_bf16 a[100:103], v[100:103], a[228:231], a[100:103]
    s_add_u32 m0, s91, 49152
    s_nop 0
    buffer_load_dwordx4 v253, s[20:23], s72 offen lds
    s_add_u32 s72, s82, 640
    v_mfma_f32_16x16x32_bf16 a[132:135], v[100:103], a[232:235], a[132:135]
    s_and_b32 s72, s72, 0x3ff
    s_add_u32 s72, s72, s86
    v_mfma_f32_16x16x32_bf16 a[164:167], v[100:103], a[236:239], a[164:167]
    s_add_u32 m0, s89, 61440
    s_nop 0
    buffer_load_dwordx4 v251, s[20:23], s72 offen lds
    v_mfma_f32_16x16x32_bf16 a[8:11], v[104:107], a[216:219], a[8:11]
    v_perm_b32 v108, v165, v161, s61
    v_perm_b32 v109, v173, v169, s61
    v_perm_b32 v110, v181, v177, s61
    v_mfma_f32_16x16x32_bf16 a[40:43], v[104:107], a[220:223], a[40:43]
    v_perm_b32 v111, v189, v185, s61
    s_add_u32 s72, s82, 640
    v_mfma_f32_16x16x32_bf16 a[72:75], v[104:107], a[224:227], a[72:75]
    s_and_b32 s72, s72, 0x3ff
    s_add_u32 s72, s72, s87
    v_mfma_f32_16x16x32_bf16 a[104:107], v[104:107], a[228:231], a[104:107]
    s_add_u32 m0, s90, 61440
    s_nop 0
    buffer_load_dwordx4 v252, s[20:23], s72 offen lds
    s_add_u32 s72, s82, 640
    v_mfma_f32_16x16x32_bf16 a[136:139], v[104:107], a[232:235], a[136:139]
    s_and_b32 s72, s72, 0x3ff
    s_add_u32 s72, s72, s88
    v_mfma_f32_16x16x32_bf16 a[168:171], v[104:107], a[236:239], a[168:171]
    s_add_u32 m0, s91, 61440
    s_nop 0
    buffer_load_dwordx4 v253, s[20:23], s72 offen lds
    v_mfma_f32_16x16x32_bf16 a[12:15], v[108:111], a[216:219], a[12:15]
    v_perm_b32 v96, v166, v162, s60
    v_perm_b32 v97, v174, v170, s60
    v_mfma_f32_16x16x32_bf16 a[44:47], v[108:111], a[220:223], a[44:47]
    v_perm_b32 v98, v182, v178, s60
    v_perm_b32 v99, v190, v186, s60
    v_mfma_f32_16x16x32_bf16 a[76:79], v[108:111], a[224:227], a[76:79]
    v_add_u32 v240, s81, v240
    v_mfma_f32_16x16x32_bf16 a[108:111], v[108:111], a[228:231], a[108:111]
    v_and_b32 v240, 0x3fffff, v240
    buffer_load_dwordx4 v[32:35], v240, s[32:35], 0 offen
    v_mfma_f32_16x16x32_bf16 a[140:143], v[108:111], a[232:235], a[140:143]
    buffer_load_dwordx4 v[36:39], v240, s[32:35], s52 offen
    ds_read_b128 a[192:195], v241 offset:36864
    v_mfma_f32_16x16x32_bf16 a[172:175], v[108:111], a[236:239], a[172:175]
    ds_read_b128 a[196:199], v241 offset:38912
    v_mfma_f32_16x16x32_bf16 a[16:19], v[96:99], a[216:219], a[16:19]
    v_perm_b32 v100, v166, v162, s61
    v_perm_b32 v101, v174, v170, s61
    v_mfma_f32_16x16x32_bf16 a[48:51], v[96:99], a[220:223], a[48:51]
    v_perm_b32 v102, v182, v178, s61
    v_mfma_f32_16x16x32_bf16 a[80:83], v[96:99], a[224:227], a[80:83]
    v_perm_b32 v103, v190, v186, s61
    v_mfma_f32_16x16x32_bf16 a[112:115], v[96:99], a[228:231], a[112:115]
    buffer_load_dwordx4 v[40:43], v240, s[32:35], s53 offen
    v_mfma_f32_16x16x32_bf16 a[144:147], v[96:99], a[232:235], a[144:147]
    ds_read_b128 a[200:203], v241 offset:40960
    v_mfma_f32_16x16x32_bf16 a[176:179], v[96:99], a[236:239], a[176:179]
    ds_read_b128 a[204:207], v241 offset:43008
    v_mfma_f32_16x16x32_bf16 a[20:23], v[100:103], a[216:219], a[20:23]
    v_perm_b32 v104, v167, v163, s60
    v_perm_b32 v105, v175, v171, s60
    v_mfma_f32_16x16x32_bf16 a[52:55], v[100:103], a[220:223], a[52:55]
    v_perm_b32 v106, v183, v179, s60
    v_mfma_f32_16x16x32_bf16 a[84:87], v[100:103], a[224:227], a[84:87]
    v_perm_b32 v107, v191, v187, s60
    v_mfma_f32_16x16x32_bf16 a[116:119], v[100:103], a[228:231], a[116:119]
    buffer_load_dwordx4 v[44:47], v240, s[32:35], s54 offen
    buffer_load_dwordx4 v[48:51], v240, s[32:35], s55 offen
    v_mfma_f32_16x16x32_bf16 a[148:151], v[100:103], a[232:235], a[148:151]
    ds_read_b128 a[208:211], v241 offset:45056
    v_mfma_f32_16x16x32_bf16 a[180:183], v[100:103], a[236:239], a[180:183]
    ds_read_b128 a[212:215], v241 offset:47104
    v_mfma_f32_16x16x32_bf16 a[24:27], v[104:107], a[216:219], a[24:27]
    v_perm_b32 v108, v167, v163, s61
    v_mfma_f32_16x16x32_bf16 a[56:59], v[104:107], a[220:223], a[56:59]
    v_perm_b32 v109, v175, v171, s61
    v_mfma_f32_16x16x32_bf16 a[88:91], v[104:107], a[224:227], a[88:91]
    v_perm_b32 v110, v183, v179, s61
    v_mfma_f32_16x16x32_bf16 a[120:123], v[104:107], a[228:231], a[120:123]
    v_perm_b32 v111, v191, v187, s61
    v_mfma_f32_16x16x32_bf16 a[152:155], v[104:107], a[232:235], a[152:155]
    buffer_load_dwordx4 v[52:55], v240, s[32:35], s56 offen
    v_mfma_f32_16x16x32_bf16 a[184:187], v[104:107], a[236:239], a[184:187]
    buffer_load_dwordx4 v[56:59], v240, s[32:35], s57 offen
    v_mfma_f32_16x16x32_bf16 a[28:31], v[108:111], a[216:219], a[28:31]
    s_waitcnt vmcnt(21)
    v_perm_b32 v96, v196, v192, s60
    v_mfma_f32_16x16x32_bf16 a[60:63], v[108:111], a[220:223], a[60:63]
    v_perm_b32 v97, v204, v200, s60
    v_mfma_f32_16x16x32_bf16 a[92:95], v[108:111], a[224:227], a[92:95]
    v_perm_b32 v98, v212, v208, s60
    v_perm_b32 v99, v220, v216, s60
    v_mfma_f32_16x16x32_bf16 a[124:127], v[108:111], a[228:231], a[124:127]
    buffer_load_dwordx4 v[60:63], v240, s[32:35], s58 offen
    v_mfma_f32_16x16x32_bf16 a[156:159], v[108:111], a[232:235], a[156:159]
    v_add_u32 v240, s80, v240
    v_and_b32 v240, 0x3fffff, v240
    v_mfma_f32_16x16x32_bf16 a[188:191], v[108:111], a[236:239], a[188:191]
    buffer_load_dwordx4 v[64:67], v240, s[32:35], 0 offen
    s_waitcnt lgkmcnt(0)
    v_mfma_f32_16x16x32_bf16 a[0:3], v[96:99], a[192:195], a[0:3]
    v_perm_b32 v100, v196, v192, s61
    v_mfma_f32_16x16x32_bf16 a[32:35], v[96:99], a[196:199], a[32:35]
    v_perm_b32 v101, v204, v200, s61
    v_mfma_f32_16x16x32_bf16 a[64:67], v[96:99], a[200:203], a[64:67]
    v_perm_b32 v102, v212, v208, s61
    v_mfma_f32_16x16x32_bf16 a[96:99], v[96:99], a[204:207], a[96:99]
    v_perm_b32 v103, v220, v216, s61
    v_mfma_f32_16x16x32_bf16 a[128:131], v[96:99], a[208:211], a[128:131]
    buffer_load_dwordx4 v[68:71], v240, s[32:35], s52 offen
    v_mfma_f32_16x16x32_bf16 a[160:163], v[96:99], a[212:215], a[160:163]
    v_mfma_f32_16x16x32_bf16 a[4:7], v[100:103], a[192:195], a[4:7]
    v_perm_b32 v104, v197, v193, s60
    v_mfma_f32_16x16x32_bf16 a[36:39], v[100:103], a[196:199], a[36:39]
    v_perm_b32 v105, v205, v201, s60
    v_mfma_f32_16x16x32_bf16 a[68:71], v[100:103], a[200:203], a[68:71]
    v_perm_b32 v106, v213, v209, s60
    v_mfma_f32_16x16x32_bf16 a[100:103], v[100:103], a[204:207], a[100:103]
    v_perm_b32 v107, v221, v217, s60
    v_mfma_f32_16x16x32_bf16 a[132:135], v[100:103], a[208:211], a[132:135]
    buffer_load_dwordx4 v[72:75], v240, s[32:35], s53 offen
    v_mfma_f32_16x16x32_bf16 a[164:167], v[100:103], a[212:215], a[164:167]
    buffer_load_dwordx4 v[76:79], v240, s[32:35], s54 offen
    v_mfma_f32_16x16x32_bf16 a[8:11], v[104:107], a[192:195], a[8:11]
    v_perm_b32 v108, v197, v193, s61
    v_mfma_f32_16x16x32_bf16 a[40:43], v[104:107], a[196:199], a[40:43]
    v_perm_b32 v109, v205, v201, s61
    v_mfma_f32_16x16x32_bf16 a[72:75], v[104:107], a[200:203], a[72:75]
    v_perm_b32 v110, v213, v209, s61
    v_mfma_f32_16x16x32_bf16 a[104:107], v[104:107], a[204:207], a[104:107]
    v_perm_b32 v111, v221, v217, s61
    v_mfma_f32_16x16x32_bf16 a[136:139], v[104:107], a[208:211], a[136:139]
    buffer_load_dwordx4 v[80:83], v240, s[32:35], s55 offen
    v_mfma_f32_16x16x32_bf16 a[168:171], v[104:107], a[212:215], a[168:171]
    buffer_load_dwordx4 v[84:87], v240, s[32:35], s56 offen
    v_mfma_f32_16x16x32_bf16 a[12:15], v[108:111], a[192:195], a[12:15]
    v_perm_b32 v96, v198, v194, s60
    v_perm_b32 v97, v206, v202, s60
    v_mfma_f32_16x16x32_bf16 a[44:47], v[108:111], a[196:199], a[44:47]
    v_perm_b32 v98, v214, v210, s60
    v_mfma_f32_16x16x32_bf16 a[76:79], v[108:111], a[200:203], a[76:79]
    v_perm_b32 v99, v222, v218, s60
    v_mfma_f32_16x16x32_bf16 a[108:111], v[108:111], a[204:207], a[108:111]
    buffer_load_dwordx4 v[88:91], v240, s[32:35], s57 offen
    buffer_load_dwordx4 v[92:95], v240, s[32:35], s58 offen
    v_mfma_f32_16x16x32_bf16 a[140:143], v[108:111], a[208:211], a[140:143]
    ds_read_b128 a[216:219], v242 offset:36864
    v_mfma_f32_16x16x32_bf16 a[172:175], v[108:111], a[212:215], a[172:175]
    ds_read_b128 a[220:223], v242 offset:38912
    v_mfma_f32_16x16x32_bf16 a[16:19], v[96:99], a[192:195], a[16:19]
    v_perm_b32 v100, v198, v194, s61
    v_perm_b32 v101, v206, v202, s61
    v_mfma_f32_16x16x32_bf16 a[48:51], v[96:99], a[196:199], a[48:51]
    v_perm_b32 v102, v214, v210, s61
    v_mfma_f32_16x16x32_bf16 a[80:83], v[96:99], a[200:203], a[80:83]
    v_perm_b32 v103, v222, v218, s61
    v_add_u32 v240, s81, v240
    v_mfma_f32_16x16x32_bf16 a[112:115], v[96:99], a[204:207], a[112:115]
    v_and_b32 v240, 0x3fffff, v240
    v_mfma_f32_16x16x32_bf16 a[144:147], v[96:99], a[208:211], a[144:147]
    buffer_load_dwordx4 v[0:3], v240, s[32:35], 0 offen
    ds_read_b128 a[224:227], v242 offset:40960
    v_mfma_f32_16x16x32_bf16 a[176:179], v[96:99], a[212:215], a[176:179]
    ds_read_b128 a[228:231], v242 offset:43008
    v_mfma_f32_16x16x32_bf16 a[20:23], v[100:103], a[192:195], a[20:23]
    v_perm_b32 v104, v199, v195, s60
    v_perm_b32 v105, v207, v203, s60
    v_mfma_f32_16x16x32_bf16 a[52:55], v[100:103], a[196:199], a[52:55]
    v_perm_b32 v106, v215, v211, s60
    v_mfma_f32_16x16x32_bf16 a[84:87], v[100:103], a[200:203], a[84:87]
    v_perm_b32 v107, v223, v219, s60
    v_mfma_f32_16x16x32_bf16 a[116:119], v[100:103], a[204:207], a[116:119]
    buffer_load_dwordx4 v[4:7], v240, s[32:35], s52 offen
    buffer_load_dwordx4 v[8:11], v240, s[32:35], s53 offen
    v_mfma_f32_16x16x32_bf16 a[148:151], v[100:103], a[208:211], a[148:151]
    ds_read_b128 a[232:235], v242 offset:45056
    v_mfma_f32_16x16x32_bf16 a[180:183], v[100:103], a[212:215], a[180:183]
    ds_read_b128 a[236:239], v242 offset:47104
    v_mfma_f32_16x16x32_bf16 a[24:27], v[104:107], a[192:195], a[24:27]
    v_perm_b32 v108, v199, v195, s61
    v_mfma_f32_16x16x32_bf16 a[56:59], v[104:107], a[196:199], a[56:59]
    v_perm_b32 v109, v207, v203, s61
    v_mfma_f32_16x16x32_bf16 a[88:91], v[104:107], a[200:203], a[88:91]
    v_perm_b32 v110, v215, v211, s61
    v_mfma_f32_16x16x32_bf16 a[120:123], v[104:107], a[204:207], a[120:123]
    v_perm_b32 v111, v223, v219, s61
    v_mfma_f32_16x16x32_bf16 a[152:155], v[104:107], a[208:211], a[152:155]
    buffer_load_dwordx4 v[12:15], v240, s[32:35], s54 offen
    v_mfma_f32_16x16x32_bf16 a[184:187], v[104:107], a[212:215], a[184:187]
    buffer_load_dwordx4 v[16:19], v240, s[32:35], s55 offen
    v_mfma_f32_16x16x32_bf16 a[28:31], v[108:111], a[192:195], a[28:31]
    s_waitcnt vmcnt(13)
    v_perm_b32 v96, v36, v32, s60
    v_mfma_f32_16x16x32_bf16 a[60:63], v[108:111], a[196:199], a[60:63]
    v_perm_b32 v97, v44, v40, s60
    v_mfma_f32_16x16x32_bf16 a[92:95], v[108:111], a[200:203], a[92:95]
    v_perm_b32 v98, v52, v48, s60
    v_mfma_f32_16x16x32_bf16 a[124:127], v[108:111], a[204:207], a[124:127]
    v_perm_b32 v99, v60, v56, s60
    v_mfma_f32_16x16x32_bf16 a[156:159], v[108:111], a[208:211], a[156:159]
    buffer_load_dwordx4 v[20:23], v240, s[32:35], s56 offen
    v_mfma_f32_16x16x32_bf16 a[188:191], v[108:111], a[212:215], a[188:191]
    buffer_load_dwordx4 v[24:27], v240, s[32:35], s57 offen
    s_waitcnt lgkmcnt(0)
    v_mfma_f32_16x16x32_bf16 a[0:3], v[96:99], a[216:219], a[0:3]
    v_perm_b32 v100, v36, v32, s61
    v_mfma_f32_16x16x32_bf16 a[32:35], v[96:99], a[220:223], a[32:35]
    v_perm_b32 v101, v44, v40, s61
    v_mfma_f32_16x16x32_bf16 a[64:67], v[96:99], a[224:227], a[64:67]
    v_perm_b32 v102, v52, v48, s61
    v_mfma_f32_16x16x32_bf16 a[96:99], v[96:99], a[228:231], a[96:99]
    v_perm_b32 v103, v60, v56, s61
    v_mfma_f32_16x16x32_bf16 a[128:131], v[96:99], a[232:235], a[128:131]
    buffer_load_dwordx4 v[28:31], v240, s[32:35], s58 offen
    v_mfma_f32_16x16x32_bf16 a[160:163], v[96:99], a[236:239], a[160:163]
    v_mfma_f32_16x16x32_bf16 a[4:7], v[100:103], a[216:219], a[4:7]
    v_perm_b32 v104, v37, v33, s60
    v_perm_b32 v105, v45, v41, s60
    v_mfma_f32_16x16x32_bf16 a[36:39], v[100:103], a[220:223], a[36:39]
    v_perm_b32 v106, v53, v49, s60
    v_mfma_f32_16x16x32_bf16 a[68:71], v[100:103], a[224:227], a[68:71]
    v_perm_b32 v107, v61, v57, s60
    v_mfma_f32_16x16x32_bf16 a[100:103], v[100:103], a[228:231], a[100:103]
    v_add_u32 v240, s80, v240
    v_and_b32 v240, 0x3fffff, v240
    v_mfma_f32_16x16x32_bf16 a[132:135], v[100:103], a[232:235], a[132:135]
    buffer_load_dwordx4 v[128:131], v240, s[32:35], 0 offen
    v_mfma_f32_16x16x32_bf16 a[164:167], v[100:103], a[236:239], a[164:167]
    buffer_load_dwordx4 v[132:135], v240, s[32:35], s52 offen
    v_mfma_f32_16x16x32_bf16 a[8:11], v[104:107], a[216:219], a[8:11]
    v_perm_b32 v108, v37, v33, s61
    v_mfma_f32_16x16x32_bf16 a[40:43], v[104:107], a[220:223], a[40:43]
    v_perm_b32 v109, v45, v41, s61
    v_mfma_f32_16x16x32_bf16 a[72:75], v[104:107], a[224:227], a[72:75]
    v_perm_b32 v110, v53, v49, s61
    v_mfma_f32_16x16x32_bf16 a[104:107], v[104:107], a[228:231], a[104:107]
    v_perm_b32 v111, v61, v57, s61
    v_mfma_f32_16x16x32_bf16 a[136:139], v[104:107], a[232:235], a[136:139]
    buffer_load_dwordx4 v[136:139], v240, s[32:35], s53 offen
    v_mfma_f32_16x16x32_bf16 a[168:171], v[104:107], a[236:239], a[168:171]
    buffer_load_dwordx4 v[140:143], v240, s[32:35], s54 offen
    v_mfma_f32_16x16x32_bf16 a[12:15], v[108:111], a[216:219], a[12:15]
    v_perm_b32 v96, v38, v34, s60
    v_perm_b32 v97, v46, v42, s60
    v_mfma_f32_16x16x32_bf16 a[44:47], v[108:111], a[220:223], a[44:47]
    v_perm_b32 v98, v54, v50, s60
    v_perm_b32 v99, v62, v58, s60
    v_mfma_f32_16x16x32_bf16 a[76:79], v[108:111], a[224:227], a[76:79]
    buffer_load_dwordx4 v[144:147], v240, s[32:35], s55 offen
    v_mfma_f32_16x16x32_bf16 a[108:111], v[108:111], a[228:231], a[108:111]
    buffer_load_dwordx4 v[148:151], v240, s[32:35], s56 offen
    v_mfma_f32_16x16x32_bf16 a[140:143], v[108:111], a[232:235], a[140:143]
    s_barrier
    ds_read_b128 a[192:195], v243 offset:0
    v_mfma_f32_16x16x32_bf16 a[172:175], v[108:111], a[236:239], a[172:175]
    ds_read_b128 a[196:199], v243 offset:2048
    v_mfma_f32_16x16x32_bf16 a[16:19], v[96:99], a[216:219], a[16:19]
    v_perm_b32 v100, v38, v34, s61
    v_perm_b32 v101, v46, v42, s61
    v_mfma_f32_16x16x32_bf16 a[48:51], v[96:99], a[220:223], a[48:51]
    v_perm_b32 v102, v54, v50, s61
    v_mfma_f32_16x16x32_bf16 a[80:83], v[96:99], a[224:227], a[80:83]
    v_perm_b32 v103, v62, v58, s61
    v_mfma_f32_16x16x32_bf16 a[112:115], v[96:99], a[228:231], a[112:115]
    buffer_load_dwordx4 v[152:155], v240, s[32:35], s57 offen
    v_mfma_f32_16x16x32_bf16 a[144:147], v[96:99], a[232:235], a[144:147]
    ds_read_b128 a[200:203], v243 offset:4096
    v_mfma_f32_16x16x32_bf16 a[176:179], v[96:99], a[236:239], a[176:179]
    ds_read_b128 a[204:207], v243 offset:6144
    v_mfma_f32_16x16x32_bf16 a[20:23], v[100:103], a[216:219], a[20:23]
    v_perm_b32 v104, v39, v35, s60
    v_perm_b32 v105, v47, v43, s60
    v_mfma_f32_16x16x32_bf16 a[52:55], v[100:103], a[220:223], a[52:55]
    v_perm_b32 v106, v55, v51, s60
    v_mfma_f32_16x16x32_bf16 a[84:87], v[100:103], a[224:227], a[84:87]
    v_perm_b32 v107, v63, v59, s60
    v_mfma_f32_16x16x32_bf16 a[116:119], v[100:103], a[228:231], a[116:119]
    buffer_load_dwordx4 v[156:159], v240, s[32:35], s58 offen
    v_mfma_f32_16x16x32_bf16 a[148:151], v[100:103], a[232:235], a[148:151]
    ds_read_b128 a[208:211], v243 offset:8192
    v_mfma_f32_16x16x32_bf16 a[180:183], v[100:103], a[236:239], a[180:183]
    ds_read_b128 a[212:215], v243 offset:10240
    v_mfma_f32_16x16x32_bf16 a[24:27], v[104:107], a[216:219], a[24:27]
    v_perm_b32 v108, v39, v35, s61
    v_perm_b32 v109, v47, v43, s61
    v_mfma_f32_16x16x32_bf16 a[56:59], v[104:107], a[220:223], a[56:59]
    v_perm_b32 v110, v55, v51, s61
    v_mfma_f32_16x16x32_bf16 a[88:91], v[104:107], a[224:227], a[88:91]
    v_perm_b32 v111, v63, v59, s61
    v_mfma_f32_16x16x32_bf16 a[120:123], v[104:107], a[228:231], a[120:123]
    s_add_u32 s73, s62, 8192
    v_mfma_f32_16x16x32_bf16 a[152:155], v[104:107], a[232:235], a[152:155]
    s_add_u32 m0, s92, 8192
    v_mfma_f32_16x16x32_bf16 a[184:187], v[104:107], a[236:239], a[184:187]
    buffer_load_dwordx4 v113, s[24:27], s73 offen nt lds
    v_mfma_f32_16x16x32_bf16 a[28:31], v[108:111], a[216:219], a[28:31]
    s_waitcnt vmcnt(17)
    v_perm_b32 v96, v68, v64, s60
    v_mfma_f32_16x16x32_bf16 a[60:63], v[108:111], a[220:223], a[60:63]
    v_perm_b32 v97, v76, v72, s60
    v_mfma_f32_16x16x32_bf16 a[92:95], v[108:111], a[224:227], a[92:95]
    v_perm_b32 v98, v84, v80, s60
    v_mfma_f32_16x16x32_bf16 a[124:127], v[108:111], a[228:231], a[124:127]
    v_perm_b32 v99, v92, v88, s60
    s_add_u32 s73, s62, 9216
    v_mfma_f32_16x16x32_bf16 a[156:159], v[108:111], a[232:235], a[156:159]
    s_add_u32 m0, s92, 9216
    v_mfma_f32_16x16x32_bf16 a[188:191], v[108:111], a[236:239], a[188:191]
    buffer_load_dwordx4 v114, s[24:27], s73 offen nt lds
    s_waitcnt lgkmcnt(0)
    v_mfma_f32_16x16x32_bf16 a[0:3], v[96:99], a[192:195], a[0:3]
    v_perm_b32 v100, v68, v64, s61
    v_perm_b32 v101, v76, v72, s61
    v_mfma_f32_16x16x32_bf16 a[32:35], v[96:99], a[196:199], a[32:35]
    v_perm_b32 v102, v84, v80, s61
    v_mfma_f32_16x16x32_bf16 a[64:67], v[96:99], a[200:203], a[64:67]
    v_perm_b32 v103, v92, v88, s61
    v_mfma_f32_16x16x32_bf16 a[96:99], v[96:99], a[204:207], a[96:99]
    s_add_u32 s73, s62, 10240
    v_mfma_f32_16x16x32_bf16 a[128:131], v[96:99], a[208:211], a[128:131]
    s_add_u32 m0, s92, 10240
    v_mfma_f32_16x16x32_bf16 a[160:163], v[96:99], a[212:215], a[160:163]
    buffer_load_dwordx4 v115, s[24:27], s73 offen nt lds
    v_mfma_f32_16x16x32_bf16 a[4:7], v[100:103], a[192:195], a[4:7]
    v_perm_b32 v104, v69, v65, s60
    v_perm_b32 v105, v77, v73, s60
    v_mfma_f32_16x16x32_bf16 a[36:39], v[100:103], a[196:199], a[36:39]
    v_perm_b32 v106, v85, v81, s60
    v_mfma_f32_16x16x32_bf16 a[68:71], v[100:103], a[200:203], a[68:71]
    v_perm_b32 v107, v93, v89, s60
    v_mfma_f32_16x16x32_bf16 a[100:103], v[100:103], a[204:207], a[100:103]
    s_add_u32 s73, s62, 11264
    v_mfma_f32_16x16x32_bf16 a[132:135], v[100:103], a[208:211], a[132:135]
    s_add_u32 m0, s92, 11264
    v_mfma_f32_16x16x32_bf16 a[164:167], v[100:103], a[212:215], a[164:167]
    buffer_load_dwordx4 v116, s[24:27], s73 offen nt lds
    v_mfma_f32_16x16x32_bf16 a[8:11], v[104:107], a[192:195], a[8:11]
    v_perm_b32 v108, v69, v65, s61
    v_perm_b32 v109, v77, v73, s61
    v_mfma_f32_16x16x32_bf16 a[40:43], v[104:107], a[196:199], a[40:43]
    v_perm_b32 v110, v85, v81, s61
    v_mfma_f32_16x16x32_bf16 a[72:75], v[104:107], a[200:203], a[72:75]
    v_perm_b32 v111, v93, v89, s61
    v_mfma_f32_16x16x32_bf16 a[104:107], v[104:107], a[204:207], a[104:107]
    s_add_u32 s73, s62, 12288
    v_mfma_f32_16x16x32_bf16 a[136:139], v[104:107], a[208:211], a[136:139]
    s_add_u32 m0, s92, 12288
    v_mfma_f32_16x16x32_bf16 a[168:171], v[104:107], a[212:215], a[168:171]
    buffer_load_dwordx4 v113, s[24:27], s73 offen nt lds
    v_mfma_f32_16x16x32_bf16 a[12:15], v[108:111], a[192:195], a[12:15]
    v_perm_b32 v96, v70, v66, s60
    v_perm_b32 v97, v78, v74, s60
    v_mfma_f32_16x16x32_bf16 a[44:47], v[108:111], a[196:199], a[44:47]
    v_perm_b32 v98, v86, v82, s60
    v_mfma_f32_16x16x32_bf16 a[76:79], v[108:111], a[200:203], a[76:79]
    v_perm_b32 v99, v94, v90, s60
    s_add_u32 s73, s62, 13312
    v_mfma_f32_16x16x32_bf16 a[108:111], v[108:111], a[204:207], a[108:111]
    s_add_u32 m0, s92, 13312
    v_mfma_f32_16x16x32_bf16 a[140:143], v[108:111], a[208:211], a[140:143]
    buffer_load_dwordx4 v114, s[24:27], s73 offen nt lds
    ds_read_b128 a[216:219], v244 offset:0
    v_mfma_f32_16x16x32_bf16 a[172:175], v[108:111], a[212:215], a[172:175]
    ds_read_b128 a[220:223], v244 offset:2048
    v_mfma_f32_16x16x32_bf16 a[16:19], v[96:99], a[192:195], a[16:19]
    v_perm_b32 v100, v70, v66, s61
    v_mfma_f32_16x16x32_bf16 a[48:51], v[96:99], a[196:199], a[48:51]
    v_perm_b32 v101, v78, v74, s61
    v_mfma_f32_16x16x32_bf16 a[80:83], v[96:99], a[200:203], a[80:83]
    v_perm_b32 v102, v86, v82, s61
    v_mfma_f32_16x16x32_bf16 a[112:115], v[96:99], a[204:207], a[112:115]
    v_perm_b32 v103, v94, v90, s61
    v_mfma_f32_16x16x32_bf16 a[144:147], v[96:99], a[208:211], a[144:147]
    ds_read_b128 a[224:227], v244 offset:4096
    v_mfma_f32_16x16x32_bf16 a[176:179], v[96:99], a[212:215], a[176:179]
    ds_read_b128 a[228:231], v244 offset:6144
    v_mfma_f32_16x16x32_bf16 a[20:23], v[100:103], a[192:195], a[20:23]
    v_perm_b32 v104, v71, v67, s60
    v_perm_b32 v105, v79, v75, s60
    v_mfma_f32_16x16x32_bf16 a[52:55], v[100:103], a[196:199], a[52:55]
    v_perm_b32 v106, v87, v83, s60
    v_mfma_f32_16x16x32_bf16 a[84:87], v[100:103], a[200:203], a[84:87]
    v_perm_b32 v107, v95, v91, s60
    s_add_u32 s73, s62, 14336
    v_mfma_f32_16x16x32_bf16 a[116:119], v[100:103], a[204:207], a[116:119]
    s_add_u32 m0, s92, 14336
    v_mfma_f32_16x16x32_bf16 a[148:151], v[100:103], a[208:211], a[148:151]
    buffer_load_dwordx4 v115, s[24:27], s73 offen nt lds
    ds_read_b128 a[232:235], v244 offset:8192
    v_mfma_f32_16x16x32_bf16 a[180:183], v[100:103], a[212:215], a[180:183]
    ds_read_b128 a[236:239], v244 offset:10240
    v_mfma_f32_16x16x32_bf16 a[24:27], v[104:107], a[192:195], a[24:27]
    v_perm_b32 v108, v71, v67, s61
    v_perm_b32 v109, v79, v75, s61
    v_mfma_f32_16x16x32_bf16 a[56:59], v[104:107], a[196:199], a[56:59]
    v_perm_b32 v110, v87, v83, s61
    v_mfma_f32_16x16x32_bf16 a[88:91], v[104:107], a[200:203], a[88:91]
    v_perm_b32 v111, v95, v91, s61
    v_mfma_f32_16x16x32_bf16 a[120:123], v[104:107], a[204:207], a[120:123]
    s_add_u32 s73, s62, 15360
    v_mfma_f32_16x16x32_bf16 a[152:155], v[104:107], a[208:211], a[152:155]
    s_add_u32 m0, s92, 15360
    v_mfma_f32_16x16x32_bf16 a[184:187], v[104:107], a[212:215], a[184:187]
    buffer_load_dwordx4 v116, s[24:27], s73 offen nt lds
    v_mfma_f32_16x16x32_bf16 a[28:31], v[108:111], a[192:195], a[28:31]
    s_waitcnt vmcnt(16)
    v_perm_b32 v96, v4, v0, s60
    v_perm_b32 v97, v12, v8, s60
    v_mfma_f32_16x16x32_bf16 a[60:63], v[108:111], a[196:199], a[60:63]
    v_perm_b32 v98, v20, v16, s60
    v_perm_b32 v99, v28, v24, s60
    v_mfma_f32_16x16x32_bf16 a[92:95], v[108:111], a[200:203], a[92:95]
    s_add_u32 s72, s82, 768
    s_and_b32 s72, s72, 0x3ff
    s_add_u32 s72, s72, s86
    v_mfma_f32_16x16x32_bf16 a[124:127], v[108:111], a[204:207], a[124:127]
    s_add_u32 m0, s89, 73728
    s_nop 0
    buffer_load_dwordx4 v251, s[20:23], s72 offen lds
    v_mfma_f32_16x16x32_bf16 a[156:159], v[108:111], a[208:211], a[156:159]
    s_add_u32 s72, s82, 768
    s_and_b32 s72, s72, 0x3ff
    s_add_u32 s72, s72, s87
    v_mfma_f32_16x16x32_bf16 a[188:191], v[108:111], a[212:215], a[188:191]
    s_add_u32 m0, s90, 73728
    s_nop 0
    buffer_load_dwordx4 v252, s[20:23], s72 offen lds
    s_waitcnt lgkmcnt(0)
    v_mfma_f32_16x16x32_bf16 a[0:3], v[96:99], a[216:219], a[0:3]
    v_perm_b32 v100, v4, v0, s61
    v_perm_b32 v101, v12, v8, s61
    v_perm_b32 v102, v20, v16, s61
    v_mfma_f32_16x16x32_bf16 a[32:35], v[96:99], a[220:223], a[32:35]
    v_perm_b32 v103, v28, v24, s61
    s_add_u32 s72, s82, 768
    v_mfma_f32_16x16x32_bf16 a[64:67], v[96:99], a[224:227], a[64:67]
    s_and_b32 s72, s72, 0x3ff
    s_add_u32 s72, s72, s88
    v_mfma_f32_16x16x32_bf16 a[96:99], v[96:99], a[228:231], a[96:99]
    s_add_u32 m0, s91, 73728
    s_nop 0
    buffer_load_dwordx4 v253, s[20:23], s72 offen lds
    s_add_u32 s72, s82, 896
    v_mfma_f32_16x16x32_bf16 a[128:131], v[96:99], a[232:235], a[128:131]
    s_and_b32 s72, s72, 0x3ff
    s_add_u32 s72, s72, s86
    v_mfma_f32_16x16x32_bf16 a[160:163], v[96:99], a[236:239], a[160:163]
    s_add_u32 m0, s89, 86016
    s_nop 0
    buffer_load_dwordx4 v251, s[20:23], s72 offen lds
    v_mfma_f32_16x16x32_bf16 a[4:7], v[100:103], a[216:219], a[4:7]
    v_perm_b32 v104, v5, v1, s60
    v_perm_b32 v105, v13, v9, s60
    v_perm_b32 v106, v21, v17, s60
    v_mfma_f32_16x16x32_bf16 a[36:39], v[100:103], a[220:223], a[36:39]
    v_perm_b32 v107, v29, v25, s60
    s_add_u32 s72, s82, 896
    v_mfma_f32_16x16x32_bf16 a[68:71], v[100:103], a[224:227], a[68:71]
    s_and_b32 s72, s72, 0x3ff
    s_add_u32 s72, s72, s87
    v_mfma_f32_16x16x32_bf16 a[100:103], v[100:103], a[228:231], a[100:103]
    s_add_u32 m0, s90, 86016
    s_nop 0
    buffer_load_dwordx4 v252, s[20:23], s72 offen lds
    s_add_u32 s72, s82, 896
    v_mfma_f32_16x16x32_bf16 a[132:135], v[100:103], a[232:235], a[132:135]
    s_and_b32 s72, s72, 0x3ff
    s_add_u32 s72, s72, s88
    v_mfma_f32_16x16x32_bf16 a[164:167], v[100:103], a[236:239], a[164:167]
    s_add_u32 m0, s91, 86016
    s_nop 0
    buffer_load_dwordx4 v253, s[20:23], s72 offen lds
    v_mfma_f32_16x16x32_bf16 a[8:11], v[104:107], a[216:219], a[8:11]
    v_perm_b32 v108, v5, v1, s61
    v_perm_b32 v109, v13, v9, s61
    v_mfma_f32_16x16x32_bf16 a[40:43], v[104:107], a[220:223], a[40:43]
    v_perm_b32 v110, v21, v17, s61
    v_mfma_f32_16x16x32_bf16 a[72:75], v[104:107], a[224:227], a[72:75]
    v_perm_b32 v111, v29, v25, s61
    v_mfma_f32_16x16x32_bf16 a[104:107], v[104:107], a[228:231], a[104:107]
    v_add_u32 v240, s81, v240
    v_mfma_f32_16x16x32_bf16 a[136:139], v[104:107], a[232:235], a[136:139]
    v_and_b32 v240, 0x3fffff, v240
    v_mfma_f32_16x16x32_bf16 a[168:171], v[104:107], a[236:239], a[168:171]
    buffer_load_dwordx4 v[160:163], v240, s[32:35], 0 offen
    v_mfma_f32_16x16x32_bf16 a[12:15], v[108:111], a[216:219], a[12:15]
    v_perm_b32 v96, v6, v2, s60
    v_perm_b32 v97, v14, v10, s60
    v_mfma_f32_16x16x32_bf16 a[44:47], v[108:111], a[220:223], a[44:47]
    v_perm_b32 v98, v22, v18, s60
    v_mfma_f32_16x16x32_bf16 a[76:79], v[108:111], a[224:227], a[76:79]
    v_perm_b32 v99, v30, v26, s60
    v_mfma_f32_16x16x32_bf16 a[108:111], v[108:111], a[228:231], a[108:111]
    buffer_load_dwordx4 v[164:167], v240, s[32:35], s52 offen
    buffer_load_dwordx4 v[168:171], v240, s[32:35], s53 offen
    v_mfma_f32_16x16x32_bf16 a[140:143], v[108:111], a[232:235], a[140:143]
    ds_read_b128 a[192:195], v243 offset:12288
    v_mfma_f32_16x16x32_bf16 a[172:175], v[108:111], a[236:239], a[172:175]
    ds_read_b128 a[196:199], v243 offset:14336
    v_mfma_f32_16x16x32_bf16 a[16:19], v[96:99], a[216:219], a[16:19]
    v_perm_b32 v100, v6, v2, s61
    v_perm_b32 v101, v14, v10, s61
    v_mfma_f32_16x16x32_bf16 a[48:51], v[96:99], a[220:223], a[48:51]
    v_perm_b32 v102, v22, v18, s61
    v_mfma_f32_16x16x32_bf16 a[80:83], v[96:99], a[224:227], a[80:83]
    v_perm_b32 v103, v30, v26, s61
    v_mfma_f32_16x16x32_bf16 a[112:115], v[96:99], a[228:231], a[112:115]
    buffer_load_dwordx4 v[172:175], v240, s[32:35], s54 offen
    buffer_load_dwordx4 v[176:179], v240, s[32:35], s55 offen
    v_mfma_f32_16x16x32_bf16 a[144:147], v[96:99], a[232:235], a[144:147]
    ds_read_b128 a[200:203], v243 offset:16384
    v_mfma_f32_16x16x32_bf16 a[176:179], v[96:99], a[236:239], a[176:179]
    ds_read_b128 a[204:207], v243 offset:18432
    v_mfma_f32_16x16x32_bf16 a[20:23], v[100:103], a[216:219], a[20:23]
    v_perm_b32 v104, v7, v3, s60
    v_perm_b32 v105, v15, v11, s60
    v_mfma_f32_16x16x32_bf16 a[52:55], v[100:103], a[220:223], a[52:55]
    v_perm_b32 v106, v23, v19, s60
    v_mfma_f32_16x16x32_bf16 a[84:87], v[100:103], a[224:227], a[84:87]
    v_perm_b32 v107, v31, v27, s60
    v_mfma_f32_16x16x32_bf16 a[116:119], v[100:103], a[228:231], a[116:119]
    buffer_load_dwordx4 v[180:183], v240, s[32:35], s56 offen
    buffer_load_dwordx4 v[184:187], v240, s[32:35], s57 offen
    v_mfma_f32_16x16x32_bf16 a[148:151], v[100:103], a[232:235], a[148:151]
    ds_read_b128 a[208:211], v243 offset:20480
    v_mfma_f32_16x16x32_bf16 a[180:183], v[100:103], a[236:239], a[180:183]
    ds_read_b128 a[212:215], v243 offset:22528
    v_mfma_f32_16x16x32_bf16 a[24:27], v[104:107], a[216:219], a[24:27]
    v_perm_b32 v108, v7, v3, s61
    v_mfma_f32_16x16x32_bf16 a[56:59], v[104:107], a[220:223], a[56:59]
    v_perm_b32 v109, v15, v11, s61
    v_mfma_f32_16x16x32_bf16 a[88:91], v[104:107], a[224:227], a[88:91]
    v_perm_b32 v110, v23, v19, s61
    v_mfma_f32_16x16x32_bf16 a[120:123], v[104:107], a[228:231], a[120:123]
    v_perm_b32 v111, v31, v27, s61
    v_mfma_f32_16x16x32_bf16 a[152:155], v[104:107], a[232:235], a[152:155]
    buffer_load_dwordx4 v[188:191], v240, s[32:35], s58 offen
    v_mfma_f32_16x16x32_bf16 a[184:187], v[104:107], a[236:239], a[184:187]
    v_mfma_f32_16x16x32_bf16 a[28:31], v[108:111], a[216:219], a[28:31]
    s_waitcnt vmcnt(22)
    v_perm_b32 v96, v132, v128, s60
    v_mfma_f32_16x16x32_bf16 a[60:63], v[108:111], a[220:223], a[60:63]
    v_perm_b32 v97, v140, v136, s60
    v_mfma_f32_16x16x32_bf16 a[92:95], v[108:111], a[224:227], a[92:95]
    v_perm_b32 v98, v148, v144, s60
    v_perm_b32 v99, v156, v152, s60
    v_mfma_f32_16x16x32_bf16 a[124:127], v[108:111], a[228:231], a[124:127]
    v_add_u32 v240, s80, v240
    v_mfma_f32_16x16x32_bf16 a[156:159], v[108:111], a[232:235], a[156:159]
    v_and_b32 v240, 0x3fffff, v240
    buffer_load_dwordx4 v[192:195], v240, s[32:35], 0 offen
    v_mfma_f32_16x16x32_bf16 a[188:191], v[108:111], a[236:239], a[188:191]
    buffer_load_dwordx4 v[196:199], v240, s[32:35], s52 offen
    s_waitcnt lgkmcnt(0)
    v_mfma_f32_16x16x32_bf16 a[0:3], v[96:99], a[192:195], a[0:3]
    v_perm_b32 v100, v132, v128, s61
    v_mfma_f32_16x16x32_bf16 a[32:35], v[96:99], a[196:199], a[32:35]
    v_perm_b32 v101, v140, v136, s61
    v_mfma_f32_16x16x32_bf16 a[64:67], v[96:99], a[200:203], a[64:67]
    v_perm_b32 v102, v148, v144, s61
    v_mfma_f32_16x16x32_bf16 a[96:99], v[96:99], a[204:207], a[96:99]
    v_perm_b32 v103, v156, v152, s61
    v_mfma_f32_16x16x32_bf16 a[128:131], v[96:99], a[208:211], a[128:131]
    buffer_load_dwordx4 v[200:203], v240, s[32:35], s53 offen
    v_mfma_f32_16x16x32_bf16 a[160:163], v[96:99], a[212:215], a[160:163]
    buffer_load_dwordx4 v[204:207], v240, s[32:35], s54 offen
    v_mfma_f32_16x16x32_bf16 a[4:7], v[100:103], a[192:195], a[4:7]
    v_perm_b32 v104, v133, v129, s60
    v_mfma_f32_16x16x32_bf16 a[36:39], v[100:103], a[196:199], a[36:39]
    v_perm_b32 v105, v141, v137, s60
    v_mfma_f32_16x16x32_bf16 a[68:71], v[100:103], a[200:203], a[68:71]
    v_perm_b32 v106, v149, v145, s60
    v_mfma_f32_16x16x32_bf16 a[100:103], v[100:103], a[204:207], a[100:103]
    v_perm_b32 v107, v157, v153, s60
    v_mfma_f32_16x16x32_bf16 a[132:135], v[100:103], a[208:211], a[132:135]
    buffer_load_dwordx4 v[208:211], v240, s[32:35], s55 offen
    v_mfma_f32_16x16x32_bf16 a[164:167], v[100:103], a[212:215], a[164:167]
    buffer_load_dwordx4 v[212:215], v240, s[32:35], s56 offen
    v_mfma_f32_16x16x32_bf16 a[8:11], v[104:107], a[192:195], a[8:11]
    v_perm_b32 v108, v133, v129, s61
    v_mfma_f32_16x16x32_bf16 a[40:43], v[104:107], a[196:199], a[40:43]
    v_perm_b32 v109, v141, v137, s61
    v_mfma_f32_16x16x32_bf16 a[72:75], v[104:107], a[200:203], a[72:75]
    v_perm_b32 v110, v149, v145, s61
    v_mfma_f32_16x16x32_bf16 a[104:107], v[104:107], a[204:207], a[104:107]
    v_perm_b32 v111, v157, v153, s61
    v_mfma_f32_16x16x32_bf16 a[136:139], v[104:107], a[208:211], a[136:139]
    buffer_load_dwordx4 v[216:219], v240, s[32:35], s57 offen
    v_mfma_f32_16x16x32_bf16 a[168:171], v[104:107], a[212:215], a[168:171]
    v_mfma_f32_16x16x32_bf16 a[12:15], v[108:111], a[192:195], a[12:15]
    v_perm_b32 v96, v134, v130, s60
    v_perm_b32 v97, v142, v138, s60
    v_mfma_f32_16x16x32_bf16 a[44:47], v[108:111], a[196:199], a[44:47]
    v_perm_b32 v98, v150, v146, s60
    v_perm_b32 v99, v158, v154, s60
    v_mfma_f32_16x16x32_bf16 a[76:79], v[108:111], a[200:203], a[76:79]
    buffer_load_dwordx4 v[220:223], v240, s[32:35], s58 offen
    v_mfma_f32_16x16x32_bf16 a[108:111], v[108:111], a[204:207], a[108:111]
    v_add_u32 v240, s81, v240
    v_and_b32 v240, 0x3fffff, v240
    v_mfma_f32_16x16x32_bf16 a[140:143], v[108:111], a[208:211], a[140:143]
    buffer_load_dwordx4 v[32:35], v240, s[32:35], 0 offen
    ds_read_b128 a[216:219], v244 offset:12288
    v_mfma_f32_16x16x32_bf16 a[172:175], v[108:111], a[212:215], a[172:175]
    ds_read_b128 a[220:223], v244 offset:14336
    v_mfma_f32_16x16x32_bf16 a[16:19], v[96:99], a[192:195], a[16:19]
    v_perm_b32 v100, v134, v130, s61
    v_perm_b32 v101, v142, v138, s61
    v_mfma_f32_16x16x32_bf16 a[48:51], v[96:99], a[196:199], a[48:51]
    v_perm_b32 v102, v150, v146, s61
    v_mfma_f32_16x16x32_bf16 a[80:83], v[96:99], a[200:203], a[80:83]
    v_perm_b32 v103, v158, v154, s61
    v_mfma_f32_16x16x32_bf16 a[112:115], v[96:99], a[204:207], a[112:115]
    buffer_load_dwordx4 v[36:39], v240, s[32:35], s52 offen
    buffer_load_dwordx4 v[40:43], v240, s[32:35], s53 offen
    v_mfma_f32_16x16x32_bf16 a[144:147], v[96:99], a[208:211], a[144:147]
    ds_read_b128 a[224:227], v244 offset:16384
    v_mfma_f32_16x16x32_bf16 a[176:179], v[96:99], a[212:215], a[176:179]
    ds_read_b128 a[228:231], v244 offset:18432
    v_mfma_f32_16x16x32_bf16 a[20:23], v[100:103], a[192:195], a[20:23]
    v_perm_b32 v104, v135, v131, s60
    v_perm_b32 v105, v143, v139, s60
    v_mfma_f32_16x16x32_bf16 a[52:55], v[100:103], a[196:199], a[52:55]
    v_perm_b32 v106, v151, v147, s60
    v_mfma_f32_16x16x32_bf16 a[84:87], v[100:103], a[200:203], a[84:87]
    v_perm_b32 v107, v159, v155, s60
    v_mfma_f32_16x16x32_bf16 a[116:119], v[100:103], a[204:207], a[116:119]
    buffer_load_dwordx4 v[44:47], v240, s[32:35], s54 offen
    buffer_load_dwordx4 v[48:51], v240, s[32:35], s55 offen
    v_mfma_f32_16x16x32_bf16 a[148:151], v[100:103], a[208:211], a[148:151]
    ds_read_b128 a[232:235], v244 offset:20480
    v_mfma_f32_16x16x32_bf16 a[180:183], v[100:103], a[212:215], a[180:183]
    ds_read_b128 a[236:239], v244 offset:22528
    v_mfma_f32_16x16x32_bf16 a[24:27], v[104:107], a[192:195], a[24:27]
    v_perm_b32 v108, v135, v131, s61
    v_mfma_f32_16x16x32_bf16 a[56:59], v[104:107], a[196:199], a[56:59]
    v_perm_b32 v109, v143, v139, s61
    v_mfma_f32_16x16x32_bf16 a[88:91], v[104:107], a[200:203], a[88:91]
    v_perm_b32 v110, v151, v147, s61
    v_mfma_f32_16x16x32_bf16 a[120:123], v[104:107], a[204:207], a[120:123]
    v_perm_b32 v111, v159, v155, s61
    v_mfma_f32_16x16x32_bf16 a[152:155], v[104:107], a[208:211], a[152:155]
    buffer_load_dwordx4 v[52:55], v240, s[32:35], s56 offen
    v_mfma_f32_16x16x32_bf16 a[184:187], v[104:107], a[212:215], a[184:187]
    v_mfma_f32_16x16x32_bf16 a[28:31], v[108:111], a[192:195], a[28:31]
    s_waitcnt vmcnt(14)
    v_perm_b32 v96, v164, v160, s60
    v_mfma_f32_16x16x32_bf16 a[60:63], v[108:111], a[196:199], a[60:63]
    v_perm_b32 v97, v172, v168, s60
    v_mfma_f32_16x16x32_bf16 a[92:95], v[108:111], a[200:203], a[92:95]
    v_perm_b32 v98, v180, v176, s60
    v_mfma_f32_16x16x32_bf16 a[124:127], v[108:111], a[204:207], a[124:127]
    v_perm_b32 v99, v188, v184, s60
    v_mfma_f32_16x16x32_bf16 a[156:159], v[108:111], a[208:211], a[156:159]
    buffer_load_dwordx4 v[56:59], v240, s[32:35], s57 offen
    v_mfma_f32_16x16x32_bf16 a[188:191], v[108:111], a[212:215], a[188:191]
    buffer_load_dwordx4 v[60:63], v240, s[32:35], s58 offen
    s_waitcnt lgkmcnt(0)
    v_mfma_f32_16x16x32_bf16 a[0:3], v[96:99], a[216:219], a[0:3]
    v_perm_b32 v100, v164, v160, s61
    v_perm_b32 v101, v172, v168, s61
    v_perm_b32 v102, v180, v176, s61
    v_mfma_f32_16x16x32_bf16 a[32:35], v[96:99], a[220:223], a[32:35]
    v_perm_b32 v103, v188, v184, s61
    v_add_u32 v240, s80, v240
    v_mfma_f32_16x16x32_bf16 a[64:67], v[96:99], a[224:227], a[64:67]
    v_and_b32 v240, 0x3fffff, v240
    buffer_load_dwordx4 v[64:67], v240, s[32:35], 0 offen
    v_mfma_f32_16x16x32_bf16 a[96:99], v[96:99], a[228:231], a[96:99]
    buffer_load_dwordx4 v[68:71], v240, s[32:35], s52 offen
    v_mfma_f32_16x16x32_bf16 a[128:131], v[96:99], a[232:235], a[128:131]
    ds_read_b128 v[128:131], v117 offset:0
    v_mfma_f32_16x16x32_bf16 a[160:163], v[96:99], a[236:239], a[160:163]
    ds_read_b128 v[132:135], v118 offset:0
    ds_read_b128 v[136:139], v119 offset:0
    v_mfma_f32_16x16x32_bf16 a[4:7], v[100:103], a[216:219], a[4:7]
    v_perm_b32 v104, v165, v161, s60
    v_perm_b32 v105, v173, v169, s60
    v_mfma_f32_16x16x32_bf16 a[36:39], v[100:103], a[220:223], a[36:39]
    v_perm_b32 v106, v181, v177, s60
    v_mfma_f32_16x16x32_bf16 a[68:71], v[100:103], a[224:227], a[68:71]
    v_perm_b32 v107, v189, v185, s60
    buffer_load_dwordx4 v[72:75], v240, s[32:35], s53 offen
    v_mfma_f32_16x16x32_bf16 a[100:103], v[100:103], a[228:231], a[100:103]
    buffer_load_dwordx4 v[76:79], v240, s[32:35], s54 offen
    v_mfma_f32_16x16x32_bf16 a[132:135], v[100:103], a[232:235], a[132:135]
    ds_read_b128 v[140:143], v120 offset:0
    ds_read_b128 v[144:147], v117 offset:4096
    v_mfma_f32_16x16x32_bf16 a[164:167], v[100:103], a[236:239], a[164:167]
    ds_read_b128 v[148:151], v118 offset:4096
    v_mfma_f32_16x16x32_bf16 a[8:11], v[104:107], a[216:219], a[8:11]
    v_perm_b32 v108, v165, v161, s61
    v_perm_b32 v109, v173, v169, s61
    v_mfma_f32_16x16x32_bf16 a[40:43], v[104:107], a[220:223], a[40:43]
    v_perm_b32 v110, v181, v177, s61
    v_mfma_f32_16x16x32_bf16 a[72:75], v[104:107], a[224:227], a[72:75]
    v_perm_b32 v111, v189, v185, s61
    buffer_load_dwordx4 v[80:83], v240, s[32:35], s55 offen
    v_mfma_f32_16x16x32_bf16 a[104:107], v[104:107], a[228:231], a[104:107]
    buffer_load_dwordx4 v[84:87], v240, s[32:35], s56 offen
    v_mfma_f32_16x16x32_bf16 a[136:139], v[104:107], a[232:235], a[136:139]
    ds_read_b128 v[152:155], v119 offset:4096
    ds_read_b128 v[156:159], v120 offset:4096
    v_mfma_f32_16x16x32_bf16 a[168:171], v[104:107], a[236:239], a[168:171]
    v_mfma_f32_16x16x32_bf16 a[12:15], v[108:111], a[216:219], a[12:15]
    v_perm_b32 v96, v166, v162, s60
    v_perm_b32 v97, v174, v170, s60
    v_mfma_f32_16x16x32_bf16 a[44:47], v[108:111], a[220:223], a[44:47]
    v_perm_b32 v98, v182, v178, s60
    v_mfma_f32_16x16x32_bf16 a[76:79], v[108:111], a[224:227], a[76:79]
    v_perm_b32 v99, v190, v186, s60
    buffer_load_dwordx4 v[88:91], v240, s[32:35], s57 offen
    v_mfma_f32_16x16x32_bf16 a[108:111], v[108:111], a[228:231], a[108:111]
    v_mfma_f32_16x16x32_bf16 a[140:143], v[108:111], a[232:235], a[140:143]
    s_barrier
    ds_read_b128 a[192:195], v243 offset:24576
    v_mfma_f32_16x16x32_bf16 a[172:175], v[108:111], a[236:239], a[172:175]
    ds_read_b128 a[196:199], v243 offset:26624
    v_mfma_f32_16x16x32_bf16 a[16:19], v[96:99], a[216:219], a[16:19]
    v_perm_b32 v100, v166, v162, s61
    v_perm_b32 v101, v174, v170, s61
    v_mfma_f32_16x16x32_bf16 a[48:51], v[96:99], a[220:223], a[48:51]
    v_perm_b32 v102, v182, v178, s61
    v_mfma_f32_16x16x32_bf16 a[80:83], v[96:99], a[224:227], a[80:83]
    v_perm_b32 v103, v190, v186, s61
    v_mfma_f32_16x16x32_bf16 a[112:115], v[96:99], a[228:231], a[112:115]
    buffer_load_dwordx4 v[92:95], v240, s[32:35], s58 offen
    v_mfma_f32_16x16x32_bf16 a[144:147], v[96:99], a[232:235], a[144:147]
    ds_read_b128 a[200:203], v243 offset:28672
    v_mfma_f32_16x16x32_bf16 a[176:179], v[96:99], a[236:239], a[176:179]
    ds_read_b128 a[204:207], v243 offset:30720
    v_mfma_f32_16x16x32_bf16 a[20:23], v[100:103], a[216:219], a[20:23]
    v_perm_b32 v104, v167, v163, s60
    v_perm_b32 v105, v175, v171, s60
    v_mfma_f32_16x16x32_bf16 a[52:55], v[100:103], a[220:223], a[52:55]
    v_perm_b32 v106, v183, v179, s60
    v_mfma_f32_16x16x32_bf16 a[84:87], v[100:103], a[224:227], a[84:87]
    v_perm_b32 v107, v191, v187, s60
    s_add_u32 s73, s62, 16384
    v_mfma_f32_16x16x32_bf16 a[116:119], v[100:103], a[228:231], a[116:119]
    s_add_u32 m0, s4, 0
    v_mfma_f32_16x16x32_bf16 a[148:151], v[100:103], a[232:235], a[148:151]
    buffer_load_dwordx4 v113, s[24:27], s73 offen nt lds
    ds_read_b128 a[208:211], v243 offset:32768
    v_mfma_f32_16x16x32_bf16 a[180:183], v[100:103], a[236:239], a[180:183]
    ds_read_b128 a[212:215], v243 offset:34816
    v_mfma_f32_16x16x32_bf16 a[24:27], v[104:107], a[216:219], a[24:27]
    v_perm_b32 v108, v167, v163, s61
    v_perm_b32 v109, v175, v171, s61
    v_mfma_f32_16x16x32_bf16 a[56:59], v[104:107], a[220:223], a[56:59]
    v_perm_b32 v110, v183, v179, s61
    v_mfma_f32_16x16x32_bf16 a[88:91], v[104:107], a[224:227], a[88:91]
    v_perm_b32 v111, v191, v187, s61
    v_mfma_f32_16x16x32_bf16 a[120:123], v[104:107], a[228:231], a[120:123]
    s_add_u32 s73, s62, 17408
    v_mfma_f32_16x16x32_bf16 a[152:155], v[104:107], a[232:235], a[152:155]
    s_add_u32 m0, s4, 1024
    v_mfma_f32_16x16x32_bf16 a[184:187], v[104:107], a[236:239], a[184:187]
    buffer_load_dwordx4 v114, s[24:27], s73 offen nt lds
    v_mfma_f32_16x16x32_bf16 a[28:31], v[108:111], a[216:219], a[28:31]
    s_waitcnt vmcnt(18)
    v_perm_b32 v96, v196, v192, s60
    v_mfma_f32_16x16x32_bf16 a[60:63], v[108:111], a[220:223], a[60:63]
    v_perm_b32 v97, v204, v200, s60
    v_mfma_f32_16x16x32_bf16 a[92:95], v[108:111], a[224:227], a[92:95]
    v_perm_b32 v98, v212, v208, s60
    v_mfma_f32_16x16x32_bf16 a[124:127], v[108:111], a[228:231], a[124:127]
    v_perm_b32 v99, v220, v216, s60
    s_add_u32 s73, s62, 18432
    v_mfma_f32_16x16x32_bf16 a[156:159], v[108:111], a[232:235], a[156:159]
    s_add_u32 m0, s4, 2048
    v_mfma_f32_16x16x32_bf16 a[188:191], v[108:111], a[236:239], a[188:191]
    buffer_load_dwordx4 v115, s[24:27], s73 offen nt lds
    s_waitcnt lgkmcnt(0)
    v_mfma_f32_16x16x32_bf16 a[0:3], v[96:99], a[192:195], a[0:3]
    v_perm_b32 v100, v196, v192, s61
    v_perm_b32 v101, v204, v200, s61
    v_mfma_f32_16x16x32_bf16 a[32:35], v[96:99], a[196:199], a[32:35]
    v_perm_b32 v102, v212, v208, s61
    v_perm_b32 v103, v220, v216, s61
    v_mfma_f32_16x16x32_bf16 a[64:67], v[96:99], a[200:203], a[64:67]
    s_add_u32 s73, s62, 19456
    s_add_u32 m0, s4, 3072
    v_mfma_f32_16x16x32_bf16 a[96:99], v[96:99], a[204:207], a[96:99]
    buffer_load_dwordx4 v116, s[24:27], s73 offen nt lds
    v_mfma_f32_16x16x32_bf16 a[128:131], v[96:99], a[208:211], a[128:131]
    ds_read_b128 v[160:163], v117 offset:8192
    v_mfma_f32_16x16x32_bf16 a[160:163], v[96:99], a[212:215], a[160:163]
    ds_read_b128 v[164:167], v118 offset:8192
    ds_read_b128 v[168:171], v119 offset:8192
    v_mfma_f32_16x16x32_bf16 a[4:7], v[100:103], a[192:195], a[4:7]
    v_perm_b32 v104, v197, v193, s60
    v_perm_b32 v105, v205, v201, s60
    v_mfma_f32_16x16x32_bf16 a[36:39], v[100:103], a[196:199], a[36:39]
    v_perm_b32 v106, v213, v209, s60
    v_perm_b32 v107, v221, v217, s60
    v_mfma_f32_16x16x32_bf16 a[68:71], v[100:103], a[200:203], a[68:71]
    s_add_u32 s73, s62, 20480
    v_mfma_f32_16x16x32_bf16 a[100:103], v[100:103], a[204:207], a[100:103]
    s_add_u32 m0, s4, 4096
    s_nop 0
    buffer_load_dwordx4 v113, s[24:27], s73 offen nt lds
    v_mfma_f32_16x16x32_bf16 a[132:135], v[100:103], a[208:211], a[132:135]
    ds_read_b128 v[172:175], v120 offset:8192
    ds_read_b128 v[176:179], v117 offset:12288
    v_mfma_f32_16x16x32_bf16 a[164:167], v[100:103], a[212:215], a[164:167]
    ds_read_b128 v[180:183], v118 offset:12288
    v_mfma_f32_16x16x32_bf16 a[8:11], v[104:107], a[192:195], a[8:11]
    v_perm_b32 v108, v197, v193, s61
    v_perm_b32 v109, v205, v201, s61
    v_mfma_f32_16x16x32_bf16 a[40:43], v[104:107], a[196:199], a[40:43]
    v_perm_b32 v110, v213, v209, s61
    v_perm_b32 v111, v221, v217, s61
    v_mfma_f32_16x16x32_bf16 a[72:75], v[104:107], a[200:203], a[72:75]
    s_add_u32 s73, s62, 21504
    v_mfma_f32_16x16x32_bf16 a[104:107], v[104:107], a[204:207], a[104:107]
    s_add_u32 m0, s4, 5120
    s_nop 0
    buffer_load_dwordx4 v114, s[24:27], s73 offen nt lds
    v_mfma_f32_16x16x32_bf16 a[136:139], v[104:107], a[208:211], a[136:139]
    ds_read_b128 v[184:187], v119 offset:12288
    ds_read_b128 v[188:191], v120 offset:12288
    v_mfma_f32_16x16x32_bf16 a[168:171], v[104:107], a[212:215], a[168:171]
    v_mfma_f32_16x16x32_bf16 a[12:15], v[108:111], a[192:195], a[12:15]
    v_perm_b32 v96, v198, v194, s60
    v_mfma_f32_16x16x32_bf16 a[44:47], v[108:111], a[196:199], a[44:47]
    v_perm_b32 v97, v206, v202, s60
    v_mfma_f32_16x16x32_bf16 a[76:79], v[108:111], a[200:203], a[76:79]
    v_perm_b32 v98, v214, v210, s60
    v_mfma_f32_16x16x32_bf16 a[108:111], v[108:111], a[204:207], a[108:111]
    v_perm_b32 v99, v222, v218, s60
    v_mfma_f32_16x16x32_bf16 a[140:143], v[108:111], a[208:211], a[140:143]
    ds_read_b128 a[216:219], v244 offset:24576
    v_mfma_f32_16x16x32_bf16 a[172:175], v[108:111], a[212:215], a[172:175]
    ds_read_b128 a[220:223], v244 offset:26624
    v_mfma_f32_16x16x32_bf16 a[16:19], v[96:99], a[192:195], a[16:19]
    v_perm_b32 v100, v198, v194, s61
    v_perm_b32 v101, v206, v202, s61
    v_mfma_f32_16x16x32_bf16 a[48:51], v[96:99], a[196:199], a[48:51]
    v_perm_b32 v102, v214, v210, s61
    v_mfma_f32_16x16x32_bf16 a[80:83], v[96:99], a[200:203], a[80:83]
    v_perm_b32 v103, v222, v218, s61
    s_add_u32 s73, s62, 22528
    v_mfma_f32_16x16x32_bf16 a[112:115], v[96:99], a[204:207], a[112:115]
    s_add_u32 m0, s4, 6144
    v_mfma_f32_16x16x32_bf16 a[144:147], v[96:99], a[208:211], a[144:147]
    buffer_load_dwordx4 v115, s[24:27], s73 offen nt lds
    ds_read_b128 a[224:227], v244 offset:28672
    v_mfma_f32_16x16x32_bf16 a[176:179], v[96:99], a[212:215], a[176:179]
    ds_read_b128 a[228:231], v244 offset:30720
    v_mfma_f32_16x16x32_bf16 a[20:23], v[100:103], a[192:195], a[20:23]
    v_perm_b32 v104, v199, v195, s60
    v_perm_b32 v105, v207, v203, s60
    v_mfma_f32_16x16x32_bf16 a[52:55], v[100:103], a[196:199], a[52:55]
    v_perm_b32 v106, v215, v211, s60
    v_mfma_f32_16x16x32_bf16 a[84:87], v[100:103], a[200:203], a[84:87]
    v_perm_b32 v107, v223, v219, s60
    s_add_u32 s73, s62, 23552
    v_mfma_f32_16x16x32_bf16 a[116:119], v[100:103], a[204:207], a[116:119]
    s_add_u32 m0, s4, 7168
    v_mfma_f32_16x16x32_bf16 a[148:151], v[100:103], a[208:211], a[148:151]
    buffer_load_dwordx4 v116, s[24:27], s73 offen nt lds
    ds_read_b128 a[232:235], v244 offset:32768
    v_mfma_f32_16x16x32_bf16 a[180:183], v[100:103], a[212:215], a[180:183]
    ds_read_b128 a[236:239], v244 offset:34816
    v_mfma_f32_16x16x32_bf16 a[24:27], v[104:107], a[192:195], a[24:27]
    v_perm_b32 v108, v199, v195, s61
    v_perm_b32 v109, v207, v203, s61
    v_mfma_f32_16x16x32_bf16 a[56:59], v[104:107], a[196:199], a[56:59]
    v_perm_b32 v110, v215, v211, s61
    v_mfma_f32_16x16x32_bf16 a[88:91], v[104:107], a[200:203], a[88:91]
    v_perm_b32 v111, v223, v219, s61
    v_mfma_f32_16x16x32_bf16 a[120:123], v[104:107], a[204:207], a[120:123]
    v_add_u32 v240, s81, v240
    v_and_b32 v240, 0x3fffff, v240
    v_mfma_f32_16x16x32_bf16 a[152:155], v[104:107], a[208:211], a[152:155]
    buffer_load_dwordx4 v[0:3], v240, s[32:35], 0 offen
    v_mfma_f32_16x16x32_bf16 a[184:187], v[104:107], a[212:215], a[184:187]
    buffer_load_dwordx4 v[4:7], v240, s[32:35], s52 offen
    v_mfma_f32_16x16x32_bf16 a[28:31], v[108:111], a[192:195], a[28:31]
    s_waitcnt vmcnt(18)
    v_perm_b32 v96, v36, v32, s60
    v_mfma_f32_16x16x32_bf16 a[60:63], v[108:111], a[196:199], a[60:63]
    v_perm_b32 v97, v44, v40, s60
    v_mfma_f32_16x16x32_bf16 a[92:95], v[108:111], a[200:203], a[92:95]
    v_perm_b32 v98, v52, v48, s60
    v_mfma_f32_16x16x32_bf16 a[124:127], v[108:111], a[204:207], a[124:127]
    v_perm_b32 v99, v60, v56, s60
    v_mfma_f32_16x16x32_bf16 a[156:159], v[108:111], a[208:211], a[156:159]
    buffer_load_dwordx4 v[8:11], v240, s[32:35], s53 offen
    v_mfma_f32_16x16x32_bf16 a[188:191], v[108:111], a[212:215], a[188:191]
    buffer_load_dwordx4 v[12:15], v240, s[32:35], s54 offen
    s_waitcnt lgkmcnt(0)
    v_mfma_f32_16x16x32_bf16 a[0:3], v[96:99], a[216:219], a[0:3]
    v_perm_b32 v100, v36, v32, s61
    v_mfma_f32_16x16x32_bf16 a[32:35], v[96:99], a[220:223], a[32:35]
    v_perm_b32 v101, v44, v40, s61
    v_mfma_f32_16x16x32_bf16 a[64:67], v[96:99], a[224:227], a[64:67]
    v_perm_b32 v102, v52, v48, s61
    v_mfma_f32_16x16x32_bf16 a[96:99], v[96:99], a[228:231], a[96:99]
    v_perm_b32 v103, v60, v56, s61
    v_mfma_f32_16x16x32_bf16 a[128:131], v[96:99], a[232:235], a[128:131]
    buffer_load_dwordx4 v[16:19], v240, s[32:35], s55 offen
    v_mfma_f32_16x16x32_bf16 a[160:163], v[96:99], a[236:239], a[160:163]
    buffer_load_dwordx4 v[20:23], v240, s[32:35], s56 offen
    v_mfma_f32_16x16x32_bf16 a[4:7], v[100:103], a[216:219], a[4:7]
    v_perm_b32 v104, v37, v33, s60
    v_mfma_f32_16x16x32_bf16 a[36:39], v[100:103], a[220:223], a[36:39]
    v_perm_b32 v105, v45, v41, s60
    v_mfma_f32_16x16x32_bf16 a[68:71], v[100:103], a[224:227], a[68:71]
    v_perm_b32 v106, v53, v49, s60
    v_mfma_f32_16x16x32_bf16 a[100:103], v[100:103], a[228:231], a[100:103]
    v_perm_b32 v107, v61, v57, s60
    v_mfma_f32_16x16x32_bf16 a[132:135], v[100:103], a[232:235], a[132:135]
    buffer_load_dwordx4 v[24:27], v240, s[32:35], s57 offen
    v_mfma_f32_16x16x32_bf16 a[164:167], v[100:103], a[236:239], a[164:167]
    v_mfma_f32_16x16x32_bf16 a[8:11], v[104:107], a[216:219], a[8:11]
    v_perm_b32 v108, v37, v33, s61
    v_mfma_f32_16x16x32_bf16 a[40:43], v[104:107], a[220:223], a[40:43]
    v_perm_b32 v109, v45, v41, s61
    v_mfma_f32_16x16x32_bf16 a[72:75], v[104:107], a[224:227], a[72:75]
    v_perm_b32 v110, v53, v49, s61
    v_mfma_f32_16x16x32_bf16 a[104:107], v[104:107], a[228:231], a[104:107]
    v_perm_b32 v111, v61, v57, s61
    v_mfma_f32_16x16x32_bf16 a[136:139], v[104:107], a[232:235], a[136:139]
    buffer_load_dwordx4 v[28:31], v240, s[32:35], s58 offen
    v_mfma_f32_16x16x32_bf16 a[168:171], v[104:107], a[236:239], a[168:171]
    v_mfma_f32_16x16x32_bf16 a[12:15], v[108:111], a[216:219], a[12:15]
    v_perm_b32 v96, v38, v34, s60
    v_perm_b32 v97, v46, v42, s60
    v_mfma_f32_16x16x32_bf16 a[44:47], v[108:111], a[220:223], a[44:47]
    v_perm_b32 v98, v54, v50, s60
    v_perm_b32 v99, v62, v58, s60
    v_mfma_f32_16x16x32_bf16 a[76:79], v[108:111], a[224:227], a[76:79]
    v_mfma_f32_16x16x32_bf16 a[108:111], v[108:111], a[228:231], a[108:111]
    s_add_u32 s73, s62, 0
    s_add_u32 m0, s92, 0
    v_mfma_f32_16x16x32_bf16 a[140:143], v[108:111], a[232:235], a[140:143]
    buffer_load_dwordx4 v246, s[28:31], s73 offen nt lds
    ds_read_b128 a[192:195], v243 offset:36864
    v_mfma_f32_16x16x32_bf16 a[172:175], v[108:111], a[236:239], a[172:175]
    ds_read_b128 a[196:199], v243 offset:38912
    v_mfma_f32_16x16x32_bf16 a[16:19], v[96:99], a[216:219], a[16:19]
    v_perm_b32 v100, v38, v34, s61
    v_perm_b32 v101, v46, v42, s61
    v_mfma_f32_16x16x32_bf16 a[48:51], v[96:99], a[220:223], a[48:51]
    v_perm_b32 v102, v54, v50, s61
    v_mfma_f32_16x16x32_bf16 a[80:83], v[96:99], a[224:227], a[80:83]
    v_perm_b32 v103, v62, v58, s61
    s_add_u32 s73, s62, 1024
    v_mfma_f32_16x16x32_bf16 a[112:115], v[96:99], a[228:231], a[112:115]
    s_add_u32 m0, s92, 1024
    v_mfma_f32_16x16x32_bf16 a[144:147], v[96:99], a[232:235], a[144:147]
    buffer_load_dwordx4 v245, s[28:31], s73 offen nt lds
    ds_read_b128 a[200:203], v243 offset:40960
    v_mfma_f32_16x16x32_bf16 a[176:179], v[96:99], a[236:239], a[176:179]
    ds_read_b128 a[204:207], v243 offset:43008
    v_mfma_f32_16x16x32_bf16 a[20:23], v[100:103], a[216:219], a[20:23]
    v_perm_b32 v104, v39, v35, s60
    v_perm_b32 v105, v47, v43, s60
    v_mfma_f32_16x16x32_bf16 a[52:55], v[100:103], a[220:223], a[52:55]
    v_perm_b32 v106, v55, v51, s60
    v_mfma_f32_16x16x32_bf16 a[84:87], v[100:103], a[224:227], a[84:87]
    v_perm_b32 v107, v63, v59, s60
    s_add_u32 s73, s62, 2048
    v_mfma_f32_16x16x32_bf16 a[116:119], v[100:103], a[228:231], a[116:119]
    s_add_u32 m0, s92, 2048
    v_mfma_f32_16x16x32_bf16 a[148:151], v[100:103], a[232:235], a[148:151]
    buffer_load_dwordx4 v246, s[28:31], s73 offen nt lds
    ds_read_b128 a[208:211], v243 offset:45056
    v_mfma_f32_16x16x32_bf16 a[180:183], v[100:103], a[236:239], a[180:183]
    ds_read_b128 a[212:215], v243 offset:47104
    v_mfma_f32_16x16x32_bf16 a[24:27], v[104:107], a[216:219], a[24:27]
    v_perm_b32 v108, v39, v35, s61
    v_perm_b32 v109, v47, v43, s61
    v_mfma_f32_16x16x32_bf16 a[56:59], v[104:107], a[220:223], a[56:59]
    v_perm_b32 v110, v55, v51, s61
    v_mfma_f32_16x16x32_bf16 a[88:91], v[104:107], a[224:227], a[88:91]
    v_perm_b32 v111, v63, v59, s61
    v_mfma_f32_16x16x32_bf16 a[120:123], v[104:107], a[228:231], a[120:123]
    s_add_u32 s73, s62, 3072
    v_mfma_f32_16x16x32_bf16 a[152:155], v[104:107], a[232:235], a[152:155]
    s_add_u32 m0, s92, 3072
    v_mfma_f32_16x16x32_bf16 a[184:187], v[104:107], a[236:239], a[184:187]
    buffer_load_dwordx4 v245, s[28:31], s73 offen nt lds
    v_mfma_f32_16x16x32_bf16 a[28:31], v[108:111], a[216:219], a[28:31]
    s_waitcnt vmcnt(20)
    v_perm_b32 v96, v68, v64, s60
    v_mfma_f32_16x16x32_bf16 a[60:63], v[108:111], a[220:223], a[60:63]
    v_perm_b32 v97, v76, v72, s60
    v_mfma_f32_16x16x32_bf16 a[92:95], v[108:111], a[224:227], a[92:95]
    v_perm_b32 v98, v84, v80, s60
    v_mfma_f32_16x16x32_bf16 a[124:127], v[108:111], a[228:231], a[124:127]
    v_perm_b32 v99, v92, v88, s60
    s_add_u32 s73, s62, 4096
    v_mfma_f32_16x16x32_bf16 a[156:159], v[108:111], a[232:235], a[156:159]
    s_add_u32 m0, s92, 4096
    v_mfma_f32_16x16x32_bf16 a[188:191], v[108:111], a[236:239], a[188:191]
    buffer_load_dwordx4 v246, s[28:31], s73 offen nt lds
    s_waitcnt lgkmcnt(0)
    v_mfma_f32_16x16x32_bf16 a[0:3], v[96:99], a[192:195], a[0:3]
    v_perm_b32 v100, v68, v64, s61
    v_perm_b32 v101, v76, v72, s61
    v_mfma_f32_16x16x32_bf16 a[32:35], v[96:99], a[196:199], a[32:35]
    v_perm_b32 v102, v84, v80, s61
    v_mfma_f32_16x16x32_bf16 a[64:67], v[96:99], a[200:203], a[64:67]
    v_perm_b32 v103, v92, v88, s61
    v_mfma_f32_16x16x32_bf16 a[96:99], v[96:99], a[204:207], a[96:99]
    s_add_u32 s73, s62, 5120
    v_mfma_f32_16x16x32_bf16 a[128:131], v[96:99], a[208:211], a[128:131]
    s_add_u32 m0, s92, 5120
    v_mfma_f32_16x16x32_bf16 a[160:163], v[96:99], a[212:215], a[160:163]
    buffer_load_dwordx4 v245, s[28:31], s73 offen nt lds
    v_mfma_f32_16x16x32_bf16 a[4:7], v[100:103], a[192:195], a[4:7]
    v_perm_b32 v104, v69, v65, s60
    v_mfma_f32_16x16x32_bf16 a[36:39], v[100:103], a[196:199], a[36:39]
    v_perm_b32 v105, v77, v73, s60
    v_mfma_f32_16x16x32_bf16 a[68:71], v[100:103], a[200:203], a[68:71]
    v_mfma_f32_16x16x32_bf16 a[100:103], v[100:103], a[204:207], a[100:103]
    v_perm_b32 v106, v85, v81, s60
    v_mfma_f32_16x16x32_bf16 a[132:135], v[100:103], a[208:211], a[132:135]
    v_perm_b32 v107, v93, v89, s60
    v_mfma_f32_16x16x32_bf16 a[164:167], v[100:103], a[212:215], a[164:167]
    s_nop 0
    v_mfma_f32_16x16x32_bf16 a[8:11], v[104:107], a[192:195], a[8:11]
    v_perm_b32 v108, v69, v65, s61
    v_perm_b32 v109, v77, v73, s61
    v_mfma_f32_16x16x32_bf16 a[40:43], v[104:107], a[196:199], a[40:43]
    v_perm_b32 v110, v85, v81, s61
    v_mfma_f32_16x16x32_bf16 a[72:75], v[104:107], a[200:203], a[72:75]
    v_perm_b32 v111, v93, v89, s61
    v_mfma_f32_16x16x32_bf16 a[104:107], v[104:107], a[204:207], a[104:107]
    s_add_u32 s73, s62, 6144
    v_mfma_f32_16x16x32_bf16 a[136:139], v[104:107], a[208:211], a[136:139]
    s_add_u32 m0, s92, 6144
    v_mfma_f32_16x16x32_bf16 a[168:171], v[104:107], a[212:215], a[168:171]
    buffer_load_dwordx4 v246, s[28:31], s73 offen nt lds
    v_mfma_f32_16x16x32_bf16 a[12:15], v[108:111], a[192:195], a[12:15]
    v_perm_b32 v96, v70, v66, s60
    v_perm_b32 v97, v78, v74, s60
    v_mfma_f32_16x16x32_bf16 a[44:47], v[108:111], a[196:199], a[44:47]
    v_perm_b32 v98, v86, v82, s60
    v_mfma_f32_16x16x32_bf16 a[76:79], v[108:111], a[200:203], a[76:79]
    v_perm_b32 v99, v94, v90, s60
    s_add_u32 s73, s62, 7168
    v_mfma_f32_16x16x32_bf16 a[108:111], v[108:111], a[204:207], a[108:111]
    s_add_u32 m0, s92, 7168
    v_mfma_f32_16x16x32_bf16 a[140:143], v[108:111], a[208:211], a[140:143]
    buffer_load_dwordx4 v245, s[28:31], s73 offen nt lds
    ds_read_b128 a[216:219], v244 offset:36864
    v_mfma_f32_16x16x32_bf16 a[172:175], v[108:111], a[212:215], a[172:175]
    ds_read_b128 a[220:223], v244 offset:38912
    v_mfma_f32_16x16x32_bf16 a[16:19], v[96:99], a[192:195], a[16:19]
    v_perm_b32 v100, v70, v66, s61
    v_perm_b32 v101, v78, v74, s61
    v_mfma_f32_16x16x32_bf16 a[48:51], v[96:99], a[196:199], a[48:51]
    v_perm_b32 v102, v86, v82, s61
    v_perm_b32 v103, v94, v90, s61
    v_mfma_f32_16x16x32_bf16 a[80:83], v[96:99], a[200:203], a[80:83]
    v_mfma_f32_16x16x32_bf16 a[112:115], v[96:99], a[204:207], a[112:115]
    s_add_u32 s73, s62, 8192
    s_add_u32 m0, s92, 8192
    v_mfma_f32_16x16x32_bf16 a[144:147], v[96:99], a[208:211], a[144:147]
    buffer_load_dwordx4 v246, s[28:31], s73 offen nt lds
    ds_read_b128 a[224:227], v244 offset:40960
    v_mfma_f32_16x16x32_bf16 a[176:179], v[96:99], a[212:215], a[176:179]
    ds_read_b128 a[228:231], v244 offset:43008
    v_mfma_f32_16x16x32_bf16 a[20:23], v[100:103], a[192:195], a[20:23]
    v_perm_b32 v104, v71, v67, s60
    v_perm_b32 v105, v79, v75, s60
    v_mfma_f32_16x16x32_bf16 a[52:55], v[100:103], a[196:199], a[52:55]
    v_perm_b32 v106, v87, v83, s60
    v_mfma_f32_16x16x32_bf16 a[84:87], v[100:103], a[200:203], a[84:87]
    v_perm_b32 v107, v95, v91, s60
    s_add_u32 s73, s62, 9216
    v_mfma_f32_16x16x32_bf16 a[116:119], v[100:103], a[204:207], a[116:119]
    s_add_u32 m0, s92, 9216
    v_mfma_f32_16x16x32_bf16 a[148:151], v[100:103], a[208:211], a[148:151]
    buffer_load_dwordx4 v245, s[28:31], s73 offen nt lds
    ds_read_b128 a[232:235], v244 offset:45056
    v_mfma_f32_16x16x32_bf16 a[180:183], v[100:103], a[212:215], a[180:183]
    ds_read_b128 a[236:239], v244 offset:47104
    v_mfma_f32_16x16x32_bf16 a[24:27], v[104:107], a[192:195], a[24:27]
    v_perm_b32 v108, v71, v67, s61
    v_perm_b32 v109, v79, v75, s61
    v_mfma_f32_16x16x32_bf16 a[56:59], v[104:107], a[196:199], a[56:59]
    v_perm_b32 v110, v87, v83, s61
    v_mfma_f32_16x16x32_bf16 a[88:91], v[104:107], a[200:203], a[88:91]
    v_perm_b32 v111, v95, v91, s61
    v_mfma_f32_16x16x32_bf16 a[120:123], v[104:107], a[204:207], a[120:123]
    s_add_u32 s73, s62, 10240
    v_mfma_f32_16x16x32_bf16 a[152:155], v[104:107], a[208:211], a[152:155]
    s_add_u32 m0, s92, 10240
    v_mfma_f32_16x16x32_bf16 a[184:187], v[104:107], a[212:215], a[184:187]
    buffer_load_dwordx4 v246, s[28:31], s73 offen nt lds
    v_mfma_f32_16x16x32_bf16 a[28:31], v[108:111], a[192:195], a[28:31]
    s_waitcnt vmcnt(11)
    v_perm_b32 v64, v4, v0, s60
    v_mfma_f32_16x16x32_bf16 a[60:63], v[108:111], a[196:199], a[60:63]
    v_perm_b32 v65, v12, v8, s60
    v_mfma_f32_16x16x32_bf16 a[92:95], v[108:111], a[200:203], a[92:95]
    v_perm_b32 v66, v20, v16, s60
    v_mfma_f32_16x16x32_bf16 a[124:127], v[108:111], a[204:207], a[124:127]
    v_perm_b32 v67, v28, v24, s60
    s_add_u32 s73, s62, 11264
    v_mfma_f32_16x16x32_bf16 a[156:159], v[108:111], a[208:211], a[156:159]
    s_add_u32 m0, s92, 11264
    v_mfma_f32_16x16x32_bf16 a[188:191], v[108:111], a[212:215], a[188:191]
    buffer_load_dwordx4 v245, s[28:31], s73 offen nt lds
    s_waitcnt lgkmcnt(0)
    v_mfma_f32_16x16x32_bf16 a[0:3], v[64:67], a[216:219], a[0:3]
    v_perm_b32 v68, v4, v0, s61
    v_perm_b32 v69, v12, v8, s61
    v_perm_b32 v70, v20, v16, s61
    v_perm_b32 v71, v28, v24, s61
    s_nop 1
    v_mfma_f32_16x16x32_bf16 a[4:7], v[68:71], a[216:219], a[4:7]
    v_perm_b32 v72, v5, v1, s60
    v_perm_b32 v73, v13, v9, s60
    v_perm_b32 v74, v21, v17, s60
    v_perm_b32 v75, v29, v25, s60
    s_nop 1
    v_mfma_f32_16x16x32_bf16 a[8:11], v[72:75], a[216:219], a[8:11]
    v_perm_b32 v76, v5, v1, s61
    v_perm_b32 v77, v13, v9, s61
    v_perm_b32 v78, v21, v17, s61
    v_perm_b32 v79, v29, v25, s61
    s_nop 1
    v_mfma_f32_16x16x32_bf16 a[12:15], v[76:79], a[216:219], a[12:15]
    v_perm_b32 v80, v6, v2, s60
    v_perm_b32 v81, v14, v10, s60
    v_perm_b32 v82, v22, v18, s60
    v_perm_b32 v83, v30, v26, s60
    s_nop 1
    v_mfma_f32_16x16x32_bf16 a[16:19], v[80:83], a[216:219], a[16:19]
    v_perm_b32 v84, v6, v2, s61
    v_perm_b32 v85, v14, v10, s61
    v_perm_b32 v86, v22, v18, s61
    v_perm_b32 v87, v30, v26, s61
    s_nop 1
    v_mfma_f32_16x16x32_bf16 a[20:23], v[84:87], a[216:219], a[20:23]
    v_perm_b32 v88, v7, v3, s60
    v_perm_b32 v89, v15, v11, s60
    v_perm_b32 v90, v23, v19, s60
    v_perm_b32 v91, v31, v27, s60
    s_nop 1
    v_mfma_f32_16x16x32_bf16 a[24:27], v[88:91], a[216:219], a[24:27]
    v_perm_b32 v92, v7, v3, s61
    v_perm_b32 v93, v15, v11, s61
    v_perm_b32 v94, v23, v19, s61
    v_perm_b32 v95, v31, v27, s61
    s_nop 1
    v_mfma_f32_16x16x32_bf16 a[28:31], v[92:95], a[216:219], a[28:31]
    v_mfma_f32_16x16x32_bf16 a[32:35], v[64:67], a[220:223], a[32:35]
    v_subrev_u32 v117, s5, v117
    v_subrev_u32 v118, s5, v118
    v_subrev_u32 v119, s5, v119
    v_subrev_u32 v120, s5, v120
    ds_read_b128 v[192:195], v117 offset:0
    ds_read_b128 v[196:199], v118 offset:0
    ds_read_b128 v[200:203], v119 offset:0
    ds_read_b128 v[204:207], v120 offset:0
    v_mfma_f32_16x16x32_bf16 a[36:39], v[68:71], a[220:223], a[36:39]
    s_add_u32 s73, s62, 12288
    s_add_u32 m0, s92, 12288
    s_nop 0
    buffer_load_dwordx4 v246, s[28:31], s73 offen nt lds
    v_accvgpr_read_b32 v251, a0
    v_mfma_f32_16x16x32_bf16 a[40:43], v[72:75], a[220:223], a[40:43]
    v_accvgpr_read_b32 v252, a4
    v_cvt_pk_bf16_f32 v32, v251, v252
    v_accvgpr_read_b32 v253, a8
    v_mfma_f32_16x16x32_bf16 a[44:47], v[76:79], a[220:223], a[44:47]
    v_accvgpr_read_b32 v254, a12
    v_cvt_pk_bf16_f32 v33, v253, v254
    v_accvgpr_read_b32 v251, a16
    v_mfma_f32_16x16x32_bf16 a[48:51], v[80:83], a[220:223], a[48:51]
    v_accvgpr_read_b32 v252, a20
    v_cvt_pk_bf16_f32 v34, v251, v252
    v_accvgpr_read_b32 v253, a24
    v_accvgpr_read_b32 v254, a28
    v_mfma_f32_16x16x32_bf16 a[52:55], v[84:87], a[220:223], a[52:55]
    v_cvt_pk_bf16_f32 v35, v253, v254
    v_accvgpr_read_b32 v251, a1
    v_accvgpr_read_b32 v252, a5
    v_mfma_f32_16x16x32_bf16 a[56:59], v[88:91], a[220:223], a[56:59]
    v_cvt_pk_bf16_f32 v36, v251, v252
    v_accvgpr_read_b32 v253, a9
    v_accvgpr_read_b32 v254, a13
    v_mfma_f32_16x16x32_bf16 a[60:63], v[92:95], a[220:223], a[60:63]
    v_cvt_pk_bf16_f32 v37, v253, v254
    v_accvgpr_read_b32 v251, a17
    v_accvgpr_read_b32 v252, a21
    v_mfma_f32_16x16x32_bf16 a[64:67], v[64:67], a[224:227], a[64:67]
    ds_read_b128 v[208:211], v117 offset:4096
    ds_read_b128 v[212:215], v118 offset:4096
    ds_read_b128 v[216:219], v119 offset:4096
    ds_read_b128 v[220:223], v120 offset:4096
    v_mfma_f32_16x16x32_bf16 a[68:71], v[68:71], a[224:227], a[68:71]
    s_add_u32 s73, s62, 13312
    s_add_u32 m0, s92, 13312
    s_nop 0
    buffer_load_dwordx4 v245, s[28:31], s73 offen nt lds
    s_add_u32 s73, s62, 14336
    v_mfma_f32_16x16x32_bf16 a[72:75], v[72:75], a[224:227], a[72:75]
    s_add_u32 m0, s92, 14336
    s_nop 0
    buffer_load_dwordx4 v246, s[28:31], s73 offen nt lds
    v_cvt_pk_bf16_f32 v38, v251, v252
    v_accvgpr_read_b32 v253, a25
    v_mfma_f32_16x16x32_bf16 a[76:79], v[76:79], a[224:227], a[76:79]
    v_accvgpr_read_b32 v254, a29
    v_cvt_pk_bf16_f32 v39, v253, v254
    v_accvgpr_read_b32 v251, a2
    v_accvgpr_read_b32 v252, a6
    v_mfma_f32_16x16x32_bf16 a[80:83], v[80:83], a[224:227], a[80:83]
    v_cvt_pk_bf16_f32 v40, v251, v252
    v_accvgpr_read_b32 v253, a10
    v_accvgpr_read_b32 v254, a14
    v_mfma_f32_16x16x32_bf16 a[84:87], v[84:87], a[224:227], a[84:87]
    v_cvt_pk_bf16_f32 v41, v253, v254
    v_accvgpr_read_b32 v251, a18
    v_accvgpr_read_b32 v252, a22
    v_cvt_pk_bf16_f32 v42, v251, v252
    v_mfma_f32_16x16x32_bf16 a[88:91], v[88:91], a[224:227], a[88:91]
    v_accvgpr_read_b32 v253, a26
    v_accvgpr_read_b32 v254, a30
    v_cvt_pk_bf16_f32 v43, v253, v254
    v_accvgpr_read_b32 v251, a3
    v_mfma_f32_16x16x32_bf16 a[92:95], v[92:95], a[224:227], a[92:95]
    v_accvgpr_read_b32 v252, a7
    v_cvt_pk_bf16_f32 v44, v251, v252
    v_accvgpr_read_b32 v253, a11
    v_mfma_f32_16x16x32_bf16 a[96:99], v[64:67], a[228:231], a[96:99]
    v_mfma_f32_16x16x32_bf16 a[100:103], v[68:71], a[228:231], a[100:103]
    s_add_u32 s73, s62, 15360
    s_add_u32 m0, s92, 15360
    s_nop 0
    buffer_load_dwordx4 v245, s[28:31], s73 offen nt lds
    v_accvgpr_read_b32 v254, a15
    v_mfma_f32_16x16x32_bf16 a[104:107], v[72:75], a[228:231], a[104:107]
    v_cvt_pk_bf16_f32 v45, v253, v254
    v_accvgpr_read_b32 v251, a19
    v_accvgpr_read_b32 v252, a23
    v_mfma_f32_16x16x32_bf16 a[108:111], v[76:79], a[228:231], a[108:111]
    v_cvt_pk_bf16_f32 v46, v251, v252
    v_accvgpr_read_b32 v253, a27
    v_accvgpr_read_b32 v254, a31
    v_mfma_f32_16x16x32_bf16 a[112:115], v[80:83], a[228:231], a[112:115]
    v_cvt_pk_bf16_f32 v47, v253, v254
    v_accvgpr_read_b32 v251, a32
    v_accvgpr_read_b32 v252, a36
    v_cvt_pk_bf16_f32 v48, v251, v252
    v_mfma_f32_16x16x32_bf16 a[116:119], v[84:87], a[228:231], a[116:119]
    v_accvgpr_read_b32 v253, a40
    v_accvgpr_read_b32 v254, a44
    v_cvt_pk_bf16_f32 v49, v253, v254
    v_mfma_f32_16x16x32_bf16 a[120:123], v[88:91], a[228:231], a[120:123]
    v_accvgpr_read_b32 v251, a48
    v_accvgpr_read_b32 v252, a52
    v_cvt_pk_bf16_f32 v50, v251, v252
    v_mfma_f32_16x16x32_bf16 a[124:127], v[92:95], a[228:231], a[124:127]
    v_accvgpr_read_b32 v253, a56
    v_accvgpr_read_b32 v254, a60
    v_cvt_pk_bf16_f32 v51, v253, v254
    v_mfma_f32_16x16x32_bf16 a[128:131], v[64:67], a[232:235], a[128:131]
    v_mfma_f32_16x16x32_bf16 a[132:135], v[68:71], a[232:235], a[132:135]
    v_accvgpr_read_b32 v251, a33
    v_accvgpr_read_b32 v252, a37
    v_cvt_pk_bf16_f32 v52, v251, v252
    v_mfma_f32_16x16x32_bf16 a[136:139], v[72:75], a[232:235], a[136:139]
    v_accvgpr_read_b32 v253, a41
    v_accvgpr_read_b32 v254, a45
    v_cvt_pk_bf16_f32 v53, v253, v254
    v_mfma_f32_16x16x32_bf16 a[140:143], v[76:79], a[232:235], a[140:143]
    v_accvgpr_read_b32 v251, a49
    v_accvgpr_read_b32 v252, a53
    v_cvt_pk_bf16_f32 v54, v251, v252
    v_mfma_f32_16x16x32_bf16 a[144:147], v[80:83], a[232:235], a[144:147]
    v_accvgpr_read_b32 v253, a57
    v_accvgpr_read_b32 v254, a61
    v_cvt_pk_bf16_f32 v55, v253, v254
    v_mfma_f32_16x16x32_bf16 a[148:151], v[84:87], a[232:235], a[148:151]
    v_accvgpr_read_b32 v251, a34
    v_accvgpr_read_b32 v252, a38
    v_cvt_pk_bf16_f32 v56, v251, v252
    v_mfma_f32_16x16x32_bf16 a[152:155], v[88:91], a[232:235], a[152:155]
    v_accvgpr_read_b32 v253, a42
    v_accvgpr_read_b32 v254, a46
    v_cvt_pk_bf16_f32 v57, v253, v254
    v_mfma_f32_16x16x32_bf16 a[156:159], v[92:95], a[232:235], a[156:159]
    v_accvgpr_read_b32 v251, a50
    v_accvgpr_read_b32 v252, a54
    v_mfma_f32_16x16x32_bf16 a[160:163], v[64:67], a[236:239], a[160:163]
    v_mfma_f32_16x16x32_bf16 a[164:167], v[68:71], a[236:239], a[164:167]
    v_cvt_pk_bf16_f32 v58, v251, v252
    v_accvgpr_read_b32 v253, a58
    v_accvgpr_read_b32 v254, a62
    v_mfma_f32_16x16x32_bf16 a[168:171], v[72:75], a[236:239], a[168:171]
    v_cvt_pk_bf16_f32 v59, v253, v254
    v_accvgpr_read_b32 v251, a35
    v_mfma_f32_16x16x32_bf16 a[172:175], v[76:79], a[236:239], a[172:175]
    v_accvgpr_read_b32 v252, a39
    v_cvt_pk_bf16_f32 v60, v251, v252
    v_mfma_f32_16x16x32_bf16 a[176:179], v[80:83], a[236:239], a[176:179]
    v_accvgpr_read_b32 v253, a43
    v_accvgpr_read_b32 v254, a47
    v_cvt_pk_bf16_f32 v61, v253, v254
    v_mfma_f32_16x16x32_bf16 a[180:183], v[84:87], a[236:239], a[180:183]
    v_accvgpr_read_b32 v251, a51
    v_accvgpr_read_b32 v252, a55
    v_mfma_f32_16x16x32_bf16 a[184:187], v[88:91], a[236:239], a[184:187]
    v_cvt_pk_bf16_f32 v62, v251, v252
    v_accvgpr_read_b32 v253, a59
    v_mfma_f32_16x16x32_bf16 a[188:191], v[92:95], a[236:239], a[188:191]
    v_accvgpr_read_b32 v254, a63
    v_cvt_pk_bf16_f32 v63, v253, v254
    s_lshl_b32 s72, s3, 13
    v_add_u32 v241, s72, v248
    s_nop 7
    s_branch join
cls2:
    s_add_u32 s72, s82, 0
    s_and_b32 s72, s72, 0x3ff
    s_add_u32 s72, s72, s86
    s_add_u32 m0, s89, 0
    s_nop 0
    buffer_load_dwordx4 v251, s[20:23], s72 offen lds
    s_add_u32 s72, s82, 0
    s_and_b32 s72, s72, 0x3ff
    s_add_u32 s72, s72, s87
    s_add_u32 m0, s90, 0
    s_nop 0
    buffer_load_dwordx4 v252, s[20:23], s72 offen lds
    s_add_u32 s72, s82, 0
    s_and_b32 s72, s72, 0x3ff
    s_add_u32 s72, s72, s88
    s_add_u32 m0, s91, 0
    s_nop 0
    buffer_load_dwordx4 v253, s[20:23], s72 offen lds
    buffer_load_dwordx4 v[192:195], v240, s[32:35], 0 offen
    buffer_load_dwordx4 v[196:199], v240, s[32:35], s52 offen
    buffer_load_dwordx4 v[200:203], v240, s[32:35], s53 offen
    buffer_load_dwordx4 v[204:207], v240, s[32:35], s54 offen
    buffer_load_dwordx4 v[208:211], v240, s[32:35], s55 offen
    buffer_load_dwordx4 v[212:215], v240, s[32:35], s56 offen
    buffer_load_dwordx4 v[216:219], v240, s[32:35], s57 offen
    buffer_load_dwordx4 v[220:223], v240, s[32:35], s58 offen
    s_add_u32 s72, s82, 128
    s_and_b32 s72, s72, 0x3ff
    s_add_u32 s72, s72, s86
    s_add_u32 m0, s89, 12288
    s_nop 0
    buffer_load_dwordx4 v251, s[20:23], s72 offen lds
    s_add_u32 s72, s82, 128
    s_and_b32 s72, s72, 0x3ff
    s_add_u32 s72, s72, s87
    s_add_u32 m0, s90, 12288
    s_nop 0
    buffer_load_dwordx4 v252, s[20:23], s72 offen lds
    s_add_u32 s72, s82, 128
    s_and_b32 s72, s72, 0x3ff
    s_add_u32 s72, s72, s88
    s_add_u32 m0, s91, 12288
    s_nop 0
    buffer_load_dwordx4 v253, s[20:23], s72 offen lds
    v_add_u32 v240, s81, v240
    v_and_b32 v240, 0x3fffff, v240
    buffer_load_dwordx4 v[32:35], v240, s[32:35], 0 offen
    buffer_load_dwordx4 v[36:39], v240, s[32:35], s52 offen
    buffer_load_dwordx4 v[40:43], v240, s[32:35], s53 offen
    buffer_load_dwordx4 v[44:47], v240, s[32:35], s54 offen
    buffer_load_dwordx4 v[48:51], v240, s[32:35], s55 offen
    buffer_load_dwordx4 v[52:55], v240, s[32:35], s56 offen
    buffer_load_dwordx4 v[56:59], v240, s[32:35], s57 offen
    buffer_load_dwordx4 v[60:63], v240, s[32:35], s58 offen
    buffer_load_dword v254, v112, s[32:35], 0 offen
    s_waitcnt vmcnt(9)
    s_barrier
    ds_read_b128 a[192:195], v241 offset:0
    ds_read_b128 a[196:199], v241 offset:2048
    ds_read_b128 a[200:203], v241 offset:4096
    ds_read_b128 a[204:207], v241 offset:6144
    ds_read_b128 a[208:211], v241 offset:8192
    ds_read_b128 a[212:215], v241 offset:10240
    v_perm_b32 v96, v196, v192, s60
    v_perm_b32 v97, v204, v200, s60
    v_perm_b32 v98, v212, v208, s60
    v_perm_b32 v99, v220, v216, s60
    s_waitcnt lgkmcnt(0)
    s_nop 0
    v_mfma_f32_16x16x32_bf16 a[0:3], v[96:99], a[192:195], 0
    v_perm_b32 v100, v196, v192, s61
    v_perm_b32 v101, v204, v200, s61
    v_mfma_f32_16x16x32_bf16 a[32:35], v[96:99], a[196:199], 0
    v_perm_b32 v102, v212, v208, s61
    v_mfma_f32_16x16x32_bf16 a[64:67], v[96:99], a[200:203], 0
    v_perm_b32 v103, v220, v216, s61
    v_mfma_f32_16x16x32_bf16 a[96:99], v[96:99], a[204:207], 0
    v_add_u32 v240, s80, v240
    v_mfma_f32_16x16x32_bf16 a[128:131], v[96:99], a[208:211], 0
    v_and_b32 v240, 0x3fffff, v240
    v_mfma_f32_16x16x32_bf16 a[160:163], v[96:99], a[212:215], 0
    buffer_load_dwordx4 v[64:67], v240, s[32:35], 0 offen
    v_mfma_f32_16x16x32_bf16 a[4:7], v[100:103], a[192:195], 0
    v_perm_b32 v104, v197, v193, s60
    v_mfma_f32_16x16x32_bf16 a[36:39], v[100:103], a[196:199], 0
    v_perm_b32 v105, v205, v201, s60
    v_mfma_f32_16x16x32_bf16 a[68:71], v[100:103], a[200:203], 0
    v_perm_b32 v106, v213, v209, s60
    v_mfma_f32_16x16x32_bf16 a[100:103], v[100:103], a[204:207], 0
    v_perm_b32 v107, v221, v217, s60
    v_mfma_f32_16x16x32_bf16 a[132:135], v[100:103], a[208:211], 0
    buffer_load_dwordx4 v[68:71], v240, s[32:35], s52 offen
    v_mfma_f32_16x16x32_bf16 a[164:167], v[100:103], a[212:215], 0
    buffer_load_dwordx4 v[72:75], v240, s[32:35], s53 offen
    v_mfma_f32_16x16x32_bf16 a[8:11], v[104:107], a[192:195], 0
    v_perm_b32 v108, v197, v193, s61
    v_mfma_f32_16x16x32_bf16 a[40:43], v[104:107], a[196:199], 0
    v_perm_b32 v109, v205, v201, s61
    v_mfma_f32_16x16x32_bf16 a[72:75], v[104:107], a[200:203], 0
    v_perm_b32 v110, v213, v209, s61
    v_mfma_f32_16x16x32_bf16 a[104:107], v[104:107], a[204:207], 0
    v_perm_b32 v111, v221, v217, s61
    v_mfma_f32_16x16x32_bf16 a[136:139], v[104:107], a[208:211], 0
    buffer_load_dwordx4 v[76:79], v240, s[32:35], s54 offen
    v_mfma_f32_16x16x32_bf16 a[168:171], v[104:107], a[212:215], 0
    buffer_load_dwordx4 v[80:83], v240, s[32:35], s55 offen
    v_mfma_f32_16x16x32_bf16 a[12:15], v[108:111], a[192:195], 0
    v_perm_b32 v96, v198, v194, s60
    v_perm_b32 v97, v206, v202, s60
    v_mfma_f32_16x16x32_bf16 a[44:47], v[108:111], a[196:199], 0
    v_perm_b32 v98, v214, v210, s60
    v_mfma_f32_16x16x32_bf16 a[76:79], v[108:111], a[200:203], 0
    v_perm_b32 v99, v222, v218, s60
    v_mfma_f32_16x16x32_bf16 a[108:111], v[108:111], a[204:207], 0
    buffer_load_dwordx4 v[84:87], v240, s[32:35], s56 offen
    buffer_load_dwordx4 v[88:91], v240, s[32:35], s57 offen
    v_mfma_f32_16x16x32_bf16 a[140:143], v[108:111], a[208:211], 0
    ds_read_b128 a[216:219], v242 offset:0
    v_mfma_f32_16x16x32_bf16 a[172:175], v[108:111], a[212:215], 0
    ds_read_b128 a[220:223], v242 offset:2048
    v_mfma_f32_16x16x32_bf16 a[16:19], v[96:99], a[192:195], 0
    v_perm_b32 v100, v198, v194, s61
    v_perm_b32 v101, v206, v202, s61
    v_mfma_f32_16x16x32_bf16 a[48:51], v[96:99], a[196:199], 0
    v_perm_b32 v102, v214, v210, s61
    v_mfma_f32_16x16x32_bf16 a[80:83], v[96:99], a[200:203], 0
    v_perm_b32 v103, v222, v218, s61
    v_mfma_f32_16x16x32_bf16 a[112:115], v[96:99], a[204:207], 0
    buffer_load_dwordx4 v[92:95], v240, s[32:35], s58 offen
    v_mfma_f32_16x16x32_bf16 a[144:147], v[96:99], a[208:211], 0
    ds_read_b128 a[224:227], v242 offset:4096
    v_mfma_f32_16x16x32_bf16 a[176:179], v[96:99], a[212:215], 0
    ds_read_b128 a[228:231], v242 offset:6144
    v_mfma_f32_16x16x32_bf16 a[20:23], v[100:103], a[192:195], 0
    v_perm_b32 v104, v199, v195, s60
    v_perm_b32 v105, v207, v203, s60
    v_mfma_f32_16x16x32_bf16 a[52:55], v[100:103], a[196:199], 0
    v_perm_b32 v106, v215, v211, s60
    v_perm_b32 v107, v223, v219, s60
    v_mfma_f32_16x16x32_bf16 a[84:87], v[100:103], a[200:203], 0
    s_add_u32 s72, s82, 256
    s_and_b32 s72, s72, 0x3ff
    v_mfma_f32_16x16x32_bf16 a[116:119], v[100:103], a[204:207], 0
    s_add_u32 s72, s72, s86
    s_add_u32 m0, s89, 24576
    v_mfma_f32_16x16x32_bf16 a[148:151], v[100:103], a[208:211], 0
    buffer_load_dwordx4 v251, s[20:23], s72 offen lds
    ds_read_b128 a[232:235], v242 offset:8192
    v_mfma_f32_16x16x32_bf16 a[180:183], v[100:103], a[212:215], 0
    ds_read_b128 a[236:239], v242 offset:10240
    v_mfma_f32_16x16x32_bf16 a[24:27], v[104:107], a[192:195], 0
    v_perm_b32 v108, v199, v195, s61
    v_perm_b32 v109, v207, v203, s61
    v_mfma_f32_16x16x32_bf16 a[56:59], v[104:107], a[196:199], 0
    v_perm_b32 v110, v215, v211, s61
    v_mfma_f32_16x16x32_bf16 a[88:91], v[104:107], a[200:203], 0
    v_perm_b32 v111, v223, v219, s61
    s_add_u32 s72, s82, 256
    v_mfma_f32_16x16x32_bf16 a[120:123], v[104:107], a[204:207], 0
    s_and_b32 s72, s72, 0x3ff
    v_mfma_f32_16x16x32_bf16 a[152:155], v[104:107], a[208:211], 0
    s_add_u32 s72, s72, s87
    s_add_u32 m0, s90, 24576
    v_mfma_f32_16x16x32_bf16 a[184:187], v[104:107], a[212:215], 0
    buffer_load_dwordx4 v252, s[20:23], s72 offen lds
    v_mfma_f32_16x16x32_bf16 a[28:31], v[108:111], a[192:195], 0
    s_waitcnt vmcnt(11)
    v_perm_b32 v96, v36, v32, s60
    v_mfma_f32_16x16x32_bf16 a[60:63], v[108:111], a[196:199], 0
    v_perm_b32 v97, v44, v40, s60
    v_perm_b32 v98, v52, v48, s60
    v_mfma_f32_16x16x32_bf16 a[92:95], v[108:111], a[200:203], 0
    v_perm_b32 v99, v60, v56, s60
    v_mfma_f32_16x16x32_bf16 a[124:127], v[108:111], a[204:207], 0
    s_add_u32 s72, s82, 256
    s_and_b32 s72, s72, 0x3ff
    v_mfma_f32_16x16x32_bf16 a[156:159], v[108:111], a[208:211], 0
    s_add_u32 s72, s72, s88
    s_add_u32 m0, s91, 24576
    v_mfma_f32_16x16x32_bf16 a[188:191], v[108:111], a[212:215], 0
    buffer_load_dwordx4 v253, s[20:23], s72 offen lds
    s_waitcnt lgkmcnt(0)
    v_mfma_f32_16x16x32_bf16 a[0:3], v[96:99], a[216:219], a[0:3]
    v_perm_b32 v100, v36, v32, s61
    v_mfma_f32_16x16x32_bf16 a[32:35], v[96:99], a[220:223], a[32:35]
    v_perm_b32 v101, v44, v40, s61
    v_mfma_f32_16x16x32_bf16 a[64:67], v[96:99], a[224:227], a[64:67]
    v_mfma_f32_16x16x32_bf16 a[96:99], v[96:99], a[228:231], a[96:99]
    v_perm_b32 v102, v52, v48, s61
    v_mfma_f32_16x16x32_bf16 a[128:131], v[96:99], a[232:235], a[128:131]
    v_perm_b32 v103, v60, v56, s61
    v_mfma_f32_16x16x32_bf16 a[160:163], v[96:99], a[236:239], a[160:163]
    s_nop 0
    v_mfma_f32_16x16x32_bf16 a[4:7], v[100:103], a[216:219], a[4:7]
    v_perm_b32 v104, v37, v33, s60
    v_perm_b32 v105, v45, v41, s60
    v_mfma_f32_16x16x32_bf16 a[36:39], v[100:103], a[220:223], a[36:39]
    v_perm_b32 v106, v53, v49, s60
    v_mfma_f32_16x16x32_bf16 a[68:71], v[100:103], a[224:227], a[68:71]
    v_perm_b32 v107, v61, v57, s60
    s_add_u32 s72, s82, 384
    v_mfma_f32_16x16x32_bf16 a[100:103], v[100:103], a[228:231], a[100:103]
    s_and_b32 s72, s72, 0x3ff
    v_mfma_f32_16x16x32_bf16 a[132:135], v[100:103], a[232:235], a[132:135]
    s_add_u32 s72, s72, s86
    s_add_u32 m0, s89, 36864
    v_mfma_f32_16x16x32_bf16 a[164:167], v[100:103], a[236:239], a[164:167]
    buffer_load_dwordx4 v251, s[20:23], s72 offen lds
    v_mfma_f32_16x16x32_bf16 a[8:11], v[104:107], a[216:219], a[8:11]
    v_perm_b32 v108, v37, v33, s61
    v_perm_b32 v109, v45, v41, s61
    v_mfma_f32_16x16x32_bf16 a[40:43], v[104:107], a[220:223], a[40:43]
    v_perm_b32 v110, v53, v49, s61
    v_mfma_f32_16x16x32_bf16 a[72:75], v[104:107], a[224:227], a[72:75]
    v_perm_b32 v111, v61, v57, s61
    s_add_u32 s72, s82, 384
    v_mfma_f32_16x16x32_bf16 a[104:107], v[104:107], a[228:231], a[104:107]
    s_and_b32 s72, s72, 0x3ff
    v_mfma_f32_16x16x32_bf16 a[136:139], v[104:107], a[232:235], a[136:139]
    s_add_u32 s72, s72, s87
    s_add_u32 m0, s90, 36864
    v_mfma_f32_16x16x32_bf16 a[168:171], v[104:107], a[236:239], a[168:171]
    buffer_load_dwordx4 v252, s[20:23], s72 offen lds
    v_mfma_f32_16x16x32_bf16 a[12:15], v[108:111], a[216:219], a[12:15]
    v_perm_b32 v96, v38, v34, s60
    v_perm_b32 v97, v46, v42, s60
    v_mfma_f32_16x16x32_bf16 a[44:47], v[108:111], a[220:223], a[44:47]
    v_perm_b32 v98, v54, v50, s60
    v_perm_b32 v99, v62, v58, s60
    v_mfma_f32_16x16x32_bf16 a[76:79], v[108:111], a[224:227], a[76:79]
    s_add_u32 s72, s82, 384
    s_and_b32 s72, s72, 0x3ff
    v_mfma_f32_16x16x32_bf16 a[108:111], v[108:111], a[228:231], a[108:111]
    s_add_u32 s72, s72, s88
    s_add_u32 m0, s91, 36864
    v_mfma_f32_16x16x32_bf16 a[140:143], v[108:111], a[232:235], a[140:143]
    buffer_load_dwordx4 v253, s[20:23], s72 offen lds
    ds_read_b128 a[192:195], v241 offset:12288
    v_mfma_f32_16x16x32_bf16 a[172:175], v[108:111], a[236:239], a[172:175]
    ds_read_b128 a[196:199], v241 offset:14336
    v_mfma_f32_16x16x32_bf16 a[16:19], v[96:99], a[216:219], a[16:19]
    v_perm_b32 v100, v38, v34, s61
    v_perm_b32 v101, v46, v42, s61
    v_mfma_f32_16x16x32_bf16 a[48:51], v[96:99], a[220:223], a[48:51]
    v_perm_b32 v102, v54, v50, s61
    v_perm_b32 v103, v62, v58, s61
    v_mfma_f32_16x16x32_bf16 a[80:83], v[96:99], a[224:227], a[80:83]
    v_add_u32 v240, s81, v240
    v_mfma_f32_16x16x32_bf16 a[112:115], v[96:99], a[228:231], a[112:115]
    v_and_b32 v240, 0x3fffff, v240
    buffer_load_dwordx4 v[0:3], v240, s[32:35], 0 offen
    v_mfma_f32_16x16x32_bf16 a[144:147], v[96:99], a[232:235], a[144:147]
    buffer_load_dwordx4 v[4:7], v240, s[32:35], s52 offen
    ds_read_b128 a[200:203], v241 offset:16384
    v_mfma_f32_16x16x32_bf16 a[176:179], v[96:99], a[236:239], a[176:179]
    ds_read_b128 a[204:207], v241 offset:18432
    v_mfma_f32_16x16x32_bf16 a[20:23], v[100:103], a[216:219], a[20:23]
    v_perm_b32 v104, v39, v35, s60
    v_perm_b32 v105, v47, v43, s60
    v_mfma_f32_16x16x32_bf16 a[52:55], v[100:103], a[220:223], a[52:55]
    v_perm_b32 v106, v55, v51, s60
    v_mfma_f32_16x16x32_bf16 a[84:87], v[100:103], a[224:227], a[84:87]
    v_perm_b32 v107, v63, v59, s60
    v_mfma_f32_16x16x32_bf16 a[116:119], v[100:103], a[228:231], a[116:119]
    buffer_load_dwordx4 v[8:11], v240, s[32:35], s53 offen
    buffer_load_dwordx4 v[12:15], v240, s[32:35], s54 offen
    v_mfma_f32_16x16x32_bf16 a[148:151], v[100:103], a[232:235], a[148:151]
    ds_read_b128 a[208:211], v241 offset:20480
    v_mfma_f32_16x16x32_bf16 a[180:183], v[100:103], a[236:239], a[180:183]
    ds_read_b128 a[212:215], v241 offset:22528
    v_mfma_f32_16x16x32_bf16 a[24:27], v[104:107], a[216:219], a[24:27]
    v_perm_b32 v108, v39, v35, s61
    v_mfma_f32_16x16x32_bf16 a[56:59], v[104:107], a[220:223], a[56:59]
    v_perm_b32 v109, v47, v43, s61
    v_mfma_f32_16x16x32_bf16 a[88:91], v[104:107], a[224:227], a[88:91]
    v_perm_b32 v110, v55, v51, s61
    v_mfma_f32_16x16x32_bf16 a[120:123], v[104:107], a[228:231], a[120:123]
    v_perm_b32 v111, v63, v59, s61
    v_mfma_f32_16x16x32_bf16 a[152:155], v[104:107], a[232:235], a[152:155]
    buffer_load_dwordx4 v[16:19], v240, s[32:35], s55 offen
    v_mfma_f32_16x16x32_bf16 a[184:187], v[104:107], a[236:239], a[184:187]
    v_mfma_f32_16x16x32_bf16 a[28:31], v[108:111], a[216:219], a[28:31]
    s_waitcnt vmcnt(11)
    v_perm_b32 v96, v68, v64, s60
    v_mfma_f32_16x16x32_bf16 a[60:63], v[108:111], a[220:223], a[60:63]
    v_perm_b32 v97, v76, v72, s60
    v_mfma_f32_16x16x32_bf16 a[92:95], v[108:111], a[224:227], a[92:95]
    v_perm_b32 v98, v84, v80, s60
    v_mfma_f32_16x16x32_bf16 a[124:127], v[108:111], a[228:231], a[124:127]
    v_perm_b32 v99, v92, v88, s60
    v_mfma_f32_16x16x32_bf16 a[156:159], v[108:111], a[232:235], a[156:159]
    buffer_load_dwordx4 v[20:23], v240, s[32:35], s56 offen
    v_mfma_f32_16x16x32_bf16 a[188:191], v[108:111], a[236:239], a[188:191]
    buffer_load_dwordx4 v[24:27], v240, s[32:35], s57 offen
    s_waitcnt lgkmcnt(0)
    v_mfma_f32_16x16x32_bf16 a[0:3], v[96:99], a[192:195], a[0:3]
    v_perm_b32 v100, v68, v64, s61
    v_perm_b32 v101, v76, v72, s61
    v_mfma_f32_16x16x32_bf16 a[32:35], v[96:99], a[196:199], a[32:35]
    v_perm_b32 v102, v84, v80, s61
    v_mfma_f32_16x16x32_bf16 a[64:67], v[96:99], a[200:203], a[64:67]
    v_perm_b32 v103, v92, v88, s61
    v_mfma_f32_16x16x32_bf16 a[96:99], v[96:99], a[204:207], a[96:99]
    buffer_load_dwordx4 v[28:31], v240, s[32:35], s58 offen
    v_add_u32 v240, s80, v240
    v_mfma_f32_16x16x32_bf16 a[128:131], v[96:99], a[208:211], a[128:131]
    v_and_b32 v240, 0x3fffff, v240
    v_mfma_f32_16x16x32_bf16 a[160:163], v[96:99], a[212:215], a[160:163]
    buffer_load_dwordx4 v[128:131], v240, s[32:35], 0 offen
    v_mfma_f32_16x16x32_bf16 a[4:7], v[100:103], a[192:195], a[4:7]
    v_perm_b32 v104, v69, v65, s60
    v_mfma_f32_16x16x32_bf16 a[36:39], v[100:103], a[196:199], a[36:39]
    v_perm_b32 v105, v77, v73, s60
    v_mfma_f32_16x16x32_bf16 a[68:71], v[100:103], a[200:203], a[68:71]
    v_perm_b32 v106, v85, v81, s60
    v_mfma_f32_16x16x32_bf16 a[100:103], v[100:103], a[204:207], a[100:103]
    v_perm_b32 v107, v93, v89, s60
    v_mfma_f32_16x16x32_bf16 a[132:135], v[100:103], a[208:211], a[132:135]
    buffer_load_dwordx4 v[132:135], v240, s[32:35], s52 offen
    v_mfma_f32_16x16x32_bf16 a[164:167], v[100:103], a[212:215], a[164:167]
    buffer_load_dwordx4 v[136:139], v240, s[32:35], s53 offen
    v_mfma_f32_16x16x32_bf16 a[8:11], v[104:107], a[192:195], a[8:11]
    v_perm_b32 v108, v69, v65, s61
    v_mfma_f32_16x16x32_bf16 a[40:43], v[104:107], a[196:199], a[40:43]
    v_perm_b32 v109, v77, v73, s61
    v_mfma_f32_16x16x32_bf16 a[72:75], v[104:107], a[200:203], a[72:75]
    v_perm_b32 v110, v85, v81, s61
    v_mfma_f32_16x16x32_bf16 a[104:107], v[104:107], a[204:207], a[104:107]
    v_perm_b32 v111, v93, v89, s61
    v_mfma_f32_16x16x32_bf16 a[136:139], v[104:107], a[208:211], a[136:139]
    buffer_load_dwordx4 v[140:143], v240, s[32:35], s54 offen
    v_mfma_f32_16x16x32_bf16 a[168:171], v[104:107], a[212:215], a[168:171]
    v_mfma_f32_16x16x32_bf16 a[12:15], v[108:111], a[192:195], a[12:15]
    v_perm_b32 v96, v70, v66, s60
    v_perm_b32 v97, v78, v74, s60
    v_mfma_f32_16x16x32_bf16 a[44:47], v[108:111], a[196:199], a[44:47]
    v_perm_b32 v98, v86, v82, s60
    v_mfma_f32_16x16x32_bf16 a[76:79], v[108:111], a[200:203], a[76:79]
    v_perm_b32 v99, v94, v90, s60
    v_mfma_f32_16x16x32_bf16 a[108:111], v[108:111], a[204:207], a[108:111]
    buffer_load_dwordx4 v[144:147], v240, s[32:35], s55 offen
    buffer_load_dwordx4 v[148:151], v240, s[32:35], s56 offen
    v_mfma_f32_16x16x32_bf16 a[140:143], v[108:111], a[208:211], a[140:143]
    ds_read_b128 a[216:219], v242 offset:12288
    v_mfma_f32_16x16x32_bf16 a[172:175], v[108:111], a[212:215], a[172:175]
    ds_read_b128 a[220:223], v242 offset:14336
    v_mfma_f32_16x16x32_bf16 a[16:19], v[96:99], a[192:195], a[16:19]
    v_perm_b32 v100, v70, v66, s61
    v_perm_b32 v101, v78, v74, s61
    v_mfma_f32_16x16x32_bf16 a[48:51], v[96:99], a[196:199], a[48:51]
    v_perm_b32 v102, v86, v82, s61
    v_mfma_f32_16x16x32_bf16 a[80:83], v[96:99], a[200:203], a[80:83]
    v_perm_b32 v103, v94, v90, s61
    v_mfma_f32_16x16x32_bf16 a[112:115], v[96:99], a[204:207], a[112:115]
    buffer_load_dwordx4 v[152:155], v240, s[32:35], s57 offen
    buffer_load_dwordx4 v[156:159], v240, s[32:35], s58 offen
    v_mfma_f32_16x16x32_bf16 a[144:147], v[96:99], a[208:211], a[144:147]
    ds_read_b128 a[224:227], v242 offset:16384
    v_mfma_f32_16x16x32_bf16 a[176:179], v[96:99], a[212:215], a[176:179]
    ds_read_b128 a[228:231], v242 offset:18432
    v_mfma_f32_16x16x32_bf16 a[20:23], v[100:103], a[192:195], a[20:23]
    v_perm_b32 v104, v71, v67, s60
    v_perm_b32 v105, v79, v75, s60
    v_mfma_f32_16x16x32_bf16 a[52:55], v[100:103], a[196:199], a[52:55]
    v_perm_b32 v106, v87, v83, s60
    v_perm_b32 v107, v95, v91, s60
    v_mfma_f32_16x16x32_bf16 a[84:87], v[100:103], a[200:203], a[84:87]
    v_add_u32 v240, s81, v240
    v_mfma_f32_16x16x32_bf16 a[116:119], v[100:103], a[204:207], a[116:119]
    v_and_b32 v240, 0x3fffff, v240
    buffer_load_dwordx4 v[160:163], v240, s[32:35], 0 offen
    v_mfma_f32_16x16x32_bf16 a[148:151], v[100:103], a[208:211], a[148:151]
    buffer_load_dwordx4 v[164:167], v240, s[32:35], s52 offen
    ds_read_b128 a[232:235], v242 offset:20480
    v_mfma_f32_16x16x32_bf16 a[180:183], v[100:103], a[212:215], a[180:183]
    ds_read_b128 a[236:239], v242 offset:22528
    v_mfma_f32_16x16x32_bf16 a[24:27], v[104:107], a[192:195], a[24:27]
    v_perm_b32 v108, v71, v67, s61
    v_mfma_f32_16x16x32_bf16 a[56:59], v[104:107], a[196:199], a[56:59]
    v_perm_b32 v109, v79, v75, s61
    v_mfma_f32_16x16x32_bf16 a[88:91], v[104:107], a[200:203], a[88:91]
    v_perm_b32 v110, v87, v83, s61
    v_mfma_f32_16x16x32_bf16 a[120:123], v[104:107], a[204:207], a[120:123]
    v_perm_b32 v111, v95, v91, s61
    v_mfma_f32_16x16x32_bf16 a[152:155], v[104:107], a[208:211], a[152:155]
    buffer_load_dwordx4 v[168:171], v240, s[32:35], s53 offen
    v_mfma_f32_16x16x32_bf16 a[184:187], v[104:107], a[212:215], a[184:187]
    v_mfma_f32_16x16x32_bf16 a[28:31], v[108:111], a[192:195], a[28:31]
    s_waitcnt vmcnt(11)
    v_perm_b32 v96, v4, v0, s60
    v_mfma_f32_16x16x32_bf16 a[60:63], v[108:111], a[196:199], a[60:63]
    v_perm_b32 v97, v12, v8, s60
    v_mfma_f32_16x16x32_bf16 a[92:95], v[108:111], a[200:203], a[92:95]
    v_perm_b32 v98, v20, v16, s60
    v_mfma_f32_16x16x32_bf16 a[124:127], v[108:111], a[204:207], a[124:127]
    v_perm_b32 v99, v28, v24, s60
    v_mfma_f32_16x16x32_bf16 a[156:159], v[108:111], a[208:211], a[156:159]
    buffer_load_dwordx4 v[172:175], v240, s[32:35], s54 offen
    v_mfma_f32_16x16x32_bf16 a[188:191], v[108:111], a[212:215], a[188:191]
    buffer_load_dwordx4 v[176:179], v240, s[32:35], s55 offen
    s_waitcnt lgkmcnt(0)
    v_mfma_f32_16x16x32_bf16 a[0:3], v[96:99], a[216:219], a[0:3]
    v_perm_b32 v100, v4, v0, s61
    v_mfma_f32_16x16x32_bf16 a[32:35], v[96:99], a[220:223], a[32:35]
    v_perm_b32 v101, v12, v8, s61
    v_mfma_f32_16x16x32_bf16 a[64:67], v[96:99], a[224:227], a[64:67]
    v_perm_b32 v102, v20, v16, s61
    v_mfma_f32_16x16x32_bf16 a[96:99], v[96:99], a[228:231], a[96:99]
    v_perm_b32 v103, v28, v24, s61
    v_mfma_f32_16x16x32_bf16 a[128:131], v[96:99], a[232:235], a[128:131]
    buffer_load_dwordx4 v[180:183], v240, s[32:35], s56 offen
    v_mfma_f32_16x16x32_bf16 a[160:163], v[96:99], a[236:239], a[160:163]
    buffer_load_dwordx4 v[184:187], v240, s[32:35], s57 offen
    v_mfma_f32_16x16x32_bf16 a[4:7], v[100:103], a[216:219], a[4:7]
    v_perm_b32 v104, v5, v1, s60
    v_perm_b32 v105, v13, v9, s60
    v_mfma_f32_16x16x32_bf16 a[36:39], v[100:103], a[220:223], a[36:39]
    v_perm_b32 v106, v21, v17, s60
    v_mfma_f32_16x16x32_bf16 a[68:71], v[100:103], a[224:227], a[68:71]
    v_perm_b32 v107, v29, v25, s60
    v_mfma_f32_16x16x32_bf16 a[100:103], v[100:103], a[228:231], a[100:103]
    buffer_load_dwordx4 v[188:191], v240, s[32:35], s58 offen
    v_add_u32 v240, s80, v240
    v_mfma_f32_16x16x32_bf16 a[132:135], v[100:103], a[232:235], a[132:135]
    v_and_b32 v240, 0x3fffff, v240
    v_mfma_f32_16x16x32_bf16 a[164:167], v[100:103], a[236:239], a[164:167]
    buffer_load_dwordx4 v[192:195], v240, s[32:35], 0 offen
    v_mfma_f32_16x16x32_bf16 a[8:11], v[104:107], a[216:219], a[8:11]
    v_perm_b32 v108, v5, v1, s61
    v_mfma_f32_16x16x32_bf16 a[40:43], v[104:107], a[220:223], a[40:43]
    v_perm_b32 v109, v13, v9, s61
    v_mfma_f32_16x16x32_bf16 a[72:75], v[104:107], a[224:227], a[72:75]
    v_perm_b32 v110, v21, v17, s61
    v_mfma_f32_16x16x32_bf16 a[104:107], v[104:107], a[228:231], a[104:107]
    v_perm_b32 v111, v29, v25, s61
    v_mfma_f32_16x16x32_bf16 a[136:139], v[104:107], a[232:235], a[136:139]
    buffer_load_dwordx4 v[196:199], v240, s[32:35], s52 offen
    v_mfma_f32_16x16x32_bf16 a[168:171], v[104:107], a[236:239], a[168:171]
    buffer_load_dwordx4 v[200:203], v240, s[32:35], s53 offen
    v_mfma_f32_16x16x32_bf16 a[12:15], v[108:111], a[216:219], a[12:15]
    v_perm_b32 v96, v6, v2, s60
    v_perm_b32 v97, v14, v10, s60
    v_mfma_f32_16x16x32_bf16 a[44:47], v[108:111], a[220:223], a[44:47]
    v_perm_b32 v98, v22, v18, s60
    v_mfma_f32_16x16x32_bf16 a[76:79], v[108:111], a[224:227], a[76:79]
    v_perm_b32 v99, v30, v26, s60
    buffer_load_dwordx4 v[204:207], v240, s[32:35], s54 offen
    v_mfma_f32_16x16x32_bf16 a[108:111], v[108:111], a[228:231], a[108:111]
    v_mfma_f32_16x16x32_bf16 a[140:143], v[108:111], a[232:235], a[140:143]
    s_barrier
    ds_read_b128 a[192:195], v241 offset:24576
    v_mfma_f32_16x16x32_bf16 a[172:175], v[108:111], a[236:239], a[172:175]
    ds_read_b128 a[196:199], v241 offset:26624
    v_mfma_f32_16x16x32_bf16 a[16:19], v[96:99], a[216:219], a[16:19]
    v_perm_b32 v100, v6, v2, s61
    v_perm_b32 v101, v14, v10, s61
    v_mfma_f32_16x16x32_bf16 a[48:51], v[96:99], a[220:223], a[48:51]
    v_perm_b32 v102, v22, v18, s61
    v_mfma_f32_16x16x32_bf16 a[80:83], v[96:99], a[224:227], a[80:83]
    v_perm_b32 v103, v30, v26, s61
    v_mfma_f32_16x16x32_bf16 a[112:115], v[96:99], a[228:231], a[112:115]
    buffer_load_dwordx4 v[208:211], v240, s[32:35], s55 offen
    buffer_load_dwordx4 v[212:215], v240, s[32:35], s56 offen
    v_mfma_f32_16x16x32_bf16 a[144:147], v[96:99], a[232:235], a[144:147]
    ds_read_b128 a[200:203], v241 offset:28672
    v_mfma_f32_16x16x32_bf16 a[176:179], v[96:99], a[236:239], a[176:179]
    ds_read_b128 a[204:207], v241 offset:30720
    v_mfma_f32_16x16x32_bf16 a[20:23], v[100:103], a[216:219], a[20:23]
    v_perm_b32 v104, v7, v3, s60
    v_perm_b32 v105, v15, v11, s60
    v_mfma_f32_16x16x32_bf16 a[52:55], v[100:103], a[220:223], a[52:55]
    v_perm_b32 v106, v23, v19, s60
    v_mfma_f32_16x16x32_bf16 a[84:87], v[100:103], a[224:227], a[84:87]
    v_perm_b32 v107, v31, v27, s60
    v_mfma_f32_16x16x32_bf16 a[116:119], v[100:103], a[228:231], a[116:119]
    buffer_load_dwordx4 v[216:219], v240, s[32:35], s57 offen
    buffer_load_dwordx4 v[220:223], v240, s[32:35], s58 offen
    v_mfma_f32_16x16x32_bf16 a[148:151], v[100:103], a[232:235], a[148:151]
    ds_read_b128 a[208:211], v241 offset:32768
    v_mfma_f32_16x16x32_bf16 a[180:183], v[100:103], a[236:239], a[180:183]
    ds_read_b128 a[212:215], v241 offset:34816
    v_mfma_f32_16x16x32_bf16 a[24:27], v[104:107], a[216:219], a[24:27]
    v_perm_b32 v108, v7, v3, s61
    v_perm_b32 v109, v15, v11, s61
    v_perm_b32 v110, v23, v19, s61
    v_mfma_f32_16x16x32_bf16 a[56:59], v[104:107], a[220:223], a[56:59]
    v_perm_b32 v111, v31, v27, s61
    s_add_u32 s72, s82, 512
    v_mfma_f32_16x16x32_bf16 a[88:91], v[104:107], a[224:227], a[88:91]
    s_and_b32 s72, s72, 0x3ff
    s_add_u32 s72, s72, s86
    v_mfma_f32_16x16x32_bf16 a[120:123], v[104:107], a[228:231], a[120:123]
    s_add_u32 m0, s89, 49152
    s_nop 0
    buffer_load_dwordx4 v251, s[20:23], s72 offen lds
    s_add_u32 s72, s82, 512
    v_mfma_f32_16x16x32_bf16 a[152:155], v[104:107], a[232:235], a[152:155]
    s_and_b32 s72, s72, 0x3ff
    s_add_u32 s72, s72, s87
    v_mfma_f32_16x16x32_bf16 a[184:187], v[104:107], a[236:239], a[184:187]
    s_add_u32 m0, s90, 49152
    s_nop 0
    buffer_load_dwordx4 v252, s[20:23], s72 offen lds
    v_mfma_f32_16x16x32_bf16 a[28:31], v[108:111], a[216:219], a[28:31]
    s_waitcnt vmcnt(18)
    v_perm_b32 v96, v132, v128, s60
    v_mfma_f32_16x16x32_bf16 a[60:63], v[108:111], a[220:223], a[60:63]
    v_perm_b32 v97, v140, v136, s60
    v_perm_b32 v98, v148, v144, s60
    v_mfma_f32_16x16x32_bf16 a[92:95], v[108:111], a[224:227], a[92:95]
    v_perm_b32 v99, v156, v152, s60
    v_mfma_f32_16x16x32_bf16 a[124:127], v[108:111], a[228:231], a[124:127]
    s_add_u32 s72, s82, 512
    s_and_b32 s72, s72, 0x3ff
    v_mfma_f32_16x16x32_bf16 a[156:159], v[108:111], a[232:235], a[156:159]
    s_add_u32 s72, s72, s88
    s_add_u32 m0, s91, 49152
    v_mfma_f32_16x16x32_bf16 a[188:191], v[108:111], a[236:239], a[188:191]
    buffer_load_dwordx4 v253, s[20:23], s72 offen lds
    s_waitcnt lgkmcnt(0)
    v_mfma_f32_16x16x32_bf16 a[0:3], v[96:99], a[192:195], a[0:3]
    v_perm_b32 v100, v132, v128, s61
    v_perm_b32 v101, v140, v136, s61
    v_perm_b32 v102, v148, v144, s61
    v_mfma_f32_16x16x32_bf16 a[32:35], v[96:99], a[196:199], a[32:35]
    v_perm_b32 v103, v156, v152, s61
    s_add_u32 s72, s82, 640
    v_mfma_f32_16x16x32_bf16 a[64:67], v[96:99], a[200:203], a[64:67]
    s_and_b32 s72, s72, 0x3ff
    s_add_u32 s72, s72, s86
    v_mfma_f32_16x16x32_bf16 a[96:99], v[96:99], a[204:207], a[96:99]
    s_add_u32 m0, s89, 61440
    s_nop 0
    buffer_load_dwordx4 v251, s[20:23], s72 offen lds
    s_add_u32 s72, s82, 640
    v_mfma_f32_16x16x32_bf16 a[128:131], v[96:99], a[208:211], a[128:131]
    s_and_b32 s72, s72, 0x3ff
    s_add_u32 s72, s72, s87
    v_mfma_f32_16x16x32_bf16 a[160:163], v[96:99], a[212:215], a[160:163]
    s_add_u32 m0, s90, 61440
    s_nop 0
    buffer_load_dwordx4 v252, s[20:23], s72 offen lds
    v_mfma_f32_16x16x32_bf16 a[4:7], v[100:103], a[192:195], a[4:7]
    v_perm_b32 v104, v133, v129, s60
    v_perm_b32 v105, v141, v137, s60
    v_mfma_f32_16x16x32_bf16 a[36:39], v[100:103], a[196:199], a[36:39]
    v_perm_b32 v106, v149, v145, s60
    v_perm_b32 v107, v157, v153, s60
    v_mfma_f32_16x16x32_bf16 a[68:71], v[100:103], a[200:203], a[68:71]
    s_add_u32 s72, s82, 640
    s_and_b32 s72, s72, 0x3ff
    v_mfma_f32_16x16x32_bf16 a[100:103], v[100:103], a[204:207], a[100:103]
    s_add_u32 s72, s72, s88
    s_add_u32 m0, s91, 61440
    v_mfma_f32_16x16x32_bf16 a[132:135], v[100:103], a[208:211], a[132:135]
    buffer_load_dwordx4 v253, s[20:23], s72 offen lds
    v_add_u32 v240, s81, v240
    v_mfma_f32_16x16x32_bf16 a[164:167], v[100:103], a[212:215], a[164:167]
    v_and_b32 v240, 0x3fffff, v240
    buffer_load_dwordx4 v[32:35], v240, s[32:35], 0 offen
    v_mfma_f32_16x16x32_bf16 a[8:11], v[104:107], a[192:195], a[8:11]
    v_perm_b32 v108, v133, v129, s61
    v_mfma_f32_16x16x32_bf16 a[40:43], v[104:107], a[196:199], a[40:43]
    v_perm_b32 v109, v141, v137, s61
    v_mfma_f32_16x16x32_bf16 a[72:75], v[104:107], a[200:203], a[72:75]
    v_perm_b32 v110, v149, v145, s61
    v_mfma_f32_16x16x32_bf16 a[104:107], v[104:107], a[204:207], a[104:107]
    v_perm_b32 v111, v157, v153, s61
    v_mfma_f32_16x16x32_bf16 a[136:139], v[104:107], a[208:211], a[136:139]
    buffer_load_dwordx4 v[36:39], v240, s[32:35], s52 offen
    v_mfma_f32_16x16x32_bf16 a[168:171], v[104:107], a[212:215], a[168:171]
    buffer_load_dwordx4 v[40:43], v240, s[32:35], s53 offen
    v_mfma_f32_16x16x32_bf16 a[12:15], v[108:111], a[192:195], a[12:15]
    v_perm_b32 v96, v134, v130, s60
    v_perm_b32 v97, v142, v138, s60
    v_mfma_f32_16x16x32_bf16 a[44:47], v[108:111], a[196:199], a[44:47]
    v_perm_b32 v98, v150, v146, s60
    v_mfma_f32_16x16x32_bf16 a[76:79], v[108:111], a[200:203], a[76:79]
    v_perm_b32 v99, v158, v154, s60
    v_mfma_f32_16x16x32_bf16 a[108:111], v[108:111], a[204:207], a[108:111]
    buffer_load_dwordx4 v[44:47], v240, s[32:35], s54 offen
    v_mfma_f32_16x16x32_bf16 a[140:143], v[108:111], a[208:211], a[140:143]
    ds_read_b128 a[216:219], v242 offset:24576
    v_mfma_f32_16x16x32_bf16 a[172:175], v[108:111], a[212:215], a[172:175]
    ds_read_b128 a[220:223], v242 offset:26624
    v_mfma_f32_16x16x32_bf16 a[16:19], v[96:99], a[192:195], a[16:19]
    v_perm_b32 v100, v134, v130, s61
    v_perm_b32 v101, v142, v138, s61
    v_mfma_f32_16x16x32_bf16 a[48:51], v[96:99], a[196:199], a[48:51]
    v_perm_b32 v102, v150, v146, s61
    v_mfma_f32_16x16x32_bf16 a[80:83], v[96:99], a[200:203], a[80:83]
    v_perm_b32 v103, v158, v154, s61
    v_mfma_f32_16x16x32_bf16 a[112:115], v[96:99], a[204:207], a[112:115]
    buffer_load_dwordx4 v[48:51], v240, s[32:35], s55 offen
    buffer_load_dwordx4 v[52:55], v240, s[32:35], s56 offen
    v_mfma_f32_16x16x32_bf16 a[144:147], v[96:99], a[208:211], a[144:147]
    ds_read_b128 a[224:227], v242 offset:28672
    v_mfma_f32_16x16x32_bf16 a[176:179], v[96:99], a[212:215], a[176:179]
    ds_read_b128 a[228:231], v242 offset:30720
    v_mfma_f32_16x16x32_bf16 a[20:23], v[100:103], a[192:195], a[20:23]
    v_perm_b32 v104, v135, v131, s60
    v_perm_b32 v105, v143, v139, s60
    v_mfma_f32_16x16x32_bf16 a[52:55], v[100:103], a[196:199], a[52:55]
    v_perm_b32 v106, v151, v147, s60
    v_mfma_f32_16x16x32_bf16 a[84:87], v[100:103], a[200:203], a[84:87]
    v_perm_b32 v107, v159, v155, s60
    v_mfma_f32_16x16x32_bf16 a[116:119], v[100:103], a[204:207], a[116:119]
    buffer_load_dwordx4 v[56:59], v240, s[32:35], s57 offen
    buffer_load_dwordx4 v[60:63], v240, s[32:35], s58 offen
    v_mfma_f32_16x16x32_bf16 a[148:151], v[100:103], a[208:211], a[148:151]
    ds_read_b128 a[232:235], v242 offset:32768
    v_mfma_f32_16x16x32_bf16 a[180:183], v[100:103], a[212:215], a[180:183]
    ds_read_b128 a[236:239], v242 offset:34816
    v_mfma_f32_16x16x32_bf16 a[24:27], v[104:107], a[192:195], a[24:27]
    v_perm_b32 v108, v135, v131, s61
    v_perm_b32 v109, v143, v139, s61
    v_mfma_f32_16x16x32_bf16 a[56:59], v[104:107], a[196:199], a[56:59]
    v_perm_b32 v110, v151, v147, s61
    v_mfma_f32_16x16x32_bf16 a[88:91], v[104:107], a[200:203], a[88:91]
    v_perm_b32 v111, v159, v155, s61
    v_mfma_f32_16x16x32_bf16 a[120:123], v[104:107], a[204:207], a[120:123]
    s_add_u32 s73, s62, 0
    v_mfma_f32_16x16x32_bf16 a[152:155], v[104:107], a[208:211], a[152:155]
    s_add_u32 m0, s92, 0
    v_mfma_f32_16x16x32_bf16 a[184:187], v[104:107], a[212:215], a[184:187]
    buffer_load_dwordx4 v113, s[24:27], s73 offen nt lds
    v_mfma_f32_16x16x32_bf16 a[28:31], v[108:111], a[192:195], a[28:31]
    s_waitcnt vmcnt(23)
    v_mfma_f32_16x16x32_bf16 a[60:63], v[108:111], a[196:199], a[60:63]
    v_perm_b32 v96, v164, v160, s60
    v_mfma_f32_16x16x32_bf16 a[92:95], v[108:111], a[200:203], a[92:95]
    v_perm_b32 v97, v172, v168, s60
    v_mfma_f32_16x16x32_bf16 a[124:127], v[108:111], a[204:207], a[124:127]
    v_perm_b32 v98, v180, v176, s60
    v_mfma_f32_16x16x32_bf16 a[156:159], v[108:111], a[208:211], a[156:159]
    v_perm_b32 v99, v188, v184, s60
    v_mfma_f32_16x16x32_bf16 a[188:191], v[108:111], a[212:215], a[188:191]
    s_waitcnt lgkmcnt(0)
    v_mfma_f32_16x16x32_bf16 a[0:3], v[96:99], a[216:219], a[0:3]
    v_perm_b32 v100, v164, v160, s61
    v_perm_b32 v101, v172, v168, s61
    v_mfma_f32_16x16x32_bf16 a[32:35], v[96:99], a[220:223], a[32:35]
    v_perm_b32 v102, v180, v176, s61
    v_mfma_f32_16x16x32_bf16 a[64:67], v[96:99], a[224:227], a[64:67]
    v_perm_b32 v103, v188, v184, s61
    v_mfma_f32_16x16x32_bf16 a[96:99], v[96:99], a[228:231], a[96:99]
    s_add_u32 s73, s62, 1024
    v_mfma_f32_16x16x32_bf16 a[128:131], v[96:99], a[232:235], a[128:131]
    s_add_u32 m0, s92, 1024
    v_mfma_f32_16x16x32_bf16 a[160:163], v[96:99], a[236:239], a[160:163]
    buffer_load_dwordx4 v114, s[24:27], s73 offen nt lds
    v_mfma_f32_16x16x32_bf16 a[4:7], v[100:103], a[216:219], a[4:7]
    v_perm_b32 v104, v165, v161, s60
    v_perm_b32 v105, v173, v169, s60
    v_mfma_f32_16x16x32_bf16 a[36:39], v[100:103], a[220:223], a[36:39]
    v_perm_b32 v106, v181, v177, s60
    v_mfma_f32_16x16x32_bf16 a[68:71], v[100:103], a[224:227], a[68:71]
    v_perm_b32 v107, v189, v185, s60
    v_mfma_f32_16x16x32_bf16 a[100:103], v[100:103], a[228:231], a[100:103]
    s_add_u32 s73, s62, 2048
    v_mfma_f32_16x16x32_bf16 a[132:135], v[100:103], a[232:235], a[132:135]
    s_add_u32 m0, s92, 2048
    v_mfma_f32_16x16x32_bf16 a[164:167], v[100:103], a[236:239], a[164:167]
    buffer_load_dwordx4 v115, s[24:27], s73 offen nt lds
    v_mfma_f32_16x16x32_bf16 a[8:11], v[104:107], a[216:219], a[8:11]
    v_perm_b32 v108, v165, v161, s61
    v_perm_b32 v109, v173, v169, s61
    v_mfma_f32_16x16x32_bf16 a[40:43], v[104:107], a[220:223], a[40:43]
    v_perm_b32 v110, v181, v177, s61
    v_mfma_f32_16x16x32_bf16 a[72:75], v[104:107], a[224:227], a[72:75]
    v_perm_b32 v111, v189, v185, s61
    v_mfma_f32_16x16x32_bf16 a[104:107], v[104:107], a[228:231], a[104:107]
    s_add_u32 s73, s62, 3072
    v_mfma_f32_16x16x32_bf16 a[136:139], v[104:107], a[232:235], a[136:139]
    s_add_u32 m0, s92, 3072
    v_mfma_f32_16x16x32_bf16 a[168:171], v[104:107], a[236:239], a[168:171]
    buffer_load_dwordx4 v116, s[24:27], s73 offen nt lds
    v_mfma_f32_16x16x32_bf16 a[12:15], v[108:111], a[216:219], a[12:15]
    v_perm_b32 v96, v166, v162, s60
    v_perm_b32 v97, v174, v170, s60
    v_mfma_f32_16x16x32_bf16 a[44:47], v[108:111], a[220:223], a[44:47]
    v_perm_b32 v98, v182, v178, s60
    v_mfma_f32_16x16x32_bf16 a[76:79], v[108:111], a[224:227], a[76:79]
    v_perm_b32 v99, v190, v186, s60
    s_add_u32 s73, s62, 4096
    v_mfma_f32_16x16x32_bf16 a[108:111], v[108:111], a[228:231], a[108:111]
    s_add_u32 m0, s92, 4096
    v_mfma_f32_16x16x32_bf16 a[140:143], v[108:111], a[232:235], a[140:143]
    buffer_load_dwordx4 v113, s[24:27], s73 offen nt lds
    ds_read_b128 a[192:195], v241 offset:36864
    v_mfma_f32_16x16x32_bf16 a[172:175], v[108:111], a[236:239], a[172:175]
    ds_read_b128 a[196:199], v241 offset:38912
    v_mfma_f32_16x16x32_bf16 a[16:19], v[96:99], a[216:219], a[16:19]
    v_perm_b32 v100, v166, v162, s61
    v_perm_b32 v101, v174, v170, s61
    v_mfma_f32_16x16x32_bf16 a[48:51], v[96:99], a[220:223], a[48:51]
    v_perm_b32 v102, v182, v178, s61
    v_mfma_f32_16x16x32_bf16 a[80:83], v[96:99], a[224:227], a[80:83]
    v_perm_b32 v103, v190, v186, s61
    s_add_u32 s73, s62, 5120
    v_mfma_f32_16x16x32_bf16 a[112:115], v[96:99], a[228:231], a[112:115]
    s_add_u32 m0, s92, 5120
    v_mfma_f32_16x16x32_bf16 a[144:147], v[96:99], a[232:235], a[144:147]
    buffer_load_dwordx4 v114, s[24:27], s73 offen nt lds
    ds_read_b128 a[200:203], v241 offset:40960
    v_mfma_f32_16x16x32_bf16 a[176:179], v[96:99], a[236:239], a[176:179]
    ds_read_b128 a[204:207], v241 offset:43008
    v_mfma_f32_16x16x32_bf16 a[20:23], v[100:103], a[216:219], a[20:23]
    v_perm_b32 v104, v167, v163, s60
    v_perm_b32 v105, v175, v171, s60
    v_mfma_f32_16x16x32_bf16 a[52:55], v[100:103], a[220:223], a[52:55]
    v_perm_b32 v106, v183, v179, s60
    v_mfma_f32_16x16x32_bf16 a[84:87], v[100:103], a[224:227], a[84:87]
    v_perm_b32 v107, v191, v187, s60
    s_add_u32 s73, s62, 6144
    v_mfma_f32_16x16x32_bf16 a[116:119], v[100:103], a[228:231], a[116:119]
    s_add_u32 m0, s92, 6144
    v_mfma_f32_16x16x32_bf16 a[148:151], v[100:103], a[232:235], a[148:151]
    buffer_load_dwordx4 v115, s[24:27], s73 offen nt lds
    ds_read_b128 a[208:211], v241 offset:45056
    v_mfma_f32_16x16x32_bf16 a[180:183], v[100:103], a[236:239], a[180:183]
    ds_read_b128 a[212:215], v241 offset:47104
    v_mfma_f32_16x16x32_bf16 a[24:27], v[104:107], a[216:219], a[24:27]
    v_perm_b32 v108, v167, v163, s61
    v_mfma_f32_16x16x32_bf16 a[56:59], v[104:107], a[220:223], a[56:59]
    v_perm_b32 v109, v175, v171, s61
    v_mfma_f32_16x16x32_bf16 a[88:91], v[104:107], a[224:227], a[88:91]
    v_mfma_f32_16x16x32_bf16 a[120:123], v[104:107], a[228:231], a[120:123]
    v_perm_b32 v110, v183, v179, s61
    v_mfma_f32_16x16x32_bf16 a[152:155], v[104:107], a[232:235], a[152:155]
    v_perm_b32 v111, v191, v187, s61
    v_mfma_f32_16x16x32_bf16 a[184:187], v[104:107], a[236:239], a[184:187]
    s_nop 0
    v_mfma_f32_16x16x32_bf16 a[28:31], v[108:111], a[216:219], a[28:31]
    s_waitcnt vmcnt(21)
    v_perm_b32 v96, v196, v192, s60
    v_mfma_f32_16x16x32_bf16 a[60:63], v[108:111], a[220:223], a[60:63]
    v_perm_b32 v97, v204, v200, s60
    v_perm_b32 v98, v212, v208, s60
    v_mfma_f32_16x16x32_bf16 a[92:95], v[108:111], a[224:227], a[92:95]
    v_perm_b32 v99, v220, v216, s60
    s_add_u32 s73, s62, 7168
    v_mfma_f32_16x16x32_bf16 a[124:127], v[108:111], a[228:231], a[124:127]
    s_add_u32 m0, s92, 7168
    s_nop 0
    buffer_load_dwordx4 v116, s[24:27], s73 offen nt lds
    v_mfma_f32_16x16x32_bf16 a[156:159], v[108:111], a[232:235], a[156:159]
    v_add_u32 v240, s80, v240
    v_and_b32 v240, 0x3fffff, v240
    v_mfma_f32_16x16x32_bf16 a[188:191], v[108:111], a[236:239], a[188:191]
    buffer_load_dwordx4 v[64:67], v240, s[32:35], 0 offen
    s_waitcnt lgkmcnt(0)
    v_mfma_f32_16x16x32_bf16 a[0:3], v[96:99], a[192:195], a[0:3]
    v_perm_b32 v100, v196, v192, s61
    v_mfma_f32_16x16x32_bf16 a[32:35], v[96:99], a[196:199], a[32:35]
    v_perm_b32 v101, v204, v200, s61
    v_mfma_f32_16x16x32_bf16 a[64:67], v[96:99], a[200:203], a[64:67]
    v_perm_b32 v102, v212, v208, s61
    v_mfma_f32_16x16x32_bf16 a[96:99], v[96:99], a[204:207], a[96:99]
    v_perm_b32 v103, v220, v216, s61
    v_mfma_f32_16x16x32_bf16 a[128:131], v[96:99], a[208:211], a[128:131]
    buffer_load_dwordx4 v[68:71], v240, s[32:35], s52 offen
    v_mfma_f32_16x16x32_bf16 a[160:163], v[96:99], a[212:215], a[160:163]
    v_mfma_f32_16x16x32_bf16 a[4:7], v[100:103], a[192:195], a[4:7]
    v_perm_b32 v104, v197, v193, s60
    v_mfma_f32_16x16x32_bf16 a[36:39], v[100:103], a[196:199], a[36:39]
    v_perm_b32 v105, v205, v201, s60
    v_mfma_f32_16x16x32_bf16 a[68:71], v[100:103], a[200:203], a[68:71]
    v_perm_b32 v106, v213, v209, s60
    v_mfma_f32_16x16x32_bf16 a[100:103], v[100:103], a[204:207], a[100:103]
    v_perm_b32 v107, v221, v217, s60
    v_mfma_f32_16x16x32_bf16 a[132:135], v[100:103], a[208:211], a[132:135]
    buffer_load_dwordx4 v[72:75], v240, s[32:35], s53 offen
    v_mfma_f32_16x16x32_bf16 a[164:167], v[100:103], a[212:215], a[164:167]
    buffer_load_dwordx4 v[76:79], v240, s[32:35], s54 offen
    v_mfma_f32_16x16x32_bf16 a[8:11], v[104:107], a[192:195], a[8:11]
    v_perm_b32 v108, v197, v193, s61
    v_mfma_f32_16x16x32_bf16 a[40:43], v[104:107], a[196:199], a[40:43]
    v_perm_b32 v109, v205, v201, s61
    v_mfma_f32_16x16x32_bf16 a[72:75], v[104:107], a[200:203], a[72:75]
    v_perm_b32 v110, v213, v209, s61
    v_mfma_f32_16x16x32_bf16 a[104:107], v[104:107], a[204:207], a[104:107]
    v_perm_b32 v111, v221, v217, s61
    v_mfma_f32_16x16x32_bf16 a[136:139], v[104:107], a[208:211], a[136:139]
    buffer_load_dwordx4 v[80:83], v240, s[32:35], s55 offen
    v_mfma_f32_16x16x32_bf16 a[168:171], v[104:107], a[212:215], a[168:171]
    buffer_load_dwordx4 v[84:87], v240, s[32:35], s56 offen
    v_mfma_f32_16x16x32_bf16 a[12:15], v[108:111], a[192:195], a[12:15]
    v_perm_b32 v96, v198, v194, s60
    v_perm_b32 v97, v206, v202, s60
    v_mfma_f32_16x16x32_bf16 a[44:47], v[108:111], a[196:199], a[44:47]
    v_perm_b32 v98, v214, v210, s60
    v_mfma_f32_16x16x32_bf16 a[76:79], v[108:111], a[200:203], a[76:79]
    v_perm_b32 v99, v222, v218, s60
    v_mfma_f32_16x16x32_bf16 a[108:111], v[108:111], a[204:207], a[108:111]
    buffer_load_dwordx4 v[88:91], v240, s[32:35], s57 offen
    buffer_load_dwordx4 v[92:95], v240, s[32:35], s58 offen
    v_mfma_f32_16x16x32_bf16 a[140:143], v[108:111], a[208:211], a[140:143]
    ds_read_b128 a[216:219], v242 offset:36864
    v_mfma_f32_16x16x32_bf16 a[172:175], v[108:111], a[212:215], a[172:175]
    ds_read_b128 a[220:223], v242 offset:38912
    v_mfma_f32_16x16x32_bf16 a[16:19], v[96:99], a[192:195], a[16:19]
    v_perm_b32 v100, v198, v194, s61
    v_perm_b32 v101, v206, v202, s61
    v_mfma_f32_16x16x32_bf16 a[48:51], v[96:99], a[196:199], a[48:51]
    v_perm_b32 v102, v214, v210, s61
    v_mfma_f32_16x16x32_bf16 a[80:83], v[96:99], a[200:203], a[80:83]
    v_perm_b32 v103, v222, v218, s61
    v_add_u32 v240, s81, v240
    v_mfma_f32_16x16x32_bf16 a[112:115], v[96:99], a[204:207], a[112:115]
    v_and_b32 v240, 0x3fffff, v240
    v_mfma_f32_16x16x32_bf16 a[144:147], v[96:99], a[208:211], a[144:147]
    buffer_load_dwordx4 v[0:3], v240, s[32:35], 0 offen
    ds_read_b128 a[224:227], v242 offset:40960
    v_mfma_f32_16x16x32_bf16 a[176:179], v[96:99], a[212:215], a[176:179]
    ds_read_b128 a[228:231], v242 offset:43008
    v_mfma_f32_16x16x32_bf16 a[20:23], v[100:103], a[192:195], a[20:23]
    v_perm_b32 v104, v199, v195, s60
    v_perm_b32 v105, v207, v203, s60
    v_mfma_f32_16x16x32_bf16 a[52:55], v[100:103], a[196:199], a[52:55]
    v_perm_b32 v106, v215, v211, s60
    v_mfma_f32_16x16x32_bf16 a[84:87], v[100:103], a[200:203], a[84:87]
    v_perm_b32 v107, v223, v219, s60
    v_mfma_f32_16x16x32_bf16 a[116:119], v[100:103], a[204:207], a[116:119]
    buffer_load_dwordx4 v[4:7], v240, s[32:35], s52 offen
    buffer_load_dwordx4 v[8:11], v240, s[32:35], s53 offen
    v_mfma_f32_16x16x32_bf16 a[148:151], v[100:103], a[208:211], a[148:151]
    ds_read_b128 a[232:235], v242 offset:45056
    v_mfma_f32_16x16x32_bf16 a[180:183], v[100:103], a[212:215], a[180:183]
    ds_read_b128 a[236:239], v242 offset:47104
    v_mfma_f32_16x16x32_bf16 a[24:27], v[104:107], a[192:195], a[24:27]
    v_perm_b32 v108, v199, v195, s61
    v_mfma_f32_16x16x32_bf16 a[56:59], v[104:107], a[196:199], a[56:59]
    v_perm_b32 v109, v207, v203, s61
    v_mfma_f32_16x16x32_bf16 a[88:91], v[104:107], a[200:203], a[88:91]
    v_perm_b32 v110, v215, v211, s61
    v_mfma_f32_16x16x32_bf16 a[120:123], v[104:107], a[204:207], a[120:123]
    v_perm_b32 v111, v223, v219, s61
    v_mfma_f32_16x16x32_bf16 a[152:155], v[104:107], a[208:211], a[152:155]
    buffer_load_dwordx4 v[12:15], v240, s[32:35], s54 offen
    v_mfma_f32_16x16x32_bf16 a[184:187], v[104:107], a[212:215], a[184:187]
    buffer_load_dwordx4 v[16:19], v240, s[32:35], s55 offen
    v_mfma_f32_16x16x32_bf16 a[28:31], v[108:111], a[192:195], a[28:31]
    s_waitcnt vmcnt(21)
    v_perm_b32 v96, v36, v32, s60
    v_mfma_f32_16x16x32_bf16 a[60:63], v[108:111], a[196:199], a[60:63]
    v_perm_b32 v97, v44, v40, s60
    v_mfma_f32_16x16x32_bf16 a[92:95], v[108:111], a[200:203], a[92:95]
    v_perm_b32 v98, v52, v48, s60
    v_mfma_f32_16x16x32_bf16 a[124:127], v[108:111], a[204:207], a[124:127]
    v_perm_b32 v99, v60, v56, s60
    v_mfma_f32_16x16x32_bf16 a[156:159], v[108:111], a[208:211], a[156:159]
    buffer_load_dwordx4 v[20:23], v240, s[32:35], s56 offen
    v_mfma_f32_16x16x32_bf16 a[188:191], v[108:111], a[212:215], a[188:191]
    buffer_load_dwordx4 v[24:27], v240, s[32:35], s57 offen
    s_waitcnt lgkmcnt(0)
    v_mfma_f32_16x16x32_bf16 a[0:3], v[96:99], a[216:219], a[0:3]
    v_perm_b32 v100, v36, v32, s61
    v_mfma_f32_16x16x32_bf16 a[32:35], v[96:99], a[220:223], a[32:35]
    v_perm_b32 v101, v44, v40, s61
    v_mfma_f32_16x16x32_bf16 a[64:67], v[96:99], a[224:227], a[64:67]
    v_perm_b32 v102, v52, v48, s61
    v_mfma_f32_16x16x32_bf16 a[96:99], v[96:99], a[228:231], a[96:99]
    v_perm_b32 v103, v60, v56, s61
    v_mfma_f32_16x16x32_bf16 a[128:131], v[96:99], a[232:235], a[128:131]
    buffer_load_dwordx4 v[28:31], v240, s[32:35], s58 offen
    v_mfma_f32_16x16x32_bf16 a[160:163], v[96:99], a[236:239], a[160:163]
    v_mfma_f32_16x16x32_bf16 a[4:7], v[100:103], a[216:219], a[4:7]
    v_perm_b32 v104, v37, v33, s60
    v_perm_b32 v105, v45, v41, s60
    v_mfma_f32_16x16x32_bf16 a[36:39], v[100:103], a[220:223], a[36:39]
    v_perm_b32 v106, v53, v49, s60
    v_mfma_f32_16x16x32_bf16 a[68:71], v[100:103], a[224:227], a[68:71]
    v_perm_b32 v107, v61, v57, s60
    v_mfma_f32_16x16x32_bf16 a[100:103], v[100:103], a[228:231], a[100:103]
    v_add_u32 v240, s80, v240
    v_and_b32 v240, 0x3fffff, v240
    v_mfma_f32_16x16x32_bf16 a[132:135], v[100:103], a[232:235], a[132:135]
    buffer_load_dwordx4 v[128:131], v240, s[32:35], 0 offen
    v_mfma_f32_16x16x32_bf16 a[164:167], v[100:103], a[236:239], a[164:167]
    buffer_load_dwordx4 v[132:135], v240, s[32:35], s52 offen
    v_mfma_f32_16x16x32_bf16 a[8:11], v[104:107], a[216:219], a[8:11]
    v_perm_b32 v108, v37, v33, s61
    v_mfma_f32_16x16x32_bf16 a[40:43], v[104:107], a[220:223], a[40:43]
    v_perm_b32 v109, v45, v41, s61
    v_mfma_f32_16x16x32_bf16 a[72:75], v[104:107], a[224:227], a[72:75]
    v_perm_b32 v110, v53, v49, s61
    v_mfma_f32_16x16x32_bf16 a[104:107], v[104:107], a[228:231], a[104:107]
    v_perm_b32 v111, v61, v57, s61
    v_mfma_f32_16x16x32_bf16 a[136:139], v[104:107], a[232:235], a[136:139]
    buffer_load_dwordx4 v[136:139], v240, s[32:35], s53 offen
    v_mfma_f32_16x16x32_bf16 a[168:171], v[104:107], a[236:239], a[168:171]
    buffer_load_dwordx4 v[140:143], v240, s[32:35], s54 offen
    v_mfma_f32_16x16x32_bf16 a[12:15], v[108:111], a[216:219], a[12:15]
    v_perm_b32 v96, v38, v34, s60
    v_perm_b32 v97, v46, v42, s60
    v_mfma_f32_16x16x32_bf16 a[44:47], v[108:111], a[220:223], a[44:47]
    v_perm_b32 v98, v54, v50, s60
    v_perm_b32 v99, v62, v58, s60
    v_mfma_f32_16x16x32_bf16 a[76:79], v[108:111], a[224:227], a[76:79]
    buffer_load_dwordx4 v[144:147], v240, s[32:35], s55 offen
    v_mfma_f32_16x16x32_bf16 a[108:111], v[108:111], a[228:231], a[108:111]
    buffer_load_dwordx4 v[148:151], v240, s[32:35], s56 offen
    v_mfma_f32_16x16x32_bf16 a[140:143], v[108:111], a[232:235], a[140:143]
    s_barrier
    ds_read_b128 a[192:195], v243 offset:0
    v_mfma_f32_16x16x32_bf16 a[172:175], v[108:111], a[236:239], a[172:175]
    ds_read_b128 a[196:199], v243 offset:2048
    v_mfma_f32_16x16x32_bf16 a[16:19], v[96:99], a[216:219], a[16:19]
    v_perm_b32 v100, v38, v34, s61
    v_perm_b32 v101, v46, v42, s61
    v_mfma_f32_16x16x32_bf16 a[48:51], v[96:99], a[220:223], a[48:51]
    v_perm_b32 v102, v54, v50, s61
    v_mfma_f32_16x16x32_bf16 a[80:83], v[96:99], a[224:227], a[80:83]
    v_perm_b32 v103, v62, v58, s61
    v_mfma_f32_16x16x32_bf16 a[112:115], v[96:99], a[228:231], a[112:115]
    buffer_load_dwordx4 v[152:155], v240, s[32:35], s57 offen
    v_mfma_f32_16x16x32_bf16 a[144:147], v[96:99], a[232:235], a[144:147]
    ds_read_b128 a[200:203], v243 offset:4096
    v_mfma_f32_16x16x32_bf16 a[176:179], v[96:99], a[236:239], a[176:179]
    ds_read_b128 a[204:207], v243 offset:6144
    v_mfma_f32_16x16x32_bf16 a[20:23], v[100:103], a[216:219], a[20:23]
    v_perm_b32 v104, v39, v35, s60
    v_perm_b32 v105, v47, v43, s60
    v_mfma_f32_16x16x32_bf16 a[52:55], v[100:103], a[220:223], a[52:55]
    v_perm_b32 v106, v55, v51, s60
    v_perm_b32 v107, v63, v59, s60
    v_mfma_f32_16x16x32_bf16 a[84:87], v[100:103], a[224:227], a[84:87]
    buffer_load_dwordx4 v[156:159], v240, s[32:35], s58 offen
    s_add_u32 s72, s82, 768
    v_mfma_f32_16x16x32_bf16 a[116:119], v[100:103], a[228:231], a[116:119]
    s_and_b32 s72, s72, 0x3ff
    s_add_u32 s72, s72, s86
    v_mfma_f32_16x16x32_bf16 a[148:151], v[100:103], a[232:235], a[148:151]
    s_add_u32 m0, s89, 73728
    s_nop 0
    buffer_load_dwordx4 v251, s[20:23], s72 offen lds
    v_mfma_f32_16x16x32_bf16 a[180:183], v[100:103], a[236:239], a[180:183]
    ds_read_b128 a[208:211], v243 offset:8192
    ds_read_b128 a[212:215], v243 offset:10240
    v_mfma_f32_16x16x32_bf16 a[24:27], v[104:107], a[216:219], a[24:27]
    v_perm_b32 v108, v39, v35, s61
    v_perm_b32 v109, v47, v43, s61
    v_perm_b32 v110, v55, v51, s61
    v_mfma_f32_16x16x32_bf16 a[56:59], v[104:107], a[220:223], a[56:59]
    v_perm_b32 v111, v63, v59, s61
    s_add_u32 s72, s82, 768
    v_mfma_f32_16x16x32_bf16 a[88:91], v[104:107], a[224:227], a[88:91]
    s_and_b32 s72, s72, 0x3ff
    s_add_u32 s72, s72, s87
    v_mfma_f32_16x16x32_bf16 a[120:123], v[104:107], a[228:231], a[120:123]
    s_add_u32 m0, s90, 73728
    s_nop 0
    buffer_load_dwordx4 v252, s[20:23], s72 offen lds
    s_add_u32 s72, s82, 768
    v_mfma_f32_16x16x32_bf16 a[152:155], v[104:107], a[232:235], a[152:155]
    s_and_b32 s72, s72, 0x3ff
    s_add_u32 s72, s72, s88
    v_mfma_f32_16x16x32_bf16 a[184:187], v[104:107], a[236:239], a[184:187]
    s_add_u32 m0, s91, 73728
    s_nop 0
    buffer_load_dwordx4 v253, s[20:23], s72 offen lds
    v_mfma_f32_16x16x32_bf16 a[28:31], v[108:111], a[216:219], a[28:31]
    s_waitcnt vmcnt(19)
    v_perm_b32 v96, v68, v64, s60
    v_perm_b32 v97, v76, v72, s60
    v_mfma_f32_16x16x32_bf16 a[60:63], v[108:111], a[220:223], a[60:63]
    v_perm_b32 v98, v84, v80, s60
    v_perm_b32 v99, v92, v88, s60
    v_mfma_f32_16x16x32_bf16 a[92:95], v[108:111], a[224:227], a[92:95]
    s_add_u32 s72, s82, 896
    s_and_b32 s72, s72, 0x3ff
    s_add_u32 s72, s72, s86
    v_mfma_f32_16x16x32_bf16 a[124:127], v[108:111], a[228:231], a[124:127]
    s_add_u32 m0, s89, 86016
    s_nop 0
    buffer_load_dwordx4 v251, s[20:23], s72 offen lds
    v_mfma_f32_16x16x32_bf16 a[156:159], v[108:111], a[232:235], a[156:159]
    s_add_u32 s72, s82, 896
    s_and_b32 s72, s72, 0x3ff
    s_add_u32 s72, s72, s87
    v_mfma_f32_16x16x32_bf16 a[188:191], v[108:111], a[236:239], a[188:191]
    s_add_u32 m0, s90, 86016
    s_nop 0
    buffer_load_dwordx4 v252, s[20:23], s72 offen lds
    s_waitcnt lgkmcnt(0)
    v_mfma_f32_16x16x32_bf16 a[0:3], v[96:99], a[192:195], a[0:3]
    v_perm_b32 v100, v68, v64, s61
    v_perm_b32 v101, v76, v72, s61
    v_mfma_f32_16x16x32_bf16 a[32:35], v[96:99], a[196:199], a[32:35]
    v_perm_b32 v102, v84, v80, s61
    v_mfma_f32_16x16x32_bf16 a[64:67], v[96:99], a[200:203], a[64:67]
    v_perm_b32 v103, v92, v88, s61
    s_add_u32 s72, s82, 896
    v_mfma_f32_16x16x32_bf16 a[96:99], v[96:99], a[204:207], a[96:99]
    s_and_b32 s72, s72, 0x3ff
    v_mfma_f32_16x16x32_bf16 a[128:131], v[96:99], a[208:211], a[128:131]
    s_add_u32 s72, s72, s88
    s_add_u32 m0, s91, 86016
    v_mfma_f32_16x16x32_bf16 a[160:163], v[96:99], a[212:215], a[160:163]
    buffer_load_dwordx4 v253, s[20:23], s72 offen lds
    v_mfma_f32_16x16x32_bf16 a[4:7], v[100:103], a[192:195], a[4:7]
    v_perm_b32 v104, v69, v65, s60
    v_perm_b32 v105, v77, v73, s60
    v_mfma_f32_16x16x32_bf16 a[36:39], v[100:103], a[196:199], a[36:39]
    v_perm_b32 v106, v85, v81, s60
    v_mfma_f32_16x16x32_bf16 a[68:71], v[100:103], a[200:203], a[68:71]
    v_perm_b32 v107, v93, v89, s60
    v_mfma_f32_16x16x32_bf16 a[100:103], v[100:103], a[204:207], a[100:103]
    v_add_u32 v240, s81, v240
    v_and_b32 v240, 0x3fffff, v240
    v_mfma_f32_16x16x32_bf16 a[132:135], v[100:103], a[208:211], a[132:135]
    buffer_load_dwordx4 v[160:163], v240, s[32:35], 0 offen
    v_mfma_f32_16x16x32_bf16 a[164:167], v[100:103], a[212:215], a[164:167]
    buffer_load_dwordx4 v[164:167], v240, s[32:35], s52 offen
    v_mfma_f32_16x16x32_bf16 a[8:11], v[104:107], a[192:195], a[8:11]
    v_perm_b32 v108, v69, v65, s61
    v_mfma_f32_16x16x32_bf16 a[40:43], v[104:107], a[196:199], a[40:43]
    v_perm_b32 v109, v77, v73, s61
    v_mfma_f32_16x16x32_bf16 a[72:75], v[104:107], a[200:203], a[72:75]
    v_perm_b32 v110, v85, v81, s61
    v_mfma_f32_16x16x32_bf16 a[104:107], v[104:107], a[204:207], a[104:107]
    v_perm_b32 v111, v93, v89, s61
    v_mfma_f32_16x16x32_bf16 a[136:139], v[104:107], a[208:211], a[136:139]
    buffer_load_dwordx4 v[168:171], v240, s[32:35], s53 offen
    v_mfma_f32_16x16x32_bf16 a[168:171], v[104:107], a[212:215], a[168:171]
    buffer_load_dwordx4 v[172:175], v240, s[32:35], s54 offen
    v_mfma_f32_16x16x32_bf16 a[12:15], v[108:111], a[192:195], a[12:15]
    v_perm_b32 v96, v70, v66, s60
    v_perm_b32 v97, v78, v74, s60
    v_mfma_f32_16x16x32_bf16 a[44:47], v[108:111], a[196:199], a[44:47]
    v_perm_b32 v98, v86, v82, s60
    v_mfma_f32_16x16x32_bf16 a[76:79], v[108:111], a[200:203], a[76:79]
    v_perm_b32 v99, v94, v90, s60
    v_mfma_f32_16x16x32_bf16 a[108:111], v[108:111], a[204:207], a[108:111]
    buffer_load_dwordx4 v[176:179], v240, s[32:35], s55 offen
    buffer_load_dwordx4 v[180:183], v240, s[32:35], s56 offen
    v_mfma_f32_16x16x32_bf16 a[140:143], v[108:111], a[208:211], a[140:143]
    ds_read_b128 a[216:219], v244 offset:0
    v_mfma_f32_16x16x32_bf16 a[172:175], v[108:111], a[212:215], a[172:175]
    ds_read_b128 a[220:223], v244 offset:2048
    v_mfma_f32_16x16x32_bf16 a[16:19], v[96:99], a[192:195], a[16:19]
    v_perm_b32 v100, v70, v66, s61
    v_perm_b32 v101, v78, v74, s61
    v_mfma_f32_16x16x32_bf16 a[48:51], v[96:99], a[196:199], a[48:51]
    v_perm_b32 v102, v86, v82, s61
    v_mfma_f32_16x16x32_bf16 a[80:83], v[96:99], a[200:203], a[80:83]
    v_perm_b32 v103, v94, v90, s61
    v_mfma_f32_16x16x32_bf16 a[112:115], v[96:99], a[204:207], a[112:115]
    buffer_load_dwordx4 v[184:187], v240, s[32:35], s57 offen
    v_mfma_f32_16x16x32_bf16 a[144:147], v[96:99], a[208:211], a[144:147]
    ds_read_b128 a[224:227], v244 offset:4096
    v_mfma_f32_16x16x32_bf16 a[176:179], v[96:99], a[212:215], a[176:179]
    ds_read_b128 a[228:231], v244 offset:6144
    v_mfma_f32_16x16x32_bf16 a[20:23], v[100:103], a[192:195], a[20:23]
    v_perm_b32 v104, v71, v67, s60
    v_perm_b32 v105, v79, v75, s60
    v_mfma_f32_16x16x32_bf16 a[52:55], v[100:103], a[196:199], a[52:55]
    v_perm_b32 v106, v87, v83, s60
    v_mfma_f32_16x16x32_bf16 a[84:87], v[100:103], a[200:203], a[84:87]
    v_perm_b32 v107, v95, v91, s60
    v_mfma_f32_16x16x32_bf16 a[116:119], v[100:103], a[204:207], a[116:119]
    buffer_load_dwordx4 v[188:191], v240, s[32:35], s58 offen
    v_mfma_f32_16x16x32_bf16 a[148:151], v[100:103], a[208:211], a[148:151]
    ds_read_b128 a[232:235], v244 offset:8192
    v_mfma_f32_16x16x32_bf16 a[180:183], v[100:103], a[212:215], a[180:183]
    ds_read_b128 a[236:239], v244 offset:10240
    v_mfma_f32_16x16x32_bf16 a[24:27], v[104:107], a[192:195], a[24:27]
    v_perm_b32 v108, v71, v67, s61
    v_perm_b32 v109, v79, v75, s61
    v_mfma_f32_16x16x32_bf16 a[56:59], v[104:107], a[196:199], a[56:59]
    v_perm_b32 v110, v87, v83, s61
    v_mfma_f32_16x16x32_bf16 a[88:91], v[104:107], a[200:203], a[88:91]
    v_perm_b32 v111, v95, v91, s61
    v_mfma_f32_16x16x32_bf16 a[120:123], v[104:107], a[204:207], a[120:123]
    s_add_u32 s73, s62, 8192
    v_mfma_f32_16x16x32_bf16 a[152:155], v[104:107], a[208:211], a[152:155]
    s_add_u32 m0, s92, 8192
    v_mfma_f32_16x16x32_bf16 a[184:187], v[104:107], a[212:215], a[184:187]
    buffer_load_dwordx4 v113, s[24:27], s73 offen nt lds
    v_mfma_f32_16x16x32_bf16 a[28:31], v[108:111], a[192:195], a[28:31]
    s_waitcnt vmcnt(23)
    v_perm_b32 v96, v4, v0, s60
    v_mfma_f32_16x16x32_bf16 a[60:63], v[108:111], a[196:199], a[60:63]
    v_perm_b32 v97, v12, v8, s60
    v_mfma_f32_16x16x32_bf16 a[92:95], v[108:111], a[200:203], a[92:95]
    v_perm_b32 v98, v20, v16, s60
    v_mfma_f32_16x16x32_bf16 a[124:127], v[108:111], a[204:207], a[124:127]
    v_perm_b32 v99, v28, v24, s60
    s_add_u32 s73, s62, 9216
    v_mfma_f32_16x16x32_bf16 a[156:159], v[108:111], a[208:211], a[156:159]
    s_add_u32 m0, s92, 9216
    v_mfma_f32_16x16x32_bf16 a[188:191], v[108:111], a[212:215], a[188:191]
    buffer_load_dwordx4 v114, s[24:27], s73 offen nt lds
    s_waitcnt lgkmcnt(0)
    v_mfma_f32_16x16x32_bf16 a[0:3], v[96:99], a[216:219], a[0:3]
    v_perm_b32 v100, v4, v0, s61
    v_perm_b32 v101, v12, v8, s61
    v_mfma_f32_16x16x32_bf16 a[32:35], v[96:99], a[220:223], a[32:35]
    v_perm_b32 v102, v20, v16, s61
    v_mfma_f32_16x16x32_bf16 a[64:67], v[96:99], a[224:227], a[64:67]
    v_perm_b32 v103, v28, v24, s61
    v_mfma_f32_16x16x32_bf16 a[96:99], v[96:99], a[228:231], a[96:99]
    s_add_u32 s73, s62, 10240
    v_mfma_f32_16x16x32_bf16 a[128:131], v[96:99], a[232:235], a[128:131]
    s_add_u32 m0, s92, 10240
    v_mfma_f32_16x16x32_bf16 a[160:163], v[96:99], a[236:239], a[160:163]
    buffer_load_dwordx4 v115, s[24:27], s73 offen nt lds
    v_mfma_f32_16x16x32_bf16 a[4:7], v[100:103], a[216:219], a[4:7]
    v_perm_b32 v104, v5, v1, s60
    v_perm_b32 v105, v13, v9, s60
    v_mfma_f32_16x16x32_bf16 a[36:39], v[100:103], a[220:223], a[36:39]
    v_perm_b32 v106, v21, v17, s60
    v_mfma_f32_16x16x32_bf16 a[68:71], v[100:103], a[224:227], a[68:71]
    v_perm_b32 v107, v29, v25, s60
    v_mfma_f32_16x16x32_bf16 a[100:103], v[100:103], a[228:231], a[100:103]
    s_add_u32 s73, s62, 11264
    v_mfma_f32_16x16x32_bf16 a[132:135], v[100:103], a[232:235], a[132:135]
    s_add_u32 m0, s92, 11264
    v_mfma_f32_16x16x32_bf16 a[164:167], v[100:103], a[236:239], a[164:167]
    buffer_load_dwordx4 v116, s[24:27], s73 offen nt lds
    v_mfma_f32_16x16x32_bf16 a[8:11], v[104:107], a[216:219], a[8:11]
    v_perm_b32 v108, v5, v1, s61
    v_perm_b32 v109, v13, v9, s61
    v_mfma_f32_16x16x32_bf16 a[40:43], v[104:107], a[220:223], a[40:43]
    v_perm_b32 v110, v21, v17, s61
    v_mfma_f32_16x16x32_bf16 a[72:75], v[104:107], a[224:227], a[72:75]
    v_perm_b32 v111, v29, v25, s61
    v_mfma_f32_16x16x32_bf16 a[104:107], v[104:107], a[228:231], a[104:107]
    s_add_u32 s73, s62, 12288
    v_mfma_f32_16x16x32_bf16 a[136:139], v[104:107], a[232:235], a[136:139]
    s_add_u32 m0, s92, 12288
    v_mfma_f32_16x16x32_bf16 a[168:171], v[104:107], a[236:239], a[168:171]
    buffer_load_dwordx4 v113, s[24:27], s73 offen nt lds
    v_mfma_f32_16x16x32_bf16 a[12:15], v[108:111], a[216:219], a[12:15]
    v_perm_b32 v96, v6, v2, s60
    v_perm_b32 v97, v14, v10, s60
    v_mfma_f32_16x16x32_bf16 a[44:47], v[108:111], a[220:223], a[44:47]
    v_perm_b32 v98, v22, v18, s60
    v_mfma_f32_16x16x32_bf16 a[76:79], v[108:111], a[224:227], a[76:79]
    v_perm_b32 v99, v30, v26, s60
    s_add_u32 s73, s62, 13312
    v_mfma_f32_16x16x32_bf16 a[108:111], v[108:111], a[228:231], a[108:111]
    s_add_u32 m0, s92, 13312
    v_mfma_f32_16x16x32_bf16 a[140:143], v[108:111], a[232:235], a[140:143]
    buffer_load_dwordx4 v114, s[24:27], s73 offen nt lds
    ds_read_b128 a[192:195], v243 offset:12288
    v_mfma_f32_16x16x32_bf16 a[172:175], v[108:111], a[236:239], a[172:175]
    ds_read_b128 a[196:199], v243 offset:14336
    v_mfma_f32_16x16x32_bf16 a[16:19], v[96:99], a[216:219], a[16:19]
    v_perm_b32 v100, v6, v2, s61
    v_mfma_f32_16x16x32_bf16 a[48:51], v[96:99], a[220:223], a[48:51]
    v_perm_b32 v101, v14, v10, s61
    v_mfma_f32_16x16x32_bf16 a[80:83], v[96:99], a[224:227], a[80:83]
    v_perm_b32 v102, v22, v18, s61
    v_mfma_f32_16x16x32_bf16 a[112:115], v[96:99], a[228:231], a[112:115]
    v_perm_b32 v103, v30, v26, s61
    v_mfma_f32_16x16x32_bf16 a[144:147], v[96:99], a[232:235], a[144:147]
    ds_read_b128 a[200:203], v243 offset:16384
    v_mfma_f32_16x16x32_bf16 a[176:179], v[96:99], a[236:239], a[176:179]
    ds_read_b128 a[204:207], v243 offset:18432
    v_mfma_f32_16x16x32_bf16 a[20:23], v[100:103], a[216:219], a[20:23]
    v_perm_b32 v104, v7, v3, s60
    v_perm_b32 v105, v15, v11, s60
    v_mfma_f32_16x16x32_bf16 a[52:55], v[100:103], a[220:223], a[52:55]
    v_perm_b32 v106, v23, v19, s60
    v_mfma_f32_16x16x32_bf16 a[84:87], v[100:103], a[224:227], a[84:87]
    v_perm_b32 v107, v31, v27, s60
    s_add_u32 s73, s62, 14336
    v_mfma_f32_16x16x32_bf16 a[116:119], v[100:103], a[228:231], a[116:119]
    s_add_u32 m0, s92, 14336
    v_mfma_f32_16x16x32_bf16 a[148:151], v[100:103], a[232:235], a[148:151]
    buffer_load_dwordx4 v115, s[24:27], s73 offen nt lds
    ds_read_b128 a[208:211], v243 offset:20480
    v_mfma_f32_16x16x32_bf16 a[180:183], v[100:103], a[236:239], a[180:183]
    ds_read_b128 a[212:215], v243 offset:22528
    v_mfma_f32_16x16x32_bf16 a[24:27], v[104:107], a[216:219], a[24:27]
    v_perm_b32 v108, v7, v3, s61
    v_perm_b32 v109, v15, v11, s61
    v_mfma_f32_16x16x32_bf16 a[56:59], v[104:107], a[220:223], a[56:59]
    v_perm_b32 v110, v23, v19, s61
    v_mfma_f32_16x16x32_bf16 a[88:91], v[104:107], a[224:227], a[88:91]
    v_perm_b32 v111, v31, v27, s61
    v_mfma_f32_16x16x32_bf16 a[120:123], v[104:107], a[228:231], a[120:123]
    s_add_u32 s73, s62, 15360
    v_mfma_f32_16x16x32_bf16 a[152:155], v[104:107], a[232:235], a[152:155]
    s_add_u32 m0, s92, 15360
    v_mfma_f32_16x16x32_bf16 a[184:187], v[104:107], a[236:239], a[184:187]
    buffer_load_dwordx4 v116, s[24:27], s73 offen nt lds
    v_mfma_f32_16x16x32_bf16 a[28:31], v[108:111], a[216:219], a[28:31]
    s_waitcnt vmcnt(22)
    v_perm_b32 v96, v132, v128, s60
    v_mfma_f32_16x16x32_bf16 a[60:63], v[108:111], a[220:223], a[60:63]
    v_perm_b32 v97, v140, v136, s60
    v_mfma_f32_16x16x32_bf16 a[92:95], v[108:111], a[224:227], a[92:95]
    v_perm_b32 v98, v148, v144, s60
    v_perm_b32 v99, v156, v152, s60
    v_mfma_f32_16x16x32_bf16 a[124:127], v[108:111], a[228:231], a[124:127]
    v_add_u32 v240, s80, v240
    v_mfma_f32_16x16x32_bf16 a[156:159], v[108:111], a[232:235], a[156:159]
    v_and_b32 v240, 0x3fffff, v240
    buffer_load_dwordx4 v[192:195], v240, s[32:35], 0 offen
    v_mfma_f32_16x16x32_bf16 a[188:191], v[108:111], a[236:239], a[188:191]
    buffer_load_dwordx4 v[196:199], v240, s[32:35], s52 offen
    s_waitcnt lgkmcnt(0)
    v_mfma_f32_16x16x32_bf16 a[0:3], v[96:99], a[192:195], a[0:3]
    v_perm_b32 v100, v132, v128, s61
    v_mfma_f32_16x16x32_bf16 a[32:35], v[96:99], a[196:199], a[32:35]
    v_perm_b32 v101, v140, v136, s61
    v_mfma_f32_16x16x32_bf16 a[64:67], v[96:99], a[200:203], a[64:67]
    v_perm_b32 v102, v148, v144, s61
    v_mfma_f32_16x16x32_bf16 a[96:99], v[96:99], a[204:207], a[96:99]
    v_perm_b32 v103, v156, v152, s61
    v_mfma_f32_16x16x32_bf16 a[128:131], v[96:99], a[208:211], a[128:131]
    buffer_load_dwordx4 v[200:203], v240, s[32:35], s53 offen
    v_mfma_f32_16x16x32_bf16 a[160:163], v[96:99], a[212:215], a[160:163]
    buffer_load_dwordx4 v[204:207], v240, s[32:35], s54 offen
    v_mfma_f32_16x16x32_bf16 a[4:7], v[100:103], a[192:195], a[4:7]
    v_perm_b32 v104, v133, v129, s60
    v_mfma_f32_16x16x32_bf16 a[36:39], v[100:103], a[196:199], a[36:39]
    v_perm_b32 v105, v141, v137, s60
    v_mfma_f32_16x16x32_bf16 a[68:71], v[100:103], a[200:203], a[68:71]
    v_perm_b32 v106, v149, v145, s60
    v_mfma_f32_16x16x32_bf16 a[100:103], v[100:103], a[204:207], a[100:103]
    v_perm_b32 v107, v157, v153, s60
    v_mfma_f32_16x16x32_bf16 a[132:135], v[100:103], a[208:211], a[132:135]
    buffer_load_dwordx4 v[208:211], v240, s[32:35], s55 offen
    v_mfma_f32_16x16x32_bf16 a[164:167], v[100:103], a[212:215], a[164:167]
    buffer_load_dwordx4 v[212:215], v240, s[32:35], s56 offen
    v_mfma_f32_16x16x32_bf16 a[8:11], v[104:107], a[192:195], a[8:11]
    v_perm_b32 v108, v133, v129, s61
    v_mfma_f32_16x16x32_bf16 a[40:43], v[104:107], a[196:199], a[40:43]
    v_perm_b32 v109, v141, v137, s61
    v_mfma_f32_16x16x32_bf16 a[72:75], v[104:107], a[200:203], a[72:75]
    v_perm_b32 v110, v149, v145, s61
    v_mfma_f32_16x16x32_bf16 a[104:107], v[104:107], a[204:207], a[104:107]
    v_perm_b32 v111, v157, v153, s61
    v_mfma_f32_16x16x32_bf16 a[136:139], v[104:107], a[208:211], a[136:139]
    buffer_load_dwordx4 v[216:219], v240, s[32:35], s57 offen
    v_mfma_f32_16x16x32_bf16 a[168:171], v[104:107], a[212:215], a[168:171]
    v_mfma_f32_16x16x32_bf16 a[12:15], v[108:111], a[192:195], a[12:15]
    v_perm_b32 v96, v134, v130, s60
    v_perm_b32 v97, v142, v138, s60
    v_mfma_f32_16x16x32_bf16 a[44:47], v[108:111], a[196:199], a[44:47]
    v_perm_b32 v98, v150, v146, s60
    v_perm_b32 v99, v158, v154, s60
    v_mfma_f32_16x16x32_bf16 a[76:79], v[108:111], a[200:203], a[76:79]
    buffer_load_dwordx4 v[220:223], v240, s[32:35], s58 offen
    v_mfma_f32_16x16x32_bf16 a[108:111], v[108:111], a[204:207], a[108:111]
    v_add_u32 v240, s81, v240
    v_and_b32 v240, 0x3fffff, v240
    v_mfma_f32_16x16x32_bf16 a[140:143], v[108:111], a[208:211], a[140:143]
    buffer_load_dwordx4 v[32:35], v240, s[32:35], 0 offen
    ds_read_b128 a[216:219], v244 offset:12288
    v_mfma_f32_16x16x32_bf16 a[172:175], v[108:111], a[212:215], a[172:175]
    ds_read_b128 a[220:223], v244 offset:14336
    v_mfma_f32_16x16x32_bf16 a[16:19], v[96:99], a[192:195], a[16:19]
    v_perm_b32 v100, v134, v130, s61
    v_perm_b32 v101, v142, v138, s61
    v_mfma_f32_16x16x32_bf16 a[48:51], v[96:99], a[196:199], a[48:51]
    v_perm_b32 v102, v150, v146, s61
    v_mfma_f32_16x16x32_bf16 a[80:83], v[96:99], a[200:203], a[80:83]
    v_perm_b32 v103, v158, v154, s61
    v_mfma_f32_16x16x32_bf16 a[112:115], v[96:99], a[204:207], a[112:115]
    buffer_load_dwordx4 v[36:39], v240, s[32:35], s52 offen
    buffer_load_dwordx4 v[40:43], v240, s[32:35], s53 offen
    v_mfma_f32_16x16x32_bf16 a[144:147], v[96:99], a[208:211], a[144:147]
    ds_read_b128 a[224:227], v244 offset:16384
    v_mfma_f32_16x16x32_bf16 a[176:179], v[96:99], a[212:215], a[176:179]
    ds_read_b128 a[228:231], v244 offset:18432
    v_mfma_f32_16x16x32_bf16 a[20:23], v[100:103], a[192:195], a[20:23]
    v_perm_b32 v104, v135, v131, s60
    v_perm_b32 v105, v143, v139, s60
    v_mfma_f32_16x16x32_bf16 a[52:55], v[100:103], a[196:199], a[52:55]
    v_perm_b32 v106, v151, v147, s60
    v_mfma_f32_16x16x32_bf16 a[84:87], v[100:103], a[200:203], a[84:87]
    v_perm_b32 v107, v159, v155, s60
    v_mfma_f32_16x16x32_bf16 a[116:119], v[100:103], a[204:207], a[116:119]
    buffer_load_dwordx4 v[44:47], v240, s[32:35], s54 offen
    buffer_load_dwordx4 v[48:51], v240, s[32:35], s55 offen
    v_mfma_f32_16x16x32_bf16 a[148:151], v[100:103], a[208:211], a[148:151]
    ds_read_b128 a[232:235], v244 offset:20480
    v_mfma_f32_16x16x32_bf16 a[180:183], v[100:103], a[212:215], a[180:183]
    ds_read_b128 a[236:239], v244 offset:22528
    v_mfma_f32_16x16x32_bf16 a[24:27], v[104:107], a[192:195], a[24:27]
    v_perm_b32 v108, v135, v131, s61
    v_mfma_f32_16x16x32_bf16 a[56:59], v[104:107], a[196:199], a[56:59]
    v_perm_b32 v109, v143, v139, s61
    v_mfma_f32_16x16x32_bf16 a[88:91], v[104:107], a[200:203], a[88:91]
    v_perm_b32 v110, v151, v147, s61
    v_mfma_f32_16x16x32_bf16 a[120:123], v[104:107], a[204:207], a[120:123]
    v_perm_b32 v111, v159, v155, s61
    v_mfma_f32_16x16x32_bf16 a[152:155], v[104:107], a[208:211], a[152:155]
    buffer_load_dwordx4 v[52:55], v240, s[32:35], s56 offen
    v_mfma_f32_16x16x32_bf16 a[184:187], v[104:107], a[212:215], a[184:187]
    v_mfma_f32_16x16x32_bf16 a[28:31], v[108:111], a[192:195], a[28:31]
    s_waitcnt vmcnt(22)
    v_perm_b32 v96, v164, v160, s60
    v_mfma_f32_16x16x32_bf16 a[60:63], v[108:111], a[196:199], a[60:63]
    v_perm_b32 v97, v172, v168, s60
    v_mfma_f32_16x16x32_bf16 a[92:95], v[108:111], a[200:203], a[92:95]
    v_perm_b32 v98, v180, v176, s60
    v_mfma_f32_16x16x32_bf16 a[124:127], v[108:111], a[204:207], a[124:127]
    v_perm_b32 v99, v188, v184, s60
    v_mfma_f32_16x16x32_bf16 a[156:159], v[108:111], a[208:211], a[156:159]
    buffer_load_dwordx4 v[56:59], v240, s[32:35], s57 offen
    v_mfma_f32_16x16x32_bf16 a[188:191], v[108:111], a[212:215], a[188:191]
    buffer_load_dwordx4 v[60:63], v240, s[32:35], s58 offen
    s_waitcnt lgkmcnt(0)
    v_mfma_f32_16x16x32_bf16 a[0:3], v[96:99], a[216:219], a[0:3]
    v_perm_b32 v100, v164, v160, s61
    v_perm_b32 v101, v172, v168, s61
    v_perm_b32 v102, v180, v176, s61
    v_mfma_f32_16x16x32_bf16 a[32:35], v[96:99], a[220:223], a[32:35]
    v_perm_b32 v103, v188, v184, s61
    v_add_u32 v240, s80, v240
    v_mfma_f32_16x16x32_bf16 a[64:67], v[96:99], a[224:227], a[64:67]
    v_and_b32 v240, 0x3fffff, v240
    buffer_load_dwordx4 v[64:67], v240, s[32:35], 0 offen
    v_mfma_f32_16x16x32_bf16 a[96:99], v[96:99], a[228:231], a[96:99]
    buffer_load_dwordx4 v[68:71], v240, s[32:35], s52 offen
    v_mfma_f32_16x16x32_bf16 a[128:131], v[96:99], a[232:235], a[128:131]
    ds_read_b128 v[128:131], v117 offset:0
    v_mfma_f32_16x16x32_bf16 a[160:163], v[96:99], a[236:239], a[160:163]
    ds_read_b128 v[132:135], v118 offset:0
    ds_read_b128 v[136:139], v119 offset:0
    v_mfma_f32_16x16x32_bf16 a[4:7], v[100:103], a[216:219], a[4:7]
    v_perm_b32 v104, v165, v161, s60
    v_perm_b32 v105, v173, v169, s60
    v_mfma_f32_16x16x32_bf16 a[36:39], v[100:103], a[220:223], a[36:39]
    v_perm_b32 v106, v181, v177, s60
    v_mfma_f32_16x16x32_bf16 a[68:71], v[100:103], a[224:227], a[68:71]
    v_perm_b32 v107, v189, v185, s60
    buffer_load_dwordx4 v[72:75], v240, s[32:35], s53 offen
    v_mfma_f32_16x16x32_bf16 a[100:103], v[100:103], a[228:231], a[100:103]
    buffer_load_dwordx4 v[76:79], v240, s[32:35], s54 offen
    v_mfma_f32_16x16x32_bf16 a[132:135], v[100:103], a[232:235], a[132:135]
    ds_read_b128 v[140:143], v120 offset:0
    ds_read_b128 v[144:147], v117 offset:4096
    v_mfma_f32_16x16x32_bf16 a[164:167], v[100:103], a[236:239], a[164:167]
    ds_read_b128 v[148:151], v118 offset:4096
    v_mfma_f32_16x16x32_bf16 a[8:11], v[104:107], a[216:219], a[8:11]
    v_perm_b32 v108, v165, v161, s61
    v_perm_b32 v109, v173, v169, s61
    v_mfma_f32_16x16x32_bf16 a[40:43], v[104:107], a[220:223], a[40:43]
    v_perm_b32 v110, v181, v177, s61
    v_mfma_f32_16x16x32_bf16 a[72:75], v[104:107], a[224:227], a[72:75]
    v_perm_b32 v111, v189, v185, s61
    v_mfma_f32_16x16x32_bf16 a[104:107], v[104:107], a[228:231], a[104:107]
    buffer_load_dwordx4 v[80:83], v240, s[32:35], s55 offen
    ds_read_b128 v[152:155], v119 offset:4096
    v_mfma_f32_16x16x32_bf16 a[136:139], v[104:107], a[232:235], a[136:139]
    ds_read_b128 v[156:159], v120 offset:4096
    v_mfma_f32_16x16x32_bf16 a[168:171], v[104:107], a[236:239], a[168:171]
    v_mfma_f32_16x16x32_bf16 a[12:15], v[108:111], a[216:219], a[12:15]
    v_perm_b32 v96, v166, v162, s60
    v_perm_b32 v97, v174, v170, s60
    v_mfma_f32_16x16x32_bf16 a[44:47], v[108:111], a[220:223], a[44:47]
    v_perm_b32 v98, v182, v178, s60
    v_perm_b32 v99, v190, v186, s60
    v_mfma_f32_16x16x32_bf16 a[76:79], v[108:111], a[224:227], a[76:79]
    buffer_load_dwordx4 v[84:87], v240, s[32:35], s56 offen
    v_mfma_f32_16x16x32_bf16 a[108:111], v[108:111], a[228:231], a[108:111]
    buffer_load_dwordx4 v[88:91], v240, s[32:35], s57 offen
    v_mfma_f32_16x16x32_bf16 a[140:143], v[108:111], a[232:235], a[140:143]
    s_barrier
    ds_read_b128 a[192:195], v243 offset:24576
    v_mfma_f32_16x16x32_bf16 a[172:175], v[108:111], a[236:239], a[172:175]
    ds_read_b128 a[196:199], v243 offset:26624
    v_mfma_f32_16x16x32_bf16 a[16:19], v[96:99], a[216:219], a[16:19]
    v_perm_b32 v100, v166, v162, s61
    v_perm_b32 v101, v174, v170, s61
    v_mfma_f32_16x16x32_bf16 a[48:51], v[96:99], a[220:223], a[48:51]
    v_perm_b32 v102, v182, v178, s61
    v_perm_b32 v103, v190, v186, s61
    v_mfma_f32_16x16x32_bf16 a[80:83], v[96:99], a[224:227], a[80:83]
    buffer_load_dwordx4 v[92:95], v240, s[32:35], s58 offen
    v_mfma_f32_16x16x32_bf16 a[112:115], v[96:99], a[228:231], a[112:115]
    v_add_u32 v240, s81, v240
    v_and_b32 v240, 0x3fffff, v240
    v_mfma_f32_16x16x32_bf16 a[144:147], v[96:99], a[232:235], a[144:147]
    buffer_load_dwordx4 v[0:3], v240, s[32:35], 0 offen
    ds_read_b128 a[200:203], v243 offset:28672
    v_mfma_f32_16x16x32_bf16 a[176:179], v[96:99], a[236:239], a[176:179]
    ds_read_b128 a[204:207], v243 offset:30720
    v_mfma_f32_16x16x32_bf16 a[20:23], v[100:103], a[216:219], a[20:23]
    v_perm_b32 v104, v167, v163, s60
    v_perm_b32 v105, v175, v171, s60
    v_mfma_f32_16x16x32_bf16 a[52:55], v[100:103], a[220:223], a[52:55]
    v_perm_b32 v106, v183, v179, s60
    v_mfma_f32_16x16x32_bf16 a[84:87], v[100:103], a[224:227], a[84:87]
    v_perm_b32 v107, v191, v187, s60
    v_mfma_f32_16x16x32_bf16 a[116:119], v[100:103], a[228:231], a[116:119]
    buffer_load_dwordx4 v[4:7], v240, s[32:35], s52 offen
    buffer_load_dwordx4 v[8:11], v240, s[32:35], s53 offen
    v_mfma_f32_16x16x32_bf16 a[148:151], v[100:103], a[232:235], a[148:151]
    ds_read_b128 a[208:211], v243 offset:32768
    v_mfma_f32_16x16x32_bf16 a[180:183], v[100:103], a[236:239], a[180:183]
    ds_read_b128 a[212:215], v243 offset:34816
    v_mfma_f32_16x16x32_bf16 a[24:27], v[104:107], a[216:219], a[24:27]
    v_perm_b32 v108, v167, v163, s61
    v_mfma_f32_16x16x32_bf16 a[56:59], v[104:107], a[220:223], a[56:59]
    v_perm_b32 v109, v175, v171, s61
    v_mfma_f32_16x16x32_bf16 a[88:91], v[104:107], a[224:227], a[88:91]
    v_perm_b32 v110, v183, v179, s61
    v_mfma_f32_16x16x32_bf16 a[120:123], v[104:107], a[228:231], a[120:123]
    v_perm_b32 v111, v191, v187, s61
    v_mfma_f32_16x16x32_bf16 a[152:155], v[104:107], a[232:235], a[152:155]
    buffer_load_dwordx4 v[12:15], v240, s[32:35], s54 offen
    v_mfma_f32_16x16x32_bf16 a[184:187], v[104:107], a[236:239], a[184:187]
    v_mfma_f32_16x16x32_bf16 a[28:31], v[108:111], a[216:219], a[28:31]
    s_waitcnt vmcnt(20)
    v_perm_b32 v96, v196, v192, s60
    v_mfma_f32_16x16x32_bf16 a[60:63], v[108:111], a[220:223], a[60:63]
    v_perm_b32 v97, v204, v200, s60
    v_mfma_f32_16x16x32_bf16 a[92:95], v[108:111], a[224:227], a[92:95]
    v_perm_b32 v98, v212, v208, s60
    v_mfma_f32_16x16x32_bf16 a[124:127], v[108:111], a[228:231], a[124:127]
    v_perm_b32 v99, v220, v216, s60
    v_mfma_f32_16x16x32_bf16 a[156:159], v[108:111], a[232:235], a[156:159]
    buffer_load_dwordx4 v[16:19], v240, s[32:35], s55 offen
    v_mfma_f32_16x16x32_bf16 a[188:191], v[108:111], a[236:239], a[188:191]
    buffer_load_dwordx4 v[20:23], v240, s[32:35], s56 offen
    s_waitcnt lgkmcnt(0)
    v_mfma_f32_16x16x32_bf16 a[0:3], v[96:99], a[192:195], a[0:3]
    v_perm_b32 v100, v196, v192, s61
    v_perm_b32 v101, v204, v200, s61
    v_mfma_f32_16x16x32_bf16 a[32:35], v[96:99], a[196:199], a[32:35]
    v_perm_b32 v102, v212, v208, s61
    v_perm_b32 v103, v220, v216, s61
    v_mfma_f32_16x16x32_bf16 a[64:67], v[96:99], a[200:203], a[64:67]
    buffer_load_dwordx4 v[24:27], v240, s[32:35], s57 offen
    buffer_load_dwordx4 v[28:31], v240, s[32:35], s58 offen
    v_mfma_f32_16x16x32_bf16 a[96:99], v[96:99], a[204:207], a[96:99]
    v_mfma_f32_16x16x32_bf16 a[128:131], v[96:99], a[208:211], a[128:131]
    ds_read_b128 v[160:163], v117 offset:8192
    ds_read_b128 v[164:167], v118 offset:8192
    v_mfma_f32_16x16x32_bf16 a[160:163], v[96:99], a[212:215], a[160:163]
    ds_read_b128 v[168:171], v119 offset:8192
    v_mfma_f32_16x16x32_bf16 a[4:7], v[100:103], a[192:195], a[4:7]
    v_perm_b32 v104, v197, v193, s60
    v_perm_b32 v105, v205, v201, s60
    v_mfma_f32_16x16x32_bf16 a[36:39], v[100:103], a[196:199], a[36:39]
    v_perm_b32 v106, v213, v209, s60
    v_perm_b32 v107, v221, v217, s60
    v_mfma_f32_16x16x32_bf16 a[68:71], v[100:103], a[200:203], a[68:71]
    s_add_u32 s73, s62, 16384
    v_mfma_f32_16x16x32_bf16 a[100:103], v[100:103], a[204:207], a[100:103]
    s_add_u32 m0, s4, 0
    s_nop 0
    buffer_load_dwordx4 v113, s[24:27], s73 offen nt lds
    v_mfma_f32_16x16x32_bf16 a[132:135], v[100:103], a[208:211], a[132:135]
    ds_read_b128 v[172:175], v120 offset:8192
    ds_read_b128 v[176:179], v117 offset:12288
    v_mfma_f32_16x16x32_bf16 a[164:167], v[100:103], a[212:215], a[164:167]
    ds_read_b128 v[180:183], v118 offset:12288
    v_mfma_f32_16x16x32_bf16 a[8:11], v[104:107], a[192:195], a[8:11]
    v_perm_b32 v108, v197, v193, s61
    v_perm_b32 v109, v205, v201, s61
    v_mfma_f32_16x16x32_bf16 a[40:43], v[104:107], a[196:199], a[40:43]
    v_perm_b32 v110, v213, v209, s61
    v_perm_b32 v111, v221, v217, s61
    v_mfma_f32_16x16x32_bf16 a[72:75], v[104:107], a[200:203], a[72:75]
    s_add_u32 s73, s62, 17408
    v_mfma_f32_16x16x32_bf16 a[104:107], v[104:107], a[204:207], a[104:107]
    s_add_u32 m0, s4, 1024
    s_nop 0
    buffer_load_dwordx4 v114, s[24:27], s73 offen nt lds
    v_mfma_f32_16x16x32_bf16 a[136:139], v[104:107], a[208:211], a[136:139]
    ds_read_b128 v[184:187], v119 offset:12288
    ds_read_b128 v[188:191], v120 offset:12288
    v_mfma_f32_16x16x32_bf16 a[168:171], v[104:107], a[212:215], a[168:171]
    v_mfma_f32_16x16x32_bf16 a[12:15], v[108:111], a[192:195], a[12:15]
    v_perm_b32 v96, v198, v194, s60
    v_mfma_f32_16x16x32_bf16 a[44:47], v[108:111], a[196:199], a[44:47]
    v_perm_b32 v97, v206, v202, s60
    v_mfma_f32_16x16x32_bf16 a[76:79], v[108:111], a[200:203], a[76:79]
    v_perm_b32 v98, v214, v210, s60
    v_mfma_f32_16x16x32_bf16 a[108:111], v[108:111], a[204:207], a[108:111]
    v_perm_b32 v99, v222, v218, s60
    v_mfma_f32_16x16x32_bf16 a[140:143], v[108:111], a[208:211], a[140:143]
    ds_read_b128 a[216:219], v244 offset:24576
    v_mfma_f32_16x16x32_bf16 a[172:175], v[108:111], a[212:215], a[172:175]
    ds_read_b128 a[220:223], v244 offset:26624
    v_mfma_f32_16x16x32_bf16 a[16:19], v[96:99], a[192:195], a[16:19]
    v_perm_b32 v100, v198, v194, s61
    v_perm_b32 v101, v206, v202, s61
    v_mfma_f32_16x16x32_bf16 a[48:51], v[96:99], a[196:199], a[48:51]
    v_perm_b32 v102, v214, v210, s61
    v_mfma_f32_16x16x32_bf16 a[80:83], v[96:99], a[200:203], a[80:83]
    v_perm_b32 v103, v222, v218, s61
    s_add_u32 s73, s62, 18432
    v_mfma_f32_16x16x32_bf16 a[112:115], v[96:99], a[204:207], a[112:115]
    s_add_u32 m0, s4, 2048
    v_mfma_f32_16x16x32_bf16 a[144:147], v[96:99], a[208:211], a[144:147]
    buffer_load_dwordx4 v115, s[24:27], s73 offen nt lds
    ds_read_b128 a[224:227], v244 offset:28672
    v_mfma_f32_16x16x32_bf16 a[176:179], v[96:99], a[212:215], a[176:179]
    ds_read_b128 a[228:231], v244 offset:30720
    v_mfma_f32_16x16x32_bf16 a[20:23], v[100:103], a[192:195], a[20:23]
    v_perm_b32 v104, v199, v195, s60
    v_perm_b32 v105, v207, v203, s60
    v_mfma_f32_16x16x32_bf16 a[52:55], v[100:103], a[196:199], a[52:55]
    v_perm_b32 v106, v215, v211, s60
    v_mfma_f32_16x16x32_bf16 a[84:87], v[100:103], a[200:203], a[84:87]
    v_perm_b32 v107, v223, v219, s60
    s_add_u32 s73, s62, 19456
    v_mfma_f32_16x16x32_bf16 a[116:119], v[100:103], a[204:207], a[116:119]
    s_add_u32 m0, s4, 3072
    v_mfma_f32_16x16x32_bf16 a[148:151], v[100:103], a[208:211], a[148:151]
    buffer_load_dwordx4 v116, s[24:27], s73 offen nt lds
    ds_read_b128 a[232:235], v244 offset:32768
    v_mfma_f32_16x16x32_bf16 a[180:183], v[100:103], a[212:215], a[180:183]
    ds_read_b128 a[236:239], v244 offset:34816
    v_mfma_f32_16x16x32_bf16 a[24:27], v[104:107], a[192:195], a[24:27]
    v_perm_b32 v108, v199, v195, s61
    v_perm_b32 v109, v207, v203, s61
    v_mfma_f32_16x16x32_bf16 a[56:59], v[104:107], a[196:199], a[56:59]
    v_perm_b32 v110, v215, v211, s61
    v_mfma_f32_16x16x32_bf16 a[88:91], v[104:107], a[200:203], a[88:91]
    v_perm_b32 v111, v223, v219, s61
    v_mfma_f32_16x16x32_bf16 a[120:123], v[104:107], a[204:207], a[120:123]
    s_add_u32 s73, s62, 20480
    v_mfma_f32_16x16x32_bf16 a[152:155], v[104:107], a[208:211], a[152:155]
    s_add_u32 m0, s4, 4096
    v_mfma_f32_16x16x32_bf16 a[184:187], v[104:107], a[212:215], a[184:187]
    buffer_load_dwordx4 v113, s[24:27], s73 offen nt lds
    v_mfma_f32_16x16x32_bf16 a[28:31], v[108:111], a[192:195], a[28:31]
    s_waitcnt vmcnt(21)
    v_perm_b32 v96, v36, v32, s60
    v_mfma_f32_16x16x32_bf16 a[60:63], v[108:111], a[196:199], a[60:63]
    v_perm_b32 v97, v44, v40, s60
    v_mfma_f32_16x16x32_bf16 a[92:95], v[108:111], a[200:203], a[92:95]
    v_perm_b32 v98, v52, v48, s60
    v_mfma_f32_16x16x32_bf16 a[124:127], v[108:111], a[204:207], a[124:127]
    v_perm_b32 v99, v60, v56, s60
    s_add_u32 s73, s62, 21504
    v_mfma_f32_16x16x32_bf16 a[156:159], v[108:111], a[208:211], a[156:159]
    s_add_u32 m0, s4, 5120
    v_mfma_f32_16x16x32_bf16 a[188:191], v[108:111], a[212:215], a[188:191]
    buffer_load_dwordx4 v114, s[24:27], s73 offen nt lds
    s_waitcnt lgkmcnt(0)
    v_mfma_f32_16x16x32_bf16 a[0:3], v[96:99], a[216:219], a[0:3]
    v_perm_b32 v100, v36, v32, s61
    v_perm_b32 v101, v44, v40, s61
    v_mfma_f32_16x16x32_bf16 a[32:35], v[96:99], a[220:223], a[32:35]
    v_perm_b32 v102, v52, v48, s61
    v_mfma_f32_16x16x32_bf16 a[64:67], v[96:99], a[224:227], a[64:67]
    v_perm_b32 v103, v60, v56, s61
    v_mfma_f32_16x16x32_bf16 a[96:99], v[96:99], a[228:231], a[96:99]
    s_add_u32 s73, s62, 22528
    v_mfma_f32_16x16x32_bf16 a[128:131], v[96:99], a[232:235], a[128:131]
    s_add_u32 m0, s4, 6144
    v_mfma_f32_16x16x32_bf16 a[160:163], v[96:99], a[236:239], a[160:163]
    buffer_load_dwordx4 v115, s[24:27], s73 offen nt lds
    v_mfma_f32_16x16x32_bf16 a[4:7], v[100:103], a[216:219], a[4:7]
    v_perm_b32 v104, v37, v33, s60
    v_perm_b32 v105, v45, v41, s60
    v_mfma_f32_16x16x32_bf16 a[36:39], v[100:103], a[220:223], a[36:39]
    v_perm_b32 v106, v53, v49, s60
    v_mfma_f32_16x16x32_bf16 a[68:71], v[100:103], a[224:227], a[68:71]
    v_perm_b32 v107, v61, v57, s60
    v_mfma_f32_16x16x32_bf16 a[100:103], v[100:103], a[228:231], a[100:103]
    s_add_u32 s73, s62, 23552
    v_mfma_f32_16x16x32_bf16 a[132:135], v[100:103], a[232:235], a[132:135]
    s_add_u32 m0, s4, 7168
    v_mfma_f32_16x16x32_bf16 a[164:167], v[100:103], a[236:239], a[164:167]
    buffer_load_dwordx4 v116, s[24:27], s73 offen nt lds
    v_mfma_f32_16x16x32_bf16 a[8:11], v[104:107], a[216:219], a[8:11]
    v_perm_b32 v108, v37, v33, s61
    v_mfma_f32_16x16x32_bf16 a[40:43], v[104:107], a[220:223], a[40:43]
    v_perm_b32 v109, v45, v41, s61
    v_mfma_f32_16x16x32_bf16 a[72:75], v[104:107], a[224:227], a[72:75]
    v_mfma_f32_16x16x32_bf16 a[104:107], v[104:107], a[228:231], a[104:107]
    v_perm_b32 v110, v53, v49, s61
    v_mfma_f32_16x16x32_bf16 a[136:139], v[104:107], a[232:235], a[136:139]
    v_perm_b32 v111, v61, v57, s61
    v_mfma_f32_16x16x32_bf16 a[168:171], v[104:107], a[236:239], a[168:171]
    s_nop 0
    v_mfma_f32_16x16x32_bf16 a[12:15], v[108:111], a[216:219], a[12:15]
    v_perm_b32 v96, v38, v34, s60
    v_perm_b32 v97, v46, v42, s60
    v_mfma_f32_16x16x32_bf16 a[44:47], v[108:111], a[220:223], a[44:47]
    v_perm_b32 v98, v54, v50, s60
    v_perm_b32 v99, v62, v58, s60
    v_mfma_f32_16x16x32_bf16 a[76:79], v[108:111], a[224:227], a[76:79]
    v_mfma_f32_16x16x32_bf16 a[108:111], v[108:111], a[228:231], a[108:111]
    s_add_u32 s73, s62, 0
    s_add_u32 m0, s92, 0
    v_mfma_f32_16x16x32_bf16 a[140:143], v[108:111], a[232:235], a[140:143]
    buffer_load_dwordx4 v246, s[28:31], s73 offen nt lds
    ds_read_b128 a[192:195], v243 offset:36864
    v_mfma_f32_16x16x32_bf16 a[172:175], v[108:111], a[236:239], a[172:175]
    ds_read_b128 a[196:199], v243 offset:38912
    v_mfma_f32_16x16x32_bf16 a[16:19], v[96:99], a[216:219], a[16:19]
    v_perm_b32 v100, v38, v34, s61
    v_perm_b32 v101, v46, v42, s61
    v_mfma_f32_16x16x32_bf16 a[48:51], v[96:99], a[220:223], a[48:51]
    v_perm_b32 v102, v54, v50, s61
    v_mfma_f32_16x16x32_bf16 a[80:83], v[96:99], a[224:227], a[80:83]
    v_perm_b32 v103, v62, v58, s61
    s_add_u32 s73, s62, 1024
    v_mfma_f32_16x16x32_bf16 a[112:115], v[96:99], a[228:231], a[112:115]
    s_add_u32 m0, s92, 1024
    v_mfma_f32_16x16x32_bf16 a[144:147], v[96:99], a[232:235], a[144:147]
    buffer_load_dwordx4 v245, s[28:31], s73 offen nt lds
    ds_read_b128 a[200:203], v243 offset:40960
    v_mfma_f32_16x16x32_bf16 a[176:179], v[96:99], a[236:239], a[176:179]
    ds_read_b128 a[204:207], v243 offset:43008
    v_mfma_f32_16x16x32_bf16 a[20:23], v[100:103], a[216:219], a[20:23]
    v_perm_b32 v104, v39, v35, s60
    v_perm_b32 v105, v47, v43, s60
    v_mfma_f32_16x16x32_bf16 a[52:55], v[100:103], a[220:223], a[52:55]
    v_perm_b32 v106, v55, v51, s60
    v_mfma_f32_16x16x32_bf16 a[84:87], v[100:103], a[224:227], a[84:87]
    v_perm_b32 v107, v63, v59, s60
    s_add_u32 s73, s62, 2048
    v_mfma_f32_16x16x32_bf16 a[116:119], v[100:103], a[228:231], a[116:119]
    s_add_u32 m0, s92, 2048
    v_mfma_f32_16x16x32_bf16 a[148:151], v[100:103], a[232:235], a[148:151]
    buffer_load_dwordx4 v246, s[28:31], s73 offen nt lds
    ds_read_b128 a[208:211], v243 offset:45056
    v_mfma_f32_16x16x32_bf16 a[180:183], v[100:103], a[236:239], a[180:183]
    ds_read_b128 a[212:215], v243 offset:47104
    v_mfma_f32_16x16x32_bf16 a[24:27], v[104:107], a[216:219], a[24:27]
    v_perm_b32 v108, v39, v35, s61
    v_perm_b32 v109, v47, v43, s61
    v_mfma_f32_16x16x32_bf16 a[56:59], v[104:107], a[220:223], a[56:59]
    v_perm_b32 v110, v55, v51, s61
    v_mfma_f32_16x16x32_bf16 a[88:91], v[104:107], a[224:227], a[88:91]
    v_perm_b32 v111, v63, v59, s61
    v_mfma_f32_16x16x32_bf16 a[120:123], v[104:107], a[228:231], a[120:123]
    s_add_u32 s73, s62, 3072
    v_mfma_f32_16x16x32_bf16 a[152:155], v[104:107], a[232:235], a[152:155]
    s_add_u32 m0, s92, 3072
    v_mfma_f32_16x16x32_bf16 a[184:187], v[104:107], a[236:239], a[184:187]
    buffer_load_dwordx4 v245, s[28:31], s73 offen nt lds
    v_mfma_f32_16x16x32_bf16 a[28:31], v[108:111], a[216:219], a[28:31]
    s_waitcnt vmcnt(20)
    v_perm_b32 v96, v68, v64, s60
    v_mfma_f32_16x16x32_bf16 a[60:63], v[108:111], a[220:223], a[60:63]
    v_perm_b32 v97, v76, v72, s60
    v_mfma_f32_16x16x32_bf16 a[92:95], v[108:111], a[224:227], a[92:95]
    v_perm_b32 v98, v84, v80, s60
    v_mfma_f32_16x16x32_bf16 a[124:127], v[108:111], a[228:231], a[124:127]
    v_perm_b32 v99, v92, v88, s60
    s_add_u32 s73, s62, 4096
    v_mfma_f32_16x16x32_bf16 a[156:159], v[108:111], a[232:235], a[156:159]
    s_add_u32 m0, s92, 4096
    v_mfma_f32_16x16x32_bf16 a[188:191], v[108:111], a[236:239], a[188:191]
    buffer_load_dwordx4 v246, s[28:31], s73 offen nt lds
    s_waitcnt lgkmcnt(0)
    v_mfma_f32_16x16x32_bf16 a[0:3], v[96:99], a[192:195], a[0:3]
    v_perm_b32 v100, v68, v64, s61
    v_perm_b32 v101, v76, v72, s61
    v_mfma_f32_16x16x32_bf16 a[32:35], v[96:99], a[196:199], a[32:35]
    v_perm_b32 v102, v84, v80, s61
    v_mfma_f32_16x16x32_bf16 a[64:67], v[96:99], a[200:203], a[64:67]
    v_perm_b32 v103, v92, v88, s61
    v_mfma_f32_16x16x32_bf16 a[96:99], v[96:99], a[204:207], a[96:99]
    s_add_u32 s73, s62, 5120
    v_mfma_f32_16x16x32_bf16 a[128:131], v[96:99], a[208:211], a[128:131]
    s_add_u32 m0, s92, 5120
    v_mfma_f32_16x16x32_bf16 a[160:163], v[96:99], a[212:215], a[160:163]
    buffer_load_dwordx4 v245, s[28:31], s73 offen nt lds
    v_mfma_f32_16x16x32_bf16 a[4:7], v[100:103], a[192:195], a[4:7]
    v_perm_b32 v104, v69, v65, s60
    v_mfma_f32_16x16x32_bf16 a[36:39], v[100:103], a[196:199], a[36:39]
    v_perm_b32 v105, v77, v73, s60
    v_mfma_f32_16x16x32_bf16 a[68:71], v[100:103], a[200:203], a[68:71]
    v_mfma_f32_16x16x32_bf16 a[100:103], v[100:103], a[204:207], a[100:103]
    v_perm_b32 v106, v85, v81, s60
    v_mfma_f32_16x16x32_bf16 a[132:135], v[100:103], a[208:211], a[132:135]
    v_perm_b32 v107, v93, v89, s60
    v_mfma_f32_16x16x32_bf16 a[164:167], v[100:103], a[212:215], a[164:167]
    s_nop 0
    v_mfma_f32_16x16x32_bf16 a[8:11], v[104:107], a[192:195], a[8:11]
    v_perm_b32 v108, v69, v65, s61
    v_perm_b32 v109, v77, v73, s61
    v_mfma_f32_16x16x32_bf16 a[40:43], v[104:107], a[196:199], a[40:43]
    v_perm_b32 v110, v85, v81, s61
    v_mfma_f32_16x16x32_bf16 a[72:75], v[104:107], a[200:203], a[72:75]
    v_perm_b32 v111, v93, v89, s61
    v_mfma_f32_16x16x32_bf16 a[104:107], v[104:107], a[204:207], a[104:107]
    s_add_u32 s73, s62, 6144
    v_mfma_f32_16x16x32_bf16 a[136:139], v[104:107], a[208:211], a[136:139]
    s_add_u32 m0, s92, 6144
    v_mfma_f32_16x16x32_bf16 a[168:171], v[104:107], a[212:215], a[168:171]
    buffer_load_dwordx4 v246, s[28:31], s73 offen nt lds
    v_mfma_f32_16x16x32_bf16 a[12:15], v[108:111], a[192:195], a[12:15]
    v_perm_b32 v96, v70, v66, s60
    v_perm_b32 v97, v78, v74, s60
    v_mfma_f32_16x16x32_bf16 a[44:47], v[108:111], a[196:199], a[44:47]
    v_perm_b32 v98, v86, v82, s60
    v_mfma_f32_16x16x32_bf16 a[76:79], v[108:111], a[200:203], a[76:79]
    v_perm_b32 v99, v94, v90, s60
    s_add_u32 s73, s62, 7168
    v_mfma_f32_16x16x32_bf16 a[108:111], v[108:111], a[204:207], a[108:111]
    s_add_u32 m0, s92, 7168
    v_mfma_f32_16x16x32_bf16 a[140:143], v[108:111], a[208:211], a[140:143]
    buffer_load_dwordx4 v245, s[28:31], s73 offen nt lds
    ds_read_b128 a[216:219], v244 offset:36864
    v_mfma_f32_16x16x32_bf16 a[172:175], v[108:111], a[212:215], a[172:175]
    ds_read_b128 a[220:223], v244 offset:38912
    v_mfma_f32_16x16x32_bf16 a[16:19], v[96:99], a[192:195], a[16:19]
    v_perm_b32 v100, v70, v66, s61
    v_perm_b32 v101, v78, v74, s61
    v_mfma_f32_16x16x32_bf16 a[48:51], v[96:99], a[196:199], a[48:51]
    v_perm_b32 v102, v86, v82, s61
    v_perm_b32 v103, v94, v90, s61
    v_mfma_f32_16x16x32_bf16 a[80:83], v[96:99], a[200:203], a[80:83]
    v_mfma_f32_16x16x32_bf16 a[112:115], v[96:99], a[204:207], a[112:115]
    s_add_u32 s73, s62, 8192
    s_add_u32 m0, s92, 8192
    v_mfma_f32_16x16x32_bf16 a[144:147], v[96:99], a[208:211], a[144:147]
    buffer_load_dwordx4 v246, s[28:31], s73 offen nt lds
    ds_read_b128 a[224:227], v244 offset:40960
    v_mfma_f32_16x16x32_bf16 a[176:179], v[96:99], a[212:215], a[176:179]
    ds_read_b128 a[228:231], v244 offset:43008
    v_mfma_f32_16x16x32_bf16 a[20:23], v[100:103], a[192:195], a[20:23]
    v_perm_b32 v104, v71, v67, s60
    v_perm_b32 v105, v79, v75, s60
    v_mfma_f32_16x16x32_bf16 a[52:55], v[100:103], a[196:199], a[52:55]
    v_perm_b32 v106, v87, v83, s60
    v_mfma_f32_16x16x32_bf16 a[84:87], v[100:103], a[200:203], a[84:87]
    v_perm_b32 v107, v95, v91, s60
    s_add_u32 s73, s62, 9216
    v_mfma_f32_16x16x32_bf16 a[116:119], v[100:103], a[204:207], a[116:119]
    s_add_u32 m0, s92, 9216
    v_mfma_f32_16x16x32_bf16 a[148:151], v[100:103], a[208:211], a[148:151]
    buffer_load_dwordx4 v245, s[28:31], s73 offen nt lds
    ds_read_b128 a[232:235], v244 offset:45056
    v_mfma_f32_16x16x32_bf16 a[180:183], v[100:103], a[212:215], a[180:183]
    ds_read_b128 a[236:239], v244 offset:47104
    v_mfma_f32_16x16x32_bf16 a[24:27], v[104:107], a[192:195], a[24:27]
    v_perm_b32 v108, v71, v67, s61
    v_perm_b32 v109, v79, v75, s61
    v_mfma_f32_16x16x32_bf16 a[56:59], v[104:107], a[196:199], a[56:59]
    v_perm_b32 v110, v87, v83, s61
    v_mfma_f32_16x16x32_bf16 a[88:91], v[104:107], a[200:203], a[88:91]
    v_perm_b32 v111, v95, v91, s61
    v_mfma_f32_16x16x32_bf16 a[120:123], v[104:107], a[204:207], a[120:123]
    s_add_u32 s73, s62, 10240
    v_mfma_f32_16x16x32_bf16 a[152:155], v[104:107], a[208:211], a[152:155]
    s_add_u32 m0, s92, 10240
    v_mfma_f32_16x16x32_bf16 a[184:187], v[104:107], a[212:215], a[184:187]
    buffer_load_dwordx4 v246, s[28:31], s73 offen nt lds
    v_mfma_f32_16x16x32_bf16 a[28:31], v[108:111], a[192:195], a[28:31]
    s_waitcnt vmcnt(19)
    v_perm_b32 v64, v4, v0, s60
    v_mfma_f32_16x16x32_bf16 a[60:63], v[108:111], a[196:199], a[60:63]
    v_perm_b32 v65, v12, v8, s60
    v_mfma_f32_16x16x32_bf16 a[92:95], v[108:111], a[200:203], a[92:95]
    v_perm_b32 v66, v20, v16, s60
    v_mfma_f32_16x16x32_bf16 a[124:127], v[108:111], a[204:207], a[124:127]
    v_perm_b32 v67, v28, v24, s60
    s_add_u32 s73, s62, 11264
    v_mfma_f32_16x16x32_bf16 a[156:159], v[108:111], a[208:211], a[156:159]
    s_add_u32 m0, s92, 11264
    v_mfma_f32_16x16x32_bf16 a[188:191], v[108:111], a[212:215], a[188:191]
    buffer_load_dwordx4 v245, s[28:31], s73 offen nt lds
    s_waitcnt lgkmcnt(0)
    v_mfma_f32_16x16x32_bf16 a[0:3], v[64:67], a[216:219], a[0:3]
    v_perm_b32 v68, v4, v0, s61
    v_perm_b32 v69, v12, v8, s61
    v_perm_b32 v70, v20, v16, s61
    v_perm_b32 v71, v28, v24, s61
    s_nop 1
    v_mfma_f32_16x16x32_bf16 a[4:7], v[68:71], a[216:219], a[4:7]
    v_perm_b32 v72, v5, v1, s60
    v_perm_b32 v73, v13, v9, s60
    v_perm_b32 v74, v21, v17, s60
    v_perm_b32 v75, v29, v25, s60
    s_nop 1
    v_mfma_f32_16x16x32_bf16 a[8:11], v[72:75], a[216:219], a[8:11]
    v_perm_b32 v76, v5, v1, s61
    v_perm_b32 v77, v13, v9, s61
    v_perm_b32 v78, v21, v17, s61
    v_perm_b32 v79, v29, v25, s61
    s_nop 1
    v_mfma_f32_16x16x32_bf16 a[12:15], v[76:79], a[216:219], a[12:15]
    v_perm_b32 v80, v6, v2, s60
    v_perm_b32 v81, v14, v10, s60
    v_perm_b32 v82, v22, v18, s60
    v_perm_b32 v83, v30, v26, s60
    s_nop 1
    v_mfma_f32_16x16x32_bf16 a[16:19], v[80:83], a[216:219], a[16:19]
    v_perm_b32 v84, v6, v2, s61
    v_perm_b32 v85, v14, v10, s61
    v_perm_b32 v86, v22, v18, s61
    v_perm_b32 v87, v30, v26, s61
    s_nop 1
    v_mfma_f32_16x16x32_bf16 a[20:23], v[84:87], a[216:219], a[20:23]
    v_perm_b32 v88, v7, v3, s60
    v_perm_b32 v89, v15, v11, s60
    v_perm_b32 v90, v23, v19, s60
    v_perm_b32 v91, v31, v27, s60
    s_nop 1
    v_mfma_f32_16x16x32_bf16 a[24:27], v[88:91], a[216:219], a[24:27]
    v_perm_b32 v92, v7, v3, s61
    v_perm_b32 v93, v15, v11, s61
    v_perm_b32 v94, v23, v19, s61
    v_perm_b32 v95, v31, v27, s61
    s_nop 1
    v_mfma_f32_16x16x32_bf16 a[28:31], v[92:95], a[216:219], a[28:31]
    v_mfma_f32_16x16x32_bf16 a[32:35], v[64:67], a[220:223], a[32:35]
    s_waitcnt vmcnt(12)
    v_subrev_u32 v117, s5, v117
    v_subrev_u32 v118, s5, v118
    v_subrev_u32 v119, s5, v119
    v_subrev_u32 v120, s5, v120
    ds_read_b128 v[192:195], v117 offset:0
    ds_read_b128 v[196:199], v118 offset:0
    ds_read_b128 v[200:203], v119 offset:0
    ds_read_b128 v[204:207], v120 offset:0
    v_mfma_f32_16x16x32_bf16 a[36:39], v[68:71], a[220:223], a[36:39]
    s_add_u32 s73, s62, 12288
    s_add_u32 m0, s92, 12288
    s_nop 0
    buffer_load_dwordx4 v246, s[28:31], s73 offen nt lds
    v_accvgpr_read_b32 v251, a0
    v_mfma_f32_16x16x32_bf16 a[40:43], v[72:75], a[220:223], a[40:43]
    v_accvgpr_read_b32 v252, a4
    v_cvt_pk_bf16_f32 v32, v251, v252
    v_accvgpr_read_b32 v253, a8
    v_mfma_f32_16x16x32_bf16 a[44:47], v[76:79], a[220:223], a[44:47]
    v_accvgpr_read_b32 v254, a12
    v_cvt_pk_bf16_f32 v33, v253, v254
    v_accvgpr_read_b32 v251, a16
    v_mfma_f32_16x16x32_bf16 a[48:51], v[80:83], a[220:223], a[48:51]
    v_accvgpr_read_b32 v252, a20
    v_cvt_pk_bf16_f32 v34, v251, v252
    v_accvgpr_read_b32 v253, a24
    v_accvgpr_read_b32 v254, a28
    v_mfma_f32_16x16x32_bf16 a[52:55], v[84:87], a[220:223], a[52:55]
    v_cvt_pk_bf16_f32 v35, v253, v254
    v_accvgpr_read_b32 v251, a1
    v_accvgpr_read_b32 v252, a5
    v_mfma_f32_16x16x32_bf16 a[56:59], v[88:91], a[220:223], a[56:59]
    v_cvt_pk_bf16_f32 v36, v251, v252
    v_accvgpr_read_b32 v253, a9
    v_accvgpr_read_b32 v254, a13
    v_mfma_f32_16x16x32_bf16 a[60:63], v[92:95], a[220:223], a[60:63]
    v_cvt_pk_bf16_f32 v37, v253, v254
    v_accvgpr_read_b32 v251, a17
    v_accvgpr_read_b32 v252, a21
    v_mfma_f32_16x16x32_bf16 a[64:67], v[64:67], a[224:227], a[64:67]
    ds_read_b128 v[208:211], v117 offset:4096
    ds_read_b128 v[212:215], v118 offset:4096
    ds_read_b128 v[216:219], v119 offset:4096
    ds_read_b128 v[220:223], v120 offset:4096
    v_mfma_f32_16x16x32_bf16 a[68:71], v[68:71], a[224:227], a[68:71]
    s_add_u32 s73, s62, 13312
    s_add_u32 m0, s92, 13312
    s_nop 0
    buffer_load_dwordx4 v245, s[28:31], s73 offen nt lds
    s_add_u32 s73, s62, 14336
    v_mfma_f32_16x16x32_bf16 a[72:75], v[72:75], a[224:227], a[72:75]
    s_add_u32 m0, s92, 14336
    s_nop 0
    buffer_load_dwordx4 v246, s[28:31], s73 offen nt lds
    v_cvt_pk_bf16_f32 v38, v251, v252
    v_accvgpr_read_b32 v253, a25
    v_mfma_f32_16x16x32_bf16 a[76:79], v[76:79], a[224:227], a[76:79]
    v_accvgpr_read_b32 v254, a29
    v_cvt_pk_bf16_f32 v39, v253, v254
    v_accvgpr_read_b32 v251, a2
    v_accvgpr_read_b32 v252, a6
    v_mfma_f32_16x16x32_bf16 a[80:83], v[80:83], a[224:227], a[80:83]
    v_cvt_pk_bf16_f32 v40, v251, v252
    v_accvgpr_read_b32 v253, a10
    v_accvgpr_read_b32 v254, a14
    v_mfma_f32_16x16x32_bf16 a[84:87], v[84:87], a[224:227], a[84:87]
    v_cvt_pk_bf16_f32 v41, v253, v254
    v_accvgpr_read_b32 v251, a18
    v_accvgpr_read_b32 v252, a22
    v_cvt_pk_bf16_f32 v42, v251, v252
    v_mfma_f32_16x16x32_bf16 a[88:91], v[88:91], a[224:227], a[88:91]
    v_accvgpr_read_b32 v253, a26
    v_accvgpr_read_b32 v254, a30
    v_cvt_pk_bf16_f32 v43, v253, v254
    v_accvgpr_read_b32 v251, a3
    v_mfma_f32_16x16x32_bf16 a[92:95], v[92:95], a[224:227], a[92:95]
    v_accvgpr_read_b32 v252, a7
    v_cvt_pk_bf16_f32 v44, v251, v252
    v_accvgpr_read_b32 v253, a11
    v_mfma_f32_16x16x32_bf16 a[96:99], v[64:67], a[228:231], a[96:99]
    v_mfma_f32_16x16x32_bf16 a[100:103], v[68:71], a[228:231], a[100:103]
    s_add_u32 s73, s62, 15360
    s_add_u32 m0, s92, 15360
    s_nop 0
    buffer_load_dwordx4 v245, s[28:31], s73 offen nt lds
    v_accvgpr_read_b32 v254, a15
    v_mfma_f32_16x16x32_bf16 a[104:107], v[72:75], a[228:231], a[104:107]
    v_cvt_pk_bf16_f32 v45, v253, v254
    v_accvgpr_read_b32 v251, a19
    v_accvgpr_read_b32 v252, a23
    v_mfma_f32_16x16x32_bf16 a[108:111], v[76:79], a[228:231], a[108:111]
    v_cvt_pk_bf16_f32 v46, v251, v252
    v_accvgpr_read_b32 v253, a27
    v_accvgpr_read_b32 v254, a31
    v_mfma_f32_16x16x32_bf16 a[112:115], v[80:83], a[228:231], a[112:115]
    v_cvt_pk_bf16_f32 v47, v253, v254
    v_accvgpr_read_b32 v251, a32
    v_accvgpr_read_b32 v252, a36
    v_cvt_pk_bf16_f32 v48, v251, v252
    v_mfma_f32_16x16x32_bf16 a[116:119], v[84:87], a[228:231], a[116:119]
    v_accvgpr_read_b32 v253, a40
    v_accvgpr_read_b32 v254, a44
    v_cvt_pk_bf16_f32 v49, v253, v254
    v_mfma_f32_16x16x32_bf16 a[120:123], v[88:91], a[228:231], a[120:123]
    v_accvgpr_read_b32 v251, a48
    v_accvgpr_read_b32 v252, a52
    v_cvt_pk_bf16_f32 v50, v251, v252
    v_mfma_f32_16x16x32_bf16 a[124:127], v[92:95], a[228:231], a[124:127]
    v_accvgpr_read_b32 v253, a56
    v_accvgpr_read_b32 v254, a60
    v_cvt_pk_bf16_f32 v51, v253, v254
    v_mfma_f32_16x16x32_bf16 a[128:131], v[64:67], a[232:235], a[128:131]
    v_mfma_f32_16x16x32_bf16 a[132:135], v[68:71], a[232:235], a[132:135]
    v_accvgpr_read_b32 v251, a33
    v_accvgpr_read_b32 v252, a37
    v_cvt_pk_bf16_f32 v52, v251, v252
    v_mfma_f32_16x16x32_bf16 a[136:139], v[72:75], a[232:235], a[136:139]
    v_accvgpr_read_b32 v253, a41
    v_accvgpr_read_b32 v254, a45
    v_cvt_pk_bf16_f32 v53, v253, v254
    v_mfma_f32_16x16x32_bf16 a[140:143], v[76:79], a[232:235], a[140:143]
    v_accvgpr_read_b32 v251, a49
    v_accvgpr_read_b32 v252, a53
    v_cvt_pk_bf16_f32 v54, v251, v252
    v_mfma_f32_16x16x32_bf16 a[144:147], v[80:83], a[232:235], a[144:147]
    v_accvgpr_read_b32 v253, a57
    v_accvgpr_read_b32 v254, a61
    v_cvt_pk_bf16_f32 v55, v253, v254
    v_mfma_f32_16x16x32_bf16 a[148:151], v[84:87], a[232:235], a[148:151]
    v_accvgpr_read_b32 v251, a34
    v_accvgpr_read_b32 v252, a38
    v_cvt_pk_bf16_f32 v56, v251, v252
    v_mfma_f32_16x16x32_bf16 a[152:155], v[88:91], a[232:235], a[152:155]
    v_accvgpr_read_b32 v253, a42
    v_accvgpr_read_b32 v254, a46
    v_cvt_pk_bf16_f32 v57, v253, v254
    v_mfma_f32_16x16x32_bf16 a[156:159], v[92:95], a[232:235], a[156:159]
    v_accvgpr_read_b32 v251, a50
    v_accvgpr_read_b32 v252, a54
    v_mfma_f32_16x16x32_bf16 a[160:163], v[64:67], a[236:239], a[160:163]
    v_mfma_f32_16x16x32_bf16 a[164:167], v[68:71], a[236:239], a[164:167]
    v_cvt_pk_bf16_f32 v58, v251, v252
    v_accvgpr_read_b32 v253, a58
    v_accvgpr_read_b32 v254, a62
    v_mfma_f32_16x16x32_bf16 a[168:171], v[72:75], a[236:239], a[168:171]
    v_cvt_pk_bf16_f32 v59, v253, v254
    v_accvgpr_read_b32 v251, a35
    v_mfma_f32_16x16x32_bf16 a[172:175], v[76:79], a[236:239], a[172:175]
    v_accvgpr_read_b32 v252, a39
    v_cvt_pk_bf16_f32 v60, v251, v252
    v_mfma_f32_16x16x32_bf16 a[176:179], v[80:83], a[236:239], a[176:179]
    v_accvgpr_read_b32 v253, a43
    v_accvgpr_read_b32 v254, a47
    v_cvt_pk_bf16_f32 v61, v253, v254
    v_mfma_f32_16x16x32_bf16 a[180:183], v[84:87], a[236:239], a[180:183]
    v_accvgpr_read_b32 v251, a51
    v_accvgpr_read_b32 v252, a55
    v_mfma_f32_16x16x32_bf16 a[184:187], v[88:91], a[236:239], a[184:187]
    v_cvt_pk_bf16_f32 v62, v251, v252
    v_accvgpr_read_b32 v253, a59
    v_mfma_f32_16x16x32_bf16 a[188:191], v[92:95], a[236:239], a[188:191]
    v_accvgpr_read_b32 v254, a63
    v_cvt_pk_bf16_f32 v63, v253, v254
    s_lshl_b32 s72, s3, 13
    v_add_u32 v241, s72, v248
    s_nop 7
    s_branch join
cls3:
    s_add_u32 s72, s82, 0
    s_and_b32 s72, s72, 0x3ff
    s_add_u32 s72, s72, s86
    s_add_u32 m0, s89, 0
    s_nop 0
    buffer_load_dwordx4 v251, s[20:23], s72 offen lds
    s_add_u32 s72, s82, 0
    s_and_b32 s72, s72, 0x3ff
    s_add_u32 s72, s72, s87
    s_add_u32 m0, s90, 0
    s_nop 0
    buffer_load_dwordx4 v252, s[20:23], s72 offen lds
    s_add_u32 s72, s82, 0
    s_and_b32 s72, s72, 0x3ff
    s_add_u32 s72, s72, s88
    s_add_u32 m0, s91, 0
    s_nop 0
    buffer_load_dwordx4 v253, s[20:23], s72 offen lds
    buffer_load_dwordx4 v[192:195], v240, s[32:35], 0 offen
    buffer_load_dwordx4 v[196:199], v240, s[32:35], s52 offen
    buffer_load_dwordx4 v[200:203], v240, s[32:35], s53 offen
    buffer_load_dwordx4 v[204:207], v240, s[32:35], s54 offen
    buffer_load_dwordx4 v[208:211], v240, s[32:35], s55 offen
    buffer_load_dwordx4 v[212:215], v240, s[32:35], s56 offen
    buffer_load_dwordx4 v[216:219], v240, s[32:35], s57 offen
    buffer_load_dwordx4 v[220:223], v240, s[32:35], s58 offen
    s_add_u32 s72, s82, 128
    s_and_b32 s72, s72, 0x3ff
    s_add_u32 s72, s72, s86
    s_add_u32 m0, s89, 12288
    s_nop 0
    buffer_load_dwordx4 v251, s[20:23], s72 offen lds
    s_add_u32 s72, s82, 128
    s_and_b32 s72, s72, 0x3ff
    s_add_u32 s72, s72, s87
    s_add_u32 m0, s90, 12288
    s_nop 0
    buffer_load_dwordx4 v252, s[20:23], s72 offen lds
    s_add_u32 s72, s82, 128
    s_and_b32 s72, s72, 0x3ff
    s_add_u32 s72, s72, s88
    s_add_u32 m0, s91, 12288
    s_nop 0
    buffer_load_dwordx4 v253, s[20:23], s72 offen lds
    v_add_u32 v240, s81, v240
    v_and_b32 v240, 0x3fffff, v240
    buffer_load_dwordx4 v[32:35], v240, s[32:35], 0 offen
    buffer_load_dwordx4 v[36:39], v240, s[32:35], s52 offen
    buffer_load_dwordx4 v[40:43], v240, s[32:35], s53 offen
    buffer_load_dwordx4 v[44:47], v240, s[32:35], s54 offen
    buffer_load_dwordx4 v[48:51], v240, s[32:35], s55 offen
    buffer_load_dwordx4 v[52:55], v240, s[32:35], s56 offen
    buffer_load_dwordx4 v[56:59], v240, s[32:35], s57 offen
    buffer_load_dwordx4 v[60:63], v240, s[32:35], s58 offen
    buffer_load_dword v254, v112, s[32:35], 0 offen
    s_waitcnt vmcnt(9)
    s_barrier
    ds_read_b128 a[192:195], v241 offset:0
    ds_read_b128 a[196:199], v241 offset:2048
    ds_read_b128 a[200:203], v241 offset:4096
    ds_read_b128 a[204:207], v241 offset:6144
    ds_read_b128 a[208:211], v241 offset:8192
    ds_read_b128 a[212:215], v241 offset:10240
    v_perm_b32 v96, v196, v192, s60
    v_perm_b32 v97, v204, v200, s60
    v_perm_b32 v98, v212, v208, s60
    v_perm_b32 v99, v220, v216, s60
    s_waitcnt lgkmcnt(0)
    s_nop 0
    v_mfma_f32_16x16x32_bf16 a[0:3], v[96:99], a[192:195], 0
    v_perm_b32 v100, v196, v192, s61
    v_perm_b32 v101, v204, v200, s61
    v_mfma_f32_16x16x32_bf16 a[32:35], v[96:99], a[196:199], 0
    v_perm_b32 v102, v212, v208, s61
    v_mfma_f32_16x16x32_bf16 a[64:67], v[96:99], a[200:203], 0
    v_perm_b32 v103, v220, v216, s61
    v_mfma_f32_16x16x32_bf16 a[96:99], v[96:99], a[204:207], 0
    v_add_u32 v240, s80, v240
    v_mfma_f32_16x16x32_bf16 a[128:131], v[96:99], a[208:211], 0
    v_and_b32 v240, 0x3fffff, v240
    v_mfma_f32_16x16x32_bf16 a[160:163], v[96:99], a[212:215], 0
    buffer_load_dwordx4 v[64:67], v240, s[32:35], 0 offen
    v_mfma_f32_16x16x32_bf16 a[4:7], v[100:103], a[192:195], 0
    v_perm_b32 v104, v197, v193, s60
    v_mfma_f32_16x16x32_bf16 a[36:39], v[100:103], a[196:199], 0
    v_perm_b32 v105, v205, v201, s60
    v_mfma_f32_16x16x32_bf16 a[68:71], v[100:103], a[200:203], 0
    v_perm_b32 v106, v213, v209, s60
    v_mfma_f32_16x16x32_bf16 a[100:103], v[100:103], a[204:207], 0
    v_perm_b32 v107, v221, v217, s60
    v_mfma_f32_16x16x32_bf16 a[132:135], v[100:103], a[208:211], 0
    buffer_load_dwordx4 v[68:71], v240, s[32:35], s52 offen
    v_mfma_f32_16x16x32_bf16 a[164:167], v[100:103], a[212:215], 0
    buffer_load_dwordx4 v[72:75], v240, s[32:35], s53 offen
    v_mfma_f32_16x16x32_bf16 a[8:11], v[104:107], a[192:195], 0
    v_perm_b32 v108, v197, v193, s61
    v_mfma_f32_16x16x32_bf16 a[40:43], v[104:107], a[196:199], 0
    v_perm_b32 v109, v205, v201, s61
    v_mfma_f32_16x16x32_bf16 a[72:75], v[104:107], a[200:203], 0
    v_perm_b32 v110, v213, v209, s61
    v_mfma_f32_16x16x32_bf16 a[104:107], v[104:107], a[204:207], 0
    v_perm_b32 v111, v221, v217, s61
    v_mfma_f32_16x16x32_bf16 a[136:139], v[104:107], a[208:211], 0
    buffer_load_dwordx4 v[76:79], v240, s[32:35], s54 offen
    v_mfma_f32_16x16x32_bf16 a[168:171], v[104:107], a[212:215], 0
    buffer_load_dwordx4 v[80:83], v240, s[32:35], s55 offen
    v_mfma_f32_16x16x32_bf16 a[12:15], v[108:111], a[192:195], 0
    v_perm_b32 v96, v198, v194, s60
    v_perm_b32 v97, v206, v202, s60
    v_mfma_f32_16x16x32_bf16 a[44:47], v[108:111], a[196:199], 0
    v_perm_b32 v98, v214, v210, s60
    v_mfma_f32_16x16x32_bf16 a[76:79], v[108:111], a[200:203], 0
    v_perm_b32 v99, v222, v218, s60
    v_mfma_f32_16x16x32_bf16 a[108:111], v[108:111], a[204:207], 0
    buffer_load_dwordx4 v[84:87], v240, s[32:35], s56 offen
    buffer_load_dwordx4 v[88:91], v240, s[32:35], s57 offen
    v_mfma_f32_16x16x32_bf16 a[140:143], v[108:111], a[208:211], 0
    ds_read_b128 a[216:219], v242 offset:0
    v_mfma_f32_16x16x32_bf16 a[172:175], v[108:111], a[212:215], 0
    ds_read_b128 a[220:223], v242 offset:2048
    v_mfma_f32_16x16x32_bf16 a[16:19], v[96:99], a[192:195], 0
    v_perm_b32 v100, v198, v194, s61
    v_perm_b32 v101, v206, v202, s61
    v_mfma_f32_16x16x32_bf16 a[48:51], v[96:99], a[196:199], 0
    v_perm_b32 v102, v214, v210, s61
    v_mfma_f32_16x16x32_bf16 a[80:83], v[96:99], a[200:203], 0
    v_perm_b32 v103, v222, v218, s61
    v_mfma_f32_16x16x32_bf16 a[112:115], v[96:99], a[204:207], 0
    buffer_load_dwordx4 v[92:95], v240, s[32:35], s58 offen
    v_mfma_f32_16x16x32_bf16 a[144:147], v[96:99], a[208:211], 0
    ds_read_b128 a[224:227], v242 offset:4096
    v_mfma_f32_16x16x32_bf16 a[176:179], v[96:99], a[212:215], 0
    ds_read_b128 a[228:231], v242 offset:6144
    v_mfma_f32_16x16x32_bf16 a[20:23], v[100:103], a[192:195], 0
    v_perm_b32 v104, v199, v195, s60
    v_perm_b32 v105, v207, v203, s60
    v_mfma_f32_16x16x32_bf16 a[52:55], v[100:103], a[196:199], 0
    v_perm_b32 v106, v215, v211, s60
    v_perm_b32 v107, v223, v219, s60
    v_mfma_f32_16x16x32_bf16 a[84:87], v[100:103], a[200:203], 0
    s_add_u32 s72, s82, 256
    s_and_b32 s72, s72, 0x3ff
    v_mfma_f32_16x16x32_bf16 a[116:119], v[100:103], a[204:207], 0
    s_add_u32 s72, s72, s86
    s_add_u32 m0, s89, 24576
    v_mfma_f32_16x16x32_bf16 a[148:151], v[100:103], a[208:211], 0
    buffer_load_dwordx4 v251, s[20:23], s72 offen lds
    ds_read_b128 a[232:235], v242 offset:8192
    v_mfma_f32_16x16x32_bf16 a[180:183], v[100:103], a[212:215], 0
    ds_read_b128 a[236:239], v242 offset:10240
    v_mfma_f32_16x16x32_bf16 a[24:27], v[104:107], a[192:195], 0
    v_perm_b32 v108, v199, v195, s61
    v_perm_b32 v109, v207, v203, s61
    v_mfma_f32_16x16x32_bf16 a[56:59], v[104:107], a[196:199], 0
    v_perm_b32 v110, v215, v211, s61
    v_mfma_f32_16x16x32_bf16 a[88:91], v[104:107], a[200:203], 0
    v_perm_b32 v111, v223, v219, s61
    s_add_u32 s72, s82, 256
    v_mfma_f32_16x16x32_bf16 a[120:123], v[104:107], a[204:207], 0
    s_and_b32 s72, s72, 0x3ff
    v_mfma_f32_16x16x32_bf16 a[152:155], v[104:107], a[208:211], 0
    s_add_u32 s72, s72, s87
    s_add_u32 m0, s90, 24576
    v_mfma_f32_16x16x32_bf16 a[184:187], v[104:107], a[212:215], 0
    buffer_load_dwordx4 v252, s[20:23], s72 offen lds
    v_mfma_f32_16x16x32_bf16 a[28:31], v[108:111], a[192:195], 0
    s_waitcnt vmcnt(11)
    v_perm_b32 v96, v36, v32, s60
    v_mfma_f32_16x16x32_bf16 a[60:63], v[108:111], a[196:199], 0
    v_perm_b32 v97, v44, v40, s60
    v_perm_b32 v98, v52, v48, s60
    v_mfma_f32_16x16x32_bf16 a[92:95], v[108:111], a[200:203], 0
    v_perm_b32 v99, v60, v56, s60
    v_mfma_f32_16x16x32_bf16 a[124:127], v[108:111], a[204:207], 0
    s_add_u32 s72, s82, 256
    s_and_b32 s72, s72, 0x3ff
    v_mfma_f32_16x16x32_bf16 a[156:159], v[108:111], a[208:211], 0
    s_add_u32 s72, s72, s88
    s_add_u32 m0, s91, 24576
    v_mfma_f32_16x16x32_bf16 a[188:191], v[108:111], a[212:215], 0
    buffer_load_dwordx4 v253, s[20:23], s72 offen lds
    s_waitcnt lgkmcnt(0)
    v_mfma_f32_16x16x32_bf16 a[0:3], v[96:99], a[216:219], a[0:3]
    v_perm_b32 v100, v36, v32, s61
    v_mfma_f32_16x16x32_bf16 a[32:35], v[96:99], a[220:223], a[32:35]
    v_perm_b32 v101, v44, v40, s61
    v_mfma_f32_16x16x32_bf16 a[64:67], v[96:99], a[224:227], a[64:67]
    v_mfma_f32_16x16x32_bf16 a[96:99], v[96:99], a[228:231], a[96:99]
    v_perm_b32 v102, v52, v48, s61
    v_mfma_f32_16x16x32_bf16 a[128:131], v[96:99], a[232:235], a[128:131]
    v_perm_b32 v103, v60, v56, s61
    v_mfma_f32_16x16x32_bf16 a[160:163], v[96:99], a[236:239], a[160:163]
    s_nop 0
    v_mfma_f32_16x16x32_bf16 a[4:7], v[100:103], a[216:219], a[4:7]
    v_perm_b32 v104, v37, v33, s60
    v_perm_b32 v105, v45, v41, s60
    v_mfma_f32_16x16x32_bf16 a[36:39], v[100:103], a[220:223], a[36:39]
    v_perm_b32 v106, v53, v49, s60
    v_mfma_f32_16x16x32_bf16 a[68:71], v[100:103], a[224:227], a[68:71]
    v_perm_b32 v107, v61, v57, s60
    s_add_u32 s72, s82, 384
    v_mfma_f32_16x16x32_bf16 a[100:103], v[100:103], a[228:231], a[100:103]
    s_and_b32 s72, s72, 0x3ff
    v_mfma_f32_16x16x32_bf16 a[132:135], v[100:103], a[232:235], a[132:135]
    s_add_u32 s72, s72, s86
    s_add_u32 m0, s89, 36864
    v_mfma_f32_16x16x32_bf16 a[164:167], v[100:103], a[236:239], a[164:167]
    buffer_load_dwordx4 v251, s[20:23], s72 offen lds
    v_mfma_f32_16x16x32_bf16 a[8:11], v[104:107], a[216:219], a[8:11]
    v_perm_b32 v108, v37, v33, s61
    v_perm_b32 v109, v45, v41, s61
    v_mfma_f32_16x16x32_bf16 a[40:43], v[104:107], a[220:223], a[40:43]
    v_perm_b32 v110, v53, v49, s61
    v_mfma_f32_16x16x32_bf16 a[72:75], v[104:107], a[224:227], a[72:75]
    v_perm_b32 v111, v61, v57, s61
    s_add_u32 s72, s82, 384
    v_mfma_f32_16x16x32_bf16 a[104:107], v[104:107], a[228:231], a[104:107]
    s_and_b32 s72, s72, 0x3ff
    v_mfma_f32_16x16x32_bf16 a[136:139], v[104:107], a[232:235], a[136:139]
    s_add_u32 s72, s72, s87
    s_add_u32 m0, s90, 36864
    v_mfma_f32_16x16x32_bf16 a[168:171], v[104:107], a[236:239], a[168:171]
    buffer_load_dwordx4 v252, s[20:23], s72 offen lds
    v_mfma_f32_16x16x32_bf16 a[12:15], v[108:111], a[216:219], a[12:15]
    v_perm_b32 v96, v38, v34, s60
    v_perm_b32 v97, v46, v42, s60
    v_mfma_f32_16x16x32_bf16 a[44:47], v[108:111], a[220:223], a[44:47]
    v_perm_b32 v98, v54, v50, s60
    v_perm_b32 v99, v62, v58, s60
    v_mfma_f32_16x16x32_bf16 a[76:79], v[108:111], a[224:227], a[76:79]
    s_add_u32 s72, s82, 384
    s_and_b32 s72, s72, 0x3ff
    v_mfma_f32_16x16x32_bf16 a[108:111], v[108:111], a[228:231], a[108:111]
    s_add_u32 s72, s72, s88
    s_add_u32 m0, s91, 36864
    v_mfma_f32_16x16x32_bf16 a[140:143], v[108:111], a[232:235], a[140:143]
    buffer_load_dwordx4 v253, s[20:23], s72 offen lds
    ds_read_b128 a[192:195], v241 offset:12288
    v_mfma_f32_16x16x32_bf16 a[172:175], v[108:111], a[236:239], a[172:175]
    ds_read_b128 a[196:199], v241 offset:14336
    v_mfma_f32_16x16x32_bf16 a[16:19], v[96:99], a[216:219], a[16:19]
    v_perm_b32 v100, v38, v34, s61
    v_perm_b32 v101, v46, v42, s61
    v_mfma_f32_16x16x32_bf16 a[48:51], v[96:99], a[220:223], a[48:51]
    v_perm_b32 v102, v54, v50, s61
    v_perm_b32 v103, v62, v58, s61
    v_mfma_f32_16x16x32_bf16 a[80:83], v[96:99], a[224:227], a[80:83]
    v_add_u32 v240, s81, v240
    v_mfma_f32_16x16x32_bf16 a[112:115], v[96:99], a[228:231], a[112:115]
    v_and_b32 v240, 0x3fffff, v240
    buffer_load_dwordx4 v[0:3], v240, s[32:35], 0 offen
    v_mfma_f32_16x16x32_bf16 a[144:147], v[96:99], a[232:235], a[144:147]
    buffer_load_dwordx4 v[4:7], v240, s[32:35], s52 offen
    ds_read_b128 a[200:203], v241 offset:16384
    v_mfma_f32_16x16x32_bf16 a[176:179], v[96:99], a[236:239], a[176:179]
    ds_read_b128 a[204:207], v241 offset:18432
    v_mfma_f32_16x16x32_bf16 a[20:23], v[100:103], a[216:219], a[20:23]
    v_perm_b32 v104, v39, v35, s60
    v_perm_b32 v105, v47, v43, s60
    v_mfma_f32_16x16x32_bf16 a[52:55], v[100:103], a[220:223], a[52:55]
    v_perm_b32 v106, v55, v51, s60
    v_mfma_f32_16x16x32_bf16 a[84:87], v[100:103], a[224:227], a[84:87]
    v_perm_b32 v107, v63, v59, s60
    v_mfma_f32_16x16x32_bf16 a[116:119], v[100:103], a[228:231], a[116:119]
    buffer_load_dwordx4 v[8:11], v240, s[32:35], s53 offen
    buffer_load_dwordx4 v[12:15], v240, s[32:35], s54 offen
    v_mfma_f32_16x16x32_bf16 a[148:151], v[100:103], a[232:235], a[148:151]
    ds_read_b128 a[208:211], v241 offset:20480
    v_mfma_f32_16x16x32_bf16 a[180:183], v[100:103], a[236:239], a[180:183]
    ds_read_b128 a[212:215], v241 offset:22528
    v_mfma_f32_16x16x32_bf16 a[24:27], v[104:107], a[216:219], a[24:27]
    v_perm_b32 v108, v39, v35, s61
    v_mfma_f32_16x16x32_bf16 a[56:59], v[104:107], a[220:223], a[56:59]
    v_perm_b32 v109, v47, v43, s61
    v_mfma_f32_16x16x32_bf16 a[88:91], v[104:107], a[224:227], a[88:91]
    v_perm_b32 v110, v55, v51, s61
    v_mfma_f32_16x16x32_bf16 a[120:123], v[104:107], a[228:231], a[120:123]
    v_perm_b32 v111, v63, v59, s61
    v_mfma_f32_16x16x32_bf16 a[152:155], v[104:107], a[232:235], a[152:155]
    buffer_load_dwordx4 v[16:19], v240, s[32:35], s55 offen
    v_mfma_f32_16x16x32_bf16 a[184:187], v[104:107], a[236:239], a[184:187]
    v_mfma_f32_16x16x32_bf16 a[28:31], v[108:111], a[216:219], a[28:31]
    s_waitcnt vmcnt(11)
    v_perm_b32 v96, v68, v64, s60
    v_mfma_f32_16x16x32_bf16 a[60:63], v[108:111], a[220:223], a[60:63]
    v_perm_b32 v97, v76, v72, s60
    v_mfma_f32_16x16x32_bf16 a[92:95], v[108:111], a[224:227], a[92:95]
    v_perm_b32 v98, v84, v80, s60
    v_mfma_f32_16x16x32_bf16 a[124:127], v[108:111], a[228:231], a[124:127]
    v_perm_b32 v99, v92, v88, s60
    v_mfma_f32_16x16x32_bf16 a[156:159], v[108:111], a[232:235], a[156:159]
    buffer_load_dwordx4 v[20:23], v240, s[32:35], s56 offen
    v_mfma_f32_16x16x32_bf16 a[188:191], v[108:111], a[236:239], a[188:191]
    buffer_load_dwordx4 v[24:27], v240, s[32:35], s57 offen
    s_waitcnt lgkmcnt(0)
    v_mfma_f32_16x16x32_bf16 a[0:3], v[96:99], a[192:195], a[0:3]
    v_perm_b32 v100, v68, v64, s61
    v_perm_b32 v101, v76, v72, s61
    v_mfma_f32_16x16x32_bf16 a[32:35], v[96:99], a[196:199], a[32:35]
    v_perm_b32 v102, v84, v80, s61
    v_mfma_f32_16x16x32_bf16 a[64:67], v[96:99], a[200:203], a[64:67]
    v_perm_b32 v103, v92, v88, s61
    v_mfma_f32_16x16x32_bf16 a[96:99], v[96:99], a[204:207], a[96:99]
    buffer_load_dwordx4 v[28:31], v240, s[32:35], s58 offen
    v_add_u32 v240, s80, v240
    v_mfma_f32_16x16x32_bf16 a[128:131], v[96:99], a[208:211], a[128:131]
    v_and_b32 v240, 0x3fffff, v240
    v_mfma_f32_16x16x32_bf16 a[160:163], v[96:99], a[212:215], a[160:163]
    buffer_load_dwordx4 v[128:131], v240, s[32:35], 0 offen
    v_mfma_f32_16x16x32_bf16 a[4:7], v[100:103], a[192:195], a[4:7]
    v_perm_b32 v104, v69, v65, s60
    v_mfma_f32_16x16x32_bf16 a[36:39], v[100:103], a[196:199], a[36:39]
    v_perm_b32 v105, v77, v73, s60
    v_mfma_f32_16x16x32_bf16 a[68:71], v[100:103], a[200:203], a[68:71]
    v_perm_b32 v106, v85, v81, s60
    v_mfma_f32_16x16x32_bf16 a[100:103], v[100:103], a[204:207], a[100:103]
    v_perm_b32 v107, v93, v89, s60
    v_mfma_f32_16x16x32_bf16 a[132:135], v[100:103], a[208:211], a[132:135]
    buffer_load_dwordx4 v[132:135], v240, s[32:35], s52 offen
    v_mfma_f32_16x16x32_bf16 a[164:167], v[100:103], a[212:215], a[164:167]
    buffer_load_dwordx4 v[136:139], v240, s[32:35], s53 offen
    v_mfma_f32_16x16x32_bf16 a[8:11], v[104:107], a[192:195], a[8:11]
    v_perm_b32 v108, v69, v65, s61
    v_mfma_f32_16x16x32_bf16 a[40:43], v[104:107], a[196:199], a[40:43]
    v_perm_b32 v109, v77, v73, s61
    v_mfma_f32_16x16x32_bf16 a[72:75], v[104:107], a[200:203], a[72:75]
    v_perm_b32 v110, v85, v81, s61
    v_mfma_f32_16x16x32_bf16 a[104:107], v[104:107], a[204:207], a[104:107]
    v_perm_b32 v111, v93, v89, s61
    v_mfma_f32_16x16x32_bf16 a[136:139], v[104:107], a[208:211], a[136:139]
    buffer_load_dwordx4 v[140:143], v240, s[32:35], s54 offen
    v_mfma_f32_16x16x32_bf16 a[168:171], v[104:107], a[212:215], a[168:171]
    v_mfma_f32_16x16x32_bf16 a[12:15], v[108:111], a[192:195], a[12:15]
    v_perm_b32 v96, v70, v66, s60
    v_perm_b32 v97, v78, v74, s60
    v_mfma_f32_16x16x32_bf16 a[44:47], v[108:111], a[196:199], a[44:47]
    v_perm_b32 v98, v86, v82, s60
    v_mfma_f32_16x16x32_bf16 a[76:79], v[108:111], a[200:203], a[76:79]
    v_perm_b32 v99, v94, v90, s60
    v_mfma_f32_16x16x32_bf16 a[108:111], v[108:111], a[204:207], a[108:111]
    buffer_load_dwordx4 v[144:147], v240, s[32:35], s55 offen
    buffer_load_dwordx4 v[148:151], v240, s[32:35], s56 offen
    v_mfma_f32_16x16x32_bf16 a[140:143], v[108:111], a[208:211], a[140:143]
    ds_read_b128 a[216:219], v242 offset:12288
    v_mfma_f32_16x16x32_bf16 a[172:175], v[108:111], a[212:215], a[172:175]
    ds_read_b128 a[220:223], v242 offset:14336
    v_mfma_f32_16x16x32_bf16 a[16:19], v[96:99], a[192:195], a[16:19]
    v_perm_b32 v100, v70, v66, s61
    v_perm_b32 v101, v78, v74, s61
    v_mfma_f32_16x16x32_bf16 a[48:51], v[96:99], a[196:199], a[48:51]
    v_perm_b32 v102, v86, v82, s61
    v_mfma_f32_16x16x32_bf16 a[80:83], v[96:99], a[200:203], a[80:83]
    v_perm_b32 v103, v94, v90, s61
    v_mfma_f32_16x16x32_bf16 a[112:115], v[96:99], a[204:207], a[112:115]
    buffer_load_dwordx4 v[152:155], v240, s[32:35], s57 offen
    buffer_load_dwordx4 v[156:159], v240, s[32:35], s58 offen
    v_mfma_f32_16x16x32_bf16 a[144:147], v[96:99], a[208:211], a[144:147]
    ds_read_b128 a[224:227], v242 offset:16384
    v_mfma_f32_16x16x32_bf16 a[176:179], v[96:99], a[212:215], a[176:179]
    ds_read_b128 a[228:231], v242 offset:18432
    v_mfma_f32_16x16x32_bf16 a[20:23], v[100:103], a[192:195], a[20:23]
    v_perm_b32 v104, v71, v67, s60
    v_perm_b32 v105, v79, v75, s60
    v_mfma_f32_16x16x32_bf16 a[52:55], v[100:103], a[196:199], a[52:55]
    v_perm_b32 v106, v87, v83, s60
    v_perm_b32 v107, v95, v91, s60
    v_mfma_f32_16x16x32_bf16 a[84:87], v[100:103], a[200:203], a[84:87]
    v_add_u32 v240, s81, v240
    v_mfma_f32_16x16x32_bf16 a[116:119], v[100:103], a[204:207], a[116:119]
    v_and_b32 v240, 0x3fffff, v240
    buffer_load_dwordx4 v[160:163], v240, s[32:35], 0 offen
    v_mfma_f32_16x16x32_bf16 a[148:151], v[100:103], a[208:211], a[148:151]
    buffer_load_dwordx4 v[164:167], v240, s[32:35], s52 offen
    ds_read_b128 a[232:235], v242 offset:20480
    v_mfma_f32_16x16x32_bf16 a[180:183], v[100:103], a[212:215], a[180:183]
    ds_read_b128 a[236:239], v242 offset:22528
    v_mfma_f32_16x16x32_bf16 a[24:27], v[104:107], a[192:195], a[24:27]
    v_perm_b32 v108, v71, v67, s61
    v_mfma_f32_16x16x32_bf16 a[56:59], v[104:107], a[196:199], a[56:59]
    v_perm_b32 v109, v79, v75, s61
    v_mfma_f32_16x16x32_bf16 a[88:91], v[104:107], a[200:203], a[88:91]
    v_perm_b32 v110, v87, v83, s61
    v_mfma_f32_16x16x32_bf16 a[120:123], v[104:107], a[204:207], a[120:123]
    v_perm_b32 v111, v95, v91, s61
    v_mfma_f32_16x16x32_bf16 a[152:155], v[104:107], a[208:211], a[152:155]
    buffer_load_dwordx4 v[168:171], v240, s[32:35], s53 offen
    v_mfma_f32_16x16x32_bf16 a[184:187], v[104:107], a[212:215], a[184:187]
    v_mfma_f32_16x16x32_bf16 a[28:31], v[108:111], a[192:195], a[28:31]
    s_waitcnt vmcnt(11)
    v_perm_b32 v96, v4, v0, s60
    v_mfma_f32_16x16x32_bf16 a[60:63], v[108:111], a[196:199], a[60:63]
    v_perm_b32 v97, v12, v8, s60
    v_mfma_f32_16x16x32_bf16 a[92:95], v[108:111], a[200:203], a[92:95]
    v_perm_b32 v98, v20, v16, s60
    v_mfma_f32_16x16x32_bf16 a[124:127], v[108:111], a[204:207], a[124:127]
    v_perm_b32 v99, v28, v24, s60
    v_mfma_f32_16x16x32_bf16 a[156:159], v[108:111], a[208:211], a[156:159]
    buffer_load_dwordx4 v[172:175], v240, s[32:35], s54 offen
    v_mfma_f32_16x16x32_bf16 a[188:191], v[108:111], a[212:215], a[188:191]
    buffer_load_dwordx4 v[176:179], v240, s[32:35], s55 offen
    s_waitcnt lgkmcnt(0)
    v_mfma_f32_16x16x32_bf16 a[0:3], v[96:99], a[216:219], a[0:3]
    v_perm_b32 v100, v4, v0, s61
    v_mfma_f32_16x16x32_bf16 a[32:35], v[96:99], a[220:223], a[32:35]
    v_perm_b32 v101, v12, v8, s61
    v_mfma_f32_16x16x32_bf16 a[64:67], v[96:99], a[224:227], a[64:67]
    v_perm_b32 v102, v20, v16, s61
    v_mfma_f32_16x16x32_bf16 a[96:99], v[96:99], a[228:231], a[96:99]
    v_perm_b32 v103, v28, v24, s61
    v_mfma_f32_16x16x32_bf16 a[128:131], v[96:99], a[232:235], a[128:131]
    buffer_load_dwordx4 v[180:183], v240, s[32:35], s56 offen
    v_mfma_f32_16x16x32_bf16 a[160:163], v[96:99], a[236:239], a[160:163]
    buffer_load_dwordx4 v[184:187], v240, s[32:35], s57 offen
    v_mfma_f32_16x16x32_bf16 a[4:7], v[100:103], a[216:219], a[4:7]
    v_perm_b32 v104, v5, v1, s60
    v_perm_b32 v105, v13, v9, s60
    v_mfma_f32_16x16x32_bf16 a[36:39], v[100:103], a[220:223], a[36:39]
    v_perm_b32 v106, v21, v17, s60
    v_mfma_f32_16x16x32_bf16 a[68:71], v[100:103], a[224:227], a[68:71]
    v_perm_b32 v107, v29, v25, s60
    v_mfma_f32_16x16x32_bf16 a[100:103], v[100:103], a[228:231], a[100:103]
    buffer_load_dwordx4 v[188:191], v240, s[32:35], s58 offen
    v_add_u32 v240, s80, v240
    v_mfma_f32_16x16x32_bf16 a[132:135], v[100:103], a[232:235], a[132:135]
    v_and_b32 v240, 0x3fffff, v240
    v_mfma_f32_16x16x32_bf16 a[164:167], v[100:103], a[236:239], a[164:167]
    buffer_load_dwordx4 v[192:195], v240, s[32:35], 0 offen
    v_mfma_f32_16x16x32_bf16 a[8:11], v[104:107], a[216:219], a[8:11]
    v_perm_b32 v108, v5, v1, s61
    v_mfma_f32_16x16x32_bf16 a[40:43], v[104:107], a[220:223], a[40:43]
    v_perm_b32 v109, v13, v9, s61
    v_mfma_f32_16x16x32_bf16 a[72:75], v[104:107], a[224:227], a[72:75]
    v_perm_b32 v110, v21, v17, s61
    v_mfma_f32_16x16x32_bf16 a[104:107], v[104:107], a[228:231], a[104:107]
    v_perm_b32 v111, v29, v25, s61
    v_mfma_f32_16x16x32_bf16 a[136:139], v[104:107], a[232:235], a[136:139]
    buffer_load_dwordx4 v[196:199], v240, s[32:35], s52 offen
    v_mfma_f32_16x16x32_bf16 a[168:171], v[104:107], a[236:239], a[168:171]
    buffer_load_dwordx4 v[200:203], v240, s[32:35], s53 offen
    v_mfma_f32_16x16x32_bf16 a[12:15], v[108:111], a[216:219], a[12:15]
    v_perm_b32 v96, v6, v2, s60
    v_perm_b32 v97, v14, v10, s60
    v_mfma_f32_16x16x32_bf16 a[44:47], v[108:111], a[220:223], a[44:47]
    v_perm_b32 v98, v22, v18, s60
    v_mfma_f32_16x16x32_bf16 a[76:79], v[108:111], a[224:227], a[76:79]
    v_perm_b32 v99, v30, v26, s60
    buffer_load_dwordx4 v[204:207], v240, s[32:35], s54 offen
    v_mfma_f32_16x16x32_bf16 a[108:111], v[108:111], a[228:231], a[108:111]
    v_mfma_f32_16x16x32_bf16 a[140:143], v[108:111], a[232:235], a[140:143]
    s_barrier
    ds_read_b128 a[192:195], v241 offset:24576
    v_mfma_f32_16x16x32_bf16 a[172:175], v[108:111], a[236:239], a[172:175]
    ds_read_b128 a[196:199], v241 offset:26624
    v_mfma_f32_16x16x32_bf16 a[16:19], v[96:99], a[216:219], a[16:19]
    v_perm_b32 v100, v6, v2, s61
    v_perm_b32 v101, v14, v10, s61
    v_mfma_f32_16x16x32_bf16 a[48:51], v[96:99], a[220:223], a[48:51]
    v_perm_b32 v102, v22, v18, s61
    v_mfma_f32_16x16x32_bf16 a[80:83], v[96:99], a[224:227], a[80:83]
    v_perm_b32 v103, v30, v26, s61
    v_mfma_f32_16x16x32_bf16 a[112:115], v[96:99], a[228:231], a[112:115]
    buffer_load_dwordx4 v[208:211], v240, s[32:35], s55 offen
    buffer_load_dwordx4 v[212:215], v240, s[32:35], s56 offen
    v_mfma_f32_16x16x32_bf16 a[144:147], v[96:99], a[232:235], a[144:147]
    ds_read_b128 a[200:203], v241 offset:28672
    v_mfma_f32_16x16x32_bf16 a[176:179], v[96:99], a[236:239], a[176:179]
    ds_read_b128 a[204:207], v241 offset:30720
    v_mfma_f32_16x16x32_bf16 a[20:23], v[100:103], a[216:219], a[20:23]
    v_perm_b32 v104, v7, v3, s60
    v_perm_b32 v105, v15, v11, s60
    v_mfma_f32_16x16x32_bf16 a[52:55], v[100:103], a[220:223], a[52:55]
    v_perm_b32 v106, v23, v19, s60
    v_mfma_f32_16x16x32_bf16 a[84:87], v[100:103], a[224:227], a[84:87]
    v_perm_b32 v107, v31, v27, s60
    v_mfma_f32_16x16x32_bf16 a[116:119], v[100:103], a[228:231], a[116:119]
    buffer_load_dwordx4 v[216:219], v240, s[32:35], s57 offen
    buffer_load_dwordx4 v[220:223], v240, s[32:35], s58 offen
    v_mfma_f32_16x16x32_bf16 a[148:151], v[100:103], a[232:235], a[148:151]
    ds_read_b128 a[208:211], v241 offset:32768
    v_mfma_f32_16x16x32_bf16 a[180:183], v[100:103], a[236:239], a[180:183]
    ds_read_b128 a[212:215], v241 offset:34816
    v_mfma_f32_16x16x32_bf16 a[24:27], v[104:107], a[216:219], a[24:27]
    v_perm_b32 v108, v7, v3, s61
    v_perm_b32 v109, v15, v11, s61
    v_perm_b32 v110, v23, v19, s61
    v_mfma_f32_16x16x32_bf16 a[56:59], v[104:107], a[220:223], a[56:59]
    v_perm_b32 v111, v31, v27, s61
    s_add_u32 s72, s82, 512
    v_mfma_f32_16x16x32_bf16 a[88:91], v[104:107], a[224:227], a[88:91]
    s_and_b32 s72, s72, 0x3ff
    s_add_u32 s72, s72, s86
    v_mfma_f32_16x16x32_bf16 a[120:123], v[104:107], a[228:231], a[120:123]
    s_add_u32 m0, s89, 49152
    s_nop 0
    buffer_load_dwordx4 v251, s[20:23], s72 offen lds
    s_add_u32 s72, s82, 512
    v_mfma_f32_16x16x32_bf16 a[152:155], v[104:107], a[232:235], a[152:155]
    s_and_b32 s72, s72, 0x3ff
    s_add_u32 s72, s72, s87
    v_mfma_f32_16x16x32_bf16 a[184:187], v[104:107], a[236:239], a[184:187]
    s_add_u32 m0, s90, 49152
    s_nop 0
    buffer_load_dwordx4 v252, s[20:23], s72 offen lds
    v_mfma_f32_16x16x32_bf16 a[28:31], v[108:111], a[216:219], a[28:31]
    s_waitcnt vmcnt(18)
    v_perm_b32 v96, v132, v128, s60
    v_mfma_f32_16x16x32_bf16 a[60:63], v[108:111], a[220:223], a[60:63]
    v_perm_b32 v97, v140, v136, s60
    v_perm_b32 v98, v148, v144, s60
    v_mfma_f32_16x16x32_bf16 a[92:95], v[108:111], a[224:227], a[92:95]
    v_perm_b32 v99, v156, v152, s60
    v_mfma_f32_16x16x32_bf16 a[124:127], v[108:111], a[228:231], a[124:127]
    s_add_u32 s72, s82, 512
    s_and_b32 s72, s72, 0x3ff
    v_mfma_f32_16x16x32_bf16 a[156:159], v[108:111], a[232:235], a[156:159]
    s_add_u32 s72, s72, s88
    s_add_u32 m0, s91, 49152
    v_mfma_f32_16x16x32_bf16 a[188:191], v[108:111], a[236:239], a[188:191]
    buffer_load_dwordx4 v253, s[20:23], s72 offen lds
    s_waitcnt lgkmcnt(0)
    v_mfma_f32_16x16x32_bf16 a[0:3], v[96:99], a[192:195], a[0:3]
    v_perm_b32 v100, v132, v128, s61
    v_perm_b32 v101, v140, v136, s61
    v_perm_b32 v102, v148, v144, s61
    v_mfma_f32_16x16x32_bf16 a[32:35], v[96:99], a[196:199], a[32:35]
    v_perm_b32 v103, v156, v152, s61
    s_add_u32 s72, s82, 640
    v_mfma_f32_16x16x32_bf16 a[64:67], v[96:99], a[200:203], a[64:67]
    s_and_b32 s72, s72, 0x3ff
    s_add_u32 s72, s72, s86
    v_mfma_f32_16x16x32_bf16 a[96:99], v[96:99], a[204:207], a[96:99]
    s_add_u32 m0, s89, 61440
    s_nop 0
    buffer_load_dwordx4 v251, s[20:23], s72 offen lds
    s_add_u32 s72, s82, 640
    v_mfma_f32_16x16x32_bf16 a[128:131], v[96:99], a[208:211], a[128:131]
    s_and_b32 s72, s72, 0x3ff
    s_add_u32 s72, s72, s87
    v_mfma_f32_16x16x32_bf16 a[160:163], v[96:99], a[212:215], a[160:163]
    s_add_u32 m0, s90, 61440
    s_nop 0
    buffer_load_dwordx4 v252, s[20:23], s72 offen lds
    v_mfma_f32_16x16x32_bf16 a[4:7], v[100:103], a[192:195], a[4:7]
    v_perm_b32 v104, v133, v129, s60
    v_perm_b32 v105, v141, v137, s60
    v_mfma_f32_16x16x32_bf16 a[36:39], v[100:103], a[196:199], a[36:39]
    v_perm_b32 v106, v149, v145, s60
    v_perm_b32 v107, v157, v153, s60
    v_mfma_f32_16x16x32_bf16 a[68:71], v[100:103], a[200:203], a[68:71]
    s_add_u32 s72, s82, 640
    s_and_b32 s72, s72, 0x3ff
    v_mfma_f32_16x16x32_bf16 a[100:103], v[100:103], a[204:207], a[100:103]
    s_add_u32 s72, s72, s88
    s_add_u32 m0, s91, 61440
    v_mfma_f32_16x16x32_bf16 a[132:135], v[100:103], a[208:211], a[132:135]
    buffer_load_dwordx4 v253, s[20:23], s72 offen lds
    v_add_u32 v240, s81, v240
    v_mfma_f32_16x16x32_bf16 a[164:167], v[100:103], a[212:215], a[164:167]
    v_and_b32 v240, 0x3fffff, v240
    buffer_load_dwordx4 v[32:35], v240, s[32:35], 0 offen
    v_mfma_f32_16x16x32_bf16 a[8:11], v[104:107], a[192:195], a[8:11]
    v_perm_b32 v108, v133, v129, s61
    v_mfma_f32_16x16x32_bf16 a[40:43], v[104:107], a[196:199], a[40:43]
    v_perm_b32 v109, v141, v137, s61
    v_mfma_f32_16x16x32_bf16 a[72:75], v[104:107], a[200:203], a[72:75]
    v_perm_b32 v110, v149, v145, s61
    v_mfma_f32_16x16x32_bf16 a[104:107], v[104:107], a[204:207], a[104:107]
    v_perm_b32 v111, v157, v153, s61
    v_mfma_f32_16x16x32_bf16 a[136:139], v[104:107], a[208:211], a[136:139]
    buffer_load_dwordx4 v[36:39], v240, s[32:35], s52 offen
    v_mfma_f32_16x16x32_bf16 a[168:171], v[104:107], a[212:215], a[168:171]
    buffer_load_dwordx4 v[40:43], v240, s[32:35], s53 offen
    v_mfma_f32_16x16x32_bf16 a[12:15], v[108:111], a[192:195], a[12:15]
    v_perm_b32 v96, v134, v130, s60
    v_perm_b32 v97, v142, v138, s60
    v_mfma_f32_16x16x32_bf16 a[44:47], v[108:111], a[196:199], a[44:47]
    v_perm_b32 v98, v150, v146, s60
    v_mfma_f32_16x16x32_bf16 a[76:79], v[108:111], a[200:203], a[76:79]
    v_perm_b32 v99, v158, v154, s60
    v_mfma_f32_16x16x32_bf16 a[108:111], v[108:111], a[204:207], a[108:111]
    buffer_load_dwordx4 v[44:47], v240, s[32:35], s54 offen
    v_mfma_f32_16x16x32_bf16 a[140:143], v[108:111], a[208:211], a[140:143]
    ds_read_b128 a[216:219], v242 offset:24576
    v_mfma_f32_16x16x32_bf16 a[172:175], v[108:111], a[212:215], a[172:175]
    ds_read_b128 a[220:223], v242 offset:26624
    v_mfma_f32_16x16x32_bf16 a[16:19], v[96:99], a[192:195], a[16:19]
    v_perm_b32 v100, v134, v130, s61
    v_perm_b32 v101, v142, v138, s61
    v_mfma_f32_16x16x32_bf16 a[48:51], v[96:99], a[196:199], a[48:51]
    v_perm_b32 v102, v150, v146, s61
    v_mfma_f32_16x16x32_bf16 a[80:83], v[96:99], a[200:203], a[80:83]
    v_perm_b32 v103, v158, v154, s61
    v_mfma_f32_16x16x32_bf16 a[112:115], v[96:99], a[204:207], a[112:115]
    buffer_load_dwordx4 v[48:51], v240, s[32:35], s55 offen
    buffer_load_dwordx4 v[52:55], v240, s[32:35], s56 offen
    v_mfma_f32_16x16x32_bf16 a[144:147], v[96:99], a[208:211], a[144:147]
    ds_read_b128 a[224:227], v242 offset:28672
    v_mfma_f32_16x16x32_bf16 a[176:179], v[96:99], a[212:215], a[176:179]
    ds_read_b128 a[228:231], v242 offset:30720
    v_mfma_f32_16x16x32_bf16 a[20:23], v[100:103], a[192:195], a[20:23]
    v_perm_b32 v104, v135, v131, s60
    v_perm_b32 v105, v143, v139, s60
    v_mfma_f32_16x16x32_bf16 a[52:55], v[100:103], a[196:199], a[52:55]
    v_perm_b32 v106, v151, v147, s60
    v_mfma_f32_16x16x32_bf16 a[84:87], v[100:103], a[200:203], a[84:87]
    v_perm_b32 v107, v159, v155, s60
    v_mfma_f32_16x16x32_bf16 a[116:119], v[100:103], a[204:207], a[116:119]
    buffer_load_dwordx4 v[56:59], v240, s[32:35], s57 offen
    buffer_load_dwordx4 v[60:63], v240, s[32:35], s58 offen
    v_mfma_f32_16x16x32_bf16 a[148:151], v[100:103], a[208:211], a[148:151]
    ds_read_b128 a[232:235], v242 offset:32768
    v_mfma_f32_16x16x32_bf16 a[180:183], v[100:103], a[212:215], a[180:183]
    ds_read_b128 a[236:239], v242 offset:34816
    v_mfma_f32_16x16x32_bf16 a[24:27], v[104:107], a[192:195], a[24:27]
    v_perm_b32 v108, v135, v131, s61
    v_perm_b32 v109, v143, v139, s61
    v_mfma_f32_16x16x32_bf16 a[56:59], v[104:107], a[196:199], a[56:59]
    v_perm_b32 v110, v151, v147, s61
    v_mfma_f32_16x16x32_bf16 a[88:91], v[104:107], a[200:203], a[88:91]
    v_perm_b32 v111, v159, v155, s61
    v_mfma_f32_16x16x32_bf16 a[120:123], v[104:107], a[204:207], a[120:123]
    v_add_u32 v240, s80, v240
    v_and_b32 v240, 0x3fffff, v240
    v_mfma_f32_16x16x32_bf16 a[152:155], v[104:107], a[208:211], a[152:155]
    buffer_load_dwordx4 v[64:67], v240, s[32:35], 0 offen
    v_mfma_f32_16x16x32_bf16 a[184:187], v[104:107], a[212:215], a[184:187]
    buffer_load_dwordx4 v[68:71], v240, s[32:35], s52 offen
    v_mfma_f32_16x16x32_bf16 a[28:31], v[108:111], a[192:195], a[28:31]
    s_waitcnt vmcnt(24)
    v_mfma_f32_16x16x32_bf16 a[60:63], v[108:111], a[196:199], a[60:63]
    v_perm_b32 v96, v164, v160, s60
    v_mfma_f32_16x16x32_bf16 a[92:95], v[108:111], a[200:203], a[92:95]
    v_perm_b32 v97, v172, v168, s60
    v_mfma_f32_16x16x32_bf16 a[124:127], v[108:111], a[204:207], a[124:127]
    v_perm_b32 v98, v180, v176, s60
    v_mfma_f32_16x16x32_bf16 a[156:159], v[108:111], a[208:211], a[156:159]
    v_perm_b32 v99, v188, v184, s60
    v_mfma_f32_16x16x32_bf16 a[188:191], v[108:111], a[212:215], a[188:191]
    buffer_load_dwordx4 v[72:75], v240, s[32:35], s53 offen
    s_waitcnt lgkmcnt(0)
    v_mfma_f32_16x16x32_bf16 a[0:3], v[96:99], a[216:219], a[0:3]
    v_perm_b32 v100, v164, v160, s61
    v_mfma_f32_16x16x32_bf16 a[32:35], v[96:99], a[220:223], a[32:35]
    v_perm_b32 v101, v172, v168, s61
    v_mfma_f32_16x16x32_bf16 a[64:67], v[96:99], a[224:227], a[64:67]
    v_perm_b32 v102, v180, v176, s61
    v_mfma_f32_16x16x32_bf16 a[96:99], v[96:99], a[228:231], a[96:99]
    v_perm_b32 v103, v188, v184, s61
    v_mfma_f32_16x16x32_bf16 a[128:131], v[96:99], a[232:235], a[128:131]
    buffer_load_dwordx4 v[76:79], v240, s[32:35], s54 offen
    v_mfma_f32_16x16x32_bf16 a[160:163], v[96:99], a[236:239], a[160:163]
    buffer_load_dwordx4 v[80:83], v240, s[32:35], s55 offen
    v_mfma_f32_16x16x32_bf16 a[4:7], v[100:103], a[216:219], a[4:7]
    v_perm_b32 v104, v165, v161, s60
    v_mfma_f32_16x16x32_bf16 a[36:39], v[100:103], a[220:223], a[36:39]
    v_perm_b32 v105, v173, v169, s60
    v_mfma_f32_16x16x32_bf16 a[68:71], v[100:103], a[224:227], a[68:71]
    v_perm_b32 v106, v181, v177, s60
    v_mfma_f32_16x16x32_bf16 a[100:103], v[100:103], a[228:231], a[100:103]
    v_perm_b32 v107, v189, v185, s60
    v_mfma_f32_16x16x32_bf16 a[132:135], v[100:103], a[232:235], a[132:135]
    buffer_load_dwordx4 v[84:87], v240, s[32:35], s56 offen
    v_mfma_f32_16x16x32_bf16 a[164:167], v[100:103], a[236:239], a[164:167]
    buffer_load_dwordx4 v[88:91], v240, s[32:35], s57 offen
    v_mfma_f32_16x16x32_bf16 a[8:11], v[104:107], a[216:219], a[8:11]
    v_perm_b32 v108, v165, v161, s61
    v_mfma_f32_16x16x32_bf16 a[40:43], v[104:107], a[220:223], a[40:43]
    v_perm_b32 v109, v173, v169, s61
    v_mfma_f32_16x16x32_bf16 a[72:75], v[104:107], a[224:227], a[72:75]
    v_perm_b32 v110, v181, v177, s61
    v_mfma_f32_16x16x32_bf16 a[104:107], v[104:107], a[228:231], a[104:107]
    v_perm_b32 v111, v189, v185, s61
    v_mfma_f32_16x16x32_bf16 a[136:139], v[104:107], a[232:235], a[136:139]
    buffer_load_dwordx4 v[92:95], v240, s[32:35], s58 offen
    v_mfma_f32_16x16x32_bf16 a[168:171], v[104:107], a[236:239], a[168:171]
    v_mfma_f32_16x16x32_bf16 a[12:15], v[108:111], a[216:219], a[12:15]
    v_perm_b32 v96, v166, v162, s60
    v_perm_b32 v97, v174, v170, s60
    v_mfma_f32_16x16x32_bf16 a[44:47], v[108:111], a[220:223], a[44:47]
    v_perm_b32 v98, v182, v178, s60
    v_mfma_f32_16x16x32_bf16 a[76:79], v[108:111], a[224:227], a[76:79]
    v_perm_b32 v99, v190, v186, s60
    s_add_u32 s73, s62, 0
    v_mfma_f32_16x16x32_bf16 a[108:111], v[108:111], a[228:231], a[108:111]
    s_add_u32 m0, s92, 0
    v_mfma_f32_16x16x32_bf16 a[140:143], v[108:111], a[232:235], a[140:143]
    buffer_load_dwordx4 v113, s[24:27], s73 offen nt lds
    ds_read_b128 a[192:195], v241 offset:36864
    v_mfma_f32_16x16x32_bf16 a[172:175], v[108:111], a[236:239], a[172:175]
    ds_read_b128 a[196:199], v241 offset:38912
    v_mfma_f32_16x16x32_bf16 a[16:19], v[96:99], a[216:219], a[16:19]
    v_perm_b32 v100, v166, v162, s61
    v_perm_b32 v101, v174, v170, s61
    v_mfma_f32_16x16x32_bf16 a[48:51], v[96:99], a[220:223], a[48:51]
    v_perm_b32 v102, v182, v178, s61
    v_mfma_f32_16x16x32_bf16 a[80:83], v[96:99], a[224:227], a[80:83]
    v_perm_b32 v103, v190, v186, s61
    s_add_u32 s73, s62, 1024
    v_mfma_f32_16x16x32_bf16 a[112:115], v[96:99], a[228:231], a[112:115]
    s_add_u32 m0, s92, 1024
    v_mfma_f32_16x16x32_bf16 a[144:147], v[96:99], a[232:235], a[144:147]
    buffer_load_dwordx4 v114, s[24:27], s73 offen nt lds
    ds_read_b128 a[200:203], v241 offset:40960
    v_mfma_f32_16x16x32_bf16 a[176:179], v[96:99], a[236:239], a[176:179]
    ds_read_b128 a[204:207], v241 offset:43008
    v_mfma_f32_16x16x32_bf16 a[20:23], v[100:103], a[216:219], a[20:23]
    v_perm_b32 v104, v167, v163, s60
    v_perm_b32 v105, v175, v171, s60
    v_mfma_f32_16x16x32_bf16 a[52:55], v[100:103], a[220:223], a[52:55]
    v_perm_b32 v106, v183, v179, s60
    v_mfma_f32_16x16x32_bf16 a[84:87], v[100:103], a[224:227], a[84:87]
    v_perm_b32 v107, v191, v187, s60
    s_add_u32 s73, s62, 2048
    v_mfma_f32_16x16x32_bf16 a[116:119], v[100:103], a[228:231], a[116:119]
    s_add_u32 m0, s92, 2048
    v_mfma_f32_16x16x32_bf16 a[148:151], v[100:103], a[232:235], a[148:151]
    buffer_load_dwordx4 v115, s[24:27], s73 offen nt lds
    ds_read_b128 a[208:211], v241 offset:45056
    v_mfma_f32_16x16x32_bf16 a[180:183], v[100:103], a[236:239], a[180:183]
    ds_read_b128 a[212:215], v241 offset:47104
    v_mfma_f32_16x16x32_bf16 a[24:27], v[104:107], a[216:219], a[24:27]
    v_perm_b32 v108, v167, v163, s61
    v_perm_b32 v109, v175, v171, s61
    v_mfma_f32_16x16x32_bf16 a[56:59], v[104:107], a[220:223], a[56:59]
    v_perm_b32 v110, v183, v179, s61
    v_mfma_f32_16x16x32_bf16 a[88:91], v[104:107], a[224:227], a[88:91]
    v_perm_b32 v111, v191, v187, s61
    v_mfma_f32_16x16x32_bf16 a[120:123], v[104:107], a[228:231], a[120:123]
    s_add_u32 s73, s62, 3072
    v_mfma_f32_16x16x32_bf16 a[152:155], v[104:107], a[232:235], a[152:155]
    s_add_u32 m0, s92, 3072
    v_mfma_f32_16x16x32_bf16 a[184:187], v[104:107], a[236:239], a[184:187]
    buffer_load_dwordx4 v116, s[24:27], s73 offen nt lds
    v_mfma_f32_16x16x32_bf16 a[28:31], v[108:111], a[216:219], a[28:31]
    s_waitcnt vmcnt(26)
    v_perm_b32 v96, v196, v192, s60
    v_mfma_f32_16x16x32_bf16 a[60:63], v[108:111], a[220:223], a[60:63]
    v_perm_b32 v97, v204, v200, s60
    v_mfma_f32_16x16x32_bf16 a[92:95], v[108:111], a[224:227], a[92:95]
    v_perm_b32 v98, v212, v208, s60
    v_mfma_f32_16x16x32_bf16 a[124:127], v[108:111], a[228:231], a[124:127]
    v_perm_b32 v99, v220, v216, s60
    s_add_u32 s73, s62, 4096
    v_mfma_f32_16x16x32_bf16 a[156:159], v[108:111], a[232:235], a[156:159]
    s_add_u32 m0, s92, 4096
    v_mfma_f32_16x16x32_bf16 a[188:191], v[108:111], a[236:239], a[188:191]
    buffer_load_dwordx4 v113, s[24:27], s73 offen nt lds
    s_waitcnt lgkmcnt(0)
    v_mfma_f32_16x16x32_bf16 a[0:3], v[96:99], a[192:195], a[0:3]
    v_perm_b32 v100, v196, v192, s61
    v_mfma_f32_16x16x32_bf16 a[32:35], v[96:99], a[196:199], a[32:35]
    v_perm_b32 v101, v204, v200, s61
    v_mfma_f32_16x16x32_bf16 a[64:67], v[96:99], a[200:203], a[64:67]
    v_mfma_f32_16x16x32_bf16 a[96:99], v[96:99], a[204:207], a[96:99]
    v_perm_b32 v102, v212, v208, s61
    v_mfma_f32_16x16x32_bf16 a[128:131], v[96:99], a[208:211], a[128:131]
    v_perm_b32 v103, v220, v216, s61
    v_mfma_f32_16x16x32_bf16 a[160:163], v[96:99], a[212:215], a[160:163]
    s_nop 0
    v_mfma_f32_16x16x32_bf16 a[4:7], v[100:103], a[192:195], a[4:7]
    v_perm_b32 v104, v197, v193, s60
    v_perm_b32 v105, v205, v201, s60
    v_mfma_f32_16x16x32_bf16 a[36:39], v[100:103], a[196:199], a[36:39]
    v_perm_b32 v106, v213, v209, s60
    v_mfma_f32_16x16x32_bf16 a[68:71], v[100:103], a[200:203], a[68:71]
    v_perm_b32 v107, v221, v217, s60
    v_mfma_f32_16x16x32_bf16 a[100:103], v[100:103], a[204:207], a[100:103]
    s_add_u32 s73, s62, 5120
    v_mfma_f32_16x16x32_bf16 a[132:135], v[100:103], a[208:211], a[132:135]
    s_add_u32 m0, s92, 5120
    v_mfma_f32_16x16x32_bf16 a[164:167], v[100:103], a[212:215], a[164:167]
    buffer_load_dwordx4 v114, s[24:27], s73 offen nt lds
    v_mfma_f32_16x16x32_bf16 a[8:11], v[104:107], a[192:195], a[8:11]
    v_perm_b32 v108, v197, v193, s61
    v_perm_b32 v109, v205, v201, s61
    v_mfma_f32_16x16x32_bf16 a[40:43], v[104:107], a[196:199], a[40:43]
    v_perm_b32 v110, v213, v209, s61
    v_mfma_f32_16x16x32_bf16 a[72:75], v[104:107], a[200:203], a[72:75]
    v_perm_b32 v111, v221, v217, s61
    v_mfma_f32_16x16x32_bf16 a[104:107], v[104:107], a[204:207], a[104:107]
    s_add_u32 s73, s62, 6144
    v_mfma_f32_16x16x32_bf16 a[136:139], v[104:107], a[208:211], a[136:139]
    s_add_u32 m0, s92, 6144
    v_mfma_f32_16x16x32_bf16 a[168:171], v[104:107], a[212:215], a[168:171]
    buffer_load_dwordx4 v115, s[24:27], s73 offen nt lds
    v_mfma_f32_16x16x32_bf16 a[12:15], v[108:111], a[192:195], a[12:15]
    v_perm_b32 v96, v198, v194, s60
    v_perm_b32 v97, v206, v202, s60
    v_mfma_f32_16x16x32_bf16 a[44:47], v[108:111], a[196:199], a[44:47]
    v_perm_b32 v98, v214, v210, s60
    v_mfma_f32_16x16x32_bf16 a[76:79], v[108:111], a[200:203], a[76:79]
    v_perm_b32 v99, v222, v218, s60
    s_add_u32 s73, s62, 7168
    v_mfma_f32_16x16x32_bf16 a[108:111], v[108:111], a[204:207], a[108:111]
    s_add_u32 m0, s92, 7168
    v_mfma_f32_16x16x32_bf16 a[140:143], v[108:111], a[208:211], a[140:143]
    buffer_load_dwordx4 v116, s[24:27], s73 offen nt lds
    ds_read_b128 a[216:219], v242 offset:36864
    v_mfma_f32_16x16x32_bf16 a[172:175], v[108:111], a[212:215], a[172:175]
    ds_read_b128 a[220:223], v242 offset:38912
    v_mfma_f32_16x16x32_bf16 a[16:19], v[96:99], a[192:195], a[16:19]
    v_perm_b32 v100, v198, v194, s61
    v_perm_b32 v101, v206, v202, s61
    v_mfma_f32_16x16x32_bf16 a[48:51], v[96:99], a[196:199], a[48:51]
    v_perm_b32 v102, v214, v210, s61
    v_perm_b32 v103, v222, v218, s61
    v_mfma_f32_16x16x32_bf16 a[80:83], v[96:99], a[200:203], a[80:83]
    v_add_u32 v240, s81, v240
    v_mfma_f32_16x16x32_bf16 a[112:115], v[96:99], a[204:207], a[112:115]
    v_and_b32 v240, 0x3fffff, v240
    buffer_load_dwordx4 v[0:3], v240, s[32:35], 0 offen
    v_mfma_f32_16x16x32_bf16 a[144:147], v[96:99], a[208:211], a[144:147]
    buffer_load_dwordx4 v[4:7], v240, s[32:35], s52 offen
    ds_read_b128 a[224:227], v242 offset:40960
    v_mfma_f32_16x16x32_bf16 a[176:179], v[96:99], a[212:215], a[176:179]
    ds_read_b128 a[228:231], v242 offset:43008
    v_mfma_f32_16x16x32_bf16 a[20:23], v[100:103], a[192:195], a[20:23]
    v_perm_b32 v104, v199, v195, s60
    v_perm_b32 v105, v207, v203, s60
    v_mfma_f32_16x16x32_bf16 a[52:55], v[100:103], a[196:199], a[52:55]
    v_perm_b32 v106, v215, v211, s60
    v_mfma_f32_16x16x32_bf16 a[84:87], v[100:103], a[200:203], a[84:87]
    v_perm_b32 v107, v223, v219, s60
    v_mfma_f32_16x16x32_bf16 a[116:119], v[100:103], a[204:207], a[116:119]
    buffer_load_dwordx4 v[8:11], v240, s[32:35], s53 offen
    buffer_load_dwordx4 v[12:15], v240, s[32:35], s54 offen
    v_mfma_f32_16x16x32_bf16 a[148:151], v[100:103], a[208:211], a[148:151]
    ds_read_b128 a[232:235], v242 offset:45056
    v_mfma_f32_16x16x32_bf16 a[180:183], v[100:103], a[212:215], a[180:183]
    ds_read_b128 a[236:239], v242 offset:47104
    v_mfma_f32_16x16x32_bf16 a[24:27], v[104:107], a[192:195], a[24:27]
    v_perm_b32 v108, v199, v195, s61
    v_mfma_f32_16x16x32_bf16 a[56:59], v[104:107], a[196:199], a[56:59]
    v_perm_b32 v109, v207, v203, s61
    v_mfma_f32_16x16x32_bf16 a[88:91], v[104:107], a[200:203], a[88:91]
    v_perm_b32 v110, v215, v211, s61
    v_mfma_f32_16x16x32_bf16 a[120:123], v[104:107], a[204:207], a[120:123]
    v_perm_b32 v111, v223, v219, s61
    v_mfma_f32_16x16x32_bf16 a[152:155], v[104:107], a[208:211], a[152:155]
    buffer_load_dwordx4 v[16:19], v240, s[32:35], s55 offen
    v_mfma_f32_16x16x32_bf16 a[184:187], v[104:107], a[212:215], a[184:187]
    v_mfma_f32_16x16x32_bf16 a[28:31], v[108:111], a[192:195], a[28:31]
    s_waitcnt vmcnt(21)
    v_perm_b32 v96, v36, v32, s60
    v_mfma_f32_16x16x32_bf16 a[60:63], v[108:111], a[196:199], a[60:63]
    v_perm_b32 v97, v44, v40, s60
    v_mfma_f32_16x16x32_bf16 a[92:95], v[108:111], a[200:203], a[92:95]
    v_perm_b32 v98, v52, v48, s60
    v_mfma_f32_16x16x32_bf16 a[124:127], v[108:111], a[204:207], a[124:127]
    v_perm_b32 v99, v60, v56, s60
    v_mfma_f32_16x16x32_bf16 a[156:159], v[108:111], a[208:211], a[156:159]
    buffer_load_dwordx4 v[20:23], v240, s[32:35], s56 offen
    v_mfma_f32_16x16x32_bf16 a[188:191], v[108:111], a[212:215], a[188:191]
    buffer_load_dwordx4 v[24:27], v240, s[32:35], s57 offen
    s_waitcnt lgkmcnt(0)
    v_mfma_f32_16x16x32_bf16 a[0:3], v[96:99], a[216:219], a[0:3]
    v_perm_b32 v100, v36, v32, s61
    v_perm_b32 v101, v44, v40, s61
    v_mfma_f32_16x16x32_bf16 a[32:35], v[96:99], a[220:223], a[32:35]
    v_perm_b32 v102, v52, v48, s61
    v_mfma_f32_16x16x32_bf16 a[64:67], v[96:99], a[224:227], a[64:67]
    v_perm_b32 v103, v60, v56, s61
    v_mfma_f32_16x16x32_bf16 a[96:99], v[96:99], a[228:231], a[96:99]
    buffer_load_dwordx4 v[28:31], v240, s[32:35], s58 offen
    v_add_u32 v240, s80, v240
    v_mfma_f32_16x16x32_bf16 a[128:131], v[96:99], a[232:235], a[128:131]
    v_and_b32 v240, 0x3fffff, v240
    v_mfma_f32_16x16x32_bf16 a[160:163], v[96:99], a[236:239], a[160:163]
    buffer_load_dwordx4 v[128:131], v240, s[32:35], 0 offen
    v_mfma_f32_16x16x32_bf16 a[4:7], v[100:103], a[216:219], a[4:7]
    v_perm_b32 v104, v37, v33, s60
    v_mfma_f32_16x16x32_bf16 a[36:39], v[100:103], a[220:223], a[36:39]
    v_perm_b32 v105, v45, v41, s60
    v_mfma_f32_16x16x32_bf16 a[68:71], v[100:103], a[224:227], a[68:71]
    v_perm_b32 v106, v53, v49, s60
    v_mfma_f32_16x16x32_bf16 a[100:103], v[100:103], a[228:231], a[100:103]
    v_perm_b32 v107, v61, v57, s60
    v_mfma_f32_16x16x32_bf16 a[132:135], v[100:103], a[232:235], a[132:135]
    buffer_load_dwordx4 v[132:135], v240, s[32:35], s52 offen
    v_mfma_f32_16x16x32_bf16 a[164:167], v[100:103], a[236:239], a[164:167]
    buffer_load_dwordx4 v[136:139], v240, s[32:35], s53 offen
    v_mfma_f32_16x16x32_bf16 a[8:11], v[104:107], a[216:219], a[8:11]
    v_perm_b32 v108, v37, v33, s61
    v_mfma_f32_16x16x32_bf16 a[40:43], v[104:107], a[220:223], a[40:43]
    v_perm_b32 v109, v45, v41, s61
    v_mfma_f32_16x16x32_bf16 a[72:75], v[104:107], a[224:227], a[72:75]
    v_perm_b32 v110, v53, v49, s61
    v_mfma_f32_16x16x32_bf16 a[104:107], v[104:107], a[228:231], a[104:107]
    v_perm_b32 v111, v61, v57, s61
    v_mfma_f32_16x16x32_bf16 a[136:139], v[104:107], a[232:235], a[136:139]
    buffer_load_dwordx4 v[140:143], v240, s[32:35], s54 offen
    v_mfma_f32_16x16x32_bf16 a[168:171], v[104:107], a[236:239], a[168:171]
    v_mfma_f32_16x16x32_bf16 a[12:15], v[108:111], a[216:219], a[12:15]
    v_perm_b32 v96, v38, v34, s60
    v_perm_b32 v97, v46, v42, s60
    v_mfma_f32_16x16x32_bf16 a[44:47], v[108:111], a[220:223], a[44:47]
    v_perm_b32 v98, v54, v50, s60
    v_perm_b32 v99, v62, v58, s60
    v_mfma_f32_16x16x32_bf16 a[76:79], v[108:111], a[224:227], a[76:79]
    buffer_load_dwordx4 v[144:147], v240, s[32:35], s55 offen
    v_mfma_f32_16x16x32_bf16 a[108:111], v[108:111], a[228:231], a[108:111]
    buffer_load_dwordx4 v[148:151], v240, s[32:35], s56 offen
    v_mfma_f32_16x16x32_bf16 a[140:143], v[108:111], a[232:235], a[140:143]
    s_barrier
    ds_read_b128 a[192:195], v243 offset:0
    v_mfma_f32_16x16x32_bf16 a[172:175], v[108:111], a[236:239], a[172:175]
    ds_read_b128 a[196:199], v243 offset:2048
    v_mfma_f32_16x16x32_bf16 a[16:19], v[96:99], a[216:219], a[16:19]
    v_perm_b32 v100, v38, v34, s61
    v_perm_b32 v101, v46, v42, s61
    v_mfma_f32_16x16x32_bf16 a[48:51], v[96:99], a[220:223], a[48:51]
    v_perm_b32 v102, v54, v50, s61
    v_mfma_f32_16x16x32_bf16 a[80:83], v[96:99], a[224:227], a[80:83]
    v_perm_b32 v103, v62, v58, s61
    v_mfma_f32_16x16x32_bf16 a[112:115], v[96:99], a[228:231], a[112:115]
    buffer_load_dwordx4 v[152:155], v240, s[32:35], s57 offen
    buffer_load_dwordx4 v[156:159], v240, s[32:35], s58 offen
    v_mfma_f32_16x16x32_bf16 a[144:147], v[96:99], a[232:235], a[144:147]
    ds_read_b128 a[200:203], v243 offset:4096
    v_mfma_f32_16x16x32_bf16 a[176:179], v[96:99], a[236:239], a[176:179]
    ds_read_b128 a[204:207], v243 offset:6144
    v_mfma_f32_16x16x32_bf16 a[20:23], v[100:103], a[216:219], a[20:23]
    v_perm_b32 v104, v39, v35, s60
    v_perm_b32 v105, v47, v43, s60
    v_perm_b32 v106, v55, v51, s60
    v_mfma_f32_16x16x32_bf16 a[52:55], v[100:103], a[220:223], a[52:55]
    v_perm_b32 v107, v63, v59, s60
    s_add_u32 s72, s82, 768
    s_and_b32 s72, s72, 0x3ff
    v_mfma_f32_16x16x32_bf16 a[84:87], v[100:103], a[224:227], a[84:87]
    s_add_u32 s72, s72, s86
    s_add_u32 m0, s89, 73728
    v_mfma_f32_16x16x32_bf16 a[116:119], v[100:103], a[228:231], a[116:119]
    buffer_load_dwordx4 v251, s[20:23], s72 offen lds
    s_add_u32 s72, s82, 768
    s_and_b32 s72, s72, 0x3ff
    v_mfma_f32_16x16x32_bf16 a[148:151], v[100:103], a[232:235], a[148:151]
    s_add_u32 s72, s72, s87
    s_add_u32 m0, s90, 73728
    s_nop 0
    buffer_load_dwordx4 v252, s[20:23], s72 offen lds
    v_mfma_f32_16x16x32_bf16 a[180:183], v[100:103], a[236:239], a[180:183]
    ds_read_b128 a[208:211], v243 offset:8192
    ds_read_b128 a[212:215], v243 offset:10240
    v_mfma_f32_16x16x32_bf16 a[24:27], v[104:107], a[216:219], a[24:27]
    v_perm_b32 v108, v39, v35, s61
    v_perm_b32 v109, v47, v43, s61
    v_mfma_f32_16x16x32_bf16 a[56:59], v[104:107], a[220:223], a[56:59]
    v_perm_b32 v110, v55, v51, s61
    v_mfma_f32_16x16x32_bf16 a[88:91], v[104:107], a[224:227], a[88:91]
    v_perm_b32 v111, v63, v59, s61
    s_add_u32 s72, s82, 768
    v_mfma_f32_16x16x32_bf16 a[120:123], v[104:107], a[228:231], a[120:123]
    s_and_b32 s72, s72, 0x3ff
    v_mfma_f32_16x16x32_bf16 a[152:155], v[104:107], a[232:235], a[152:155]
    s_add_u32 s72, s72, s88
    s_add_u32 m0, s91, 73728
    v_mfma_f32_16x16x32_bf16 a[184:187], v[104:107], a[236:239], a[184:187]
    buffer_load_dwordx4 v253, s[20:23], s72 offen lds
    v_mfma_f32_16x16x32_bf16 a[28:31], v[108:111], a[216:219], a[28:31]
    s_waitcnt vmcnt(27)
    v_perm_b32 v96, v68, v64, s60
    v_perm_b32 v97, v76, v72, s60
    v_mfma_f32_16x16x32_bf16 a[60:63], v[108:111], a[220:223], a[60:63]
    v_perm_b32 v98, v84, v80, s60
    v_perm_b32 v99, v92, v88, s60
    v_mfma_f32_16x16x32_bf16 a[92:95], v[108:111], a[224:227], a[92:95]
    s_add_u32 s72, s82, 896
    s_and_b32 s72, s72, 0x3ff
    s_add_u32 s72, s72, s86
    v_mfma_f32_16x16x32_bf16 a[124:127], v[108:111], a[228:231], a[124:127]
    s_add_u32 m0, s89, 86016
    s_nop 0
    buffer_load_dwordx4 v251, s[20:23], s72 offen lds
    v_mfma_f32_16x16x32_bf16 a[156:159], v[108:111], a[232:235], a[156:159]
    s_add_u32 s72, s82, 896
    s_and_b32 s72, s72, 0x3ff
    s_add_u32 s72, s72, s87
    v_mfma_f32_16x16x32_bf16 a[188:191], v[108:111], a[236:239], a[188:191]
    s_add_u32 m0, s90, 86016
    s_nop 0
    buffer_load_dwordx4 v252, s[20:23], s72 offen lds
    s_waitcnt lgkmcnt(0)
    v_mfma_f32_16x16x32_bf16 a[0:3], v[96:99], a[192:195], a[0:3]
    v_perm_b32 v100, v68, v64, s61
    v_perm_b32 v101, v76, v72, s61
    v_mfma_f32_16x16x32_bf16 a[32:35], v[96:99], a[196:199], a[32:35]
    v_perm_b32 v102, v84, v80, s61
    v_perm_b32 v103, v92, v88, s61
    v_mfma_f32_16x16x32_bf16 a[64:67], v[96:99], a[200:203], a[64:67]
    s_add_u32 s72, s82, 896
    s_and_b32 s72, s72, 0x3ff
    v_mfma_f32_16x16x32_bf16 a[96:99], v[96:99], a[204:207], a[96:99]
    s_add_u32 s72, s72, s88
    s_add_u32 m0, s91, 86016
    v_mfma_f32_16x16x32_bf16 a[128:131], v[96:99], a[208:211], a[128:131]
    buffer_load_dwordx4 v253, s[20:23], s72 offen lds
    v_add_u32 v240, s81, v240
    v_mfma_f32_16x16x32_bf16 a[160:163], v[96:99], a[212:215], a[160:163]
    v_and_b32 v240, 0x3fffff, v240
    buffer_load_dwordx4 v[160:163], v240, s[32:35], 0 offen
    v_mfma_f32_16x16x32_bf16 a[4:7], v[100:103], a[192:195], a[4:7]
    v_perm_b32 v104, v69, v65, s60
    v_mfma_f32_16x16x32_bf16 a[36:39], v[100:103], a[196:199], a[36:39]
    v_perm_b32 v105, v77, v73, s60
    v_mfma_f32_16x16x32_bf16 a[68:71], v[100:103], a[200:203], a[68:71]
    v_perm_b32 v106, v85, v81, s60
    v_mfma_f32_16x16x32_bf16 a[100:103], v[100:103], a[204:207], a[100:103]
    v_perm_b32 v107, v93, v89, s60
    v_mfma_f32_16x16x32_bf16 a[132:135], v[100:103], a[208:211], a[132:135]
    buffer_load_dwordx4 v[164:167], v240, s[32:35], s52 offen
    v_mfma_f32_16x16x32_bf16 a[164:167], v[100:103], a[212:215], a[164:167]
    buffer_load_dwordx4 v[168:171], v240, s[32:35], s53 offen
    v_mfma_f32_16x16x32_bf16 a[8:11], v[104:107], a[192:195], a[8:11]
    v_perm_b32 v108, v69, v65, s61
    v_mfma_f32_16x16x32_bf16 a[40:43], v[104:107], a[196:199], a[40:43]
    v_perm_b32 v109, v77, v73, s61
    v_mfma_f32_16x16x32_bf16 a[72:75], v[104:107], a[200:203], a[72:75]
    v_perm_b32 v110, v85, v81, s61
    v_mfma_f32_16x16x32_bf16 a[104:107], v[104:107], a[204:207], a[104:107]
    v_perm_b32 v111, v93, v89, s61
    v_mfma_f32_16x16x32_bf16 a[136:139], v[104:107], a[208:211], a[136:139]
    buffer_load_dwordx4 v[172:175], v240, s[32:35], s54 offen
    v_mfma_f32_16x16x32_bf16 a[168:171], v[104:107], a[212:215], a[168:171]
    buffer_load_dwordx4 v[176:179], v240, s[32:35], s55 offen
    v_mfma_f32_16x16x32_bf16 a[12:15], v[108:111], a[192:195], a[12:15]
    v_perm_b32 v96, v70, v66, s60
    v_perm_b32 v97, v78, v74, s60
    v_mfma_f32_16x16x32_bf16 a[44:47], v[108:111], a[196:199], a[44:47]
    v_perm_b32 v98, v86, v82, s60
    v_mfma_f32_16x16x32_bf16 a[76:79], v[108:111], a[200:203], a[76:79]
    v_perm_b32 v99, v94, v90, s60
    v_mfma_f32_16x16x32_bf16 a[108:111], v[108:111], a[204:207], a[108:111]
    buffer_load_dwordx4 v[180:183], v240, s[32:35], s56 offen
    v_mfma_f32_16x16x32_bf16 a[140:143], v[108:111], a[208:211], a[140:143]
    ds_read_b128 a[216:219], v244 offset:0
    v_mfma_f32_16x16x32_bf16 a[172:175], v[108:111], a[212:215], a[172:175]
    ds_read_b128 a[220:223], v244 offset:2048
    v_mfma_f32_16x16x32_bf16 a[16:19], v[96:99], a[192:195], a[16:19]
    v_perm_b32 v100, v70, v66, s61
    v_perm_b32 v101, v78, v74, s61
    v_mfma_f32_16x16x32_bf16 a[48:51], v[96:99], a[196:199], a[48:51]
    v_perm_b32 v102, v86, v82, s61
    v_mfma_f32_16x16x32_bf16 a[80:83], v[96:99], a[200:203], a[80:83]
    v_perm_b32 v103, v94, v90, s61
    v_mfma_f32_16x16x32_bf16 a[112:115], v[96:99], a[204:207], a[112:115]
    buffer_load_dwordx4 v[184:187], v240, s[32:35], s57 offen
    buffer_load_dwordx4 v[188:191], v240, s[32:35], s58 offen
    v_mfma_f32_16x16x32_bf16 a[144:147], v[96:99], a[208:211], a[144:147]
    ds_read_b128 a[224:227], v244 offset:4096
    v_mfma_f32_16x16x32_bf16 a[176:179], v[96:99], a[212:215], a[176:179]
    ds_read_b128 a[228:231], v244 offset:6144
    v_mfma_f32_16x16x32_bf16 a[20:23], v[100:103], a[192:195], a[20:23]
    v_perm_b32 v104, v71, v67, s60
    v_perm_b32 v105, v79, v75, s60
    v_mfma_f32_16x16x32_bf16 a[52:55], v[100:103], a[196:199], a[52:55]
    v_perm_b32 v106, v87, v83, s60
    v_perm_b32 v107, v95, v91, s60
    v_mfma_f32_16x16x32_bf16 a[84:87], v[100:103], a[200:203], a[84:87]
    v_add_u32 v240, s80, v240
    v_mfma_f32_16x16x32_bf16 a[116:119], v[100:103], a[204:207], a[116:119]
    v_and_b32 v240, 0x3fffff, v240
    buffer_load_dwordx4 v[192:195], v240, s[32:35], 0 offen
    v_mfma_f32_16x16x32_bf16 a[148:151], v[100:103], a[208:211], a[148:151]
    buffer_load_dwordx4 v[196:199], v240, s[32:35], s52 offen
    ds_read_b128 a[232:235], v244 offset:8192
    v_mfma_f32_16x16x32_bf16 a[180:183], v[100:103], a[212:215], a[180:183]
    ds_read_b128 a[236:239], v244 offset:10240
    v_mfma_f32_16x16x32_bf16 a[24:27], v[104:107], a[192:195], a[24:27]
    v_perm_b32 v108, v71, v67, s61
    v_mfma_f32_16x16x32_bf16 a[56:59], v[104:107], a[196:199], a[56:59]
    v_perm_b32 v109, v79, v75, s61
    v_mfma_f32_16x16x32_bf16 a[88:91], v[104:107], a[200:203], a[88:91]
    v_perm_b32 v110, v87, v83, s61
    v_mfma_f32_16x16x32_bf16 a[120:123], v[104:107], a[204:207], a[120:123]
    v_perm_b32 v111, v95, v91, s61
    v_mfma_f32_16x16x32_bf16 a[152:155], v[104:107], a[208:211], a[152:155]
    buffer_load_dwordx4 v[200:203], v240, s[32:35], s53 offen
    v_mfma_f32_16x16x32_bf16 a[184:187], v[104:107], a[212:215], a[184:187]
    buffer_load_dwordx4 v[204:207], v240, s[32:35], s54 offen
    v_mfma_f32_16x16x32_bf16 a[28:31], v[108:111], a[192:195], a[28:31]
    s_waitcnt vmcnt(26)
    v_mfma_f32_16x16x32_bf16 a[60:63], v[108:111], a[196:199], a[60:63]
    v_perm_b32 v96, v4, v0, s60
    v_mfma_f32_16x16x32_bf16 a[92:95], v[108:111], a[200:203], a[92:95]
    v_perm_b32 v97, v12, v8, s60
    v_mfma_f32_16x16x32_bf16 a[124:127], v[108:111], a[204:207], a[124:127]
    v_perm_b32 v98, v20, v16, s60
    v_mfma_f32_16x16x32_bf16 a[156:159], v[108:111], a[208:211], a[156:159]
    v_perm_b32 v99, v28, v24, s60
    v_mfma_f32_16x16x32_bf16 a[188:191], v[108:111], a[212:215], a[188:191]
    buffer_load_dwordx4 v[208:211], v240, s[32:35], s55 offen
    s_waitcnt lgkmcnt(0)
    v_mfma_f32_16x16x32_bf16 a[0:3], v[96:99], a[216:219], a[0:3]
    v_perm_b32 v100, v4, v0, s61
    v_mfma_f32_16x16x32_bf16 a[32:35], v[96:99], a[220:223], a[32:35]
    v_perm_b32 v101, v12, v8, s61
    v_mfma_f32_16x16x32_bf16 a[64:67], v[96:99], a[224:227], a[64:67]
    v_perm_b32 v102, v20, v16, s61
    v_mfma_f32_16x16x32_bf16 a[96:99], v[96:99], a[228:231], a[96:99]
    v_perm_b32 v103, v28, v24, s61
    v_mfma_f32_16x16x32_bf16 a[128:131], v[96:99], a[232:235], a[128:131]
    buffer_load_dwordx4 v[212:215], v240, s[32:35], s56 offen
    v_mfma_f32_16x16x32_bf16 a[160:163], v[96:99], a[236:239], a[160:163]
    buffer_load_dwordx4 v[216:219], v240, s[32:35], s57 offen
    v_mfma_f32_16x16x32_bf16 a[4:7], v[100:103], a[216:219], a[4:7]
    v_perm_b32 v104, v5, v1, s60
    v_mfma_f32_16x16x32_bf16 a[36:39], v[100:103], a[220:223], a[36:39]
    v_perm_b32 v105, v13, v9, s60
    v_mfma_f32_16x16x32_bf16 a[68:71], v[100:103], a[224:227], a[68:71]
    v_perm_b32 v106, v21, v17, s60
    v_mfma_f32_16x16x32_bf16 a[100:103], v[100:103], a[228:231], a[100:103]
    v_perm_b32 v107, v29, v25, s60
    v_mfma_f32_16x16x32_bf16 a[132:135], v[100:103], a[232:235], a[132:135]
    buffer_load_dwordx4 v[220:223], v240, s[32:35], s58 offen
    v_mfma_f32_16x16x32_bf16 a[164:167], v[100:103], a[236:239], a[164:167]
    v_mfma_f32_16x16x32_bf16 a[8:11], v[104:107], a[216:219], a[8:11]
    v_perm_b32 v108, v5, v1, s61
    v_perm_b32 v109, v13, v9, s61
    v_mfma_f32_16x16x32_bf16 a[40:43], v[104:107], a[220:223], a[40:43]
    v_perm_b32 v110, v21, v17, s61
    v_mfma_f32_16x16x32_bf16 a[72:75], v[104:107], a[224:227], a[72:75]
    v_perm_b32 v111, v29, v25, s61
    v_mfma_f32_16x16x32_bf16 a[104:107], v[104:107], a[228:231], a[104:107]
    s_add_u32 s73, s62, 8192
    v_mfma_f32_16x16x32_bf16 a[136:139], v[104:107], a[232:235], a[136:139]
    s_add_u32 m0, s92, 8192
    v_mfma_f32_16x16x32_bf16 a[168:171], v[104:107], a[236:239], a[168:171]
    buffer_load_dwordx4 v113, s[24:27], s73 offen nt lds
    v_mfma_f32_16x16x32_bf16 a[12:15], v[108:111], a[216:219], a[12:15]
    v_perm_b32 v96, v6, v2, s60
    v_perm_b32 v97, v14, v10, s60
    v_mfma_f32_16x16x32_bf16 a[44:47], v[108:111], a[220:223], a[44:47]
    v_perm_b32 v98, v22, v18, s60
    v_mfma_f32_16x16x32_bf16 a[76:79], v[108:111], a[224:227], a[76:79]
    v_perm_b32 v99, v30, v26, s60
    s_add_u32 s73, s62, 9216
    v_mfma_f32_16x16x32_bf16 a[108:111], v[108:111], a[228:231], a[108:111]
    s_add_u32 m0, s92, 9216
    v_mfma_f32_16x16x32_bf16 a[140:143], v[108:111], a[232:235], a[140:143]
    buffer_load_dwordx4 v114, s[24:27], s73 offen nt lds
    ds_read_b128 a[192:195], v243 offset:12288
    v_mfma_f32_16x16x32_bf16 a[172:175], v[108:111], a[236:239], a[172:175]
    ds_read_b128 a[196:199], v243 offset:14336
    v_mfma_f32_16x16x32_bf16 a[16:19], v[96:99], a[216:219], a[16:19]
    v_perm_b32 v100, v6, v2, s61
    v_perm_b32 v101, v14, v10, s61
    v_mfma_f32_16x16x32_bf16 a[48:51], v[96:99], a[220:223], a[48:51]
    v_perm_b32 v102, v22, v18, s61
    v_mfma_f32_16x16x32_bf16 a[80:83], v[96:99], a[224:227], a[80:83]
    v_perm_b32 v103, v30, v26, s61
    s_add_u32 s73, s62, 10240
    v_mfma_f32_16x16x32_bf16 a[112:115], v[96:99], a[228:231], a[112:115]
    s_add_u32 m0, s92, 10240
    v_mfma_f32_16x16x32_bf16 a[144:147], v[96:99], a[232:235], a[144:147]
    buffer_load_dwordx4 v115, s[24:27], s73 offen nt lds
    ds_read_b128 a[200:203], v243 offset:16384
    v_mfma_f32_16x16x32_bf16 a[176:179], v[96:99], a[236:239], a[176:179]
    ds_read_b128 a[204:207], v243 offset:18432
    v_mfma_f32_16x16x32_bf16 a[20:23], v[100:103], a[216:219], a[20:23]
    v_perm_b32 v104, v7, v3, s60
    v_perm_b32 v105, v15, v11, s60
    v_mfma_f32_16x16x32_bf16 a[52:55], v[100:103], a[220:223], a[52:55]
    v_perm_b32 v106, v23, v19, s60
    v_mfma_f32_16x16x32_bf16 a[84:87], v[100:103], a[224:227], a[84:87]
    v_perm_b32 v107, v31, v27, s60
    s_add_u32 s73, s62, 11264
    v_mfma_f32_16x16x32_bf16 a[116:119], v[100:103], a[228:231], a[116:119]
    s_add_u32 m0, s92, 11264
    v_mfma_f32_16x16x32_bf16 a[148:151], v[100:103], a[232:235], a[148:151]
    buffer_load_dwordx4 v116, s[24:27], s73 offen nt lds
    ds_read_b128 a[208:211], v243 offset:20480
    v_mfma_f32_16x16x32_bf16 a[180:183], v[100:103], a[236:239], a[180:183]
    ds_read_b128 a[212:215], v243 offset:22528
    v_mfma_f32_16x16x32_bf16 a[24:27], v[104:107], a[216:219], a[24:27]
    v_perm_b32 v108, v7, v3, s61
    v_perm_b32 v109, v15, v11, s61
    v_mfma_f32_16x16x32_bf16 a[56:59], v[104:107], a[220:223], a[56:59]
    v_perm_b32 v110, v23, v19, s61
    v_mfma_f32_16x16x32_bf16 a[88:91], v[104:107], a[224:227], a[88:91]
    v_perm_b32 v111, v31, v27, s61
    v_mfma_f32_16x16x32_bf16 a[120:123], v[104:107], a[228:231], a[120:123]
    s_add_u32 s73, s62, 12288
    v_mfma_f32_16x16x32_bf16 a[152:155], v[104:107], a[232:235], a[152:155]
    s_add_u32 m0, s92, 12288
    v_mfma_f32_16x16x32_bf16 a[184:187], v[104:107], a[236:239], a[184:187]
    buffer_load_dwordx4 v113, s[24:27], s73 offen nt lds
    v_mfma_f32_16x16x32_bf16 a[28:31], v[108:111], a[216:219], a[28:31]
    s_waitcnt vmcnt(27)
    v_perm_b32 v96, v132, v128, s60
    v_mfma_f32_16x16x32_bf16 a[60:63], v[108:111], a[220:223], a[60:63]
    v_perm_b32 v97, v140, v136, s60
    v_mfma_f32_16x16x32_bf16 a[92:95], v[108:111], a[224:227], a[92:95]
    v_perm_b32 v98, v148, v144, s60
    v_mfma_f32_16x16x32_bf16 a[124:127], v[108:111], a[228:231], a[124:127]
    v_perm_b32 v99, v156, v152, s60
    s_add_u32 s73, s62, 13312
    v_mfma_f32_16x16x32_bf16 a[156:159], v[108:111], a[232:235], a[156:159]
    s_add_u32 m0, s92, 13312
    v_mfma_f32_16x16x32_bf16 a[188:191], v[108:111], a[236:239], a[188:191]
    buffer_load_dwordx4 v114, s[24:27], s73 offen nt lds
    s_waitcnt lgkmcnt(0)
    v_mfma_f32_16x16x32_bf16 a[0:3], v[96:99], a[192:195], a[0:3]
    v_perm_b32 v100, v132, v128, s61
    v_mfma_f32_16x16x32_bf16 a[32:35], v[96:99], a[196:199], a[32:35]
    v_perm_b32 v101, v140, v136, s61
    v_mfma_f32_16x16x32_bf16 a[64:67], v[96:99], a[200:203], a[64:67]
    v_mfma_f32_16x16x32_bf16 a[96:99], v[96:99], a[204:207], a[96:99]
    v_perm_b32 v102, v148, v144, s61
    v_mfma_f32_16x16x32_bf16 a[128:131], v[96:99], a[208:211], a[128:131]
    v_perm_b32 v103, v156, v152, s61
    v_mfma_f32_16x16x32_bf16 a[160:163], v[96:99], a[212:215], a[160:163]
    s_nop 0
    v_mfma_f32_16x16x32_bf16 a[4:7], v[100:103], a[192:195], a[4:7]
    v_perm_b32 v104, v133, v129, s60
    v_perm_b32 v105, v141, v137, s60
    v_mfma_f32_16x16x32_bf16 a[36:39], v[100:103], a[196:199], a[36:39]
    v_perm_b32 v106, v149, v145, s60
    v_mfma_f32_16x16x32_bf16 a[68:71], v[100:103], a[200:203], a[68:71]
    v_perm_b32 v107, v157, v153, s60
    v_mfma_f32_16x16x32_bf16 a[100:103], v[100:103], a[204:207], a[100:103]
    s_add_u32 s73, s62, 14336
    v_mfma_f32_16x16x32_bf16 a[132:135], v[100:103], a[208:211], a[132:135]
    s_add_u32 m0, s92, 14336
    v_mfma_f32_16x16x32_bf16 a[164:167], v[100:103], a[212:215], a[164:167]
    buffer_load_dwordx4 v115, s[24:27], s73 offen nt lds
    v_mfma_f32_16x16x32_bf16 a[8:11], v[104:107], a[192:195], a[8:11]
    v_perm_b32 v108, v133, v129, s61
    v_perm_b32 v109, v141, v137, s61
    v_mfma_f32_16x16x32_bf16 a[40:43], v[104:107], a[196:199], a[40:43]
    v_perm_b32 v110, v149, v145, s61
    v_mfma_f32_16x16x32_bf16 a[72:75], v[104:107], a[200:203], a[72:75]
    v_perm_b32 v111, v157, v153, s61
    v_mfma_f32_16x16x32_bf16 a[104:107], v[104:107], a[204:207], a[104:107]
    s_add_u32 s73, s62, 15360
    v_mfma_f32_16x16x32_bf16 a[136:139], v[104:107], a[208:211], a[136:139]
    s_add_u32 m0, s92, 15360
    v_mfma_f32_16x16x32_bf16 a[168:171], v[104:107], a[212:215], a[168:171]
    buffer_load_dwordx4 v116, s[24:27], s73 offen nt lds
    v_mfma_f32_16x16x32_bf16 a[12:15], v[108:111], a[192:195], a[12:15]
    v_perm_b32 v96, v134, v130, s60
    v_perm_b32 v97, v142, v138, s60
    v_mfma_f32_16x16x32_bf16 a[44:47], v[108:111], a[196:199], a[44:47]
    v_perm_b32 v98, v150, v146, s60
    v_perm_b32 v99, v158, v154, s60
    v_mfma_f32_16x16x32_bf16 a[76:79], v[108:111], a[200:203], a[76:79]
    v_add_u32 v240, s81, v240
    v_mfma_f32_16x16x32_bf16 a[108:111], v[108:111], a[204:207], a[108:111]
    v_and_b32 v240, 0x3fffff, v240
    buffer_load_dwordx4 v[32:35], v240, s[32:35], 0 offen
    v_mfma_f32_16x16x32_bf16 a[140:143], v[108:111], a[208:211], a[140:143]
    buffer_load_dwordx4 v[36:39], v240, s[32:35], s52 offen
    ds_read_b128 a[216:219], v244 offset:12288
    v_mfma_f32_16x16x32_bf16 a[172:175], v[108:111], a[212:215], a[172:175]
    ds_read_b128 a[220:223], v244 offset:14336
    v_mfma_f32_16x16x32_bf16 a[16:19], v[96:99], a[192:195], a[16:19]
    v_perm_b32 v100, v134, v130, s61
    v_perm_b32 v101, v142, v138, s61
    v_mfma_f32_16x16x32_bf16 a[48:51], v[96:99], a[196:199], a[48:51]
    v_perm_b32 v102, v150, v146, s61
    v_mfma_f32_16x16x32_bf16 a[80:83], v[96:99], a[200:203], a[80:83]
    v_perm_b32 v103, v158, v154, s61
    v_mfma_f32_16x16x32_bf16 a[112:115], v[96:99], a[204:207], a[112:115]
    buffer_load_dwordx4 v[40:43], v240, s[32:35], s53 offen
    buffer_load_dwordx4 v[44:47], v240, s[32:35], s54 offen
    v_mfma_f32_16x16x32_bf16 a[144:147], v[96:99], a[208:211], a[144:147]
    ds_read_b128 a[224:227], v244 offset:16384
    v_mfma_f32_16x16x32_bf16 a[176:179], v[96:99], a[212:215], a[176:179]
    ds_read_b128 a[228:231], v244 offset:18432
    v_mfma_f32_16x16x32_bf16 a[20:23], v[100:103], a[192:195], a[20:23]
    v_perm_b32 v104, v135, v131, s60
    v_perm_b32 v105, v143, v139, s60
    v_mfma_f32_16x16x32_bf16 a[52:55], v[100:103], a[196:199], a[52:55]
    v_perm_b32 v106, v151, v147, s60
    v_mfma_f32_16x16x32_bf16 a[84:87], v[100:103], a[200:203], a[84:87]
    v_perm_b32 v107, v159, v155, s60
    v_mfma_f32_16x16x32_bf16 a[116:119], v[100:103], a[204:207], a[116:119]
    buffer_load_dwordx4 v[48:51], v240, s[32:35], s55 offen
    buffer_load_dwordx4 v[52:55], v240, s[32:35], s56 offen
    v_mfma_f32_16x16x32_bf16 a[148:151], v[100:103], a[208:211], a[148:151]
    ds_read_b128 a[232:235], v244 offset:20480
    v_mfma_f32_16x16x32_bf16 a[180:183], v[100:103], a[212:215], a[180:183]
    ds_read_b128 a[236:239], v244 offset:22528
    v_mfma_f32_16x16x32_bf16 a[24:27], v[104:107], a[192:195], a[24:27]
    v_perm_b32 v108, v135, v131, s61
    v_mfma_f32_16x16x32_bf16 a[56:59], v[104:107], a[196:199], a[56:59]
    v_perm_b32 v109, v143, v139, s61
    v_mfma_f32_16x16x32_bf16 a[88:91], v[104:107], a[200:203], a[88:91]
    v_perm_b32 v110, v151, v147, s61
    v_mfma_f32_16x16x32_bf16 a[120:123], v[104:107], a[204:207], a[120:123]
    v_perm_b32 v111, v159, v155, s61
    v_mfma_f32_16x16x32_bf16 a[152:155], v[104:107], a[208:211], a[152:155]
    buffer_load_dwordx4 v[56:59], v240, s[32:35], s57 offen
    v_mfma_f32_16x16x32_bf16 a[184:187], v[104:107], a[212:215], a[184:187]
    v_mfma_f32_16x16x32_bf16 a[28:31], v[108:111], a[192:195], a[28:31]
    s_waitcnt vmcnt(23)
    v_perm_b32 v96, v164, v160, s60
    v_mfma_f32_16x16x32_bf16 a[60:63], v[108:111], a[196:199], a[60:63]
    v_perm_b32 v97, v172, v168, s60
    v_mfma_f32_16x16x32_bf16 a[92:95], v[108:111], a[200:203], a[92:95]
    v_perm_b32 v98, v180, v176, s60
    v_perm_b32 v99, v188, v184, s60
    v_mfma_f32_16x16x32_bf16 a[124:127], v[108:111], a[204:207], a[124:127]
    buffer_load_dwordx4 v[60:63], v240, s[32:35], s58 offen
    v_mfma_f32_16x16x32_bf16 a[156:159], v[108:111], a[208:211], a[156:159]
    v_add_u32 v240, s80, v240
    v_and_b32 v240, 0x3fffff, v240
    v_mfma_f32_16x16x32_bf16 a[188:191], v[108:111], a[212:215], a[188:191]
    buffer_load_dwordx4 v[64:67], v240, s[32:35], 0 offen
    s_waitcnt lgkmcnt(0)
    v_mfma_f32_16x16x32_bf16 a[0:3], v[96:99], a[216:219], a[0:3]
    v_perm_b32 v100, v164, v160, s61
    v_perm_b32 v101, v172, v168, s61
    v_mfma_f32_16x16x32_bf16 a[32:35], v[96:99], a[220:223], a[32:35]
    v_perm_b32 v102, v180, v176, s61
    v_perm_b32 v103, v188, v184, s61
    v_mfma_f32_16x16x32_bf16 a[64:67], v[96:99], a[224:227], a[64:67]
    buffer_load_dwordx4 v[68:71], v240, s[32:35], s52 offen
    buffer_load_dwordx4 v[72:75], v240, s[32:35], s53 offen
    v_mfma_f32_16x16x32_bf16 a[96:99], v[96:99], a[228:231], a[96:99]
    v_mfma_f32_16x16x32_bf16 a[128:131], v[96:99], a[232:235], a[128:131]
    ds_read_b128 v[128:131], v117 offset:0
    ds_read_b128 v[132:135], v118 offset:0
    v_mfma_f32_16x16x32_bf16 a[160:163], v[96:99], a[236:239], a[160:163]
    ds_read_b128 v[136:139], v119 offset:0
    v_mfma_f32_16x16x32_bf16 a[4:7], v[100:103], a[216:219], a[4:7]
    v_perm_b32 v104, v165, v161, s60
    v_perm_b32 v105, v173, v169, s60
    v_mfma_f32_16x16x32_bf16 a[36:39], v[100:103], a[220:223], a[36:39]
    v_perm_b32 v106, v181, v177, s60
    v_mfma_f32_16x16x32_bf16 a[68:71], v[100:103], a[224:227], a[68:71]
    v_perm_b32 v107, v189, v185, s60
    buffer_load_dwordx4 v[76:79], v240, s[32:35], s54 offen
    v_mfma_f32_16x16x32_bf16 a[100:103], v[100:103], a[228:231], a[100:103]
    buffer_load_dwordx4 v[80:83], v240, s[32:35], s55 offen
    v_mfma_f32_16x16x32_bf16 a[132:135], v[100:103], a[232:235], a[132:135]
    ds_read_b128 v[140:143], v120 offset:0
    ds_read_b128 v[144:147], v117 offset:4096
    v_mfma_f32_16x16x32_bf16 a[164:167], v[100:103], a[236:239], a[164:167]
    ds_read_b128 v[148:151], v118 offset:4096
    v_mfma_f32_16x16x32_bf16 a[8:11], v[104:107], a[216:219], a[8:11]
    v_perm_b32 v108, v165, v161, s61
    v_perm_b32 v109, v173, v169, s61
    v_mfma_f32_16x16x32_bf16 a[40:43], v[104:107], a[220:223], a[40:43]
    v_perm_b32 v110, v181, v177, s61
    v_mfma_f32_16x16x32_bf16 a[72:75], v[104:107], a[224:227], a[72:75]
    v_perm_b32 v111, v189, v185, s61
    v_mfma_f32_16x16x32_bf16 a[104:107], v[104:107], a[228:231], a[104:107]
    buffer_load_dwordx4 v[84:87], v240, s[32:35], s56 offen
    ds_read_b128 v[152:155], v119 offset:4096
    v_mfma_f32_16x16x32_bf16 a[136:139], v[104:107], a[232:235], a[136:139]
    ds_read_b128 v[156:159], v120 offset:4096
    v_mfma_f32_16x16x32_bf16 a[168:171], v[104:107], a[236:239], a[168:171]
    v_mfma_f32_16x16x32_bf16 a[12:15], v[108:111], a[216:219], a[12:15]
    v_perm_b32 v96, v166, v162, s60
    v_perm_b32 v97, v174, v170, s60
    v_mfma_f32_16x16x32_bf16 a[44:47], v[108:111], a[220:223], a[44:47]
    v_perm_b32 v98, v182, v178, s60
    v_perm_b32 v99, v190, v186, s60
    v_mfma_f32_16x16x32_bf16 a[76:79], v[108:111], a[224:227], a[76:79]
    buffer_load_dwordx4 v[88:91], v240, s[32:35], s57 offen
    v_mfma_f32_16x16x32_bf16 a[108:111], v[108:111], a[228:231], a[108:111]
    buffer_load_dwordx4 v[92:95], v240, s[32:35], s58 offen
    v_mfma_f32_16x16x32_bf16 a[140:143], v[108:111], a[232:235], a[140:143]
    s_barrier
    ds_read_b128 a[192:195], v243 offset:24576
    v_mfma_f32_16x16x32_bf16 a[172:175], v[108:111], a[236:239], a[172:175]
    ds_read_b128 a[196:199], v243 offset:26624
    v_mfma_f32_16x16x32_bf16 a[16:19], v[96:99], a[216:219], a[16:19]
    v_perm_b32 v100, v166, v162, s61
    v_perm_b32 v101, v174, v170, s61
    v_mfma_f32_16x16x32_bf16 a[48:51], v[96:99], a[220:223], a[48:51]
    v_perm_b32 v102, v182, v178, s61
    v_perm_b32 v103, v190, v186, s61
    v_mfma_f32_16x16x32_bf16 a[80:83], v[96:99], a[224:227], a[80:83]
    v_add_u32 v240, s81, v240
    v_mfma_f32_16x16x32_bf16 a[112:115], v[96:99], a[228:231], a[112:115]
    v_and_b32 v240, 0x3fffff, v240
    buffer_load_dwordx4 v[0:3], v240, s[32:35], 0 offen
    v_mfma_f32_16x16x32_bf16 a[144:147], v[96:99], a[232:235], a[144:147]
    buffer_load_dwordx4 v[4:7], v240, s[32:35], s52 offen
    ds_read_b128 a[200:203], v243 offset:28672
    v_mfma_f32_16x16x32_bf16 a[176:179], v[96:99], a[236:239], a[176:179]
    ds_read_b128 a[204:207], v243 offset:30720
    v_mfma_f32_16x16x32_bf16 a[20:23], v[100:103], a[216:219], a[20:23]
    v_perm_b32 v104, v167, v163, s60
    v_perm_b32 v105, v175, v171, s60
    v_mfma_f32_16x16x32_bf16 a[52:55], v[100:103], a[220:223], a[52:55]
    v_perm_b32 v106, v183, v179, s60
    v_mfma_f32_16x16x32_bf16 a[84:87], v[100:103], a[224:227], a[84:87]
    v_perm_b32 v107, v191, v187, s60
    v_mfma_f32_16x16x32_bf16 a[116:119], v[100:103], a[228:231], a[116:119]
    buffer_load_dwordx4 v[8:11], v240, s[32:35], s53 offen
    buffer_load_dwordx4 v[12:15], v240, s[32:35], s54 offen
    v_mfma_f32_16x16x32_bf16 a[148:151], v[100:103], a[232:235], a[148:151]
    ds_read_b128 a[208:211], v243 offset:32768
    v_mfma_f32_16x16x32_bf16 a[180:183], v[100:103], a[236:239], a[180:183]
    ds_read_b128 a[212:215], v243 offset:34816
    v_mfma_f32_16x16x32_bf16 a[24:27], v[104:107], a[216:219], a[24:27]
    v_perm_b32 v108, v167, v163, s61
    v_mfma_f32_16x16x32_bf16 a[56:59], v[104:107], a[220:223], a[56:59]
    v_perm_b32 v109, v175, v171, s61
    v_mfma_f32_16x16x32_bf16 a[88:91], v[104:107], a[224:227], a[88:91]
    v_perm_b32 v110, v183, v179, s61
    v_mfma_f32_16x16x32_bf16 a[120:123], v[104:107], a[228:231], a[120:123]
    v_perm_b32 v111, v191, v187, s61
    v_mfma_f32_16x16x32_bf16 a[152:155], v[104:107], a[232:235], a[152:155]
    buffer_load_dwordx4 v[16:19], v240, s[32:35], s55 offen
    v_mfma_f32_16x16x32_bf16 a[184:187], v[104:107], a[236:239], a[184:187]
    v_mfma_f32_16x16x32_bf16 a[28:31], v[108:111], a[216:219], a[28:31]
    s_waitcnt vmcnt(29)
    v_perm_b32 v96, v196, v192, s60
    v_mfma_f32_16x16x32_bf16 a[60:63], v[108:111], a[220:223], a[60:63]
    v_perm_b32 v97, v204, v200, s60
    v_mfma_f32_16x16x32_bf16 a[92:95], v[108:111], a[224:227], a[92:95]
    v_perm_b32 v98, v212, v208, s60
    v_mfma_f32_16x16x32_bf16 a[124:127], v[108:111], a[228:231], a[124:127]
    v_perm_b32 v99, v220, v216, s60
    v_mfma_f32_16x16x32_bf16 a[156:159], v[108:111], a[232:235], a[156:159]
    buffer_load_dwordx4 v[20:23], v240, s[32:35], s56 offen
    v_mfma_f32_16x16x32_bf16 a[188:191], v[108:111], a[236:239], a[188:191]
    buffer_load_dwordx4 v[24:27], v240, s[32:35], s57 offen
    s_waitcnt lgkmcnt(0)
    v_mfma_f32_16x16x32_bf16 a[0:3], v[96:99], a[192:195], a[0:3]
    v_perm_b32 v100, v196, v192, s61
    v_perm_b32 v101, v204, v200, s61
    v_mfma_f32_16x16x32_bf16 a[32:35], v[96:99], a[196:199], a[32:35]
    v_perm_b32 v102, v212, v208, s61
    v_perm_b32 v103, v220, v216, s61
    v_mfma_f32_16x16x32_bf16 a[64:67], v[96:99], a[200:203], a[64:67]
    buffer_load_dwordx4 v[28:31], v240, s[32:35], s58 offen
    v_mfma_f32_16x16x32_bf16 a[96:99], v[96:99], a[204:207], a[96:99]
    s_waitcnt vmcnt(24)
    v_mfma_f32_16x16x32_bf16 a[128:131], v[96:99], a[208:211], a[128:131]
    ds_read_b128 v[160:163], v117 offset:8192
    ds_read_b128 v[164:167], v118 offset:8192
    v_mfma_f32_16x16x32_bf16 a[160:163], v[96:99], a[212:215], a[160:163]
    ds_read_b128 v[168:171], v119 offset:8192
    v_mfma_f32_16x16x32_bf16 a[4:7], v[100:103], a[192:195], a[4:7]
    v_perm_b32 v104, v197, v193, s60
    v_perm_b32 v105, v205, v201, s60
    v_mfma_f32_16x16x32_bf16 a[36:39], v[100:103], a[196:199], a[36:39]
    v_perm_b32 v106, v213, v209, s60
    v_perm_b32 v107, v221, v217, s60
    v_mfma_f32_16x16x32_bf16 a[68:71], v[100:103], a[200:203], a[68:71]
    s_add_u32 s73, s62, 16384
    v_mfma_f32_16x16x32_bf16 a[100:103], v[100:103], a[204:207], a[100:103]
    s_add_u32 m0, s4, 0
    s_nop 0
    buffer_load_dwordx4 v113, s[24:27], s73 offen nt lds
    v_mfma_f32_16x16x32_bf16 a[132:135], v[100:103], a[208:211], a[132:135]
    ds_read_b128 v[172:175], v120 offset:8192
    ds_read_b128 v[176:179], v117 offset:12288
    v_mfma_f32_16x16x32_bf16 a[164:167], v[100:103], a[212:215], a[164:167]
    ds_read_b128 v[180:183], v118 offset:12288
    v_mfma_f32_16x16x32_bf16 a[8:11], v[104:107], a[192:195], a[8:11]
    v_perm_b32 v108, v197, v193, s61
    v_perm_b32 v109, v205, v201, s61
    v_mfma_f32_16x16x32_bf16 a[40:43], v[104:107], a[196:199], a[40:43]
    v_perm_b32 v110, v213, v209, s61
    v_perm_b32 v111, v221, v217, s61
    v_mfma_f32_16x16x32_bf16 a[72:75], v[104:107], a[200:203], a[72:75]
    s_add_u32 s73, s62, 17408
    v_mfma_f32_16x16x32_bf16 a[104:107], v[104:107], a[204:207], a[104:107]
    s_add_u32 m0, s4, 1024
    s_nop 0
    buffer_load_dwordx4 v114, s[24:27], s73 offen nt lds
    v_mfma_f32_16x16x32_bf16 a[136:139], v[104:107], a[208:211], a[136:139]
    ds_read_b128 v[184:187], v119 offset:12288
    ds_read_b128 v[188:191], v120 offset:12288
    v_mfma_f32_16x16x32_bf16 a[168:171], v[104:107], a[212:215], a[168:171]
    v_mfma_f32_16x16x32_bf16 a[12:15], v[108:111], a[192:195], a[12:15]
    v_perm_b32 v96, v198, v194, s60
    v_perm_b32 v97, v206, v202, s60
    v_mfma_f32_16x16x32_bf16 a[44:47], v[108:111], a[196:199], a[44:47]
    v_perm_b32 v98, v214, v210, s60
    v_mfma_f32_16x16x32_bf16 a[76:79], v[108:111], a[200:203], a[76:79]
    v_perm_b32 v99, v222, v218, s60
    s_add_u32 s73, s62, 18432
    v_mfma_f32_16x16x32_bf16 a[108:111], v[108:111], a[204:207], a[108:111]
    s_add_u32 m0, s4, 2048
    v_mfma_f32_16x16x32_bf16 a[140:143], v[108:111], a[208:211], a[140:143]
    buffer_load_dwordx4 v115, s[24:27], s73 offen nt lds
    ds_read_b128 a[216:219], v244 offset:24576
    v_mfma_f32_16x16x32_bf16 a[172:175], v[108:111], a[212:215], a[172:175]
    ds_read_b128 a[220:223], v244 offset:26624
    v_mfma_f32_16x16x32_bf16 a[16:19], v[96:99], a[192:195], a[16:19]
    v_perm_b32 v100, v198, v194, s61
    v_perm_b32 v101, v206, v202, s61
    v_mfma_f32_16x16x32_bf16 a[48:51], v[96:99], a[196:199], a[48:51]
    v_perm_b32 v102, v214, v210, s61
    v_mfma_f32_16x16x32_bf16 a[80:83], v[96:99], a[200:203], a[80:83]
    v_perm_b32 v103, v222, v218, s61
    s_add_u32 s73, s62, 19456
    v_mfma_f32_16x16x32_bf16 a[112:115], v[96:99], a[204:207], a[112:115]
    s_add_u32 m0, s4, 3072
    v_mfma_f32_16x16x32_bf16 a[144:147], v[96:99], a[208:211], a[144:147]
    buffer_load_dwordx4 v116, s[24:27], s73 offen nt lds
    ds_read_b128 a[224:227], v244 offset:28672
    v_mfma_f32_16x16x32_bf16 a[176:179], v[96:99], a[212:215], a[176:179]
    ds_read_b128 a[228:231], v244 offset:30720
    v_mfma_f32_16x16x32_bf16 a[20:23], v[100:103], a[192:195], a[20:23]
    v_perm_b32 v104, v199, v195, s60
    v_perm_b32 v105, v207, v203, s60
    v_mfma_f32_16x16x32_bf16 a[52:55], v[100:103], a[196:199], a[52:55]
    v_perm_b32 v106, v215, v211, s60
    v_mfma_f32_16x16x32_bf16 a[84:87], v[100:103], a[200:203], a[84:87]
    v_perm_b32 v107, v223, v219, s60
    s_add_u32 s73, s62, 20480
    v_mfma_f32_16x16x32_bf16 a[116:119], v[100:103], a[204:207], a[116:119]
    s_add_u32 m0, s4, 4096
    v_mfma_f32_16x16x32_bf16 a[148:151], v[100:103], a[208:211], a[148:151]
    buffer_load_dwordx4 v113, s[24:27], s73 offen nt lds
    ds_read_b128 a[232:235], v244 offset:32768
    v_mfma_f32_16x16x32_bf16 a[180:183], v[100:103], a[212:215], a[180:183]
    ds_read_b128 a[236:239], v244 offset:34816
    v_mfma_f32_16x16x32_bf16 a[24:27], v[104:107], a[192:195], a[24:27]
    v_perm_b32 v108, v199, v195, s61
    v_perm_b32 v109, v207, v203, s61
    v_mfma_f32_16x16x32_bf16 a[56:59], v[104:107], a[196:199], a[56:59]
    v_perm_b32 v110, v215, v211, s61
    v_mfma_f32_16x16x32_bf16 a[88:91], v[104:107], a[200:203], a[88:91]
    v_perm_b32 v111, v223, v219, s61
    v_mfma_f32_16x16x32_bf16 a[120:123], v[104:107], a[204:207], a[120:123]
    s_add_u32 s73, s62, 21504
    v_mfma_f32_16x16x32_bf16 a[152:155], v[104:107], a[208:211], a[152:155]
    s_add_u32 m0, s4, 5120
    v_mfma_f32_16x16x32_bf16 a[184:187], v[104:107], a[212:215], a[184:187]
    buffer_load_dwordx4 v114, s[24:27], s73 offen nt lds
    v_mfma_f32_16x16x32_bf16 a[28:31], v[108:111], a[192:195], a[28:31]
    s_waitcnt vmcnt(22)
    v_mfma_f32_16x16x32_bf16 a[60:63], v[108:111], a[196:199], a[60:63]
    v_perm_b32 v96, v36, v32, s60
    v_mfma_f32_16x16x32_bf16 a[92:95], v[108:111], a[200:203], a[92:95]
    v_perm_b32 v97, v44, v40, s60
    v_mfma_f32_16x16x32_bf16 a[124:127], v[108:111], a[204:207], a[124:127]
    v_perm_b32 v98, v52, v48, s60
    v_mfma_f32_16x16x32_bf16 a[156:159], v[108:111], a[208:211], a[156:159]
    v_perm_b32 v99, v60, v56, s60
    v_mfma_f32_16x16x32_bf16 a[188:191], v[108:111], a[212:215], a[188:191]
    s_waitcnt lgkmcnt(0)
    v_mfma_f32_16x16x32_bf16 a[0:3], v[96:99], a[216:219], a[0:3]
    v_perm_b32 v100, v36, v32, s61
    v_perm_b32 v101, v44, v40, s61
    v_mfma_f32_16x16x32_bf16 a[32:35], v[96:99], a[220:223], a[32:35]
    v_perm_b32 v102, v52, v48, s61
    v_mfma_f32_16x16x32_bf16 a[64:67], v[96:99], a[224:227], a[64:67]
    v_perm_b32 v103, v60, v56, s61
    v_mfma_f32_16x16x32_bf16 a[96:99], v[96:99], a[228:231], a[96:99]
    s_add_u32 s73, s62, 22528
    v_mfma_f32_16x16x32_bf16 a[128:131], v[96:99], a[232:235], a[128:131]
    s_add_u32 m0, s4, 6144
    v_mfma_f32_16x16x32_bf16 a[160:163], v[96:99], a[236:239], a[160:163]
    buffer_load_dwordx4 v115, s[24:27], s73 offen nt lds
    v_mfma_f32_16x16x32_bf16 a[4:7], v[100:103], a[216:219], a[4:7]
    v_perm_b32 v104, v37, v33, s60
    v_perm_b32 v105, v45, v41, s60
    v_mfma_f32_16x16x32_bf16 a[36:39], v[100:103], a[220:223], a[36:39]
    v_perm_b32 v106, v53, v49, s60
    v_mfma_f32_16x16x32_bf16 a[68:71], v[100:103], a[224:227], a[68:71]
    v_perm_b32 v107, v61, v57, s60
    v_mfma_f32_16x16x32_bf16 a[100:103], v[100:103], a[228:231], a[100:103]
    s_add_u32 s73, s62, 23552
    v_mfma_f32_16x16x32_bf16 a[132:135], v[100:103], a[232:235], a[132:135]
    s_add_u32 m0, s4, 7168
    v_mfma_f32_16x16x32_bf16 a[164:167], v[100:103], a[236:239], a[164:167]
    buffer_load_dwordx4 v116, s[24:27], s73 offen nt lds
    v_mfma_f32_16x16x32_bf16 a[8:11], v[104:107], a[216:219], a[8:11]
    v_perm_b32 v108, v37, v33, s61
    v_perm_b32 v109, v45, v41, s61
    v_mfma_f32_16x16x32_bf16 a[40:43], v[104:107], a[220:223], a[40:43]
    v_perm_b32 v110, v53, v49, s61
    v_mfma_f32_16x16x32_bf16 a[72:75], v[104:107], a[224:227], a[72:75]
    v_perm_b32 v111, v61, v57, s61
    v_mfma_f32_16x16x32_bf16 a[104:107], v[104:107], a[228:231], a[104:107]
    s_add_u32 s73, s62, 0
    v_mfma_f32_16x16x32_bf16 a[136:139], v[104:107], a[232:235], a[136:139]
    s_add_u32 m0, s92, 0
    v_mfma_f32_16x16x32_bf16 a[168:171], v[104:107], a[236:239], a[168:171]
    buffer_load_dwordx4 v246, s[28:31], s73 offen nt lds
    v_mfma_f32_16x16x32_bf16 a[12:15], v[108:111], a[216:219], a[12:15]
    v_perm_b32 v96, v38, v34, s60
    v_perm_b32 v97, v46, v42, s60
    v_mfma_f32_16x16x32_bf16 a[44:47], v[108:111], a[220:223], a[44:47]
    v_perm_b32 v98, v54, v50, s60
    v_mfma_f32_16x16x32_bf16 a[76:79], v[108:111], a[224:227], a[76:79]
    v_perm_b32 v99, v62, v58, s60
    s_add_u32 s73, s62, 1024
    v_mfma_f32_16x16x32_bf16 a[108:111], v[108:111], a[228:231], a[108:111]
    s_add_u32 m0, s92, 1024
    v_mfma_f32_16x16x32_bf16 a[140:143], v[108:111], a[232:235], a[140:143]
    buffer_load_dwordx4 v245, s[28:31], s73 offen nt lds
    ds_read_b128 a[192:195], v243 offset:36864
    v_mfma_f32_16x16x32_bf16 a[172:175], v[108:111], a[236:239], a[172:175]
    ds_read_b128 a[196:199], v243 offset:38912
    v_mfma_f32_16x16x32_bf16 a[16:19], v[96:99], a[216:219], a[16:19]
    v_perm_b32 v100, v38, v34, s61
    v_perm_b32 v101, v46, v42, s61
    v_mfma_f32_16x16x32_bf16 a[48:51], v[96:99], a[220:223], a[48:51]
    v_perm_b32 v102, v54, v50, s61
    v_mfma_f32_16x16x32_bf16 a[80:83], v[96:99], a[224:227], a[80:83]
    v_perm_b32 v103, v62, v58, s61
    s_add_u32 s73, s62, 2048
    v_mfma_f32_16x16x32_bf16 a[112:115], v[96:99], a[228:231], a[112:115]
    s_add_u32 m0, s92, 2048
    v_mfma_f32_16x16x32_bf16 a[144:147], v[96:99], a[232:235], a[144:147]
    buffer_load_dwordx4 v246, s[28:31], s73 offen nt lds
    ds_read_b128 a[200:203], v243 offset:40960
    v_mfma_f32_16x16x32_bf16 a[176:179], v[96:99], a[236:239], a[176:179]
    ds_read_b128 a[204:207], v243 offset:43008
    v_mfma_f32_16x16x32_bf16 a[20:23], v[100:103], a[216:219], a[20:23]
    v_perm_b32 v104, v39, v35, s60
    v_perm_b32 v105, v47, v43, s60
    v_mfma_f32_16x16x32_bf16 a[52:55], v[100:103], a[220:223], a[52:55]
    v_perm_b32 v106, v55, v51, s60
    v_mfma_f32_16x16x32_bf16 a[84:87], v[100:103], a[224:227], a[84:87]
    v_perm_b32 v107, v63, v59, s60
    s_add_u32 s73, s62, 3072
    v_mfma_f32_16x16x32_bf16 a[116:119], v[100:103], a[228:231], a[116:119]
    s_add_u32 m0, s92, 3072
    v_mfma_f32_16x16x32_bf16 a[148:151], v[100:103], a[232:235], a[148:151]
    buffer_load_dwordx4 v245, s[28:31], s73 offen nt lds
    ds_read_b128 a[208:211], v243 offset:45056
    v_mfma_f32_16x16x32_bf16 a[180:183], v[100:103], a[236:239], a[180:183]
    ds_read_b128 a[212:215], v243 offset:47104
    v_mfma_f32_16x16x32_bf16 a[24:27], v[104:107], a[216:219], a[24:27]
    v_perm_b32 v108, v39, v35, s61
    v_mfma_f32_16x16x32_bf16 a[56:59], v[104:107], a[220:223], a[56:59]
    v_perm_b32 v109, v47, v43, s61
    v_mfma_f32_16x16x32_bf16 a[88:91], v[104:107], a[224:227], a[88:91]
    v_mfma_f32_16x16x32_bf16 a[120:123], v[104:107], a[228:231], a[120:123]
    v_perm_b32 v110, v55, v51, s61
    v_mfma_f32_16x16x32_bf16 a[152:155], v[104:107], a[232:235], a[152:155]
    v_perm_b32 v111, v63, v59, s61
    v_mfma_f32_16x16x32_bf16 a[184:187], v[104:107], a[236:239], a[184:187]
    s_nop 0
    v_mfma_f32_16x16x32_bf16 a[28:31], v[108:111], a[216:219], a[28:31]
    s_waitcnt vmcnt(20)
    v_perm_b32 v96, v68, v64, s60
    v_mfma_f32_16x16x32_bf16 a[60:63], v[108:111], a[220:223], a[60:63]
    v_perm_b32 v97, v76, v72, s60
    v_mfma_f32_16x16x32_bf16 a[92:95], v[108:111], a[224:227], a[92:95]
    v_perm_b32 v98, v84, v80, s60
    v_mfma_f32_16x16x32_bf16 a[124:127], v[108:111], a[228:231], a[124:127]
    v_perm_b32 v99, v92, v88, s60
    s_add_u32 s73, s62, 4096
    v_mfma_f32_16x16x32_bf16 a[156:159], v[108:111], a[232:235], a[156:159]
    s_add_u32 m0, s92, 4096
    v_mfma_f32_16x16x32_bf16 a[188:191], v[108:111], a[236:239], a[188:191]
    buffer_load_dwordx4 v246, s[28:31], s73 offen nt lds
    s_waitcnt lgkmcnt(0)
    v_mfma_f32_16x16x32_bf16 a[0:3], v[96:99], a[192:195], a[0:3]
    v_perm_b32 v100, v68, v64, s61
    v_perm_b32 v101, v76, v72, s61
    v_mfma_f32_16x16x32_bf16 a[32:35], v[96:99], a[196:199], a[32:35]
    v_perm_b32 v102, v84, v80, s61
    v_mfma_f32_16x16x32_bf16 a[64:67], v[96:99], a[200:203], a[64:67]
    v_perm_b32 v103, v92, v88, s61
    v_mfma_f32_16x16x32_bf16 a[96:99], v[96:99], a[204:207], a[96:99]
    s_add_u32 s73, s62, 5120
    v_mfma_f32_16x16x32_bf16 a[128:131], v[96:99], a[208:211], a[128:131]
    s_add_u32 m0, s92, 5120
    v_mfma_f32_16x16x32_bf16 a[160:163], v[96:99], a[212:215], a[160:163]
    buffer_load_dwordx4 v245, s[28:31], s73 offen nt lds
    v_mfma_f32_16x16x32_bf16 a[4:7], v[100:103], a[192:195], a[4:7]
    v_perm_b32 v104, v69, v65, s60
    v_perm_b32 v105, v77, v73, s60
    v_mfma_f32_16x16x32_bf16 a[36:39], v[100:103], a[196:199], a[36:39]
    v_perm_b32 v106, v85, v81, s60
    v_mfma_f32_16x16x32_bf16 a[68:71], v[100:103], a[200:203], a[68:71]
    v_perm_b32 v107, v93, v89, s60
    v_mfma_f32_16x16x32_bf16 a[100:103], v[100:103], a[204:207], a[100:103]
    s_add_u32 s73, s62, 6144
    v_mfma_f32_16x16x32_bf16 a[132:135], v[100:103], a[208:211], a[132:135]
    s_add_u32 m0, s92, 6144
    v_mfma_f32_16x16x32_bf16 a[164:167], v[100:103], a[212:215], a[164:167]
    buffer_load_dwordx4 v246, s[28:31], s73 offen nt lds
    v_mfma_f32_16x16x32_bf16 a[8:11], v[104:107], a[192:195], a[8:11]
    v_perm_b32 v108, v69, v65, s61
    v_perm_b32 v109, v77, v73, s61
    v_mfma_f32_16x16x32_bf16 a[40:43], v[104:107], a[196:199], a[40:43]
    v_perm_b32 v110, v85, v81, s61
    v_mfma_f32_16x16x32_bf16 a[72:75], v[104:107], a[200:203], a[72:75]
    v_perm_b32 v111, v93, v89, s61
    v_mfma_f32_16x16x32_bf16 a[104:107], v[104:107], a[204:207], a[104:107]
    s_add_u32 s73, s62, 7168
    v_mfma_f32_16x16x32_bf16 a[136:139], v[104:107], a[208:211], a[136:139]
    s_add_u32 m0, s92, 7168
    v_mfma_f32_16x16x32_bf16 a[168:171], v[104:107], a[212:215], a[168:171]
    buffer_load_dwordx4 v245, s[28:31], s73 offen nt lds
    v_mfma_f32_16x16x32_bf16 a[12:15], v[108:111], a[192:195], a[12:15]
    v_perm_b32 v96, v70, v66, s60
    v_perm_b32 v97, v78, v74, s60
    v_mfma_f32_16x16x32_bf16 a[44:47], v[108:111], a[196:199], a[44:47]
    v_perm_b32 v98, v86, v82, s60
    v_perm_b32 v99, v94, v90, s60
    v_mfma_f32_16x16x32_bf16 a[76:79], v[108:111], a[200:203], a[76:79]
    v_mfma_f32_16x16x32_bf16 a[108:111], v[108:111], a[204:207], a[108:111]
    s_add_u32 s73, s62, 8192
    s_add_u32 m0, s92, 8192
    v_mfma_f32_16x16x32_bf16 a[140:143], v[108:111], a[208:211], a[140:143]
    buffer_load_dwordx4 v246, s[28:31], s73 offen nt lds
    ds_read_b128 a[216:219], v244 offset:36864
    v_mfma_f32_16x16x32_bf16 a[172:175], v[108:111], a[212:215], a[172:175]
    ds_read_b128 a[220:223], v244 offset:38912
    v_mfma_f32_16x16x32_bf16 a[16:19], v[96:99], a[192:195], a[16:19]
    v_perm_b32 v100, v70, v66, s61
    v_perm_b32 v101, v78, v74, s61
    v_mfma_f32_16x16x32_bf16 a[48:51], v[96:99], a[196:199], a[48:51]
    v_perm_b32 v102, v86, v82, s61
    v_mfma_f32_16x16x32_bf16 a[80:83], v[96:99], a[200:203], a[80:83]
    v_perm_b32 v103, v94, v90, s61
    s_add_u32 s73, s62, 9216
    v_mfma_f32_16x16x32_bf16 a[112:115], v[96:99], a[204:207], a[112:115]
    s_add_u32 m0, s92, 9216
    v_mfma_f32_16x16x32_bf16 a[144:147], v[96:99], a[208:211], a[144:147]
    buffer_load_dwordx4 v245, s[28:31], s73 offen nt lds
    ds_read_b128 a[224:227], v244 offset:40960
    v_mfma_f32_16x16x32_bf16 a[176:179], v[96:99], a[212:215], a[176:179]
    ds_read_b128 a[228:231], v244 offset:43008
    v_mfma_f32_16x16x32_bf16 a[20:23], v[100:103], a[192:195], a[20:23]
    v_perm_b32 v104, v71, v67, s60
    v_mfma_f32_16x16x32_bf16 a[52:55], v[100:103], a[196:199], a[52:55]
    v_perm_b32 v105, v79, v75, s60
    v_mfma_f32_16x16x32_bf16 a[84:87], v[100:103], a[200:203], a[84:87]
    v_perm_b32 v106, v87, v83, s60
    v_mfma_f32_16x16x32_bf16 a[116:119], v[100:103], a[204:207], a[116:119]
    v_perm_b32 v107, v95, v91, s60
    v_mfma_f32_16x16x32_bf16 a[148:151], v[100:103], a[208:211], a[148:151]
    ds_read_b128 a[232:235], v244 offset:45056
    v_mfma_f32_16x16x32_bf16 a[180:183], v[100:103], a[212:215], a[180:183]
    ds_read_b128 a[236:239], v244 offset:47104
    v_mfma_f32_16x16x32_bf16 a[24:27], v[104:107], a[192:195], a[24:27]
    v_perm_b32 v108, v71, v67, s61
    v_perm_b32 v109, v79, v75, s61
    v_mfma_f32_16x16x32_bf16 a[56:59], v[104:107], a[196:199], a[56:59]
    v_perm_b32 v110, v87, v83, s61
    v_mfma_f32_16x16x32_bf16 a[88:91], v[104:107], a[200:203], a[88:91]
    v_perm_b32 v111, v95, v91, s61
    v_mfma_f32_16x16x32_bf16 a[120:123], v[104:107], a[204:207], a[120:123]
    s_add_u32 s73, s62, 10240
    v_mfma_f32_16x16x32_bf16 a[152:155], v[104:107], a[208:211], a[152:155]
    s_add_u32 m0, s92, 10240
    v_mfma_f32_16x16x32_bf16 a[184:187], v[104:107], a[212:215], a[184:187]
    buffer_load_dwordx4 v246, s[28:31], s73 offen nt lds
    v_mfma_f32_16x16x32_bf16 a[28:31], v[108:111], a[192:195], a[28:31]
    s_waitcnt vmcnt(19)
    v_perm_b32 v64, v4, v0, s60
    v_mfma_f32_16x16x32_bf16 a[60:63], v[108:111], a[196:199], a[60:63]
    v_perm_b32 v65, v12, v8, s60
    v_mfma_f32_16x16x32_bf16 a[92:95], v[108:111], a[200:203], a[92:95]
    v_perm_b32 v66, v20, v16, s60
    v_mfma_f32_16x16x32_bf16 a[124:127], v[108:111], a[204:207], a[124:127]
    v_perm_b32 v67, v28, v24, s60
    s_add_u32 s73, s62, 11264
    v_mfma_f32_16x16x32_bf16 a[156:159], v[108:111], a[208:211], a[156:159]
    s_add_u32 m0, s92, 11264
    v_mfma_f32_16x16x32_bf16 a[188:191], v[108:111], a[212:215], a[188:191]
    buffer_load_dwordx4 v245, s[28:31], s73 offen nt lds
    s_waitcnt lgkmcnt(0)
    v_mfma_f32_16x16x32_bf16 a[0:3], v[64:67], a[216:219], a[0:3]
    v_perm_b32 v68, v4, v0, s61
    v_perm_b32 v69, v12, v8, s61
    v_perm_b32 v70, v20, v16, s61
    v_perm_b32 v71, v28, v24, s61
    s_nop 1
    v_mfma_f32_16x16x32_bf16 a[4:7], v[68:71], a[216:219], a[4:7]
    v_perm_b32 v72, v5, v1, s60
    v_perm_b32 v73, v13, v9, s60
    v_perm_b32 v74, v21, v17, s60
    v_perm_b32 v75, v29, v25, s60
    s_nop 1
    v_mfma_f32_16x16x32_bf16 a[8:11], v[72:75], a[216:219], a[8:11]
    v_perm_b32 v76, v5, v1, s61
    v_perm_b32 v77, v13, v9, s61
    v_perm_b32 v78, v21, v17, s61
    v_perm_b32 v79, v29, v25, s61
    s_nop 1
    v_mfma_f32_16x16x32_bf16 a[12:15], v[76:79], a[216:219], a[12:15]
    v_perm_b32 v80, v6, v2, s60
    v_perm_b32 v81, v14, v10, s60
    v_perm_b32 v82, v22, v18, s60
    v_perm_b32 v83, v30, v26, s60
    s_nop 1
    v_mfma_f32_16x16x32_bf16 a[16:19], v[80:83], a[216:219], a[16:19]
    v_perm_b32 v84, v6, v2, s61
    v_perm_b32 v85, v14, v10, s61
    v_perm_b32 v86, v22, v18, s61
    v_perm_b32 v87, v30, v26, s61
    s_nop 1
    v_mfma_f32_16x16x32_bf16 a[20:23], v[84:87], a[216:219], a[20:23]
    v_perm_b32 v88, v7, v3, s60
    v_perm_b32 v89, v15, v11, s60
    v_perm_b32 v90, v23, v19, s60
    v_perm_b32 v91, v31, v27, s60
    s_nop 1
    v_mfma_f32_16x16x32_bf16 a[24:27], v[88:91], a[216:219], a[24:27]
    v_perm_b32 v92, v7, v3, s61
    v_perm_b32 v93, v15, v11, s61
    v_perm_b32 v94, v23, v19, s61
    v_perm_b32 v95, v31, v27, s61
    s_nop 1
    v_mfma_f32_16x16x32_bf16 a[28:31], v[92:95], a[216:219], a[28:31]
    v_mfma_f32_16x16x32_bf16 a[32:35], v[64:67], a[220:223], a[32:35]
    s_waitcnt vmcnt(12)
    v_subrev_u32 v117, s5, v117
    v_subrev_u32 v118, s5, v118
    v_subrev_u32 v119, s5, v119
    v_subrev_u32 v120, s5, v120
    ds_read_b128 v[192:195], v117 offset:0
    ds_read_b128 v[196:199], v118 offset:0
    ds_read_b128 v[200:203], v119 offset:0
    ds_read_b128 v[204:207], v120 offset:0
    v_mfma_f32_16x16x32_bf16 a[36:39], v[68:71], a[220:223], a[36:39]
    s_add_u32 s73, s62, 12288
    s_add_u32 m0, s92, 12288
    s_nop 0
    buffer_load_dwordx4 v246, s[28:31], s73 offen nt lds
    s_add_u32 s73, s62, 13312
    v_mfma_f32_16x16x32_bf16 a[40:43], v[72:75], a[220:223], a[40:43]
    s_add_u32 m0, s92, 13312
    s_nop 0
    buffer_load_dwordx4 v245, s[28:31], s73 offen nt lds
    v_accvgpr_read_b32 v251, a0
    v_accvgpr_read_b32 v252, a4
    v_mfma_f32_16x16x32_bf16 a[44:47], v[76:79], a[220:223], a[44:47]
    v_cvt_pk_bf16_f32 v32, v251, v252
    v_accvgpr_read_b32 v253, a8
    v_accvgpr_read_b32 v254, a12
    v_cvt_pk_bf16_f32 v33, v253, v254
    v_mfma_f32_16x16x32_bf16 a[48:51], v[80:83], a[220:223], a[48:51]
    v_accvgpr_read_b32 v251, a16
    v_accvgpr_read_b32 v252, a20
    v_cvt_pk_bf16_f32 v34, v251, v252
    v_mfma_f32_16x16x32_bf16 a[52:55], v[84:87], a[220:223], a[52:55]
    v_accvgpr_read_b32 v253, a24
    v_accvgpr_read_b32 v254, a28
    v_cvt_pk_bf16_f32 v35, v253, v254
    v_accvgpr_read_b32 v251, a1
    v_mfma_f32_16x16x32_bf16 a[56:59], v[88:91], a[220:223], a[56:59]
    v_accvgpr_read_b32 v252, a5
    v_cvt_pk_bf16_f32 v36, v251, v252
    v_accvgpr_read_b32 v253, a9
    v_accvgpr_read_b32 v254, a13
    v_mfma_f32_16x16x32_bf16 a[60:63], v[92:95], a[220:223], a[60:63]
    v_cvt_pk_bf16_f32 v37, v253, v254
    v_accvgpr_read_b32 v251, a17
    v_accvgpr_read_b32 v252, a21
    v_mfma_f32_16x16x32_bf16 a[64:67], v[64:67], a[224:227], a[64:67]
    ds_read_b128 v[208:211], v117 offset:4096
    ds_read_b128 v[212:215], v118 offset:4096
    ds_read_b128 v[216:219], v119 offset:4096
    ds_read_b128 v[220:223], v120 offset:4096
    v_mfma_f32_16x16x32_bf16 a[68:71], v[68:71], a[224:227], a[68:71]
    s_add_u32 s73, s62, 14336
    s_add_u32 m0, s92, 14336
    s_nop 0
    buffer_load_dwordx4 v246, s[28:31], s73 offen nt lds
    s_add_u32 s73, s62, 15360
    v_mfma_f32_16x16x32_bf16 a[72:75], v[72:75], a[224:227], a[72:75]
    s_add_u32 m0, s92, 15360
    s_nop 0
    buffer_load_dwordx4 v245, s[28:31], s73 offen nt lds
    v_cvt_pk_bf16_f32 v38, v251, v252
    v_accvgpr_read_b32 v253, a25
    v_mfma_f32_16x16x32_bf16 a[76:79], v[76:79], a[224:227], a[76:79]
    v_accvgpr_read_b32 v254, a29
    v_cvt_pk_bf16_f32 v39, v253, v254
    v_accvgpr_read_b32 v251, a2
    v_accvgpr_read_b32 v252, a6
    v_mfma_f32_16x16x32_bf16 a[80:83], v[80:83], a[224:227], a[80:83]
    v_cvt_pk_bf16_f32 v40, v251, v252
    v_accvgpr_read_b32 v253, a10
    v_accvgpr_read_b32 v254, a14
    v_mfma_f32_16x16x32_bf16 a[84:87], v[84:87], a[224:227], a[84:87]
    v_cvt_pk_bf16_f32 v41, v253, v254
    v_accvgpr_read_b32 v251, a18
    v_accvgpr_read_b32 v252, a22
    v_cvt_pk_bf16_f32 v42, v251, v252
    v_mfma_f32_16x16x32_bf16 a[88:91], v[88:91], a[224:227], a[88:91]
    v_accvgpr_read_b32 v253, a26
    v_accvgpr_read_b32 v254, a30
    v_cvt_pk_bf16_f32 v43, v253, v254
    v_accvgpr_read_b32 v251, a3
    v_mfma_f32_16x16x32_bf16 a[92:95], v[92:95], a[224:227], a[92:95]
    v_accvgpr_read_b32 v252, a7
    v_cvt_pk_bf16_f32 v44, v251, v252
    v_accvgpr_read_b32 v253, a11
    v_mfma_f32_16x16x32_bf16 a[96:99], v[64:67], a[228:231], a[96:99]
    v_mfma_f32_16x16x32_bf16 a[100:103], v[68:71], a[228:231], a[100:103]
    v_accvgpr_read_b32 v254, a15
    v_cvt_pk_bf16_f32 v45, v253, v254
    v_accvgpr_read_b32 v251, a19
    v_mfma_f32_16x16x32_bf16 a[104:107], v[72:75], a[228:231], a[104:107]
    v_accvgpr_read_b32 v252, a23
    v_cvt_pk_bf16_f32 v46, v251, v252
    v_accvgpr_read_b32 v253, a27
    v_mfma_f32_16x16x32_bf16 a[108:111], v[76:79], a[228:231], a[108:111]
    v_accvgpr_read_b32 v254, a31
    v_cvt_pk_bf16_f32 v47, v253, v254
    v_accvgpr_read_b32 v251, a32
    v_mfma_f32_16x16x32_bf16 a[112:115], v[80:83], a[228:231], a[112:115]
    v_accvgpr_read_b32 v252, a36
    v_cvt_pk_bf16_f32 v48, v251, v252
    v_accvgpr_read_b32 v253, a40
    v_mfma_f32_16x16x32_bf16 a[116:119], v[84:87], a[228:231], a[116:119]
    v_accvgpr_read_b32 v254, a44
    v_cvt_pk_bf16_f32 v49, v253, v254
    v_accvgpr_read_b32 v251, a48
    v_mfma_f32_16x16x32_bf16 a[120:123], v[88:91], a[228:231], a[120:123]
    v_accvgpr_read_b32 v252, a52
    v_cvt_pk_bf16_f32 v50, v251, v252
    v_accvgpr_read_b32 v253, a56
    v_mfma_f32_16x16x32_bf16 a[124:127], v[92:95], a[228:231], a[124:127]
    v_accvgpr_read_b32 v254, a60
    v_cvt_pk_bf16_f32 v51, v253, v254
    v_mfma_f32_16x16x32_bf16 a[128:131], v[64:67], a[232:235], a[128:131]
    v_mfma_f32_16x16x32_bf16 a[132:135], v[68:71], a[232:235], a[132:135]
    v_accvgpr_read_b32 v251, a33
    v_accvgpr_read_b32 v252, a37
    v_cvt_pk_bf16_f32 v52, v251, v252
    v_mfma_f32_16x16x32_bf16 a[136:139], v[72:75], a[232:235], a[136:139]
    v_accvgpr_read_b32 v253, a41
    v_accvgpr_read_b32 v254, a45
    v_cvt_pk_bf16_f32 v53, v253, v254
    v_mfma_f32_16x16x32_bf16 a[140:143], v[76:79], a[232:235], a[140:143]
    v_accvgpr_read_b32 v251, a49
    v_accvgpr_read_b32 v252, a53
    v_cvt_pk_bf16_f32 v54, v251, v252
    v_mfma_f32_16x16x32_bf16 a[144:147], v[80:83], a[232:235], a[144:147]
    v_accvgpr_read_b32 v253, a57
    v_accvgpr_read_b32 v254, a61
    v_cvt_pk_bf16_f32 v55, v253, v254
    v_mfma_f32_16x16x32_bf16 a[148:151], v[84:87], a[232:235], a[148:151]
    v_accvgpr_read_b32 v251, a34
    v_accvgpr_read_b32 v252, a38
    v_cvt_pk_bf16_f32 v56, v251, v252
    v_mfma_f32_16x16x32_bf16 a[152:155], v[88:91], a[232:235], a[152:155]
    v_accvgpr_read_b32 v253, a42
    v_accvgpr_read_b32 v254, a46
    v_cvt_pk_bf16_f32 v57, v253, v254
    v_mfma_f32_16x16x32_bf16 a[156:159], v[92:95], a[232:235], a[156:159]
    v_accvgpr_read_b32 v251, a50
    v_accvgpr_read_b32 v252, a54
    v_mfma_f32_16x16x32_bf16 a[160:163], v[64:67], a[236:239], a[160:163]
    v_mfma_f32_16x16x32_bf16 a[164:167], v[68:71], a[236:239], a[164:167]
    v_cvt_pk_bf16_f32 v58, v251, v252
    v_accvgpr_read_b32 v253, a58
    v_accvgpr_read_b32 v254, a62
    v_mfma_f32_16x16x32_bf16 a[168:171], v[72:75], a[236:239], a[168:171]
    v_cvt_pk_bf16_f32 v59, v253, v254
    v_accvgpr_read_b32 v251, a35
    v_mfma_f32_16x16x32_bf16 a[172:175], v[76:79], a[236:239], a[172:175]
    v_accvgpr_read_b32 v252, a39
    v_cvt_pk_bf16_f32 v60, v251, v252
    v_mfma_f32_16x16x32_bf16 a[176:179], v[80:83], a[236:239], a[176:179]
    v_accvgpr_read_b32 v253, a43
    v_accvgpr_read_b32 v254, a47
    v_cvt_pk_bf16_f32 v61, v253, v254
    v_mfma_f32_16x16x32_bf16 a[180:183], v[84:87], a[236:239], a[180:183]
    v_accvgpr_read_b32 v251, a51
    v_accvgpr_read_b32 v252, a55
    v_mfma_f32_16x16x32_bf16 a[184:187], v[88:91], a[236:239], a[184:187]
    v_cvt_pk_bf16_f32 v62, v251, v252
    v_accvgpr_read_b32 v253, a59
    v_mfma_f32_16x16x32_bf16 a[188:191], v[92:95], a[236:239], a[188:191]
    v_accvgpr_read_b32 v254, a63
    v_cvt_pk_bf16_f32 v63, v253, v254
    s_lshl_b32 s72, s3, 13
    v_add_u32 v241, s72, v248
    s_nop 7
    s_branch join
code_end:
.section .rodata,"a"
.p2align 6
.amdhsa_kernel attn_kernel
  .amdhsa_next_free_vgpr 512
  .amdhsa_next_free_sgpr 102
  .amdhsa_accum_offset 256
  .amdhsa_group_segment_fixed_size 0
  .amdhsa_kernarg_size 104
  .amdhsa_user_sgpr_count 2
  .amdhsa_user_sgpr_kernarg_segment_ptr 1
  .amdhsa_system_sgpr_workgroup_id_x 1
.end_amdhsa_kernel
```
